```python
import torch

def _softmax(x, axis=-1):
    return torch.softmax(x, dim=axis)
def _gelu(x):
    return torch.nn.functional.gelu(x, approximate="tanh")
def _silu(x):
    return torch.nn.functional.silu(x)
def _sigmoid(x):
    return torch.sigmoid(x)
def _layernorm(x, axis=-1, eps=1e-5):
    m = x.mean(dim=axis, keepdim=True)
    v = x.var(dim=axis, keepdim=True, unbiased=False)
    return (x - m) / torch.sqrt(v + eps)
def _scatter_add(tgt, idx, src, axis=0):
    return tgt.clone().index_add_(axis, idx, src)
def _segment_sum(src, seg, n):
    out = torch.zeros((n,) + src.shape[1:], dtype=src.dtype)
    return out.index_add_(0, seg, src)
def _pad(x, pw):
    flat = tuple(v for pair in reversed(pw) for v in pair)
    return torch.nn.functional.pad(x, flat)

kernel_name = 'gated_mix__sliding_block__linear_kernel_hedgehog__prompt'

def setup_inputs():

    _w = (lambda a: (lambda t: t.to(torch.bfloat16) if t.is_floating_point() else t)(torch.as_tensor(a)))
    def _A_setup():
        B, S, D = 1, 2048, 576
        return {
            "x": _w((lambda *s: torch.randn(*s, dtype=torch.bfloat16) * 0.05)(B, S, D)),
            "wqkv": _w((lambda *s: torch.randn(*s, dtype=torch.bfloat16) * 0.8)(D, 3 * D)),
            "wo": _w((lambda *s: torch.randn(*s, dtype=torch.bfloat16) * 0.05)(D, D)),
        }
    _A_in = _A_setup()

    def _B_setup():
        B, S, D, H = 1, 2048, 576, 32
        Dh = D // H
        return {
            "x": _w((lambda *s: torch.randn(*s, dtype=torch.bfloat16) * 0.05)(B, S, D)),
            "wqkv": _w((lambda *s: torch.randn(*s, dtype=torch.bfloat16) * 1.6)(D, 3 * D)),
            "w_phi": _w((lambda *s: torch.randn(*s, dtype=torch.bfloat16) * 1.6)(H, Dh, Dh) * (Dh ** -0.5)),
            "wo": _w((lambda *s: torch.randn(*s, dtype=torch.bfloat16) * 0.1)(D, D)),
        }
    _B_in = _B_setup()

    return {
        "A_x": _A_in["x"],
        "A_wqkv": _A_in["wqkv"],
        "A_wo": _A_in["wo"],
        "B_x": _B_in["x"],
        "B_wqkv": _B_in["wqkv"],
        "B_w_phi": _B_in["w_phi"],
        "B_wo": _B_in["wo"],
        "gate_w": _w((lambda *s: torch.randn(*s, dtype=torch.bfloat16) * 0.05)(576) * 16.0),
    }

def reference(A_x, A_wqkv, A_wo, B_x, B_wqkv, B_w_phi, B_wo, gate_w):
    def _A_ref(x, wqkv, wo):
        B, S, D = x.shape
        H = 32; Dh = D // H; W = 256
        qkv = (lambda x, *d: x.permute(*d))((x @ wqkv).reshape(B, S, 3, H, Dh), 2, 0, 3, 1, 4)
        q, k, v = qkv[0], qkv[1], qkv[2]
        scores = torch.einsum("bhqd,bhkd->bhqk", q, k) * (Dh ** -0.5)
        idx = torch.arange(S)
        mask = (idx[:, None] - idx[None, :] >= 0) & (idx[:, None] - idx[None, :] < W)
        scores = torch.where(mask[None, None], scores, -1e9)
        p = _softmax(scores, axis=-1)
        o = torch.einsum("bhqk,bhkd->bhqd", p, v)
        return (lambda x, *d: x.permute(*d))(o, 0, 2, 1, 3).reshape(B, S, D) @ wo

    def _B_ref(x, wqkv, w_phi, wo):
        B, S, D = x.shape
        H = 32; Dh = D // H
        qkv = (lambda x, *d: x.permute(*d))((x @ wqkv).reshape(B, S, 3, H, Dh), 2, 0, 3, 1, 4)
        q, k, v = qkv[0], qkv[1], qkv[2]
        pq = torch.einsum("bhsd,hdf->bhsf", q, w_phi)
        pk = torch.einsum("bhsd,hdf->bhsf", k, w_phi)
        phi_q = torch.concatenate([_softmax(pq, axis=-1), _softmax(-pq, axis=-1)], axis=-1)
        phi_k = torch.concatenate([_softmax(pk, axis=-1), _softmax(-pk, axis=-1)], axis=-1)
        kv = torch.einsum("bhsf,bhsd->bhfd", phi_k, v)
        z  = torch.einsum("bhsf->bhf", phi_k)
        num = torch.einsum("bhqf,bhfd->bhqd", phi_q, kv)
        den = torch.einsum("bhqf,bhf->bhq", phi_q, z)[..., None] + 1e-6
        o = num / den
        return (lambda x, *d: x.permute(*d))(o, 0, 2, 1, 3).reshape(B, S, D) @ wo

    x = A_x
    g = _sigmoid((x * gate_w).sum(-1, keepdims=True))
    a = _A_ref(x, A_wqkv, A_wo)
    b = _B_ref(x, B_wqkv, B_w_phi, B_wo)
    return g * a + (1 - g) * b
```

```asm
; @launch grid=(256,1,1) block=(512,1,1) lds=163840
.amdgcn_target "amdgcn-amd-amdhsa--gfx950"
.text
.globl gated_mix__sliding_block__linear_kernel_hedgehog__prompt_kernel
.p2align 12
.p2align 8
.type gated_mix__sliding_block__linear_kernel_hedgehog__prompt_kernel,@function
gated_mix__sliding_block__linear_kernel_hedgehog__prompt_kernel:
s_cmp_ge_u32 s2, 256
s_cbranch_scc1 L_end
s_load_dwordx4 s[4:7], s[0:1], 0
s_load_dwordx4 s[8:11], s[0:1], 32
s_load_dwordx2 s[12:13], s[0:1], 56
s_load_dwordx2 s[14:15], s[0:1], 80
s_load_dwordx2 s[96:97], s[0:1], 72
s_load_dwordx2 s[20:21], s[0:1], 16
s_load_dwordx2 s[22:23], s[0:1], 48
v_lshrrev_b32 v1, 6, v0
v_and_b32_e64 v0, 63, v0
s_and_b32 s40, s2, 7
v_readfirstlane_b32 s3, v1
s_lshr_b32 s41, s2, 3
s_and_b32 s39, s40, 1
s_lshr_b32 s40, s40, 1
s_lshl_b32 s40, s40, 2
s_and_b32 s37, s41, 3
s_add_u32 s37, s37, s40
s_bfe_u32 s38, s41, 0x20002
s_mov_b32 s58, 1073741824
s_and_b32 s52, s3, 3
s_cmp_lt_u32 s3, 4
s_cbranch_scc1 L_C
s_getpc_b64 s[54:55]
L_pc:
s_sub_u32 s54, s54, L_pc-gated_mix__sliding_block__linear_kernel_hedgehog__prompt_kernel
s_subb_u32 s55, s55, 0
s_lshl_b32 s56, s41, 2
s_add_u32 s56, s56, s52
s_lshl_b32 s56, s56, 7
v_lshl_add_u32 v18, v0, 14, s56
v_min_u32 v18, L_code_end-gated_mix__sliding_block__linear_kernel_hedgehog__prompt_kernel-4, v18
global_load_dword v19, v18, s[54:55]
v_mov_b32 v14, 161792
v_mov_b32 v16, 0
v_mov_b32_e64 v17, 0
ds_write_b64 v14, v[16:17]
ds_write_b64 v14, v[16:17] offset:8
s_lshl_b32 s47, s52, 12
s_lshl_b32 s46, s52, 10
s_lshr_b32 s42, s52, 1
s_lshl_b32 s42, s42, 5
s_and_b32 s43, s52, 1
s_add_u32 s42, s42, s43
s_mul_i32 s42, s42, 2304
v_lshrrev_b32 v14, 3, v0
v_lshrrev_b32 v15, 4, v0
v_and_b32_e64 v16, 7, v0
v_mul_u32_u24 v14, 4608, v14
v_add_u32 v14, s42, v14
v_xor_b32 v17, v16, v15
v_lshl_add_u32 v1, v17, 4, v14
v_xor_b32_e64 v17, 4, v17
v_lshl_add_u32 v2, v17, 4, v14
v_add_u32 v2, 36864, v2
v_add_u32 v3, 1152, v1
v_add_u32 v4, 1152, v2
s_lshl_b32 s42, s52, 6
v_add_u32 v14, s42, v0
s_mov_b32 s43, 3456
s_cmp_ge_u32 s41, 16
s_cbranch_scc1 L_HV
v_add_u32_e64 v15, 0, v14
v_mul_u32_u24 v16, 1821, v15
v_lshrrev_b32 v16, 16, v16
v_mul_u32_u24 v17, 36, v16
v_sub_u32_e64 v15, v15, v17
v_bfe_u32 v17, v16, 3, 1
v_lshlrev_b32 v17, 1, v17
v_sub_u32 v15, v15, v17
v_add_u32 v17, 36, v15
v_min_u32 v15, v15, v17
v_lshlrev_b32_e64 v15, 4, v15
v_mad_u32_u24 v5, v16, s43, v15
v_add_u32 v15, 256, v14
v_mul_u32_u24 v16, 1821, v15
v_lshrrev_b32 v16, 16, v16
v_mul_u32_u24 v17, 36, v16
v_sub_u32_e64 v15, v15, v17
v_bfe_u32 v17, v16, 3, 1
v_lshlrev_b32 v17, 1, v17
v_sub_u32 v15, v15, v17
v_add_u32 v17, 36, v15
v_min_u32 v15, v15, v17
v_lshlrev_b32_e64 v15, 4, v15
v_mad_u32_u24 v6, v16, s43, v15
v_add_u32 v15, 512, v14
v_mul_u32_u24 v16, 1821, v15
v_lshrrev_b32 v16, 16, v16
v_mul_u32_u24 v17, 36, v16
v_sub_u32_e64 v15, v15, v17
v_bfe_u32 v17, v16, 3, 1
v_lshlrev_b32 v17, 1, v17
v_sub_u32 v15, v15, v17
v_add_u32 v17, 36, v15
v_min_u32 v15, v15, v17
v_lshlrev_b32_e64 v15, 4, v15
v_mad_u32_u24 v7, v16, s43, v15
v_add_u32 v15, 768, v14
v_mul_u32_u24 v16, 1821, v15
v_lshrrev_b32 v16, 16, v16
v_mul_u32_u24 v17, 36, v16
v_sub_u32_e64 v15, v15, v17
v_bfe_u32 v17, v16, 3, 1
v_lshlrev_b32 v17, 1, v17
v_sub_u32 v15, v15, v17
v_add_u32 v17, 36, v15
v_min_u32 v15, v15, v17
v_lshlrev_b32_e64 v15, 4, v15
v_mad_u32_u24 v8, v16, s43, v15
v_add_u32 v15, 1024, v14
v_mul_u32_u24 v16, 1821, v15
v_lshrrev_b32 v16, 16, v16
v_mul_u32_u24 v17, 36, v16
v_sub_u32_e64 v15, v15, v17
v_bfe_u32 v17, v16, 3, 1
v_lshlrev_b32 v17, 1, v17
v_sub_u32 v15, v15, v17
v_add_u32 v17, 36, v15
v_min_u32 v15, v15, v17
v_lshlrev_b32_e64 v15, 4, v15
v_mad_u32_u24 v9, v16, s43, v15
v_add_u32 v15, 1280, v14
v_mul_u32_u24 v16, 1821, v15
v_lshrrev_b32 v16, 16, v16
v_mul_u32_u24 v17, 36, v16
v_sub_u32_e64 v15, v15, v17
v_bfe_u32 v17, v16, 3, 1
v_lshlrev_b32 v17, 1, v17
v_sub_u32 v15, v15, v17
v_add_u32 v17, 36, v15
v_min_u32 v15, v15, v17
v_lshlrev_b32_e64 v15, 4, v15
v_mad_u32_u24 v10, v16, s43, v15
v_add_u32 v15, 1536, v14
v_mul_u32_u24 v16, 1821, v15
v_lshrrev_b32 v16, 16, v16
v_mul_u32_u24 v17, 36, v16
v_sub_u32_e64 v15, v15, v17
v_bfe_u32 v17, v16, 3, 1
v_lshlrev_b32 v17, 1, v17
v_sub_u32 v15, v15, v17
v_add_u32 v17, 36, v15
v_min_u32 v15, v15, v17
v_lshlrev_b32_e64 v15, 4, v15
v_mad_u32_u24 v11, v16, s43, v15
v_add_u32 v15, 1792, v14
v_mul_u32_u24 v16, 1821, v15
v_lshrrev_b32 v16, 16, v16
v_mul_u32_u24 v17, 36, v16
v_sub_u32_e64 v15, v15, v17
v_bfe_u32 v17, v16, 3, 1
v_lshlrev_b32 v17, 1, v17
v_sub_u32 v15, v15, v17
v_add_u32 v17, 36, v15
v_min_u32 v15, v15, v17
v_lshlrev_b32_e64 v15, 4, v15
v_mad_u32_u24 v12, v16, s43, v15
v_add_u32 v15, 2048, v14
v_mul_u32_u24 v16, 1821, v15
v_lshrrev_b32 v16, 16, v16
v_mul_u32_u24 v17, 36, v16
v_sub_u32_e64 v15, v15, v17
v_bfe_u32 v17, v16, 3, 1
v_lshlrev_b32 v17, 1, v17
v_sub_u32 v15, v15, v17
v_add_u32 v17, 36, v15
v_min_u32 v15, v15, v17
v_lshlrev_b32_e64 v15, 4, v15
v_mad_u32_u24 v13, v16, s43, v15
s_waitcnt lgkmcnt(0)
s_mul_i32 s42, s37, 147456
s_add_u32 s16, s4, s42
s_addc_u32 s17, s5, 0
s_mov_b32 s18, 147456
s_mov_b32 s19, 0x20000
s_mul_i32 s42, s38, 1152
s_cmp_eq_u32 s38, 3
s_cselect_b32 s42, 0, s42
s_cselect_b32 s20, s8, s6
s_cselect_b32 s21, s9, s7
s_mul_i32 s43, s39, 576
s_add_u32 s42, s42, s43
s_add_u32 s20, s20, s42
s_addc_u32 s21, s21, 0
s_sub_u32 s22, 1990656, s42
s_mov_b32 s23, 0x20000
s_mov_b32 s44, 0
s_mov_b32 s45, 0
s_add_u32 m0, s46, 49152
s_nop 0
buffer_load_dwordx4 v5, s[20:23], s44 offen  lds
s_add_u32 m0, s47, 0
s_nop 0
buffer_load_dwordx4 v1, s[16:19], s45 offen  lds
s_add_u32 m0, s47, 1024
s_nop 0
buffer_load_dwordx4 v2, s[16:19], s45 offen  lds
s_add_u32 m0, s47, 2048
s_nop 0
buffer_load_dwordx4 v3, s[16:19], s45 offen  lds
s_add_u32 m0, s47, 3072
s_nop 0
buffer_load_dwordx4 v4, s[16:19], s45 offen  lds
s_add_u32 m0, s46, 53248
s_nop 0
buffer_load_dwordx4 v6, s[20:23], s44 offen  lds
s_add_u32 m0, s46, 57344
s_nop 0
buffer_load_dwordx4 v7, s[20:23], s44 offen  lds
s_add_u32 m0, s46, 61440
s_nop 0
buffer_load_dwordx4 v8, s[20:23], s44 offen  lds
s_add_u32 m0, s46, 65536
s_nop 0
buffer_load_dwordx4 v9, s[20:23], s44 offen  lds
s_add_u32 m0, s46, 69632
s_nop 0
buffer_load_dwordx4 v10, s[20:23], s44 offen  lds
s_branch L_HR2
L_HV:
s_mov_b32 s55, s38
s_lshl_b32 s40, s39, 2
s_add_u32 s38, s38, s40
v_mov_b32 v21, s58
v_add_u32_e64 v15, 0, v14
v_mul_u32_u24 v16, 3641, v15
v_lshrrev_b32 v16, 16, v16
v_mul_u32_u24 v17, 18, v16
v_sub_u32_e64 v15, v15, v17
v_and_b32 v17, 0x73, v16
v_bfe_u32 v18, v16, 2, 1
v_lshl_add_u32 v17, v18, 3, v17
v_bfe_u32 v18, v16, 3, 1
v_lshl_add_u32 v17, v18, 2, v17
v_mul_u32_u24_e64 v17, s43, v17
v_lshl_add_u32 v17, v15, 4, v17
v_add_u32 v18, 1008, v17
v_cmp_lt_u32 vcc, 8, v15
s_nop 1
v_cndmask_b32_e64 v5, v17, v18, vcc
v_add_u32 v15, 256, v14
v_mul_u32_u24 v16, 3641, v15
v_lshrrev_b32 v16, 16, v16
v_mul_u32_u24 v17, 18, v16
v_sub_u32_e64 v15, v15, v17
v_and_b32 v17, 0x73, v16
v_bfe_u32 v18, v16, 2, 1
v_lshl_add_u32 v17, v18, 3, v17
v_bfe_u32 v18, v16, 3, 1
v_lshl_add_u32 v17, v18, 2, v17
v_mul_u32_u24_e64 v17, s43, v17
v_lshl_add_u32 v17, v15, 4, v17
v_add_u32 v18, 1008, v17
v_cmp_lt_u32 vcc, 8, v15
s_nop 1
v_cndmask_b32_e64 v6, v17, v18, vcc
v_add_u32 v15, 512, v14
v_mul_u32_u24 v16, 3641, v15
v_lshrrev_b32 v16, 16, v16
v_mul_u32_u24 v17, 18, v16
v_sub_u32_e64 v15, v15, v17
v_and_b32 v17, 0x73, v16
v_bfe_u32 v18, v16, 2, 1
v_lshl_add_u32 v17, v18, 3, v17
v_bfe_u32 v18, v16, 3, 1
v_lshl_add_u32 v17, v18, 2, v17
v_mul_u32_u24_e64 v17, s43, v17
v_lshl_add_u32 v17, v15, 4, v17
v_add_u32 v18, 1008, v17
v_cmp_lt_u32 vcc, 8, v15
s_nop 1
v_cndmask_b32_e64 v7, v17, v18, vcc
v_add_u32 v15, 768, v14
v_mul_u32_u24 v16, 3641, v15
v_lshrrev_b32 v16, 16, v16
v_mul_u32_u24 v17, 18, v16
v_sub_u32_e64 v15, v15, v17
v_and_b32 v17, 0x73, v16
v_bfe_u32 v18, v16, 2, 1
v_lshl_add_u32 v17, v18, 3, v17
v_bfe_u32 v18, v16, 3, 1
v_lshl_add_u32 v17, v18, 2, v17
v_mul_u32_u24_e64 v17, s43, v17
v_lshl_add_u32 v17, v15, 4, v17
v_add_u32 v18, 1008, v17
v_cmp_lt_u32 vcc, 8, v15
s_nop 1
v_cndmask_b32_e64 v8, v17, v18, vcc
v_add_u32 v15, 1024, v14
v_mul_u32_u24 v16, 3641, v15
v_lshrrev_b32 v16, 16, v16
v_mul_u32_u24 v17, 18, v16
v_sub_u32_e64 v15, v15, v17
v_and_b32 v17, 0x73, v16
v_bfe_u32 v18, v16, 2, 1
v_lshl_add_u32 v17, v18, 3, v17
v_bfe_u32 v18, v16, 3, 1
v_lshl_add_u32 v17, v18, 2, v17
v_mul_u32_u24_e64 v17, s43, v17
v_lshl_add_u32 v17, v15, 4, v17
v_add_u32 v18, 1008, v17
v_cmp_lt_u32 vcc, 8, v15
s_nop 1
v_cndmask_b32 v9, v17, v18, vcc
v_cmp_lt_u32 vcc, 63, v16
s_nop 1
v_cndmask_b32_e64 v9, v9, v21, vcc
s_waitcnt lgkmcnt(0)
s_mul_i32 s42, s37, 147456
s_add_u32 s16, s4, s42
s_addc_u32 s17, s5, 0
s_mov_b32 s18, 147456
s_mov_b32 s19, 0x20000
s_mul_i32 s42, s38, 144
s_add_u32 s42, s42, 1152
s_add_u32 s20, s8, s42
s_addc_u32 s21, s9, 0
s_sub_u32 s22, 1990656, s42
s_mov_b32 s23, 0x20000
s_mov_b32 s44, 0
s_mov_b32 s45, 0
s_add_u32 m0, s46, 65536
s_nop 0
buffer_load_dwordx4 v5, s[20:23], s44 offen  lds
s_add_u32 m0, s47, 0
s_nop 0
buffer_load_dwordx4 v1, s[16:19], s45 offen  lds
s_add_u32 m0, s47, 1024
s_nop 0
buffer_load_dwordx4 v2, s[16:19], s45 offen  lds
s_add_u32 m0, s47, 2048
s_nop 0
buffer_load_dwordx4 v3, s[16:19], s45 offen  lds
s_add_u32 m0, s47, 3072
s_nop 0
buffer_load_dwordx4 v4, s[16:19], s45 offen  lds
s_add_u32 m0, s46, 69632
s_nop 0
buffer_load_dwordx4 v6, s[20:23], s44 offen  lds
s_add_u32 m0, s46, 73728
s_nop 0
buffer_load_dwordx4 v7, s[20:23], s44 offen  lds
s_add_u32 m0, s46, 77824
s_nop 0
buffer_load_dwordx4 v8, s[20:23], s44 offen  lds
s_waitcnt vmcnt(1)
s_waitcnt lgkmcnt(0)
s_barrier
s_add_u32 m0, s46, 81920
s_nop 0
buffer_load_dwordx4 v9, s[20:23], s44 offen  lds
s_mov_b32 s32, s12
s_mov_b32 s33, s13
s_mov_b32 s34, 1152
s_mov_b32 s35, 0x20000
v_lshlrev_b32 v14, 4, v0
s_add_u32 m0, s46, 147456
s_nop 0
buffer_load_dwordx4 v14, s[32:35], s46 offen lds
s_mov_b32 s44, 221184
s_mov_b32 s45, 128
s_add_u32 m0, s47, 16384
s_nop 0
buffer_load_dwordx4 v1, s[16:19], s45 offen  lds
s_add_u32 m0, s47, 17408
s_nop 0
buffer_load_dwordx4 v2, s[16:19], s45 offen  lds
s_add_u32 m0, s47, 18432
s_nop 0
buffer_load_dwordx4 v3, s[16:19], s45 offen  lds
s_add_u32 m0, s47, 19456
s_nop 0
buffer_load_dwordx4 v4, s[16:19], s45 offen  lds
s_add_u32 m0, s46, 86016
s_nop 0
buffer_load_dwordx4 v5, s[20:23], s44 offen  lds
s_add_u32 m0, s46, 90112
s_nop 0
buffer_load_dwordx4 v6, s[20:23], s44 offen  lds
s_waitcnt vmcnt(7)
s_barrier
s_add_u32 m0, s46, 94208
s_nop 0
buffer_load_dwordx4 v7, s[20:23], s44 offen  lds
s_add_u32 m0, s46, 98304
s_nop 0
buffer_load_dwordx4 v8, s[20:23], s44 offen  lds
s_add_u32 m0, s46, 102400
s_nop 0
buffer_load_dwordx4 v9, s[20:23], s44 offen  lds
s_mov_b32 s44, 442368
s_mov_b32 s45, 256
s_add_u32 m0, s47, 32768
s_nop 0
buffer_load_dwordx4 v1, s[16:19], s45 offen  lds
s_add_u32 m0, s47, 33792
s_nop 0
buffer_load_dwordx4 v2, s[16:19], s45 offen  lds
s_waitcnt vmcnt(4)
s_barrier
s_add_u32 m0, s47, 34816
s_nop 0
buffer_load_dwordx4 v3, s[16:19], s45 offen  lds
s_add_u32 m0, s47, 35840
s_nop 0
buffer_load_dwordx4 v4, s[16:19], s45 offen  lds
s_add_u32 m0, s46, 106496
s_nop 0
buffer_load_dwordx4 v5, s[20:23], s44 offen  lds
s_add_u32 m0, s46, 110592
s_nop 0
buffer_load_dwordx4 v6, s[20:23], s44 offen  lds
s_waitcnt vmcnt(6)
s_barrier
s_add_u32 m0, s46, 114688
s_nop 0
buffer_load_dwordx4 v7, s[20:23], s44 offen  lds
s_add_u32 m0, s46, 118784
s_nop 0
buffer_load_dwordx4 v8, s[20:23], s44 offen  lds
s_add_u32 m0, s46, 122880
s_nop 0
buffer_load_dwordx4 v9, s[20:23], s44 offen  lds
s_mov_b32 s44, 663552
s_mov_b32 s45, 384
s_add_u32 m0, s47, 49152
s_nop 0
buffer_load_dwordx4 v1, s[16:19], s45 offen  lds
s_add_u32 m0, s47, 50176
s_nop 0
buffer_load_dwordx4 v2, s[16:19], s45 offen  lds
s_add_u32 m0, s47, 51200
s_nop 0
buffer_load_dwordx4 v3, s[16:19], s45 offen  lds
s_add_u32 m0, s47, 52224
s_nop 0
buffer_load_dwordx4 v4, s[16:19], s45 offen  lds
s_add_u32 m0, s46, 126976
s_nop 0
buffer_load_dwordx4 v5, s[20:23], s44 offen  lds
s_add_u32 m0, s46, 131072
s_nop 0
buffer_load_dwordx4 v6, s[20:23], s44 offen  lds
s_add_u32 m0, s46, 135168
s_nop 0
buffer_load_dwordx4 v7, s[20:23], s44 offen  lds
s_add_u32 m0, s46, 139264
s_nop 0
buffer_load_dwordx4 v8, s[20:23], s44 offen  lds
s_add_u32 m0, s46, 143360
s_nop 0
buffer_load_dwordx4 v9, s[20:23], s44 offen  lds
v_and_b32 v14, 31, v0
v_lshrrev_b32 v15, 5, v0
v_bfe_u32 v16, v0, 1, 3
v_lshlrev_b32 v17, 2, v15
v_xor_b32 v16, v16, v17
v_lshlrev_b32 v14, 7, v14
v_add_u32 v14, s47, v14
v_lshlrev_b32_e64 v27, 6, v15
v_add_u32 v27, 147456, v27
v_xor_b32_e64 v17, 0, v16
v_lshl_add_u32 v28, v17, 4, v14
v_mov_b32 v64, 0
v_xor_b32 v17, 1, v16
v_lshl_add_u32 v29, v17, 4, v14
v_mov_b32 v65, 0
v_xor_b32 v17, 2, v16
v_lshl_add_u32 v30, v17, 4, v14
v_mov_b32 v66, 0
v_xor_b32 v17, 3, v16
v_lshl_add_u32 v31, v17, 4, v14
v_mov_b32_e64 v67, 0
s_cmp_lg_u32 s55, 0
s_cbranch_scc1 L_ng0
ds_read_b128 v[32:35], v28 offset:0
ds_read_b128 v[48:51], v27 offset:0
ds_read_b128 v[36:39], v29 offset:0
ds_read_b128 v[52:55], v27 offset:16
ds_read_b128 v[40:43], v30 offset:0
ds_read_b128 v[56:59], v27 offset:32
ds_read_b128 v[44:47], v31 offset:0
ds_read_b128 v[60:63], v27 offset:48
s_waitcnt lgkmcnt(0)
s_nop 0
v_dot2_f32_bf16 v64, v32, v48, v64
v_dot2_f32_bf16 v65, v36, v52, v65
v_dot2_f32_bf16 v66, v40, v56, v66
v_dot2_f32_bf16 v67, v44, v60, v67
s_nop 1
s_nop 0
v_dot2_f32_bf16 v64, v33, v49, v64
v_dot2_f32_bf16 v65, v37, v53, v65
v_dot2_f32_bf16 v66, v41, v57, v66
v_dot2_f32_bf16 v67, v45, v61, v67
s_nop 1
s_nop 0
v_dot2_f32_bf16 v64, v34, v50, v64
v_dot2_f32_bf16 v65, v38, v54, v65
v_dot2_f32_bf16 v66, v42, v58, v66
v_dot2_f32_bf16 v67, v46, v62, v67
s_nop 1
s_nop 0
v_dot2_f32_bf16 v64, v35, v51, v64
v_dot2_f32_bf16 v65, v39, v55, v65
v_dot2_f32_bf16 v66, v43, v59, v66
v_dot2_f32_bf16 v67, v47, v63, v67
L_ng0:
s_cmp_lg_u32 s55, 0
s_cbranch_scc1 L_ng1
ds_read_b128 v[32:35], v28 offset:16384
ds_read_b128 v[48:51], v27 offset:128
ds_read_b128 v[36:39], v29 offset:16384
ds_read_b128 v[52:55], v27 offset:144
ds_read_b128 v[40:43], v30 offset:16384
ds_read_b128 v[56:59], v27 offset:160
ds_read_b128 v[44:47], v31 offset:16384
ds_read_b128 v[60:63], v27 offset:176
s_waitcnt lgkmcnt(0)
s_nop 0
v_dot2_f32_bf16 v64, v32, v48, v64
v_dot2_f32_bf16 v65, v36, v52, v65
v_dot2_f32_bf16 v66, v40, v56, v66
v_dot2_f32_bf16 v67, v44, v60, v67
s_nop 1
s_nop 0
v_dot2_f32_bf16 v64, v33, v49, v64
v_dot2_f32_bf16 v65, v37, v53, v65
v_dot2_f32_bf16 v66, v41, v57, v66
v_dot2_f32_bf16 v67, v45, v61, v67
s_nop 1
s_nop 0
v_dot2_f32_bf16 v64, v34, v50, v64
v_dot2_f32_bf16 v65, v38, v54, v65
v_dot2_f32_bf16 v66, v42, v58, v66
v_dot2_f32_bf16 v67, v46, v62, v67
s_nop 1
s_nop 0
v_dot2_f32_bf16 v64, v35, v51, v64
v_dot2_f32_bf16 v65, v39, v55, v65
v_dot2_f32_bf16 v66, v43, v59, v66
v_dot2_f32_bf16 v67, v47, v63, v67
L_ng1:
s_waitcnt vmcnt(9)
s_barrier
s_mov_b32 s44, 884736
s_mov_b32 s45, 512
s_add_u32 m0, s47, 0
s_nop 0
buffer_load_dwordx4 v1, s[16:19], s45 offen  lds
s_add_u32 m0, s47, 1024
s_nop 0
buffer_load_dwordx4 v2, s[16:19], s45 offen  lds
s_add_u32 m0, s47, 2048
s_nop 0
buffer_load_dwordx4 v3, s[16:19], s45 offen  lds
s_add_u32 m0, s47, 3072
s_nop 0
buffer_load_dwordx4 v4, s[16:19], s45 offen  lds
s_add_u32 m0, s46, 65536
s_nop 0
buffer_load_dwordx4 v5, s[20:23], s44 offen  lds
s_add_u32 m0, s46, 69632
s_nop 0
buffer_load_dwordx4 v6, s[20:23], s44 offen  lds
s_add_u32 m0, s46, 73728
s_nop 0
buffer_load_dwordx4 v7, s[20:23], s44 offen  lds
s_add_u32 m0, s46, 77824
s_nop 0
buffer_load_dwordx4 v8, s[20:23], s44 offen  lds
s_add_u32 m0, s46, 81920
s_nop 0
buffer_load_dwordx4 v9, s[20:23], s44 offen  lds
s_cmp_lg_u32 s55, 0
s_cbranch_scc1 L_ng2
ds_read_b128 v[32:35], v28 offset:32768
ds_read_b128 v[48:51], v27 offset:256
ds_read_b128 v[36:39], v29 offset:32768
ds_read_b128 v[52:55], v27 offset:272
ds_read_b128 v[40:43], v30 offset:32768
ds_read_b128 v[56:59], v27 offset:288
ds_read_b128 v[44:47], v31 offset:32768
ds_read_b128 v[60:63], v27 offset:304
s_waitcnt lgkmcnt(0)
s_nop 0
v_dot2_f32_bf16 v64, v32, v48, v64
v_dot2_f32_bf16 v65, v36, v52, v65
v_dot2_f32_bf16 v66, v40, v56, v66
v_dot2_f32_bf16 v67, v44, v60, v67
s_nop 1
s_nop 0
v_dot2_f32_bf16 v64, v33, v49, v64
v_dot2_f32_bf16 v65, v37, v53, v65
v_dot2_f32_bf16 v66, v41, v57, v66
v_dot2_f32_bf16 v67, v45, v61, v67
s_nop 1
s_nop 0
v_dot2_f32_bf16 v64, v34, v50, v64
v_dot2_f32_bf16 v65, v38, v54, v65
v_dot2_f32_bf16 v66, v42, v58, v66
v_dot2_f32_bf16 v67, v46, v62, v67
s_nop 1
s_nop 0
v_dot2_f32_bf16 v64, v35, v51, v64
v_dot2_f32_bf16 v65, v39, v55, v65
v_dot2_f32_bf16 v66, v43, v59, v66
v_dot2_f32_bf16 v67, v47, v63, v67
L_ng2:
s_waitcnt vmcnt(9)
s_barrier
s_mov_b32 s44, 1105920
s_mov_b32 s45, 640
s_add_u32 m0, s47, 16384
s_nop 0
buffer_load_dwordx4 v1, s[16:19], s45 offen  lds
s_add_u32 m0, s47, 17408
s_nop 0
buffer_load_dwordx4 v2, s[16:19], s45 offen  lds
s_add_u32 m0, s47, 18432
s_nop 0
buffer_load_dwordx4 v3, s[16:19], s45 offen  lds
s_add_u32 m0, s47, 19456
s_nop 0
buffer_load_dwordx4 v4, s[16:19], s45 offen  lds
s_add_u32 m0, s46, 86016
s_nop 0
buffer_load_dwordx4 v5, s[20:23], s44 offen  lds
s_add_u32 m0, s46, 90112
s_nop 0
buffer_load_dwordx4 v6, s[20:23], s44 offen  lds
s_add_u32 m0, s46, 94208
s_nop 0
buffer_load_dwordx4 v7, s[20:23], s44 offen  lds
s_add_u32 m0, s46, 98304
s_nop 0
buffer_load_dwordx4 v8, s[20:23], s44 offen  lds
s_add_u32 m0, s46, 102400
s_nop 0
buffer_load_dwordx4 v9, s[20:23], s44 offen  lds
s_cmp_lg_u32 s55, 0
s_cbranch_scc1 L_ng3
ds_read_b128 v[32:35], v28 offset:49152
ds_read_b128 v[48:51], v27 offset:384
ds_read_b128 v[36:39], v29 offset:49152
ds_read_b128 v[52:55], v27 offset:400
ds_read_b128 v[40:43], v30 offset:49152
ds_read_b128 v[56:59], v27 offset:416
ds_read_b128 v[44:47], v31 offset:49152
ds_read_b128 v[60:63], v27 offset:432
s_waitcnt lgkmcnt(0)
v_dot2_f32_bf16 v64, v32, v48, v64
v_dot2_f32_bf16 v65, v36, v52, v65
v_dot2_f32_bf16 v66, v40, v56, v66
v_dot2_f32_bf16 v67, v44, v60, v67
s_nop 1
s_nop 0
v_dot2_f32_bf16 v64, v33, v49, v64
v_dot2_f32_bf16 v65, v37, v53, v65
v_dot2_f32_bf16 v66, v41, v57, v66
v_dot2_f32_bf16 v67, v45, v61, v67
s_nop 1
s_nop 0
v_dot2_f32_bf16 v64, v34, v50, v64
v_dot2_f32_bf16 v65, v38, v54, v65
v_dot2_f32_bf16 v66, v42, v58, v66
v_dot2_f32_bf16 v67, v46, v62, v67
s_nop 1
s_nop 0
v_dot2_f32_bf16 v64, v35, v51, v64
v_dot2_f32_bf16 v65, v39, v55, v65
v_dot2_f32_bf16 v66, v43, v59, v66
v_dot2_f32_bf16 v67, v47, v63, v67
L_ng3:
s_waitcnt vmcnt(9)
s_barrier
s_mov_b32 s44, 1327104
s_mov_b32 s45, 768
s_add_u32 m0, s47, 32768
s_nop 0
buffer_load_dwordx4 v1, s[16:19], s45 offen  lds
s_add_u32 m0, s47, 33792
s_nop 0
buffer_load_dwordx4 v2, s[16:19], s45 offen  lds
s_add_u32 m0, s47, 34816
s_nop 0
buffer_load_dwordx4 v3, s[16:19], s45 offen  lds
s_add_u32 m0, s47, 35840
s_nop 0
buffer_load_dwordx4 v4, s[16:19], s45 offen  lds
s_add_u32 m0, s46, 106496
s_nop 0
buffer_load_dwordx4 v5, s[20:23], s44 offen  lds
s_add_u32 m0, s46, 110592
s_nop 0
buffer_load_dwordx4 v6, s[20:23], s44 offen  lds
s_add_u32 m0, s46, 114688
s_nop 0
buffer_load_dwordx4 v7, s[20:23], s44 offen  lds
s_add_u32 m0, s46, 118784
s_nop 0
buffer_load_dwordx4 v8, s[20:23], s44 offen  lds
s_add_u32 m0, s46, 122880
s_nop 0
buffer_load_dwordx4 v9, s[20:23], s44 offen  lds
s_cmp_lg_u32 s55, 0
s_cbranch_scc1 L_ng4
ds_read_b128 v[32:35], v28 offset:0
ds_read_b128 v[48:51], v27 offset:512
ds_read_b128 v[36:39], v29 offset:0
ds_read_b128 v[52:55], v27 offset:528
ds_read_b128 v[40:43], v30 offset:0
ds_read_b128 v[56:59], v27 offset:544
ds_read_b128 v[44:47], v31 offset:0
ds_read_b128 v[60:63], v27 offset:560
s_waitcnt lgkmcnt(0)
v_dot2_f32_bf16 v64, v32, v48, v64
v_dot2_f32_bf16 v65, v36, v52, v65
v_dot2_f32_bf16 v66, v40, v56, v66
v_dot2_f32_bf16 v67, v44, v60, v67
s_nop 1
s_nop 0
v_dot2_f32_bf16 v64, v33, v49, v64
v_dot2_f32_bf16 v65, v37, v53, v65
v_dot2_f32_bf16 v66, v41, v57, v66
v_dot2_f32_bf16 v67, v45, v61, v67
s_nop 1
s_nop 0
v_dot2_f32_bf16 v64, v34, v50, v64
v_dot2_f32_bf16 v65, v38, v54, v65
v_dot2_f32_bf16 v66, v42, v58, v66
v_dot2_f32_bf16 v67, v46, v62, v67
s_nop 1
s_nop 0
v_dot2_f32_bf16 v64, v35, v51, v64
v_dot2_f32_bf16 v65, v39, v55, v65
v_dot2_f32_bf16 v66, v43, v59, v66
v_dot2_f32_bf16 v67, v47, v63, v67
L_ng4:
s_waitcnt vmcnt(9)
s_barrier
s_mov_b32 s44, 1548288
s_mov_b32 s45, 896
s_add_u32 m0, s47, 49152
s_nop 0
buffer_load_dwordx4 v1, s[16:19], s45 offen  lds
s_add_u32 m0, s47, 50176
s_nop 0
buffer_load_dwordx4 v2, s[16:19], s45 offen  lds
s_add_u32 m0, s47, 51200
s_nop 0
buffer_load_dwordx4 v3, s[16:19], s45 offen  lds
s_add_u32 m0, s47, 52224
s_nop 0
buffer_load_dwordx4 v4, s[16:19], s45 offen  lds
s_add_u32 m0, s46, 126976
s_nop 0
buffer_load_dwordx4 v5, s[20:23], s44 offen  lds
s_add_u32 m0, s46, 131072
s_nop 0
buffer_load_dwordx4 v6, s[20:23], s44 offen  lds
s_add_u32 m0, s46, 135168
s_nop 0
buffer_load_dwordx4 v7, s[20:23], s44 offen  lds
s_add_u32 m0, s46, 139264
s_nop 0
buffer_load_dwordx4 v8, s[20:23], s44 offen  lds
s_add_u32 m0, s46, 143360
s_nop 0
buffer_load_dwordx4 v9, s[20:23], s44 offen  lds
s_cmp_lg_u32 s55, 0
s_cbranch_scc1 L_ng5
ds_read_b128 v[32:35], v28 offset:16384
ds_read_b128 v[48:51], v27 offset:640
ds_read_b128 v[36:39], v29 offset:16384
ds_read_b128 v[52:55], v27 offset:656
ds_read_b128 v[40:43], v30 offset:16384
ds_read_b128 v[56:59], v27 offset:672
ds_read_b128 v[44:47], v31 offset:16384
ds_read_b128 v[60:63], v27 offset:688
s_waitcnt lgkmcnt(0)
v_dot2_f32_bf16 v64, v32, v48, v64
v_dot2_f32_bf16 v65, v36, v52, v65
v_dot2_f32_bf16 v66, v40, v56, v66
v_dot2_f32_bf16 v67, v44, v60, v67
s_nop 1
s_nop 0
v_dot2_f32_bf16 v64, v33, v49, v64
v_dot2_f32_bf16 v65, v37, v53, v65
v_dot2_f32_bf16 v66, v41, v57, v66
v_dot2_f32_bf16 v67, v45, v61, v67
s_nop 1
s_nop 0
v_dot2_f32_bf16 v64, v34, v50, v64
v_dot2_f32_bf16 v65, v38, v54, v65
v_dot2_f32_bf16 v66, v42, v58, v66
v_dot2_f32_bf16 v67, v46, v62, v67
s_nop 1
s_nop 0
v_dot2_f32_bf16 v64, v35, v51, v64
v_dot2_f32_bf16 v65, v39, v55, v65
v_dot2_f32_bf16 v66, v43, v59, v66
v_dot2_f32_bf16 v67, v47, v63, v67
L_ng5:
s_waitcnt vmcnt(9)
s_barrier
s_mov_b32 s44, 1769472
s_mov_b32 s45, 1024
s_add_u32 m0, s47, 0
s_nop 0
buffer_load_dwordx4 v1, s[16:19], s45 offen  lds
s_add_u32 m0, s47, 1024
s_nop 0
buffer_load_dwordx4 v2, s[16:19], s45 offen  lds
s_add_u32 m0, s47, 2048
s_nop 0
buffer_load_dwordx4 v3, s[16:19], s45 offen  lds
s_add_u32 m0, s47, 3072
s_nop 0
buffer_load_dwordx4 v4, s[16:19], s45 offen  lds
s_add_u32 m0, s46, 65536
s_nop 0
buffer_load_dwordx4 v5, s[20:23], s44 offen  lds
s_add_u32 m0, s46, 69632
s_nop 0
buffer_load_dwordx4 v6, s[20:23], s44 offen  lds
s_add_u32 m0, s46, 73728
s_nop 0
buffer_load_dwordx4 v7, s[20:23], s44 offen  lds
s_add_u32 m0, s46, 77824
s_nop 0
buffer_load_dwordx4 v8, s[20:23], s44 offen  lds
s_add_u32 m0, s46, 81920
s_nop 0
buffer_load_dwordx4 v9, s[20:23], s44 offen  lds
s_cmp_lg_u32 s55, 0
s_cbranch_scc1 L_ng6
ds_read_b128 v[32:35], v28 offset:32768
ds_read_b128 v[48:51], v27 offset:768
ds_read_b128 v[36:39], v29 offset:32768
ds_read_b128 v[52:55], v27 offset:784
ds_read_b128 v[40:43], v30 offset:32768
ds_read_b128 v[56:59], v27 offset:800
ds_read_b128 v[44:47], v31 offset:32768
ds_read_b128 v[60:63], v27 offset:816
s_waitcnt lgkmcnt(0)
s_nop 0
v_dot2_f32_bf16 v64, v32, v48, v64
v_dot2_f32_bf16 v65, v36, v52, v65
v_dot2_f32_bf16 v66, v40, v56, v66
v_dot2_f32_bf16 v67, v44, v60, v67
s_nop 1
s_nop 0
v_dot2_f32_bf16 v64, v33, v49, v64
v_dot2_f32_bf16 v65, v37, v53, v65
v_dot2_f32_bf16 v66, v41, v57, v66
v_dot2_f32_bf16 v67, v45, v61, v67
s_nop 1
s_nop 0
v_dot2_f32_bf16 v64, v34, v50, v64
v_dot2_f32_bf16 v65, v38, v54, v65
v_dot2_f32_bf16 v66, v42, v58, v66
v_dot2_f32_bf16 v67, v46, v62, v67
s_nop 1
s_nop 0
v_dot2_f32_bf16 v64, v35, v51, v64
v_dot2_f32_bf16 v65, v39, v55, v65
v_dot2_f32_bf16 v66, v43, v59, v66
v_dot2_f32_bf16 v67, v47, v63, v67
L_ng6:
s_waitcnt vmcnt(9)
s_barrier
s_cmp_lg_u32 s55, 0
s_cbranch_scc1 L_ng7
ds_read_b128 v[32:35], v28 offset:49152
ds_read_b128 v[48:51], v27 offset:896
ds_read_b128 v[36:39], v29 offset:49152
ds_read_b128 v[52:55], v27 offset:912
ds_read_b128 v[40:43], v30 offset:49152
ds_read_b128 v[56:59], v27 offset:928
ds_read_b128 v[44:47], v31 offset:49152
ds_read_b128 v[60:63], v27 offset:944
s_waitcnt lgkmcnt(0)
s_nop 0
v_dot2_f32_bf16 v64, v32, v48, v64
v_dot2_f32_bf16 v65, v36, v52, v65
v_dot2_f32_bf16 v66, v40, v56, v66
v_dot2_f32_bf16 v67, v44, v60, v67
s_nop 1
s_nop 0
v_dot2_f32_bf16 v64, v33, v49, v64
v_dot2_f32_bf16 v65, v37, v53, v65
v_dot2_f32_bf16 v66, v41, v57, v66
v_dot2_f32_bf16 v67, v45, v61, v67
s_nop 1
s_nop 0
v_dot2_f32_bf16 v64, v34, v50, v64
v_dot2_f32_bf16 v65, v38, v54, v65
v_dot2_f32_bf16 v66, v42, v58, v66
v_dot2_f32_bf16 v67, v46, v62, v67
s_nop 1
s_nop 0
v_dot2_f32_bf16 v64, v35, v51, v64
v_dot2_f32_bf16 v65, v39, v55, v65
v_dot2_f32_bf16 v66, v43, v59, v66
v_dot2_f32_bf16 v67, v47, v63, v67
L_ng7:
s_waitcnt vmcnt(0)
s_barrier
s_cmp_lg_u32 s55, 0
s_cbranch_scc1 L_ng8
ds_read_b128 v[32:35], v28 offset:0
ds_read_b128 v[48:51], v27 offset:1024
ds_read_b128 v[36:39], v29 offset:0
ds_read_b128 v[52:55], v27 offset:1040
ds_read_b128 v[40:43], v30 offset:0
ds_read_b128 v[56:59], v27 offset:1056
ds_read_b128 v[44:47], v31 offset:0
ds_read_b128 v[60:63], v27 offset:1072
s_waitcnt lgkmcnt(0)
s_nop 0
v_dot2_f32_bf16 v64, v32, v48, v64
v_dot2_f32_bf16 v65, v36, v52, v65
v_dot2_f32_bf16 v66, v40, v56, v66
v_dot2_f32_bf16 v67, v44, v60, v67
s_nop 1
s_nop 0
v_dot2_f32_bf16 v64, v33, v49, v64
v_dot2_f32_bf16 v65, v37, v53, v65
v_dot2_f32_bf16 v66, v41, v57, v66
v_dot2_f32_bf16 v67, v45, v61, v67
s_nop 1
s_nop 0
v_dot2_f32_bf16 v64, v34, v50, v64
v_dot2_f32_bf16 v65, v38, v54, v65
v_dot2_f32_bf16 v66, v42, v58, v66
v_dot2_f32_bf16 v67, v46, v62, v67
s_nop 1
s_nop 0
v_dot2_f32_bf16 v64, v35, v51, v64
v_dot2_f32_bf16 v65, v39, v55, v65
v_dot2_f32_bf16 v66, v43, v59, v66
v_dot2_f32_bf16 v67, v47, v63, v67
L_ng8:
s_barrier
s_cmp_lg_u32 s55, 0
s_cbranch_scc1 L_ngs
s_nop 3
v_add_f32 v64, v64, v65
v_add_f32 v66, v66, v67
v_add_f32 v64, v64, v66
v_mov_b32 v65, v64
s_nop 1
v_permlane32_swap_b32 v64, v65
v_add_f32_e64 v64, v64, v65
v_mul_f32 v64, 3216550459, v64
v_exp_f32_e64 v64, v64
s_add_u32 s32, s14, 10616832
s_addc_u32 s33, s15, 0
s_mov_b32 s34, 8192
v_add_f32 v64, 1.0, v64
v_rcp_f32 v64, v64
s_lshl_b32 s40, s37, 9
s_lshl_b32 s41, s52, 7
s_add_u32 s40, s40, s41
v_lshlrev_b32 v14, 2, v0
v_and_b32 v15, 35, v0
v_cmp_eq_u32 vcc, 0, v15
s_nop 1
v_cndmask_b32_e64 v14, v21, v14, vcc
v_mov_b32_dpp v65, v64 quad_perm:[1,1,1,1] row_mask:0xf bank_mask:0xf
v_mov_b32_dpp v66, v64 quad_perm:[2,2,2,2] row_mask:0xf bank_mask:0xf
v_mov_b32_dpp v67, v64 quad_perm:[3,3,3,3] row_mask:0xf bank_mask:0xf
buffer_store_dwordx4 v[64:67], v14, s[32:35], s40 offen sc1
L_ngs:
s_mov_b32 s59, 1
s_branch L_p2H2
L_HR2:
s_waitcnt vmcnt(1)
s_waitcnt lgkmcnt(0)
s_barrier
s_add_u32 m0, s46, 73728
s_nop 0
buffer_load_dwordx4 v11, s[20:23], s44 offen  lds
s_add_u32 m0, s46, 77824
s_nop 0
buffer_load_dwordx4 v12, s[20:23], s44 offen  lds
s_add_u32 m0, s46, 81920
s_nop 0
buffer_load_dwordx4 v13, s[20:23], s44 offen  lds
s_mov_b32 s44, 221184
s_mov_b32 s45, 128
s_add_u32 m0, s47, 16384
s_nop 0
buffer_load_dwordx4 v1, s[16:19], s45 offen  lds
s_add_u32 m0, s47, 17408
s_nop 0
buffer_load_dwordx4 v2, s[16:19], s45 offen  lds
s_add_u32 m0, s47, 18432
s_nop 0
buffer_load_dwordx4 v3, s[16:19], s45 offen  lds
s_add_u32 m0, s47, 19456
s_nop 0
buffer_load_dwordx4 v4, s[16:19], s45 offen  lds
s_add_u32 m0, s46, 86016
s_nop 0
buffer_load_dwordx4 v5, s[20:23], s44 offen  lds
s_add_u32 m0, s46, 90112
s_nop 0
buffer_load_dwordx4 v6, s[20:23], s44 offen  lds
s_waitcnt vmcnt(6)
s_barrier
s_add_u32 m0, s46, 94208
s_nop 0
buffer_load_dwordx4 v7, s[20:23], s44 offen  lds
s_add_u32 m0, s46, 98304
s_nop 0
buffer_load_dwordx4 v8, s[20:23], s44 offen  lds
s_add_u32 m0, s46, 102400
s_nop 0
buffer_load_dwordx4 v9, s[20:23], s44 offen  lds
s_add_u32 m0, s46, 106496
s_nop 0
buffer_load_dwordx4 v10, s[20:23], s44 offen  lds
s_add_u32 m0, s46, 110592
s_nop 0
buffer_load_dwordx4 v11, s[20:23], s44 offen  lds
s_add_u32 m0, s46, 114688
s_nop 0
buffer_load_dwordx4 v12, s[20:23], s44 offen  lds
s_add_u32 m0, s46, 118784
s_nop 0
buffer_load_dwordx4 v13, s[20:23], s44 offen  lds
s_mov_b32 s44, 442368
s_mov_b32 s45, 256
s_add_u32 m0, s47, 32768
s_nop 0
buffer_load_dwordx4 v1, s[16:19], s45 offen  lds
s_add_u32 m0, s47, 33792
s_nop 0
buffer_load_dwordx4 v2, s[16:19], s45 offen  lds
s_waitcnt vmcnt(6)
s_barrier
s_add_u32 m0, s47, 34816
s_nop 0
buffer_load_dwordx4 v3, s[16:19], s45 offen  lds
s_add_u32 m0, s47, 35840
s_nop 0
buffer_load_dwordx4 v4, s[16:19], s45 offen  lds
s_add_u32 m0, s46, 122880
s_nop 0
buffer_load_dwordx4 v5, s[20:23], s44 offen  lds
s_add_u32 m0, s46, 126976
s_nop 0
buffer_load_dwordx4 v6, s[20:23], s44 offen  lds
s_add_u32 m0, s46, 131072
s_nop 0
buffer_load_dwordx4 v7, s[20:23], s44 offen  lds
s_add_u32 m0, s46, 135168
s_nop 0
buffer_load_dwordx4 v8, s[20:23], s44 offen  lds
s_add_u32 m0, s46, 139264
s_nop 0
buffer_load_dwordx4 v9, s[20:23], s44 offen  lds
s_barrier
s_waitcnt vmcnt(9)
s_add_u32 m0, s46, 143360
s_nop 0
buffer_load_dwordx4 v10, s[20:23], s44 offen  lds
s_add_u32 m0, s46, 147456
s_nop 0
buffer_load_dwordx4 v11, s[20:23], s44 offen  lds
s_add_u32 m0, s46, 151552
s_nop 0
buffer_load_dwordx4 v12, s[20:23], s44 offen  lds
s_add_u32 m0, s46, 155648
s_nop 0
buffer_load_dwordx4 v13, s[20:23], s44 offen  lds
s_barrier
s_mov_b32 s44, 663552
s_mov_b32 s45, 384
s_add_u32 m0, s47, 0
s_nop 0
buffer_load_dwordx4 v1, s[16:19], s45 offen  lds
s_add_u32 m0, s47, 1024
s_nop 0
buffer_load_dwordx4 v2, s[16:19], s45 offen  lds
s_add_u32 m0, s47, 2048
s_nop 0
buffer_load_dwordx4 v3, s[16:19], s45 offen  lds
s_add_u32 m0, s47, 3072
s_nop 0
buffer_load_dwordx4 v4, s[16:19], s45 offen  lds
s_add_u32 m0, s46, 49152
s_nop 0
buffer_load_dwordx4 v5, s[20:23], s44 offen  lds
s_add_u32 m0, s46, 53248
s_nop 0
buffer_load_dwordx4 v6, s[20:23], s44 offen  lds
s_add_u32 m0, s46, 57344
s_nop 0
buffer_load_dwordx4 v7, s[20:23], s44 offen  lds
s_add_u32 m0, s46, 61440
s_nop 0
buffer_load_dwordx4 v8, s[20:23], s44 offen  lds
s_add_u32 m0, s46, 65536
s_nop 0
buffer_load_dwordx4 v9, s[20:23], s44 offen  lds
s_waitcnt vmcnt(9)
s_barrier
s_add_u32 m0, s46, 69632
s_nop 0
buffer_load_dwordx4 v10, s[20:23], s44 offen  lds
s_add_u32 m0, s46, 73728
s_nop 0
buffer_load_dwordx4 v11, s[20:23], s44 offen  lds
s_add_u32 m0, s46, 77824
s_nop 0
buffer_load_dwordx4 v12, s[20:23], s44 offen  lds
s_add_u32 m0, s46, 81920
s_nop 0
buffer_load_dwordx4 v13, s[20:23], s44 offen  lds
s_barrier
s_mov_b32 s44, 884736
s_mov_b32 s45, 512
s_add_u32 m0, s47, 16384
s_nop 0
buffer_load_dwordx4 v1, s[16:19], s45 offen  lds
s_add_u32 m0, s47, 17408
s_nop 0
buffer_load_dwordx4 v2, s[16:19], s45 offen  lds
s_add_u32 m0, s47, 18432
s_nop 0
buffer_load_dwordx4 v3, s[16:19], s45 offen  lds
s_add_u32 m0, s47, 19456
s_nop 0
buffer_load_dwordx4 v4, s[16:19], s45 offen  lds
s_add_u32 m0, s46, 86016
s_nop 0
buffer_load_dwordx4 v5, s[20:23], s44 offen  lds
s_add_u32 m0, s46, 90112
s_nop 0
buffer_load_dwordx4 v6, s[20:23], s44 offen  lds
s_add_u32 m0, s46, 94208
s_nop 0
buffer_load_dwordx4 v7, s[20:23], s44 offen  lds
s_add_u32 m0, s46, 98304
s_nop 0
buffer_load_dwordx4 v8, s[20:23], s44 offen  lds
s_add_u32 m0, s46, 102400
s_nop 0
buffer_load_dwordx4 v9, s[20:23], s44 offen  lds
s_waitcnt vmcnt(9)
s_barrier
s_add_u32 m0, s46, 106496
s_nop 0
buffer_load_dwordx4 v10, s[20:23], s44 offen  lds
s_add_u32 m0, s46, 110592
s_nop 0
buffer_load_dwordx4 v11, s[20:23], s44 offen  lds
s_add_u32 m0, s46, 114688
s_nop 0
buffer_load_dwordx4 v12, s[20:23], s44 offen  lds
s_add_u32 m0, s46, 118784
s_nop 0
buffer_load_dwordx4 v13, s[20:23], s44 offen  lds
s_barrier
s_mov_b32 s44, 1105920
s_mov_b32 s45, 640
s_add_u32 m0, s47, 32768
s_nop 0
buffer_load_dwordx4 v1, s[16:19], s45 offen  lds
s_add_u32 m0, s47, 33792
s_nop 0
buffer_load_dwordx4 v2, s[16:19], s45 offen  lds
s_add_u32 m0, s47, 34816
s_nop 0
buffer_load_dwordx4 v3, s[16:19], s45 offen  lds
s_add_u32 m0, s47, 35840
s_nop 0
buffer_load_dwordx4 v4, s[16:19], s45 offen  lds
s_add_u32 m0, s46, 122880
s_nop 0
buffer_load_dwordx4 v5, s[20:23], s44 offen  lds
s_add_u32 m0, s46, 126976
s_nop 0
buffer_load_dwordx4 v6, s[20:23], s44 offen  lds
s_add_u32 m0, s46, 131072
s_nop 0
buffer_load_dwordx4 v7, s[20:23], s44 offen  lds
s_add_u32 m0, s46, 135168
s_nop 0
buffer_load_dwordx4 v8, s[20:23], s44 offen  lds
s_add_u32 m0, s46, 139264
s_nop 0
buffer_load_dwordx4 v9, s[20:23], s44 offen  lds
s_waitcnt vmcnt(9)
s_barrier
s_add_u32 m0, s46, 143360
s_nop 0
buffer_load_dwordx4 v10, s[20:23], s44 offen  lds
s_add_u32 m0, s46, 147456
s_nop 0
buffer_load_dwordx4 v11, s[20:23], s44 offen  lds
s_add_u32 m0, s46, 151552
s_nop 0
buffer_load_dwordx4 v12, s[20:23], s44 offen  lds
s_add_u32 m0, s46, 155648
s_nop 0
buffer_load_dwordx4 v13, s[20:23], s44 offen  lds
s_barrier
s_mov_b32 s44, 1327104
s_mov_b32 s45, 768
s_add_u32 m0, s47, 0
s_nop 0
buffer_load_dwordx4 v1, s[16:19], s45 offen  lds
s_add_u32 m0, s47, 1024
s_nop 0
buffer_load_dwordx4 v2, s[16:19], s45 offen  lds
s_add_u32 m0, s47, 2048
s_nop 0
buffer_load_dwordx4 v3, s[16:19], s45 offen  lds
s_add_u32 m0, s47, 3072
s_nop 0
buffer_load_dwordx4 v4, s[16:19], s45 offen  lds
s_add_u32 m0, s46, 49152
s_nop 0
buffer_load_dwordx4 v5, s[20:23], s44 offen  lds
s_add_u32 m0, s46, 53248
s_nop 0
buffer_load_dwordx4 v6, s[20:23], s44 offen  lds
s_add_u32 m0, s46, 57344
s_nop 0
buffer_load_dwordx4 v7, s[20:23], s44 offen  lds
s_add_u32 m0, s46, 61440
s_nop 0
buffer_load_dwordx4 v8, s[20:23], s44 offen  lds
s_add_u32 m0, s46, 65536
s_nop 0
buffer_load_dwordx4 v9, s[20:23], s44 offen  lds
s_waitcnt vmcnt(9)
s_barrier
s_add_u32 m0, s46, 69632
s_nop 0
buffer_load_dwordx4 v10, s[20:23], s44 offen  lds
s_add_u32 m0, s46, 73728
s_nop 0
buffer_load_dwordx4 v11, s[20:23], s44 offen  lds
s_add_u32 m0, s46, 77824
s_nop 0
buffer_load_dwordx4 v12, s[20:23], s44 offen  lds
s_add_u32 m0, s46, 81920
s_nop 0
buffer_load_dwordx4 v13, s[20:23], s44 offen  lds
s_barrier
s_mov_b32 s44, 1548288
s_mov_b32 s45, 896
s_add_u32 m0, s47, 16384
s_nop 0
buffer_load_dwordx4 v1, s[16:19], s45 offen  lds
s_add_u32 m0, s47, 17408
s_nop 0
buffer_load_dwordx4 v2, s[16:19], s45 offen  lds
s_add_u32 m0, s47, 18432
s_nop 0
buffer_load_dwordx4 v3, s[16:19], s45 offen  lds
s_add_u32 m0, s47, 19456
s_nop 0
buffer_load_dwordx4 v4, s[16:19], s45 offen  lds
s_add_u32 m0, s46, 86016
s_nop 0
buffer_load_dwordx4 v5, s[20:23], s44 offen  lds
s_add_u32 m0, s46, 90112
s_nop 0
buffer_load_dwordx4 v6, s[20:23], s44 offen  lds
s_add_u32 m0, s46, 94208
s_nop 0
buffer_load_dwordx4 v7, s[20:23], s44 offen  lds
s_add_u32 m0, s46, 98304
s_nop 0
buffer_load_dwordx4 v8, s[20:23], s44 offen  lds
s_add_u32 m0, s46, 102400
s_nop 0
buffer_load_dwordx4 v9, s[20:23], s44 offen  lds
s_waitcnt vmcnt(9)
s_barrier
s_add_u32 m0, s46, 106496
s_nop 0
buffer_load_dwordx4 v10, s[20:23], s44 offen  lds
s_add_u32 m0, s46, 110592
s_nop 0
buffer_load_dwordx4 v11, s[20:23], s44 offen  lds
s_add_u32 m0, s46, 114688
s_nop 0
buffer_load_dwordx4 v12, s[20:23], s44 offen  lds
s_add_u32 m0, s46, 118784
s_nop 0
buffer_load_dwordx4 v13, s[20:23], s44 offen  lds
s_barrier
s_mov_b32 s44, 1769472
s_mov_b32 s45, 1024
s_add_u32 m0, s47, 32768
s_nop 0
buffer_load_dwordx4 v1, s[16:19], s45 offen  lds
s_add_u32 m0, s47, 33792
s_nop 0
buffer_load_dwordx4 v2, s[16:19], s45 offen  lds
s_add_u32 m0, s47, 34816
s_nop 0
buffer_load_dwordx4 v3, s[16:19], s45 offen  lds
s_add_u32 m0, s47, 35840
s_nop 0
buffer_load_dwordx4 v4, s[16:19], s45 offen  lds
s_add_u32 m0, s46, 122880
s_nop 0
buffer_load_dwordx4 v5, s[20:23], s44 offen  lds
s_add_u32 m0, s46, 126976
s_nop 0
buffer_load_dwordx4 v6, s[20:23], s44 offen  lds
s_add_u32 m0, s46, 131072
s_nop 0
buffer_load_dwordx4 v7, s[20:23], s44 offen  lds
s_add_u32 m0, s46, 135168
s_nop 0
buffer_load_dwordx4 v8, s[20:23], s44 offen  lds
s_add_u32 m0, s46, 139264
s_nop 0
buffer_load_dwordx4 v9, s[20:23], s44 offen  lds
s_waitcnt vmcnt(9)
s_barrier
s_add_u32 m0, s46, 143360
s_nop 0
buffer_load_dwordx4 v10, s[20:23], s44 offen  lds
s_add_u32 m0, s46, 147456
s_nop 0
buffer_load_dwordx4 v11, s[20:23], s44 offen  lds
s_add_u32 m0, s46, 151552
s_nop 0
buffer_load_dwordx4 v12, s[20:23], s44 offen  lds
s_add_u32 m0, s46, 155648
s_nop 0
buffer_load_dwordx4 v13, s[20:23], s44 offen  lds
s_waitcnt vmcnt(0)
s_barrier
s_branch L_p2H
.p2align 12
L_C:
v_and_b32 v13, 15, v0
v_lshrrev_b32 v14, 4, v0
v_lshrrev_b32 v9, 1, v13
v_xor_b32 v9, v9, v14
v_lshlrev_b32_e64 v10, 7, v13
v_lshl_add_u32 v1, v9, 4, v10
v_bfe_u32 v11, v0, 2, 2
v_and_b32 v12, 3, v0
s_cmp_ge_u32 s41, 16
s_cbranch_scc1 L_V
s_and_b32 s53, s52, 1
s_lshr_b32 s54, s52, 1
s_lshl_b32 s42, s53, 13
v_add_u32 v1, s42, v1
v_xor_b32 v2, 64, v1
v_lshl_add_u32 v9, v14, 3, v11
v_mul_u32_u24 v9, 576, v9
v_add_u32 v9, 49152, v9
v_mul_u32_u24 v10, 72, v12
s_mul_i32 s42, s54, 288
v_add_u32 v10, s42, v10
v_and_b32 v11, 1, v14
v_lshlrev_b32 v11, 5, v11
v_add_u32 v10, v10, v11
v_add_u32_e64 v9, v9, v10
v_add_u32 v11, 4294966720, v9
v_cmp_eq_u32 vcc, 536, v10
s_nop 1
v_cndmask_b32 v10, v9, v11, vcc
v_add_u32 v3, 0, v9
v_add_u32 v4, 0, v10
v_add_u32 v5, 36864, v9
v_add_u32 v6, 36864, v10
v_add_u32 v7, 73728, v9
v_add_u32 v8, 73728, v10
s_waitcnt lgkmcnt(0)
s_lshl_b32 s40, s2, 2
s_add_u32 s40, s40, s52
s_mul_i32 s41, s40, 2304
s_add_u32 s41, s41, 0
s_add_u32 s16, s4, s41
s_addc_u32 s17, s5, 0
s_min_u32 s41, s40, 863
s_cmp_lt_u32 s41, 432
s_cselect_b32 s18, s6, s8
s_cselect_b32 s19, s7, s9
s_cselect_b32 s42, 0, 432
s_sub_u32 s41, s41, s42
s_lshl_b32 s42, s41, 9
s_add_u32 s42, s42, 0
s_add_u32 s18, s18, s42
s_addc_u32 s19, s19, 0
s_sub_u32 s18, s18, 256
s_subb_u32 s19, s19, 0
s_min_u32 s41, s40, 575
s_cmp_lt_u32 s41, 288
s_cselect_b32 s20, s20, s22
s_cselect_b32 s21, s21, s23
s_cselect_b32 s42, 0, 288
s_sub_u32 s41, s41, s42
s_mul_i32 s42, s41, 2304
s_add_u32 s20, s20, s42
s_addc_u32 s21, s21, 0
s_sub_u32 s20, s20, 768
s_subb_u32 s21, s21, 0
v_min_u32 v9, 7, v0
v_mul_u32_u24 v10, 1152, v9
v_lshlrev_b32_e64 v9, 7, v9
v_cmp_gt_u32 vcc, 2, v0
v_cmp_gt_u32 s[22:23], 6, v0
s_nop 0
v_cndmask_b32 v9, v9, v10, vcc
v_mov_b32 v16, s20
v_mov_b32 v10, s18
v_cndmask_b32 v16, v16, v10, s[22:23]
v_mov_b32 v10, s16
v_cndmask_b32 v16, v16, v10, vcc
v_mov_b32 v17, s21
v_mov_b32 v10, s19
v_cndmask_b32 v17, v17, v10, s[22:23]
v_mov_b32 v10, s17
v_cndmask_b32 v17, v17, v10, vcc
v_mov_b32 v18, 256
v_mov_b32 v10, 221184
v_cndmask_b32 v18, v18, v10, s[22:23]
v_mov_b32 v10, 128
v_cndmask_b32 v18, v18, v10, vcc
v_add_co_u32 v16, vcc, v16, v9
s_nop 1
v_addc_co_u32 v17, vcc, 0, v17, vcc
global_load_dword v19, v[16:17], off
v_add_co_u32 v16, vcc, v16, v18
s_nop 1
v_addc_co_u32 v17, vcc, 0, v17, vcc
global_load_dword v19, v[16:17], off
v_add_co_u32 v16, vcc, v16, v18
s_nop 1
v_addc_co_u32 v17, vcc, 0, v17, vcc
global_load_dword v19, v[16:17], off
v_add_co_u32 v16, vcc, v16, v18
s_nop 1
v_addc_co_u32 v17, vcc, 0, v17, vcc
global_load_dword v19, v[16:17], off
v_add_co_u32 v16, vcc, v16, v18
s_nop 1
v_addc_co_u32 v17, vcc, 0, v17, vcc
s_or_b32 s42, s2, s3
s_cmp_lg_u32 s42, 0
s_cbranch_scc1 L_notag
s_add_u32 s56, s14, 15343616
s_addc_u32 s57, s15, 0
s_load_dword s42, s[56:57], 0
v_mov_b32 v10, 0
s_waitcnt lgkmcnt(0)
s_add_u32 s42, s42, 1
s_max_u32 s42, s42, 1
v_mov_b32_e64 v9, s42
global_store_dword v10, v9, s[96:97] sc1
global_store_dword v10, v9, s[56:57] sc1
L_notag:
L_pdR0_0:
s_cbranch_execz L_pdR0_1
s_mov_b32 s43, 2432
s_mov_b32 s26, 4980736
s_mov_b32 s42, 4718592
s_mov_b32 s62, 1051597459
s_mov_b32 s63, 1051597459
s_cmp_eq_u32 s38, 2
s_cselect_b32 s42, 4719744, s42
s_cselect_b32 s26, 4979584, s26
s_cmp_eq_u32 s38, 0
s_cselect_b32 s42, 0, s42
s_cselect_b32 s43, 1152, s43
s_cselect_b32 s26, 2359296, s26
s_cmp_eq_u32 s38, 3
s_cselect_b32 s62, 1069066811, s62
s_cselect_b32 s63, 1069066811, s63
s_cselect_b32 s42, 2359296, s42
s_cselect_b32 s43, 1152, s43
s_cselect_b32 s26, 2359296, s26
s_add_u32 s24, s14, s42
s_addc_u32 s25, s15, 0
s_mov_b32 s27, 0x20000
s_lshl_b32 s40, s39, 10
s_lshl_b32 s41, s54, 9
s_add_u32 s40, s40, s41
s_lshl_b32 s41, s37, 2
s_add_u32 s40, s40, s41
s_lshl_b32 s41, s53, 1
s_add_u32 s40, s40, s41
s_mul_i32 s56, s40, s43
s_lshl_b32 s40, s43, 6
s_add_u32 s57, s56, s40
v_lshlrev_b32 v9, 7, v14
v_lshrrev_b32 v10, 3, v13
v_add_u32 v9, v9, v10
v_mul_lo_u32 v9, v9, s43
v_and_b32_e64 v10, 7, v0
v_lshl_add_u32 v244, v10, 4, v9
v_xor_b32_e64 v245, 64, v244
v_mov_b32 v229, 0x3f80
v_mov_b32 v231, 0x3f80
v_mov_b32 v233, 0x3f80
v_mov_b32 v235, 0x3f80
v_mov_b32 v237, 0x3f80
v_mov_b32 v239, 0x3f80
v_mov_b32 v241, 0x3f80
v_mov_b32 v243, 0x3f80
s_and_b32 s40, s2, 7
s_lshr_b32 s41, s2, 3
s_mul_i32 s40, s40, 30
s_add_u32 s40, s40, s41
s_cmp_lt_u32 s41, 30
s_cselect_b32 s40, s40, 255
s_cmp_lt_u32 s40, 234
s_cselect_b32 s30, 1, 0
s_cselect_b32 s40, s40, 0
s_mul_i32 s28, s40, 7282
s_lshr_b32 s28, s28, 16
s_mul_i32 s41, s28, 9
s_sub_u32 s29, s40, s41
s_mul_i32 s28, s28, 9
s_add_u32 s28, s28, s29
s_lshl_b32 s28, s28, 8
s_add_u32 s28, s28, 65536
s_and_b32 s40, s2, 7
s_lshr_b32 s41, s2, 3
s_and_b32 s29, s40, 1
s_lshl_b32 s29, s29, 4
s_lshr_b32 s42, s41, 1
s_add_u32 s29, s29, s42
s_and_b32 s30, s40, 6
s_and_b32 s41, s41, 1
s_add_u32 s30, s30, s41
s_lshl_b32 s30, s30, 5
s_add_u32 s29, s29, s30
s_lshl_b32 s29, s29, 8
s_add_u32 s16, s14, 15347712
s_addc_u32 s17, s15, 0
s_mov_b32 s18, 196608
s_mov_b32 s19, 0x20000
v_and_b32 v9, 1, v0
v_lshlrev_b32 v9, 7, v9
v_bfe_u32 v10, v0, 1, 1
v_lshl_add_u32 v10, v10, 16, s28
v_mov_b32 v11, s29
v_cmp_gt_u32 vcc, 4, v0
s_nop 1
v_cndmask_b32 v10, v11, v10, vcc
v_add_u32_e64 v9, v9, v10
s_cmp_lg_u32 s52, 1
s_cbranch_scc1 L_nmb0
buffer_load_dword v19, v9, s[16:19], 0 offen
L_nmb0:
s_mov_b32 s16, s10
s_mov_b32 s17, s11
s_mov_b32 s18, 20736
s_mov_b32 s19, 0x20000
v_add_u32_e64 v9, 0, v0
v_mul_u32_u24 v10, 6554, v9
v_lshrrev_b32 v10, 16, v10
v_mul_u32_u24 v20, 10, v10
v_sub_u32 v20, v9, v20
v_cmp_eq_u32 vcc, 9, v20
v_sub_u32 v9, v9, v10
v_lshlrev_b32 v9, 2, v9
v_mov_b32 v10, s58
v_cndmask_b32 v20, v9, v10, vcc
v_add_u32_e64 v9, 64, v0
v_mul_u32_u24 v10, 6554, v9
v_lshrrev_b32 v10, 16, v10
v_mul_u32_u24 v21, 10, v10
v_sub_u32 v21, v9, v21
v_cmp_eq_u32 vcc, 9, v21
v_sub_u32 v9, v9, v10
v_lshlrev_b32 v9, 2, v9
v_mov_b32 v10, s58
v_cndmask_b32 v21, v9, v10, vcc
v_add_u32 v9, 128, v0
v_mul_u32_u24 v10, 6554, v9
v_lshrrev_b32 v10, 16, v10
v_mul_u32_u24 v22, 10, v10
v_sub_u32 v22, v9, v22
v_cmp_eq_u32 vcc, 9, v22
v_sub_u32 v9, v9, v10
v_lshlrev_b32 v9, 2, v9
v_mov_b32 v10, s58
v_cndmask_b32 v22, v9, v10, vcc
v_cmp_lt_u32 vcc, 51, v0
s_nop 1
v_cndmask_b32_e64 v22, v22, v10, vcc
s_and_b32 s40, s2, 1
s_lshl_b32 s40, s40, 4
s_lshr_b32 s41, s2, 4
s_add_u32 s40, s40, s41
s_mul_i32 s40, s40, 648
s_cmp_eq_u32 s52, 0
s_cselect_b32 s41, 0, 768
s_cselect_b32 s18, s18, 0
s_add_u32 m0, s41, 162048
s_nop 0
buffer_load_dword v20, s[16:19], s40 offen lds
s_add_u32 m0, s41, 162304
s_nop 0
buffer_load_dword v21, s[16:19], s40 offen lds
s_add_u32 m0, s41, 162560
s_nop 0
buffer_load_dword v22, s[16:19], s40 offen lds
s_mov_b64 exec, 0
s_cmp_eq_u32 s52, 0
s_cbranch_scc1 L_pdR0_0
s_cmp_eq_u32 s52, 1
s_cbranch_scc1 L_pdR1_0
s_cmp_eq_u32 s52, 2
s_cbranch_scc1 L_pdR2_0
s_branch L_pdR3_0
L_retR:
s_mov_b64 exec, -1
s_barrier
ds_read_b128 v[20:23], v1 offset:0
ds_read_b128 v[24:27], v1 offset:2048
ds_read_b128 v[28:31], v1 offset:4096
ds_read_b128 v[32:35], v1 offset:6144
ds_read_b64_tr_b16 v[68:69], v3 offset:0
ds_read_b64_tr_b16 v[70:71], v3 offset:2304
ds_read_b64_tr_b16 v[72:73], v3 offset:8
ds_read_b64_tr_b16 v[74:75], v3 offset:2312
ds_read_b64_tr_b16 v[76:77], v3 offset:16
ds_read_b64_tr_b16 v[78:79], v3 offset:2320
s_waitcnt lgkmcnt(4)
v_mfma_f32_16x16x32_bf16 v[84:87], v[68:71], v[20:23], 0
ds_read_b64_tr_b16 v[80:81], v3 offset:24
v_mfma_f32_16x16x32_bf16 v[120:123], v[68:71], v[24:27], 0
ds_read_b64_tr_b16 v[82:83], v3 offset:2328
v_mfma_f32_16x16x32_bf16 v[156:159], v[68:71], v[28:31], 0
v_mfma_f32_16x16x32_bf16 v[192:195], v[68:71], v[32:35], 0
s_waitcnt lgkmcnt(4)
v_mfma_f32_16x16x32_bf16 v[88:91], v[72:75], v[20:23], 0
ds_read_b64_tr_b16 v[68:69], v3 offset:32
v_mfma_f32_16x16x32_bf16 v[124:127], v[72:75], v[24:27], 0
ds_read_b64_tr_b16 v[70:71], v3 offset:2336
v_mfma_f32_16x16x32_bf16 v[160:163], v[72:75], v[28:31], 0
v_mfma_f32_16x16x32_bf16 v[196:199], v[72:75], v[32:35], 0
s_waitcnt lgkmcnt(4)
v_mfma_f32_16x16x32_bf16 v[92:95], v[76:79], v[20:23], 0
ds_read_b64_tr_b16 v[72:73], v4 offset:40
v_mfma_f32_16x16x32_bf16 v[128:131], v[76:79], v[24:27], 0
ds_read_b64_tr_b16 v[74:75], v4 offset:2344
v_mfma_f32_16x16x32_bf16 v[164:167], v[76:79], v[28:31], 0
v_mfma_f32_16x16x32_bf16 v[200:203], v[76:79], v[32:35], 0
s_waitcnt lgkmcnt(4)
v_mfma_f32_16x16x32_bf16 v[96:99], v[80:83], v[20:23], 0
ds_read_b64_tr_b16 v[76:77], v4 offset:48
v_mfma_f32_16x16x32_bf16 v[132:135], v[80:83], v[24:27], 0
ds_read_b64_tr_b16 v[78:79], v4 offset:2352
v_mfma_f32_16x16x32_bf16 v[168:171], v[80:83], v[28:31], 0
v_mfma_f32_16x16x32_bf16 v[204:207], v[80:83], v[32:35], 0
s_waitcnt lgkmcnt(4)
v_mfma_f32_16x16x32_bf16 v[100:103], v[68:71], v[20:23], 0
ds_read_b64_tr_b16 v[80:81], v4 offset:56
v_mfma_f32_16x16x32_bf16 v[136:139], v[68:71], v[24:27], 0
ds_read_b64_tr_b16 v[82:83], v4 offset:2360
v_mfma_f32_16x16x32_bf16 v[172:175], v[68:71], v[28:31], 0
v_mfma_f32_16x16x32_bf16 v[208:211], v[68:71], v[32:35], 0
s_waitcnt lgkmcnt(4)
v_mfma_f32_16x16x32_bf16 v[104:107], v[72:75], v[20:23], 0
ds_read_b64_tr_b16 v[68:69], v4 offset:64
v_mfma_f32_16x16x32_bf16 v[140:143], v[72:75], v[24:27], 0
ds_read_b64_tr_b16 v[70:71], v4 offset:2368
v_mfma_f32_16x16x32_bf16 v[176:179], v[72:75], v[28:31], 0
v_mfma_f32_16x16x32_bf16 v[212:215], v[72:75], v[32:35], 0
s_waitcnt lgkmcnt(4)
v_mfma_f32_16x16x32_bf16 v[108:111], v[76:79], v[20:23], 0
s_barrier
ds_read_b128 v[36:39], v2 offset:0
v_mfma_f32_16x16x32_bf16 v[144:147], v[76:79], v[24:27], 0
ds_read_b128 v[40:43], v2 offset:2048
ds_read_b128 v[44:47], v2 offset:4096
v_mfma_f32_16x16x32_bf16 v[180:183], v[76:79], v[28:31], 0
ds_read_b128 v[48:51], v2 offset:6144
ds_read_b64_tr_b16 v[72:73], v3 offset:18432
v_mfma_f32_16x16x32_bf16 v[216:219], v[76:79], v[32:35], 0
ds_read_b64_tr_b16 v[74:75], v3 offset:20736
s_waitcnt lgkmcnt(8)
v_mfma_f32_16x16x32_bf16 v[112:115], v[80:83], v[20:23], 0
ds_read_b64_tr_b16 v[76:77], v3 offset:18440
v_mfma_f32_16x16x32_bf16 v[148:151], v[80:83], v[24:27], 0
ds_read_b64_tr_b16 v[78:79], v3 offset:20744
v_mfma_f32_16x16x32_bf16 v[184:187], v[80:83], v[28:31], 0
v_mfma_f32_16x16x32_bf16 v[220:223], v[80:83], v[32:35], 0
s_waitcnt lgkmcnt(8)
v_mfma_f32_16x16x32_bf16 v[116:119], v[68:71], v[20:23], 0
ds_read_b64_tr_b16 v[80:81], v3 offset:18448
v_mfma_f32_16x16x32_bf16 v[152:155], v[68:71], v[24:27], 0
ds_read_b64_tr_b16 v[82:83], v3 offset:20752
v_mfma_f32_16x16x32_bf16 v[188:191], v[68:71], v[28:31], 0
v_mfma_f32_16x16x32_bf16 v[224:227], v[68:71], v[32:35], 0
s_waitcnt lgkmcnt(4)
v_mfma_f32_16x16x32_bf16 v[84:87], v[72:75], v[36:39], v[84:87]
ds_read_b64_tr_b16 v[68:69], v3 offset:18456
v_mfma_f32_16x16x32_bf16 v[120:123], v[72:75], v[40:43], v[120:123]
ds_read_b64_tr_b16 v[70:71], v3 offset:20760
v_mfma_f32_16x16x32_bf16 v[156:159], v[72:75], v[44:47], v[156:159]
v_mfma_f32_16x16x32_bf16 v[192:195], v[72:75], v[48:51], v[192:195]
s_waitcnt lgkmcnt(4)
v_mfma_f32_16x16x32_bf16 v[88:91], v[76:79], v[36:39], v[88:91]
ds_read_b64_tr_b16 v[72:73], v3 offset:18464
v_mfma_f32_16x16x32_bf16 v[124:127], v[76:79], v[40:43], v[124:127]
ds_read_b64_tr_b16 v[74:75], v3 offset:20768
v_mfma_f32_16x16x32_bf16 v[160:163], v[76:79], v[44:47], v[160:163]
v_mfma_f32_16x16x32_bf16 v[196:199], v[76:79], v[48:51], v[196:199]
s_waitcnt lgkmcnt(4)
v_mfma_f32_16x16x32_bf16 v[92:95], v[80:83], v[36:39], v[92:95]
ds_read_b64_tr_b16 v[76:77], v4 offset:18472
v_mfma_f32_16x16x32_bf16 v[128:131], v[80:83], v[40:43], v[128:131]
ds_read_b64_tr_b16 v[78:79], v4 offset:20776
v_mfma_f32_16x16x32_bf16 v[164:167], v[80:83], v[44:47], v[164:167]
v_mfma_f32_16x16x32_bf16 v[200:203], v[80:83], v[48:51], v[200:203]
s_waitcnt lgkmcnt(4)
v_mfma_f32_16x16x32_bf16 v[96:99], v[68:71], v[36:39], v[96:99]
ds_read_b64_tr_b16 v[80:81], v4 offset:18480
v_mfma_f32_16x16x32_bf16 v[132:135], v[68:71], v[40:43], v[132:135]
ds_read_b64_tr_b16 v[82:83], v4 offset:20784
v_mfma_f32_16x16x32_bf16 v[168:171], v[68:71], v[44:47], v[168:171]
v_mfma_f32_16x16x32_bf16 v[204:207], v[68:71], v[48:51], v[204:207]
s_waitcnt lgkmcnt(4)
v_mfma_f32_16x16x32_bf16 v[100:103], v[72:75], v[36:39], v[100:103]
ds_read_b64_tr_b16 v[68:69], v4 offset:18488
v_mfma_f32_16x16x32_bf16 v[136:139], v[72:75], v[40:43], v[136:139]
ds_read_b64_tr_b16 v[70:71], v4 offset:20792
v_mfma_f32_16x16x32_bf16 v[172:175], v[72:75], v[44:47], v[172:175]
v_mfma_f32_16x16x32_bf16 v[208:211], v[72:75], v[48:51], v[208:211]
s_waitcnt lgkmcnt(4)
v_mfma_f32_16x16x32_bf16 v[104:107], v[76:79], v[36:39], v[104:107]
ds_read_b64_tr_b16 v[72:73], v4 offset:18496
v_mfma_f32_16x16x32_bf16 v[140:143], v[76:79], v[40:43], v[140:143]
ds_read_b64_tr_b16 v[74:75], v4 offset:20800
v_mfma_f32_16x16x32_bf16 v[176:179], v[76:79], v[44:47], v[176:179]
v_mfma_f32_16x16x32_bf16 v[212:215], v[76:79], v[48:51], v[212:215]
s_waitcnt lgkmcnt(4)
v_mfma_f32_16x16x32_bf16 v[108:111], v[80:83], v[36:39], v[108:111]
s_barrier
ds_read_b128 v[20:23], v1 offset:16384
v_mfma_f32_16x16x32_bf16 v[144:147], v[80:83], v[40:43], v[144:147]
ds_read_b128 v[24:27], v1 offset:18432
ds_read_b128 v[28:31], v1 offset:20480
v_mfma_f32_16x16x32_bf16 v[180:183], v[80:83], v[44:47], v[180:183]
ds_read_b128 v[32:35], v1 offset:22528
ds_read_b64_tr_b16 v[76:77], v5 offset:0
v_mfma_f32_16x16x32_bf16 v[216:219], v[80:83], v[48:51], v[216:219]
ds_read_b64_tr_b16 v[78:79], v5 offset:2304
s_waitcnt lgkmcnt(8)
v_mfma_f32_16x16x32_bf16 v[112:115], v[68:71], v[36:39], v[112:115]
ds_read_b64_tr_b16 v[80:81], v5 offset:8
v_mfma_f32_16x16x32_bf16 v[148:151], v[68:71], v[40:43], v[148:151]
ds_read_b64_tr_b16 v[82:83], v5 offset:2312
v_mfma_f32_16x16x32_bf16 v[184:187], v[68:71], v[44:47], v[184:187]
v_mfma_f32_16x16x32_bf16 v[220:223], v[68:71], v[48:51], v[220:223]
s_waitcnt lgkmcnt(8)
v_mfma_f32_16x16x32_bf16 v[116:119], v[72:75], v[36:39], v[116:119]
ds_read_b64_tr_b16 v[68:69], v5 offset:16
v_mfma_f32_16x16x32_bf16 v[152:155], v[72:75], v[40:43], v[152:155]
ds_read_b64_tr_b16 v[70:71], v5 offset:2320
v_mfma_f32_16x16x32_bf16 v[188:191], v[72:75], v[44:47], v[188:191]
v_mfma_f32_16x16x32_bf16 v[224:227], v[72:75], v[48:51], v[224:227]
s_barrier
global_load_dword v19, v[16:17], off
v_add_co_u32 v16, vcc, v16, v18
s_nop 1
v_addc_co_u32 v17, vcc, 0, v17, vcc
s_waitcnt lgkmcnt(4)
v_mfma_f32_16x16x32_bf16 v[84:87], v[76:79], v[20:23], v[84:87]
ds_read_b64_tr_b16 v[72:73], v5 offset:24
v_mfma_f32_16x16x32_bf16 v[120:123], v[76:79], v[24:27], v[120:123]
ds_read_b64_tr_b16 v[74:75], v5 offset:2328
v_mfma_f32_16x16x32_bf16 v[156:159], v[76:79], v[28:31], v[156:159]
v_mfma_f32_16x16x32_bf16 v[192:195], v[76:79], v[32:35], v[192:195]
s_waitcnt lgkmcnt(4)
v_mfma_f32_16x16x32_bf16 v[88:91], v[80:83], v[20:23], v[88:91]
ds_read_b64_tr_b16 v[76:77], v5 offset:32
v_mfma_f32_16x16x32_bf16 v[124:127], v[80:83], v[24:27], v[124:127]
ds_read_b64_tr_b16 v[78:79], v5 offset:2336
v_mfma_f32_16x16x32_bf16 v[160:163], v[80:83], v[28:31], v[160:163]
v_mfma_f32_16x16x32_bf16 v[196:199], v[80:83], v[32:35], v[196:199]
s_waitcnt lgkmcnt(4)
v_mfma_f32_16x16x32_bf16 v[92:95], v[68:71], v[20:23], v[92:95]
ds_read_b64_tr_b16 v[80:81], v6 offset:40
v_mfma_f32_16x16x32_bf16 v[128:131], v[68:71], v[24:27], v[128:131]
ds_read_b64_tr_b16 v[82:83], v6 offset:2344
v_mfma_f32_16x16x32_bf16 v[164:167], v[68:71], v[28:31], v[164:167]
v_mfma_f32_16x16x32_bf16 v[200:203], v[68:71], v[32:35], v[200:203]
s_waitcnt lgkmcnt(4)
v_mfma_f32_16x16x32_bf16 v[96:99], v[72:75], v[20:23], v[96:99]
ds_read_b64_tr_b16 v[68:69], v6 offset:48
v_mfma_f32_16x16x32_bf16 v[132:135], v[72:75], v[24:27], v[132:135]
ds_read_b64_tr_b16 v[70:71], v6 offset:2352
v_mfma_f32_16x16x32_bf16 v[168:171], v[72:75], v[28:31], v[168:171]
v_mfma_f32_16x16x32_bf16 v[204:207], v[72:75], v[32:35], v[204:207]
s_waitcnt lgkmcnt(4)
v_mfma_f32_16x16x32_bf16 v[100:103], v[76:79], v[20:23], v[100:103]
ds_read_b64_tr_b16 v[72:73], v6 offset:56
v_mfma_f32_16x16x32_bf16 v[136:139], v[76:79], v[24:27], v[136:139]
ds_read_b64_tr_b16 v[74:75], v6 offset:2360
v_mfma_f32_16x16x32_bf16 v[172:175], v[76:79], v[28:31], v[172:175]
v_mfma_f32_16x16x32_bf16 v[208:211], v[76:79], v[32:35], v[208:211]
s_waitcnt lgkmcnt(4)
v_mfma_f32_16x16x32_bf16 v[104:107], v[80:83], v[20:23], v[104:107]
ds_read_b64_tr_b16 v[76:77], v6 offset:64
v_mfma_f32_16x16x32_bf16 v[140:143], v[80:83], v[24:27], v[140:143]
ds_read_b64_tr_b16 v[78:79], v6 offset:2368
v_mfma_f32_16x16x32_bf16 v[176:179], v[80:83], v[28:31], v[176:179]
v_mfma_f32_16x16x32_bf16 v[212:215], v[80:83], v[32:35], v[212:215]
s_waitcnt lgkmcnt(4)
v_mfma_f32_16x16x32_bf16 v[108:111], v[68:71], v[20:23], v[108:111]
s_barrier
ds_read_b128 v[36:39], v2 offset:16384
v_mfma_f32_16x16x32_bf16 v[144:147], v[68:71], v[24:27], v[144:147]
ds_read_b128 v[40:43], v2 offset:18432
ds_read_b128 v[44:47], v2 offset:20480
v_mfma_f32_16x16x32_bf16 v[180:183], v[68:71], v[28:31], v[180:183]
ds_read_b128 v[48:51], v2 offset:22528
ds_read_b64_tr_b16 v[80:81], v5 offset:18432
v_mfma_f32_16x16x32_bf16 v[216:219], v[68:71], v[32:35], v[216:219]
ds_read_b64_tr_b16 v[82:83], v5 offset:20736
s_waitcnt lgkmcnt(8)
v_mfma_f32_16x16x32_bf16 v[112:115], v[72:75], v[20:23], v[112:115]
ds_read_b64_tr_b16 v[68:69], v5 offset:18440
v_mfma_f32_16x16x32_bf16 v[148:151], v[72:75], v[24:27], v[148:151]
ds_read_b64_tr_b16 v[70:71], v5 offset:20744
v_mfma_f32_16x16x32_bf16 v[184:187], v[72:75], v[28:31], v[184:187]
v_mfma_f32_16x16x32_bf16 v[220:223], v[72:75], v[32:35], v[220:223]
s_waitcnt lgkmcnt(8)
v_mfma_f32_16x16x32_bf16 v[116:119], v[76:79], v[20:23], v[116:119]
ds_read_b64_tr_b16 v[72:73], v5 offset:18448
v_mfma_f32_16x16x32_bf16 v[152:155], v[76:79], v[24:27], v[152:155]
ds_read_b64_tr_b16 v[74:75], v5 offset:20752
v_mfma_f32_16x16x32_bf16 v[188:191], v[76:79], v[28:31], v[188:191]
v_mfma_f32_16x16x32_bf16 v[224:227], v[76:79], v[32:35], v[224:227]
s_waitcnt lgkmcnt(4)
v_mfma_f32_16x16x32_bf16 v[84:87], v[80:83], v[36:39], v[84:87]
ds_read_b64_tr_b16 v[76:77], v5 offset:18456
v_mfma_f32_16x16x32_bf16 v[120:123], v[80:83], v[40:43], v[120:123]
ds_read_b64_tr_b16 v[78:79], v5 offset:20760
v_mfma_f32_16x16x32_bf16 v[156:159], v[80:83], v[44:47], v[156:159]
v_mfma_f32_16x16x32_bf16 v[192:195], v[80:83], v[48:51], v[192:195]
s_waitcnt lgkmcnt(4)
v_mfma_f32_16x16x32_bf16 v[88:91], v[68:71], v[36:39], v[88:91]
ds_read_b64_tr_b16 v[80:81], v5 offset:18464
v_mfma_f32_16x16x32_bf16 v[124:127], v[68:71], v[40:43], v[124:127]
ds_read_b64_tr_b16 v[82:83], v5 offset:20768
v_mfma_f32_16x16x32_bf16 v[160:163], v[68:71], v[44:47], v[160:163]
v_mfma_f32_16x16x32_bf16 v[196:199], v[68:71], v[48:51], v[196:199]
s_waitcnt lgkmcnt(4)
v_mfma_f32_16x16x32_bf16 v[92:95], v[72:75], v[36:39], v[92:95]
ds_read_b64_tr_b16 v[68:69], v6 offset:18472
v_mfma_f32_16x16x32_bf16 v[128:131], v[72:75], v[40:43], v[128:131]
ds_read_b64_tr_b16 v[70:71], v6 offset:20776
v_mfma_f32_16x16x32_bf16 v[164:167], v[72:75], v[44:47], v[164:167]
v_mfma_f32_16x16x32_bf16 v[200:203], v[72:75], v[48:51], v[200:203]
s_waitcnt lgkmcnt(4)
v_mfma_f32_16x16x32_bf16 v[96:99], v[76:79], v[36:39], v[96:99]
ds_read_b64_tr_b16 v[72:73], v6 offset:18480
v_mfma_f32_16x16x32_bf16 v[132:135], v[76:79], v[40:43], v[132:135]
ds_read_b64_tr_b16 v[74:75], v6 offset:20784
v_mfma_f32_16x16x32_bf16 v[168:171], v[76:79], v[44:47], v[168:171]
v_mfma_f32_16x16x32_bf16 v[204:207], v[76:79], v[48:51], v[204:207]
s_waitcnt lgkmcnt(4)
v_mfma_f32_16x16x32_bf16 v[100:103], v[80:83], v[36:39], v[100:103]
ds_read_b64_tr_b16 v[76:77], v6 offset:18488
v_mfma_f32_16x16x32_bf16 v[136:139], v[80:83], v[40:43], v[136:139]
ds_read_b64_tr_b16 v[78:79], v6 offset:20792
v_mfma_f32_16x16x32_bf16 v[172:175], v[80:83], v[44:47], v[172:175]
v_mfma_f32_16x16x32_bf16 v[208:211], v[80:83], v[48:51], v[208:211]
s_waitcnt lgkmcnt(4)
v_mfma_f32_16x16x32_bf16 v[104:107], v[68:71], v[36:39], v[104:107]
ds_read_b64_tr_b16 v[80:81], v6 offset:18496
v_mfma_f32_16x16x32_bf16 v[140:143], v[68:71], v[40:43], v[140:143]
ds_read_b64_tr_b16 v[82:83], v6 offset:20800
v_mfma_f32_16x16x32_bf16 v[176:179], v[68:71], v[44:47], v[176:179]
v_mfma_f32_16x16x32_bf16 v[212:215], v[68:71], v[48:51], v[212:215]
s_waitcnt lgkmcnt(4)
v_mfma_f32_16x16x32_bf16 v[108:111], v[72:75], v[36:39], v[108:111]
s_barrier
ds_read_b128 v[20:23], v1 offset:32768
v_mfma_f32_16x16x32_bf16 v[144:147], v[72:75], v[40:43], v[144:147]
ds_read_b128 v[24:27], v1 offset:34816
ds_read_b128 v[28:31], v1 offset:36864
v_mfma_f32_16x16x32_bf16 v[180:183], v[72:75], v[44:47], v[180:183]
ds_read_b128 v[32:35], v1 offset:38912
ds_read_b64_tr_b16 v[68:69], v7 offset:0
v_mfma_f32_16x16x32_bf16 v[216:219], v[72:75], v[48:51], v[216:219]
ds_read_b64_tr_b16 v[70:71], v7 offset:2304
s_waitcnt lgkmcnt(8)
v_mfma_f32_16x16x32_bf16 v[112:115], v[76:79], v[36:39], v[112:115]
ds_read_b64_tr_b16 v[72:73], v7 offset:8
v_mfma_f32_16x16x32_bf16 v[148:151], v[76:79], v[40:43], v[148:151]
ds_read_b64_tr_b16 v[74:75], v7 offset:2312
v_mfma_f32_16x16x32_bf16 v[184:187], v[76:79], v[44:47], v[184:187]
v_mfma_f32_16x16x32_bf16 v[220:223], v[76:79], v[48:51], v[220:223]
s_waitcnt lgkmcnt(8)
v_mfma_f32_16x16x32_bf16 v[116:119], v[80:83], v[36:39], v[116:119]
ds_read_b64_tr_b16 v[76:77], v7 offset:16
v_mfma_f32_16x16x32_bf16 v[152:155], v[80:83], v[40:43], v[152:155]
ds_read_b64_tr_b16 v[78:79], v7 offset:2320
v_mfma_f32_16x16x32_bf16 v[188:191], v[80:83], v[44:47], v[188:191]
v_mfma_f32_16x16x32_bf16 v[224:227], v[80:83], v[48:51], v[224:227]
s_barrier
global_load_dword v19, v[16:17], off
v_add_co_u32 v16, vcc, v16, v18
s_nop 1
v_addc_co_u32 v17, vcc, 0, v17, vcc
s_waitcnt lgkmcnt(4)
v_mfma_f32_16x16x32_bf16 v[84:87], v[68:71], v[20:23], v[84:87]
ds_read_b64_tr_b16 v[80:81], v7 offset:24
v_mfma_f32_16x16x32_bf16 v[120:123], v[68:71], v[24:27], v[120:123]
ds_read_b64_tr_b16 v[82:83], v7 offset:2328
v_mfma_f32_16x16x32_bf16 v[156:159], v[68:71], v[28:31], v[156:159]
v_mfma_f32_16x16x32_bf16 v[192:195], v[68:71], v[32:35], v[192:195]
s_waitcnt lgkmcnt(4)
v_mfma_f32_16x16x32_bf16 v[88:91], v[72:75], v[20:23], v[88:91]
ds_read_b64_tr_b16 v[68:69], v7 offset:32
v_mfma_f32_16x16x32_bf16 v[124:127], v[72:75], v[24:27], v[124:127]
ds_read_b64_tr_b16 v[70:71], v7 offset:2336
v_mfma_f32_16x16x32_bf16 v[160:163], v[72:75], v[28:31], v[160:163]
v_mfma_f32_16x16x32_bf16 v[196:199], v[72:75], v[32:35], v[196:199]
s_waitcnt lgkmcnt(4)
v_mfma_f32_16x16x32_bf16 v[92:95], v[76:79], v[20:23], v[92:95]
ds_read_b64_tr_b16 v[72:73], v8 offset:40
v_mfma_f32_16x16x32_bf16 v[128:131], v[76:79], v[24:27], v[128:131]
ds_read_b64_tr_b16 v[74:75], v8 offset:2344
v_mfma_f32_16x16x32_bf16 v[164:167], v[76:79], v[28:31], v[164:167]
v_mfma_f32_16x16x32_bf16 v[200:203], v[76:79], v[32:35], v[200:203]
s_waitcnt lgkmcnt(4)
v_mfma_f32_16x16x32_bf16 v[96:99], v[80:83], v[20:23], v[96:99]
ds_read_b64_tr_b16 v[76:77], v8 offset:48
v_mfma_f32_16x16x32_bf16 v[132:135], v[80:83], v[24:27], v[132:135]
ds_read_b64_tr_b16 v[78:79], v8 offset:2352
v_mfma_f32_16x16x32_bf16 v[168:171], v[80:83], v[28:31], v[168:171]
v_mfma_f32_16x16x32_bf16 v[204:207], v[80:83], v[32:35], v[204:207]
s_waitcnt lgkmcnt(4)
v_mfma_f32_16x16x32_bf16 v[100:103], v[68:71], v[20:23], v[100:103]
ds_read_b64_tr_b16 v[80:81], v8 offset:56
v_mfma_f32_16x16x32_bf16 v[136:139], v[68:71], v[24:27], v[136:139]
ds_read_b64_tr_b16 v[82:83], v8 offset:2360
v_mfma_f32_16x16x32_bf16 v[172:175], v[68:71], v[28:31], v[172:175]
v_mfma_f32_16x16x32_bf16 v[208:211], v[68:71], v[32:35], v[208:211]
s_waitcnt lgkmcnt(4)
v_mfma_f32_16x16x32_bf16 v[104:107], v[72:75], v[20:23], v[104:107]
ds_read_b64_tr_b16 v[68:69], v8 offset:64
v_mfma_f32_16x16x32_bf16 v[140:143], v[72:75], v[24:27], v[140:143]
ds_read_b64_tr_b16 v[70:71], v8 offset:2368
v_mfma_f32_16x16x32_bf16 v[176:179], v[72:75], v[28:31], v[176:179]
v_mfma_f32_16x16x32_bf16 v[212:215], v[72:75], v[32:35], v[212:215]
s_waitcnt lgkmcnt(4)
v_mfma_f32_16x16x32_bf16 v[108:111], v[76:79], v[20:23], v[108:111]
ds_read_b128 v[36:39], v2 offset:32768
ds_read_b128 v[40:43], v2 offset:34816
v_mfma_f32_16x16x32_bf16 v[144:147], v[76:79], v[24:27], v[144:147]
ds_read_b128 v[44:47], v2 offset:36864
ds_read_b128 v[48:51], v2 offset:38912
v_mfma_f32_16x16x32_bf16 v[180:183], v[76:79], v[28:31], v[180:183]
ds_read_b64_tr_b16 v[72:73], v7 offset:18432
v_mfma_f32_16x16x32_bf16 v[216:219], v[76:79], v[32:35], v[216:219]
ds_read_b64_tr_b16 v[74:75], v7 offset:20736
s_waitcnt lgkmcnt(8)
v_mfma_f32_16x16x32_bf16 v[112:115], v[80:83], v[20:23], v[112:115]
ds_read_b64_tr_b16 v[76:77], v7 offset:18440
v_mfma_f32_16x16x32_bf16 v[148:151], v[80:83], v[24:27], v[148:151]
ds_read_b64_tr_b16 v[78:79], v7 offset:20744
v_mfma_f32_16x16x32_bf16 v[184:187], v[80:83], v[28:31], v[184:187]
v_mfma_f32_16x16x32_bf16 v[220:223], v[80:83], v[32:35], v[220:223]
s_waitcnt lgkmcnt(8)
v_mfma_f32_16x16x32_bf16 v[116:119], v[68:71], v[20:23], v[116:119]
L_pdR1_0:
s_cbranch_execz L_pdR1_1
ds_read_b64_tr_b16 v[80:81], v7 offset:18448
v_mfma_f32_16x16x32_bf16 v[152:155], v[68:71], v[24:27], v[152:155]
ds_read_b64_tr_b16 v[82:83], v7 offset:20752
v_mfma_f32_16x16x32_bf16 v[188:191], v[68:71], v[28:31], v[188:191]
v_mfma_f32_16x16x32_bf16 v[224:227], v[68:71], v[32:35], v[224:227]
s_waitcnt lgkmcnt(4)
v_mfma_f32_16x16x32_bf16 v[84:87], v[72:75], v[36:39], v[84:87]
ds_read_b64_tr_b16 v[68:69], v7 offset:18456
v_mfma_f32_16x16x32_bf16 v[120:123], v[72:75], v[40:43], v[120:123]
ds_read_b64_tr_b16 v[70:71], v7 offset:20760
v_mfma_f32_16x16x32_bf16 v[156:159], v[72:75], v[44:47], v[156:159]
v_mfma_f32_16x16x32_bf16 v[192:195], v[72:75], v[48:51], v[192:195]
s_waitcnt lgkmcnt(4)
v_mfma_f32_16x16x32_bf16 v[88:91], v[76:79], v[36:39], v[88:91]
ds_read_b64_tr_b16 v[72:73], v7 offset:18464
v_mfma_f32_16x16x32_bf16 v[124:127], v[76:79], v[40:43], v[124:127]
ds_read_b64_tr_b16 v[74:75], v7 offset:20768
v_mfma_f32_16x16x32_bf16 v[160:163], v[76:79], v[44:47], v[160:163]
v_mfma_f32_16x16x32_bf16 v[196:199], v[76:79], v[48:51], v[196:199]
s_waitcnt lgkmcnt(4)
v_mfma_f32_16x16x32_bf16 v[92:95], v[80:83], v[36:39], v[92:95]
ds_read_b64_tr_b16 v[76:77], v8 offset:18472
v_mfma_f32_16x16x32_bf16 v[128:131], v[80:83], v[40:43], v[128:131]
ds_read_b64_tr_b16 v[78:79], v8 offset:20776
v_mfma_f32_16x16x32_bf16 v[164:167], v[80:83], v[44:47], v[164:167]
v_mfma_f32_16x16x32_bf16 v[200:203], v[80:83], v[48:51], v[200:203]
s_waitcnt lgkmcnt(4)
v_mfma_f32_16x16x32_bf16 v[96:99], v[68:71], v[36:39], v[96:99]
ds_read_b64_tr_b16 v[80:81], v8 offset:18480
v_mfma_f32_16x16x32_bf16 v[132:135], v[68:71], v[40:43], v[132:135]
ds_read_b64_tr_b16 v[82:83], v8 offset:20784
v_mfma_f32_16x16x32_bf16 v[168:171], v[68:71], v[44:47], v[168:171]
v_mfma_f32_16x16x32_bf16 v[204:207], v[68:71], v[48:51], v[204:207]
s_waitcnt lgkmcnt(4)
v_mfma_f32_16x16x32_bf16 v[100:103], v[72:75], v[36:39], v[100:103]
ds_read_b64_tr_b16 v[68:69], v8 offset:18488
v_mfma_f32_16x16x32_bf16 v[136:139], v[72:75], v[40:43], v[136:139]
ds_read_b64_tr_b16 v[70:71], v8 offset:20792
v_mfma_f32_16x16x32_bf16 v[172:175], v[72:75], v[44:47], v[172:175]
v_mfma_f32_16x16x32_bf16 v[208:211], v[72:75], v[48:51], v[208:211]
s_waitcnt lgkmcnt(4)
v_mfma_f32_16x16x32_bf16 v[104:107], v[76:79], v[36:39], v[104:107]
ds_read_b64_tr_b16 v[72:73], v8 offset:18496
v_mfma_f32_16x16x32_bf16 v[140:143], v[76:79], v[40:43], v[140:143]
ds_read_b64_tr_b16 v[74:75], v8 offset:20800
v_mfma_f32_16x16x32_bf16 v[176:179], v[76:79], v[44:47], v[176:179]
v_mfma_f32_16x16x32_bf16 v[212:215], v[76:79], v[48:51], v[212:215]
s_waitcnt lgkmcnt(4)
v_mfma_f32_16x16x32_bf16 v[108:111], v[80:83], v[36:39], v[108:111]
s_barrier
ds_read_b128 v[20:23], v1 offset:0
v_mfma_f32_16x16x32_bf16 v[144:147], v[80:83], v[40:43], v[144:147]
ds_read_b128 v[24:27], v1 offset:2048
ds_read_b128 v[28:31], v1 offset:4096
v_mfma_f32_16x16x32_bf16 v[180:183], v[80:83], v[44:47], v[180:183]
ds_read_b128 v[32:35], v1 offset:6144
ds_read_b64_tr_b16 v[76:77], v3 offset:0
v_mfma_f32_16x16x32_bf16 v[216:219], v[80:83], v[48:51], v[216:219]
ds_read_b64_tr_b16 v[78:79], v3 offset:2304
s_waitcnt lgkmcnt(8)
v_mfma_f32_16x16x32_bf16 v[112:115], v[68:71], v[36:39], v[112:115]
ds_read_b64_tr_b16 v[80:81], v3 offset:8
v_mfma_f32_16x16x32_bf16 v[148:151], v[68:71], v[40:43], v[148:151]
ds_read_b64_tr_b16 v[82:83], v3 offset:2312
v_mfma_f32_16x16x32_bf16 v[184:187], v[68:71], v[44:47], v[184:187]
v_mfma_f32_16x16x32_bf16 v[220:223], v[68:71], v[48:51], v[220:223]
s_waitcnt lgkmcnt(8)
v_mfma_f32_16x16x32_bf16 v[116:119], v[72:75], v[36:39], v[116:119]
ds_read_b64_tr_b16 v[68:69], v3 offset:16
v_mfma_f32_16x16x32_bf16 v[152:155], v[72:75], v[40:43], v[152:155]
ds_read_b64_tr_b16 v[70:71], v3 offset:2320
v_mfma_f32_16x16x32_bf16 v[188:191], v[72:75], v[44:47], v[188:191]
v_mfma_f32_16x16x32_bf16 v[224:227], v[72:75], v[48:51], v[224:227]
s_barrier
global_load_dword v19, v[16:17], off
v_add_co_u32 v16, vcc, v16, v18
s_nop 1
v_addc_co_u32 v17, vcc, 0, v17, vcc
s_waitcnt lgkmcnt(4)
v_mfma_f32_16x16x32_bf16 v[84:87], v[76:79], v[20:23], v[84:87]
ds_read_b64_tr_b16 v[72:73], v3 offset:24
v_mfma_f32_16x16x32_bf16 v[120:123], v[76:79], v[24:27], v[120:123]
ds_read_b64_tr_b16 v[74:75], v3 offset:2328
v_mfma_f32_16x16x32_bf16 v[156:159], v[76:79], v[28:31], v[156:159]
v_mfma_f32_16x16x32_bf16 v[192:195], v[76:79], v[32:35], v[192:195]
s_waitcnt lgkmcnt(4)
v_mfma_f32_16x16x32_bf16 v[88:91], v[80:83], v[20:23], v[88:91]
ds_read_b64_tr_b16 v[76:77], v3 offset:32
v_mfma_f32_16x16x32_bf16 v[124:127], v[80:83], v[24:27], v[124:127]
ds_read_b64_tr_b16 v[78:79], v3 offset:2336
v_mfma_f32_16x16x32_bf16 v[160:163], v[80:83], v[28:31], v[160:163]
v_mfma_f32_16x16x32_bf16 v[196:199], v[80:83], v[32:35], v[196:199]
s_waitcnt lgkmcnt(4)
v_mfma_f32_16x16x32_bf16 v[92:95], v[68:71], v[20:23], v[92:95]
ds_read_b64_tr_b16 v[80:81], v4 offset:40
v_mfma_f32_16x16x32_bf16 v[128:131], v[68:71], v[24:27], v[128:131]
ds_read_b64_tr_b16 v[82:83], v4 offset:2344
v_mfma_f32_16x16x32_bf16 v[164:167], v[68:71], v[28:31], v[164:167]
v_mfma_f32_16x16x32_bf16 v[200:203], v[68:71], v[32:35], v[200:203]
s_waitcnt lgkmcnt(4)
v_mfma_f32_16x16x32_bf16 v[96:99], v[72:75], v[20:23], v[96:99]
ds_read_b64_tr_b16 v[68:69], v4 offset:48
v_mfma_f32_16x16x32_bf16 v[132:135], v[72:75], v[24:27], v[132:135]
ds_read_b64_tr_b16 v[70:71], v4 offset:2352
v_mfma_f32_16x16x32_bf16 v[168:171], v[72:75], v[28:31], v[168:171]
v_mfma_f32_16x16x32_bf16 v[204:207], v[72:75], v[32:35], v[204:207]
s_waitcnt lgkmcnt(4)
v_mfma_f32_16x16x32_bf16 v[100:103], v[76:79], v[20:23], v[100:103]
ds_read_b64_tr_b16 v[72:73], v4 offset:56
v_mfma_f32_16x16x32_bf16 v[136:139], v[76:79], v[24:27], v[136:139]
ds_read_b64_tr_b16 v[74:75], v4 offset:2360
v_mfma_f32_16x16x32_bf16 v[172:175], v[76:79], v[28:31], v[172:175]
v_mfma_f32_16x16x32_bf16 v[208:211], v[76:79], v[32:35], v[208:211]
s_waitcnt lgkmcnt(4)
v_mfma_f32_16x16x32_bf16 v[104:107], v[80:83], v[20:23], v[104:107]
ds_read_b64_tr_b16 v[76:77], v4 offset:64
v_mfma_f32_16x16x32_bf16 v[140:143], v[80:83], v[24:27], v[140:143]
ds_read_b64_tr_b16 v[78:79], v4 offset:2368
v_mfma_f32_16x16x32_bf16 v[176:179], v[80:83], v[28:31], v[176:179]
v_mfma_f32_16x16x32_bf16 v[212:215], v[80:83], v[32:35], v[212:215]
s_waitcnt lgkmcnt(4)
v_mfma_f32_16x16x32_bf16 v[108:111], v[68:71], v[20:23], v[108:111]
ds_read_b128 v[36:39], v2 offset:0
ds_read_b128 v[40:43], v2 offset:2048
v_mfma_f32_16x16x32_bf16 v[144:147], v[68:71], v[24:27], v[144:147]
ds_read_b128 v[44:47], v2 offset:4096
ds_read_b128 v[48:51], v2 offset:6144
v_mfma_f32_16x16x32_bf16 v[180:183], v[68:71], v[28:31], v[180:183]
ds_read_b64_tr_b16 v[80:81], v3 offset:18432
v_mfma_f32_16x16x32_bf16 v[216:219], v[68:71], v[32:35], v[216:219]
ds_read_b64_tr_b16 v[82:83], v3 offset:20736
s_waitcnt lgkmcnt(8)
v_mfma_f32_16x16x32_bf16 v[112:115], v[72:75], v[20:23], v[112:115]
ds_read_b64_tr_b16 v[68:69], v3 offset:18440
v_mfma_f32_16x16x32_bf16 v[148:151], v[72:75], v[24:27], v[148:151]
ds_read_b64_tr_b16 v[70:71], v3 offset:20744
v_mfma_f32_16x16x32_bf16 v[184:187], v[72:75], v[28:31], v[184:187]
v_mfma_f32_16x16x32_bf16 v[220:223], v[72:75], v[32:35], v[220:223]
s_waitcnt lgkmcnt(8)
v_mfma_f32_16x16x32_bf16 v[116:119], v[76:79], v[20:23], v[116:119]
ds_read_b64_tr_b16 v[72:73], v3 offset:18448
v_mfma_f32_16x16x32_bf16 v[152:155], v[76:79], v[24:27], v[152:155]
ds_read_b64_tr_b16 v[74:75], v3 offset:20752
v_mfma_f32_16x16x32_bf16 v[188:191], v[76:79], v[28:31], v[188:191]
v_mfma_f32_16x16x32_bf16 v[224:227], v[76:79], v[32:35], v[224:227]
s_waitcnt lgkmcnt(4)
v_mfma_f32_16x16x32_bf16 v[84:87], v[80:83], v[36:39], v[84:87]
ds_read_b64_tr_b16 v[76:77], v3 offset:18456
v_mfma_f32_16x16x32_bf16 v[120:123], v[80:83], v[40:43], v[120:123]
ds_read_b64_tr_b16 v[78:79], v3 offset:20760
v_mfma_f32_16x16x32_bf16 v[156:159], v[80:83], v[44:47], v[156:159]
v_mfma_f32_16x16x32_bf16 v[192:195], v[80:83], v[48:51], v[192:195]
s_waitcnt lgkmcnt(4)
v_mfma_f32_16x16x32_bf16 v[88:91], v[68:71], v[36:39], v[88:91]
ds_read_b64_tr_b16 v[80:81], v3 offset:18464
v_mfma_f32_16x16x32_bf16 v[124:127], v[68:71], v[40:43], v[124:127]
ds_read_b64_tr_b16 v[82:83], v3 offset:20768
v_mfma_f32_16x16x32_bf16 v[160:163], v[68:71], v[44:47], v[160:163]
v_mfma_f32_16x16x32_bf16 v[196:199], v[68:71], v[48:51], v[196:199]
s_waitcnt lgkmcnt(4)
v_mfma_f32_16x16x32_bf16 v[92:95], v[72:75], v[36:39], v[92:95]
ds_read_b64_tr_b16 v[68:69], v4 offset:18472
v_mfma_f32_16x16x32_bf16 v[128:131], v[72:75], v[40:43], v[128:131]
ds_read_b64_tr_b16 v[70:71], v4 offset:20776
v_mfma_f32_16x16x32_bf16 v[164:167], v[72:75], v[44:47], v[164:167]
v_mfma_f32_16x16x32_bf16 v[200:203], v[72:75], v[48:51], v[200:203]
s_waitcnt lgkmcnt(4)
v_mfma_f32_16x16x32_bf16 v[96:99], v[76:79], v[36:39], v[96:99]
ds_read_b64_tr_b16 v[72:73], v4 offset:18480
v_mfma_f32_16x16x32_bf16 v[132:135], v[76:79], v[40:43], v[132:135]
ds_read_b64_tr_b16 v[74:75], v4 offset:20784
v_mfma_f32_16x16x32_bf16 v[168:171], v[76:79], v[44:47], v[168:171]
v_mfma_f32_16x16x32_bf16 v[204:207], v[76:79], v[48:51], v[204:207]
s_waitcnt lgkmcnt(4)
v_mfma_f32_16x16x32_bf16 v[100:103], v[80:83], v[36:39], v[100:103]
ds_read_b64_tr_b16 v[76:77], v4 offset:18488
v_mfma_f32_16x16x32_bf16 v[136:139], v[80:83], v[40:43], v[136:139]
ds_read_b64_tr_b16 v[78:79], v4 offset:20792
v_mfma_f32_16x16x32_bf16 v[172:175], v[80:83], v[44:47], v[172:175]
v_mfma_f32_16x16x32_bf16 v[208:211], v[80:83], v[48:51], v[208:211]
s_waitcnt lgkmcnt(4)
v_mfma_f32_16x16x32_bf16 v[104:107], v[68:71], v[36:39], v[104:107]
ds_read_b64_tr_b16 v[80:81], v4 offset:18496
v_mfma_f32_16x16x32_bf16 v[140:143], v[68:71], v[40:43], v[140:143]
ds_read_b64_tr_b16 v[82:83], v4 offset:20800
v_mfma_f32_16x16x32_bf16 v[176:179], v[68:71], v[44:47], v[176:179]
v_mfma_f32_16x16x32_bf16 v[212:215], v[68:71], v[48:51], v[212:215]
s_waitcnt lgkmcnt(4)
v_mfma_f32_16x16x32_bf16 v[108:111], v[72:75], v[36:39], v[108:111]
s_barrier
ds_read_b128 v[20:23], v1 offset:16384
v_mfma_f32_16x16x32_bf16 v[144:147], v[72:75], v[40:43], v[144:147]
ds_read_b128 v[24:27], v1 offset:18432
ds_read_b128 v[28:31], v1 offset:20480
v_mfma_f32_16x16x32_bf16 v[180:183], v[72:75], v[44:47], v[180:183]
ds_read_b128 v[32:35], v1 offset:22528
ds_read_b64_tr_b16 v[68:69], v5 offset:0
v_mfma_f32_16x16x32_bf16 v[216:219], v[72:75], v[48:51], v[216:219]
ds_read_b64_tr_b16 v[70:71], v5 offset:2304
s_waitcnt lgkmcnt(8)
v_mfma_f32_16x16x32_bf16 v[112:115], v[76:79], v[36:39], v[112:115]
ds_read_b64_tr_b16 v[72:73], v5 offset:8
v_mfma_f32_16x16x32_bf16 v[148:151], v[76:79], v[40:43], v[148:151]
ds_read_b64_tr_b16 v[74:75], v5 offset:2312
v_mfma_f32_16x16x32_bf16 v[184:187], v[76:79], v[44:47], v[184:187]
v_mfma_f32_16x16x32_bf16 v[220:223], v[76:79], v[48:51], v[220:223]
s_waitcnt lgkmcnt(8)
v_mfma_f32_16x16x32_bf16 v[116:119], v[80:83], v[36:39], v[116:119]
ds_read_b64_tr_b16 v[76:77], v5 offset:16
v_mfma_f32_16x16x32_bf16 v[152:155], v[80:83], v[40:43], v[152:155]
ds_read_b64_tr_b16 v[78:79], v5 offset:2320
v_mfma_f32_16x16x32_bf16 v[188:191], v[80:83], v[44:47], v[188:191]
v_mfma_f32_16x16x32_bf16 v[224:227], v[80:83], v[48:51], v[224:227]
s_barrier
global_load_dword v19, v[16:17], off
v_add_co_u32 v16, vcc, v16, v18
s_nop 1
v_addc_co_u32 v17, vcc, 0, v17, vcc
s_waitcnt lgkmcnt(4)
v_mfma_f32_16x16x32_bf16 v[84:87], v[68:71], v[20:23], v[84:87]
ds_read_b64_tr_b16 v[80:81], v5 offset:24
v_mfma_f32_16x16x32_bf16 v[120:123], v[68:71], v[24:27], v[120:123]
ds_read_b64_tr_b16 v[82:83], v5 offset:2328
v_mfma_f32_16x16x32_bf16 v[156:159], v[68:71], v[28:31], v[156:159]
v_mfma_f32_16x16x32_bf16 v[192:195], v[68:71], v[32:35], v[192:195]
s_waitcnt lgkmcnt(4)
v_mfma_f32_16x16x32_bf16 v[88:91], v[72:75], v[20:23], v[88:91]
ds_read_b64_tr_b16 v[68:69], v5 offset:32
v_mfma_f32_16x16x32_bf16 v[124:127], v[72:75], v[24:27], v[124:127]
ds_read_b64_tr_b16 v[70:71], v5 offset:2336
v_mfma_f32_16x16x32_bf16 v[160:163], v[72:75], v[28:31], v[160:163]
v_mfma_f32_16x16x32_bf16 v[196:199], v[72:75], v[32:35], v[196:199]
s_waitcnt lgkmcnt(4)
v_mfma_f32_16x16x32_bf16 v[92:95], v[76:79], v[20:23], v[92:95]
ds_read_b64_tr_b16 v[72:73], v6 offset:40
v_mfma_f32_16x16x32_bf16 v[128:131], v[76:79], v[24:27], v[128:131]
ds_read_b64_tr_b16 v[74:75], v6 offset:2344
v_mfma_f32_16x16x32_bf16 v[164:167], v[76:79], v[28:31], v[164:167]
v_mfma_f32_16x16x32_bf16 v[200:203], v[76:79], v[32:35], v[200:203]
s_waitcnt lgkmcnt(4)
v_mfma_f32_16x16x32_bf16 v[96:99], v[80:83], v[20:23], v[96:99]
ds_read_b64_tr_b16 v[76:77], v6 offset:48
v_mfma_f32_16x16x32_bf16 v[132:135], v[80:83], v[24:27], v[132:135]
ds_read_b64_tr_b16 v[78:79], v6 offset:2352
v_mfma_f32_16x16x32_bf16 v[168:171], v[80:83], v[28:31], v[168:171]
v_mfma_f32_16x16x32_bf16 v[204:207], v[80:83], v[32:35], v[204:207]
s_waitcnt lgkmcnt(4)
v_mfma_f32_16x16x32_bf16 v[100:103], v[68:71], v[20:23], v[100:103]
ds_read_b64_tr_b16 v[80:81], v6 offset:56
v_mfma_f32_16x16x32_bf16 v[136:139], v[68:71], v[24:27], v[136:139]
ds_read_b64_tr_b16 v[82:83], v6 offset:2360
v_mfma_f32_16x16x32_bf16 v[172:175], v[68:71], v[28:31], v[172:175]
v_mfma_f32_16x16x32_bf16 v[208:211], v[68:71], v[32:35], v[208:211]
s_waitcnt lgkmcnt(4)
v_mfma_f32_16x16x32_bf16 v[104:107], v[72:75], v[20:23], v[104:107]
ds_read_b64_tr_b16 v[68:69], v6 offset:64
v_mfma_f32_16x16x32_bf16 v[140:143], v[72:75], v[24:27], v[140:143]
ds_read_b64_tr_b16 v[70:71], v6 offset:2368
v_mfma_f32_16x16x32_bf16 v[176:179], v[72:75], v[28:31], v[176:179]
v_mfma_f32_16x16x32_bf16 v[212:215], v[72:75], v[32:35], v[212:215]
s_waitcnt lgkmcnt(4)
v_mfma_f32_16x16x32_bf16 v[108:111], v[76:79], v[20:23], v[108:111]
ds_read_b128 v[36:39], v2 offset:16384
ds_read_b128 v[40:43], v2 offset:18432
v_mfma_f32_16x16x32_bf16 v[144:147], v[76:79], v[24:27], v[144:147]
ds_read_b128 v[44:47], v2 offset:20480
ds_read_b128 v[48:51], v2 offset:22528
v_mfma_f32_16x16x32_bf16 v[180:183], v[76:79], v[28:31], v[180:183]
ds_read_b64_tr_b16 v[72:73], v5 offset:18432
v_mfma_f32_16x16x32_bf16 v[216:219], v[76:79], v[32:35], v[216:219]
ds_read_b64_tr_b16 v[74:75], v5 offset:20736
s_waitcnt lgkmcnt(8)
v_mfma_f32_16x16x32_bf16 v[112:115], v[80:83], v[20:23], v[112:115]
ds_read_b64_tr_b16 v[76:77], v5 offset:18440
v_mfma_f32_16x16x32_bf16 v[148:151], v[80:83], v[24:27], v[148:151]
ds_read_b64_tr_b16 v[78:79], v5 offset:20744
v_mfma_f32_16x16x32_bf16 v[184:187], v[80:83], v[28:31], v[184:187]
v_mfma_f32_16x16x32_bf16 v[220:223], v[80:83], v[32:35], v[220:223]
s_waitcnt lgkmcnt(8)
v_mfma_f32_16x16x32_bf16 v[116:119], v[68:71], v[20:23], v[116:119]
ds_read_b64_tr_b16 v[80:81], v5 offset:18448
v_mfma_f32_16x16x32_bf16 v[152:155], v[68:71], v[24:27], v[152:155]
ds_read_b64_tr_b16 v[82:83], v5 offset:20752
v_mfma_f32_16x16x32_bf16 v[188:191], v[68:71], v[28:31], v[188:191]
v_mfma_f32_16x16x32_bf16 v[224:227], v[68:71], v[32:35], v[224:227]
s_waitcnt lgkmcnt(4)
v_mfma_f32_16x16x32_bf16 v[84:87], v[72:75], v[36:39], v[84:87]
ds_read_b64_tr_b16 v[68:69], v5 offset:18456
v_mfma_f32_16x16x32_bf16 v[120:123], v[72:75], v[40:43], v[120:123]
ds_read_b64_tr_b16 v[70:71], v5 offset:20760
v_mfma_f32_16x16x32_bf16 v[156:159], v[72:75], v[44:47], v[156:159]
v_mfma_f32_16x16x32_bf16 v[192:195], v[72:75], v[48:51], v[192:195]
s_waitcnt lgkmcnt(4)
v_mfma_f32_16x16x32_bf16 v[88:91], v[76:79], v[36:39], v[88:91]
ds_read_b64_tr_b16 v[72:73], v5 offset:18464
v_mfma_f32_16x16x32_bf16 v[124:127], v[76:79], v[40:43], v[124:127]
ds_read_b64_tr_b16 v[74:75], v5 offset:20768
v_mfma_f32_16x16x32_bf16 v[160:163], v[76:79], v[44:47], v[160:163]
v_mfma_f32_16x16x32_bf16 v[196:199], v[76:79], v[48:51], v[196:199]
s_waitcnt lgkmcnt(4)
v_mfma_f32_16x16x32_bf16 v[92:95], v[80:83], v[36:39], v[92:95]
ds_read_b64_tr_b16 v[76:77], v6 offset:18472
v_mfma_f32_16x16x32_bf16 v[128:131], v[80:83], v[40:43], v[128:131]
ds_read_b64_tr_b16 v[78:79], v6 offset:20776
v_mfma_f32_16x16x32_bf16 v[164:167], v[80:83], v[44:47], v[164:167]
v_mfma_f32_16x16x32_bf16 v[200:203], v[80:83], v[48:51], v[200:203]
s_waitcnt lgkmcnt(4)
v_mfma_f32_16x16x32_bf16 v[96:99], v[68:71], v[36:39], v[96:99]
ds_read_b64_tr_b16 v[80:81], v6 offset:18480
v_mfma_f32_16x16x32_bf16 v[132:135], v[68:71], v[40:43], v[132:135]
ds_read_b64_tr_b16 v[82:83], v6 offset:20784
v_mfma_f32_16x16x32_bf16 v[168:171], v[68:71], v[44:47], v[168:171]
v_mfma_f32_16x16x32_bf16 v[204:207], v[68:71], v[48:51], v[204:207]
s_waitcnt lgkmcnt(4)
v_mfma_f32_16x16x32_bf16 v[100:103], v[72:75], v[36:39], v[100:103]
ds_read_b64_tr_b16 v[68:69], v6 offset:18488
v_mfma_f32_16x16x32_bf16 v[136:139], v[72:75], v[40:43], v[136:139]
ds_read_b64_tr_b16 v[70:71], v6 offset:20792
v_mfma_f32_16x16x32_bf16 v[172:175], v[72:75], v[44:47], v[172:175]
v_mfma_f32_16x16x32_bf16 v[208:211], v[72:75], v[48:51], v[208:211]
s_waitcnt lgkmcnt(4)
v_mfma_f32_16x16x32_bf16 v[104:107], v[76:79], v[36:39], v[104:107]
ds_read_b64_tr_b16 v[72:73], v6 offset:18496
v_mfma_f32_16x16x32_bf16 v[140:143], v[76:79], v[40:43], v[140:143]
ds_read_b64_tr_b16 v[74:75], v6 offset:20800
v_mfma_f32_16x16x32_bf16 v[176:179], v[76:79], v[44:47], v[176:179]
v_mfma_f32_16x16x32_bf16 v[212:215], v[76:79], v[48:51], v[212:215]
s_waitcnt lgkmcnt(4)
v_mfma_f32_16x16x32_bf16 v[108:111], v[80:83], v[36:39], v[108:111]
s_barrier
ds_read_b128 v[20:23], v1 offset:32768
v_mfma_f32_16x16x32_bf16 v[144:147], v[80:83], v[40:43], v[144:147]
ds_read_b128 v[24:27], v1 offset:34816
ds_read_b128 v[28:31], v1 offset:36864
v_mfma_f32_16x16x32_bf16 v[180:183], v[80:83], v[44:47], v[180:183]
ds_read_b128 v[32:35], v1 offset:38912
ds_read_b64_tr_b16 v[76:77], v7 offset:0
v_mfma_f32_16x16x32_bf16 v[216:219], v[80:83], v[48:51], v[216:219]
ds_read_b64_tr_b16 v[78:79], v7 offset:2304
s_waitcnt lgkmcnt(8)
v_mfma_f32_16x16x32_bf16 v[112:115], v[68:71], v[36:39], v[112:115]
ds_read_b64_tr_b16 v[80:81], v7 offset:8
v_mfma_f32_16x16x32_bf16 v[148:151], v[68:71], v[40:43], v[148:151]
ds_read_b64_tr_b16 v[82:83], v7 offset:2312
v_mfma_f32_16x16x32_bf16 v[184:187], v[68:71], v[44:47], v[184:187]
v_mfma_f32_16x16x32_bf16 v[220:223], v[68:71], v[48:51], v[220:223]
s_waitcnt lgkmcnt(8)
v_mfma_f32_16x16x32_bf16 v[116:119], v[72:75], v[36:39], v[116:119]
ds_read_b64_tr_b16 v[68:69], v7 offset:16
v_mfma_f32_16x16x32_bf16 v[152:155], v[72:75], v[40:43], v[152:155]
ds_read_b64_tr_b16 v[70:71], v7 offset:2320
v_mfma_f32_16x16x32_bf16 v[188:191], v[72:75], v[44:47], v[188:191]
v_mfma_f32_16x16x32_bf16 v[224:227], v[72:75], v[48:51], v[224:227]
s_barrier
global_load_dword v19, v[16:17], off
v_add_co_u32 v16, vcc, v16, v18
s_nop 1
v_addc_co_u32 v17, vcc, 0, v17, vcc
s_waitcnt lgkmcnt(4)
v_mfma_f32_16x16x32_bf16 v[84:87], v[76:79], v[20:23], v[84:87]
ds_read_b64_tr_b16 v[72:73], v7 offset:24
v_mfma_f32_16x16x32_bf16 v[120:123], v[76:79], v[24:27], v[120:123]
ds_read_b64_tr_b16 v[74:75], v7 offset:2328
v_mfma_f32_16x16x32_bf16 v[156:159], v[76:79], v[28:31], v[156:159]
v_mfma_f32_16x16x32_bf16 v[192:195], v[76:79], v[32:35], v[192:195]
s_waitcnt lgkmcnt(4)
v_mfma_f32_16x16x32_bf16 v[88:91], v[80:83], v[20:23], v[88:91]
ds_read_b64_tr_b16 v[76:77], v7 offset:32
v_mfma_f32_16x16x32_bf16 v[124:127], v[80:83], v[24:27], v[124:127]
ds_read_b64_tr_b16 v[78:79], v7 offset:2336
v_mfma_f32_16x16x32_bf16 v[160:163], v[80:83], v[28:31], v[160:163]
v_mfma_f32_16x16x32_bf16 v[196:199], v[80:83], v[32:35], v[196:199]
s_waitcnt lgkmcnt(4)
v_mfma_f32_16x16x32_bf16 v[92:95], v[68:71], v[20:23], v[92:95]
ds_read_b64_tr_b16 v[80:81], v8 offset:40
v_mfma_f32_16x16x32_bf16 v[128:131], v[68:71], v[24:27], v[128:131]
ds_read_b64_tr_b16 v[82:83], v8 offset:2344
v_mfma_f32_16x16x32_bf16 v[164:167], v[68:71], v[28:31], v[164:167]
v_mfma_f32_16x16x32_bf16 v[200:203], v[68:71], v[32:35], v[200:203]
s_waitcnt lgkmcnt(4)
v_mfma_f32_16x16x32_bf16 v[96:99], v[72:75], v[20:23], v[96:99]
ds_read_b64_tr_b16 v[68:69], v8 offset:48
v_mfma_f32_16x16x32_bf16 v[132:135], v[72:75], v[24:27], v[132:135]
ds_read_b64_tr_b16 v[70:71], v8 offset:2352
v_mfma_f32_16x16x32_bf16 v[168:171], v[72:75], v[28:31], v[168:171]
v_mfma_f32_16x16x32_bf16 v[204:207], v[72:75], v[32:35], v[204:207]
s_waitcnt lgkmcnt(4)
v_mfma_f32_16x16x32_bf16 v[100:103], v[76:79], v[20:23], v[100:103]
ds_read_b64_tr_b16 v[72:73], v8 offset:56
v_mfma_f32_16x16x32_bf16 v[136:139], v[76:79], v[24:27], v[136:139]
ds_read_b64_tr_b16 v[74:75], v8 offset:2360
v_mfma_f32_16x16x32_bf16 v[172:175], v[76:79], v[28:31], v[172:175]
v_mfma_f32_16x16x32_bf16 v[208:211], v[76:79], v[32:35], v[208:211]
s_waitcnt lgkmcnt(4)
v_mfma_f32_16x16x32_bf16 v[104:107], v[80:83], v[20:23], v[104:107]
ds_read_b64_tr_b16 v[76:77], v8 offset:64
v_mfma_f32_16x16x32_bf16 v[140:143], v[80:83], v[24:27], v[140:143]
ds_read_b64_tr_b16 v[78:79], v8 offset:2368
v_mfma_f32_16x16x32_bf16 v[176:179], v[80:83], v[28:31], v[176:179]
v_mfma_f32_16x16x32_bf16 v[212:215], v[80:83], v[32:35], v[212:215]
s_waitcnt lgkmcnt(4)
v_mfma_f32_16x16x32_bf16 v[108:111], v[68:71], v[20:23], v[108:111]
ds_read_b128 v[36:39], v2 offset:32768
ds_read_b128 v[40:43], v2 offset:34816
v_mfma_f32_16x16x32_bf16 v[144:147], v[68:71], v[24:27], v[144:147]
ds_read_b128 v[44:47], v2 offset:36864
ds_read_b128 v[48:51], v2 offset:38912
v_mfma_f32_16x16x32_bf16 v[180:183], v[68:71], v[28:31], v[180:183]
ds_read_b64_tr_b16 v[80:81], v7 offset:18432
v_mfma_f32_16x16x32_bf16 v[216:219], v[68:71], v[32:35], v[216:219]
ds_read_b64_tr_b16 v[82:83], v7 offset:20736
s_waitcnt lgkmcnt(8)
v_mfma_f32_16x16x32_bf16 v[112:115], v[72:75], v[20:23], v[112:115]
ds_read_b64_tr_b16 v[68:69], v7 offset:18440
v_mfma_f32_16x16x32_bf16 v[148:151], v[72:75], v[24:27], v[148:151]
ds_read_b64_tr_b16 v[70:71], v7 offset:20744
v_mfma_f32_16x16x32_bf16 v[184:187], v[72:75], v[28:31], v[184:187]
v_mfma_f32_16x16x32_bf16 v[220:223], v[72:75], v[32:35], v[220:223]
s_waitcnt lgkmcnt(8)
v_mfma_f32_16x16x32_bf16 v[116:119], v[76:79], v[20:23], v[116:119]
ds_read_b64_tr_b16 v[72:73], v7 offset:18448
v_mfma_f32_16x16x32_bf16 v[152:155], v[76:79], v[24:27], v[152:155]
ds_read_b64_tr_b16 v[74:75], v7 offset:20752
v_mfma_f32_16x16x32_bf16 v[188:191], v[76:79], v[28:31], v[188:191]
v_mfma_f32_16x16x32_bf16 v[224:227], v[76:79], v[32:35], v[224:227]
s_waitcnt lgkmcnt(4)
v_mfma_f32_16x16x32_bf16 v[84:87], v[80:83], v[36:39], v[84:87]
ds_read_b64_tr_b16 v[76:77], v7 offset:18456
v_mfma_f32_16x16x32_bf16 v[120:123], v[80:83], v[40:43], v[120:123]
ds_read_b64_tr_b16 v[78:79], v7 offset:20760
v_mfma_f32_16x16x32_bf16 v[156:159], v[80:83], v[44:47], v[156:159]
v_mfma_f32_16x16x32_bf16 v[192:195], v[80:83], v[48:51], v[192:195]
s_waitcnt lgkmcnt(4)
v_mfma_f32_16x16x32_bf16 v[88:91], v[68:71], v[36:39], v[88:91]
ds_read_b64_tr_b16 v[80:81], v7 offset:18464
v_mfma_f32_16x16x32_bf16 v[124:127], v[68:71], v[40:43], v[124:127]
ds_read_b64_tr_b16 v[82:83], v7 offset:20768
v_mfma_f32_16x16x32_bf16 v[160:163], v[68:71], v[44:47], v[160:163]
v_mfma_f32_16x16x32_bf16 v[196:199], v[68:71], v[48:51], v[196:199]
s_waitcnt lgkmcnt(4)
v_mfma_f32_16x16x32_bf16 v[92:95], v[72:75], v[36:39], v[92:95]
ds_read_b64_tr_b16 v[68:69], v8 offset:18472
v_mfma_f32_16x16x32_bf16 v[128:131], v[72:75], v[40:43], v[128:131]
ds_read_b64_tr_b16 v[70:71], v8 offset:20776
v_mfma_f32_16x16x32_bf16 v[164:167], v[72:75], v[44:47], v[164:167]
v_mfma_f32_16x16x32_bf16 v[200:203], v[72:75], v[48:51], v[200:203]
s_waitcnt lgkmcnt(4)
v_mfma_f32_16x16x32_bf16 v[96:99], v[76:79], v[36:39], v[96:99]
ds_read_b64_tr_b16 v[72:73], v8 offset:18480
v_mfma_f32_16x16x32_bf16 v[132:135], v[76:79], v[40:43], v[132:135]
ds_read_b64_tr_b16 v[74:75], v8 offset:20784
v_mfma_f32_16x16x32_bf16 v[168:171], v[76:79], v[44:47], v[168:171]
v_mfma_f32_16x16x32_bf16 v[204:207], v[76:79], v[48:51], v[204:207]
s_waitcnt lgkmcnt(4)
v_mfma_f32_16x16x32_bf16 v[100:103], v[80:83], v[36:39], v[100:103]
ds_read_b64_tr_b16 v[76:77], v8 offset:18488
v_mfma_f32_16x16x32_bf16 v[136:139], v[80:83], v[40:43], v[136:139]
ds_read_b64_tr_b16 v[78:79], v8 offset:20792
v_mfma_f32_16x16x32_bf16 v[172:175], v[80:83], v[44:47], v[172:175]
v_mfma_f32_16x16x32_bf16 v[208:211], v[80:83], v[48:51], v[208:211]
s_waitcnt lgkmcnt(4)
v_mfma_f32_16x16x32_bf16 v[104:107], v[68:71], v[36:39], v[104:107]
ds_read_b64_tr_b16 v[80:81], v8 offset:18496
v_mfma_f32_16x16x32_bf16 v[140:143], v[68:71], v[40:43], v[140:143]
ds_read_b64_tr_b16 v[82:83], v8 offset:20800
v_mfma_f32_16x16x32_bf16 v[176:179], v[68:71], v[44:47], v[176:179]
v_mfma_f32_16x16x32_bf16 v[212:215], v[68:71], v[48:51], v[212:215]
s_waitcnt lgkmcnt(4)
v_mfma_f32_16x16x32_bf16 v[108:111], v[72:75], v[36:39], v[108:111]
s_barrier
ds_read_b128 v[20:23], v1 offset:0
v_mfma_f32_16x16x32_bf16 v[144:147], v[72:75], v[40:43], v[144:147]
ds_read_b128 v[24:27], v1 offset:2048
ds_read_b128 v[28:31], v1 offset:4096
v_mfma_f32_16x16x32_bf16 v[180:183], v[72:75], v[44:47], v[180:183]
ds_read_b128 v[32:35], v1 offset:6144
ds_read_b64_tr_b16 v[68:69], v3 offset:0
v_mfma_f32_16x16x32_bf16 v[216:219], v[72:75], v[48:51], v[216:219]
ds_read_b64_tr_b16 v[70:71], v3 offset:2304
s_waitcnt lgkmcnt(8)
v_mfma_f32_16x16x32_bf16 v[112:115], v[76:79], v[36:39], v[112:115]
ds_read_b64_tr_b16 v[72:73], v3 offset:8
v_mfma_f32_16x16x32_bf16 v[148:151], v[76:79], v[40:43], v[148:151]
ds_read_b64_tr_b16 v[74:75], v3 offset:2312
v_mfma_f32_16x16x32_bf16 v[184:187], v[76:79], v[44:47], v[184:187]
v_mfma_f32_16x16x32_bf16 v[220:223], v[76:79], v[48:51], v[220:223]
s_waitcnt lgkmcnt(8)
v_mfma_f32_16x16x32_bf16 v[116:119], v[80:83], v[36:39], v[116:119]
ds_read_b64_tr_b16 v[76:77], v3 offset:16
v_mfma_f32_16x16x32_bf16 v[152:155], v[80:83], v[40:43], v[152:155]
ds_read_b64_tr_b16 v[78:79], v3 offset:2320
v_mfma_f32_16x16x32_bf16 v[188:191], v[80:83], v[44:47], v[188:191]
v_mfma_f32_16x16x32_bf16 v[224:227], v[80:83], v[48:51], v[224:227]
s_barrier
s_waitcnt lgkmcnt(4)
v_mfma_f32_16x16x32_bf16 v[84:87], v[68:71], v[20:23], v[84:87]
ds_read_b64_tr_b16 v[80:81], v3 offset:24
v_mfma_f32_16x16x32_bf16 v[120:123], v[68:71], v[24:27], v[120:123]
ds_read_b64_tr_b16 v[82:83], v3 offset:2328
v_mfma_f32_16x16x32_bf16 v[156:159], v[68:71], v[28:31], v[156:159]
v_mfma_f32_16x16x32_bf16 v[192:195], v[68:71], v[32:35], v[192:195]
s_waitcnt lgkmcnt(4)
v_mfma_f32_16x16x32_bf16 v[88:91], v[72:75], v[20:23], v[88:91]
ds_read_b64_tr_b16 v[68:69], v3 offset:32
v_mfma_f32_16x16x32_bf16 v[124:127], v[72:75], v[24:27], v[124:127]
ds_read_b64_tr_b16 v[70:71], v3 offset:2336
v_mfma_f32_16x16x32_bf16 v[160:163], v[72:75], v[28:31], v[160:163]
v_mfma_f32_16x16x32_bf16 v[196:199], v[72:75], v[32:35], v[196:199]
s_waitcnt lgkmcnt(4)
v_mfma_f32_16x16x32_bf16 v[92:95], v[76:79], v[20:23], v[92:95]
ds_read_b64_tr_b16 v[72:73], v4 offset:40
v_mfma_f32_16x16x32_bf16 v[128:131], v[76:79], v[24:27], v[128:131]
ds_read_b64_tr_b16 v[74:75], v4 offset:2344
v_mfma_f32_16x16x32_bf16 v[164:167], v[76:79], v[28:31], v[164:167]
v_mfma_f32_16x16x32_bf16 v[200:203], v[76:79], v[32:35], v[200:203]
s_waitcnt lgkmcnt(4)
v_mfma_f32_16x16x32_bf16 v[96:99], v[80:83], v[20:23], v[96:99]
ds_read_b64_tr_b16 v[76:77], v4 offset:48
v_mfma_f32_16x16x32_bf16 v[132:135], v[80:83], v[24:27], v[132:135]
ds_read_b64_tr_b16 v[78:79], v4 offset:2352
v_mfma_f32_16x16x32_bf16 v[168:171], v[80:83], v[28:31], v[168:171]
v_mfma_f32_16x16x32_bf16 v[204:207], v[80:83], v[32:35], v[204:207]
s_waitcnt lgkmcnt(4)
v_mfma_f32_16x16x32_bf16 v[100:103], v[68:71], v[20:23], v[100:103]
ds_read_b64_tr_b16 v[80:81], v4 offset:56
v_mfma_f32_16x16x32_bf16 v[136:139], v[68:71], v[24:27], v[136:139]
ds_read_b64_tr_b16 v[82:83], v4 offset:2360
v_mfma_f32_16x16x32_bf16 v[172:175], v[68:71], v[28:31], v[172:175]
v_mfma_f32_16x16x32_bf16 v[208:211], v[68:71], v[32:35], v[208:211]
s_waitcnt lgkmcnt(4)
v_mfma_f32_16x16x32_bf16 v[104:107], v[72:75], v[20:23], v[104:107]
ds_read_b64_tr_b16 v[68:69], v4 offset:64
v_mfma_f32_16x16x32_bf16 v[140:143], v[72:75], v[24:27], v[140:143]
ds_read_b64_tr_b16 v[70:71], v4 offset:2368
v_mfma_f32_16x16x32_bf16 v[176:179], v[72:75], v[28:31], v[176:179]
v_mfma_f32_16x16x32_bf16 v[212:215], v[72:75], v[32:35], v[212:215]
s_waitcnt lgkmcnt(4)
v_mfma_f32_16x16x32_bf16 v[108:111], v[76:79], v[20:23], v[108:111]
ds_read_b128 v[36:39], v2 offset:0
ds_read_b128 v[40:43], v2 offset:2048
v_mfma_f32_16x16x32_bf16 v[144:147], v[76:79], v[24:27], v[144:147]
ds_read_b128 v[44:47], v2 offset:4096
ds_read_b128 v[48:51], v2 offset:6144
v_mfma_f32_16x16x32_bf16 v[180:183], v[76:79], v[28:31], v[180:183]
ds_read_b64_tr_b16 v[72:73], v3 offset:18432
v_mfma_f32_16x16x32_bf16 v[216:219], v[76:79], v[32:35], v[216:219]
ds_read_b64_tr_b16 v[74:75], v3 offset:20736
s_waitcnt lgkmcnt(8)
v_mfma_f32_16x16x32_bf16 v[112:115], v[80:83], v[20:23], v[112:115]
ds_read_b64_tr_b16 v[76:77], v3 offset:18440
v_mfma_f32_16x16x32_bf16 v[148:151], v[80:83], v[24:27], v[148:151]
ds_read_b64_tr_b16 v[78:79], v3 offset:20744
v_mfma_f32_16x16x32_bf16 v[184:187], v[80:83], v[28:31], v[184:187]
v_mfma_f32_16x16x32_bf16 v[220:223], v[80:83], v[32:35], v[220:223]
s_waitcnt lgkmcnt(8)
v_mfma_f32_16x16x32_bf16 v[116:119], v[68:71], v[20:23], v[116:119]
L_pdR2_0:
s_cbranch_execz L_retR
ds_read_b64_tr_b16 v[80:81], v3 offset:18448
v_mfma_f32_16x16x32_bf16 v[152:155], v[68:71], v[24:27], v[152:155]
ds_read_b64_tr_b16 v[82:83], v3 offset:20752
v_mfma_f32_16x16x32_bf16 v[188:191], v[68:71], v[28:31], v[188:191]
v_mfma_f32_16x16x32_bf16 v[224:227], v[68:71], v[32:35], v[224:227]
s_waitcnt lgkmcnt(4)
v_mfma_f32_16x16x32_bf16 v[84:87], v[72:75], v[36:39], v[84:87]
ds_read_b64_tr_b16 v[68:69], v3 offset:18456
v_mfma_f32_16x16x32_bf16 v[120:123], v[72:75], v[40:43], v[120:123]
ds_read_b64_tr_b16 v[70:71], v3 offset:20760
v_mfma_f32_16x16x32_bf16 v[156:159], v[72:75], v[44:47], v[156:159]
v_mfma_f32_16x16x32_bf16 v[192:195], v[72:75], v[48:51], v[192:195]
s_waitcnt lgkmcnt(4)
v_mfma_f32_16x16x32_bf16 v[88:91], v[76:79], v[36:39], v[88:91]
ds_read_b64_tr_b16 v[72:73], v3 offset:18464
v_mfma_f32_16x16x32_bf16 v[124:127], v[76:79], v[40:43], v[124:127]
ds_read_b64_tr_b16 v[74:75], v3 offset:20768
v_mfma_f32_16x16x32_bf16 v[160:163], v[76:79], v[44:47], v[160:163]
v_mfma_f32_16x16x32_bf16 v[196:199], v[76:79], v[48:51], v[196:199]
s_waitcnt lgkmcnt(4)
v_mfma_f32_16x16x32_bf16 v[92:95], v[80:83], v[36:39], v[92:95]
ds_read_b64_tr_b16 v[76:77], v4 offset:18472
v_mfma_f32_16x16x32_bf16 v[128:131], v[80:83], v[40:43], v[128:131]
ds_read_b64_tr_b16 v[78:79], v4 offset:20776
v_mfma_f32_16x16x32_bf16 v[164:167], v[80:83], v[44:47], v[164:167]
v_mfma_f32_16x16x32_bf16 v[200:203], v[80:83], v[48:51], v[200:203]
s_waitcnt lgkmcnt(4)
v_mfma_f32_16x16x32_bf16 v[96:99], v[68:71], v[36:39], v[96:99]
ds_read_b64_tr_b16 v[80:81], v4 offset:18480
v_mfma_f32_16x16x32_bf16 v[132:135], v[68:71], v[40:43], v[132:135]
ds_read_b64_tr_b16 v[82:83], v4 offset:20784
v_mfma_f32_16x16x32_bf16 v[168:171], v[68:71], v[44:47], v[168:171]
v_mfma_f32_16x16x32_bf16 v[204:207], v[68:71], v[48:51], v[204:207]
s_waitcnt lgkmcnt(4)
v_mfma_f32_16x16x32_bf16 v[100:103], v[72:75], v[36:39], v[100:103]
ds_read_b64_tr_b16 v[68:69], v4 offset:18488
v_mfma_f32_16x16x32_bf16 v[136:139], v[72:75], v[40:43], v[136:139]
ds_read_b64_tr_b16 v[70:71], v4 offset:20792
v_mfma_f32_16x16x32_bf16 v[172:175], v[72:75], v[44:47], v[172:175]
v_mfma_f32_16x16x32_bf16 v[208:211], v[72:75], v[48:51], v[208:211]
s_waitcnt lgkmcnt(4)
v_mfma_f32_16x16x32_bf16 v[104:107], v[76:79], v[36:39], v[104:107]
ds_read_b64_tr_b16 v[72:73], v4 offset:18496
v_mfma_f32_16x16x32_bf16 v[140:143], v[76:79], v[40:43], v[140:143]
ds_read_b64_tr_b16 v[74:75], v4 offset:20800
v_mfma_f32_16x16x32_bf16 v[176:179], v[76:79], v[44:47], v[176:179]
v_mfma_f32_16x16x32_bf16 v[212:215], v[76:79], v[48:51], v[212:215]
s_waitcnt lgkmcnt(4)
v_mfma_f32_16x16x32_bf16 v[108:111], v[80:83], v[36:39], v[108:111]
s_waitcnt vmcnt(0)
s_barrier
ds_read_b128 v[20:23], v1 offset:16384
v_mfma_f32_16x16x32_bf16 v[144:147], v[80:83], v[40:43], v[144:147]
ds_read_b128 v[24:27], v1 offset:18432
ds_read_b128 v[28:31], v1 offset:20480
v_mfma_f32_16x16x32_bf16 v[180:183], v[80:83], v[44:47], v[180:183]
ds_read_b128 v[32:35], v1 offset:22528
ds_read_b64_tr_b16 v[76:77], v5 offset:0
v_mfma_f32_16x16x32_bf16 v[216:219], v[80:83], v[48:51], v[216:219]
ds_read_b64_tr_b16 v[78:79], v5 offset:2304
s_waitcnt lgkmcnt(8)
v_mfma_f32_16x16x32_bf16 v[112:115], v[68:71], v[36:39], v[112:115]
ds_read_b64_tr_b16 v[80:81], v5 offset:8
v_mfma_f32_16x16x32_bf16 v[148:151], v[68:71], v[40:43], v[148:151]
ds_read_b64_tr_b16 v[82:83], v5 offset:2312
v_mfma_f32_16x16x32_bf16 v[184:187], v[68:71], v[44:47], v[184:187]
v_mfma_f32_16x16x32_bf16 v[220:223], v[68:71], v[48:51], v[220:223]
s_waitcnt lgkmcnt(8)
v_mfma_f32_16x16x32_bf16 v[116:119], v[72:75], v[36:39], v[116:119]
ds_read_b64_tr_b16 v[68:69], v5 offset:16
v_mfma_f32_16x16x32_bf16 v[152:155], v[72:75], v[40:43], v[152:155]
ds_read_b64_tr_b16 v[70:71], v5 offset:2320
v_mfma_f32_16x16x32_bf16 v[188:191], v[72:75], v[44:47], v[188:191]
v_mfma_f32_16x16x32_bf16 v[224:227], v[72:75], v[48:51], v[224:227]
s_waitcnt lgkmcnt(4)
v_mfma_f32_16x16x32_bf16 v[84:87], v[76:79], v[20:23], v[84:87]
ds_read_b64_tr_b16 v[72:73], v5 offset:24
v_mfma_f32_16x16x32_bf16 v[120:123], v[76:79], v[24:27], v[120:123]
ds_read_b64_tr_b16 v[74:75], v5 offset:2328
v_mfma_f32_16x16x32_bf16 v[156:159], v[76:79], v[28:31], v[156:159]
v_mfma_f32_16x16x32_bf16 v[192:195], v[76:79], v[32:35], v[192:195]
s_waitcnt lgkmcnt(4)
v_mfma_f32_16x16x32_bf16 v[88:91], v[80:83], v[20:23], v[88:91]
ds_read_b64_tr_b16 v[76:77], v5 offset:32
v_mfma_f32_16x16x32_bf16 v[124:127], v[80:83], v[24:27], v[124:127]
ds_read_b64_tr_b16 v[78:79], v5 offset:2336
v_mfma_f32_16x16x32_bf16 v[160:163], v[80:83], v[28:31], v[160:163]
v_mfma_f32_16x16x32_bf16 v[196:199], v[80:83], v[32:35], v[196:199]
s_waitcnt lgkmcnt(4)
v_mfma_f32_16x16x32_bf16 v[92:95], v[68:71], v[20:23], v[92:95]
ds_read_b64_tr_b16 v[80:81], v6 offset:40
v_mfma_f32_16x16x32_bf16 v[128:131], v[68:71], v[24:27], v[128:131]
ds_read_b64_tr_b16 v[82:83], v6 offset:2344
v_mfma_f32_16x16x32_bf16 v[164:167], v[68:71], v[28:31], v[164:167]
v_mfma_f32_16x16x32_bf16 v[200:203], v[68:71], v[32:35], v[200:203]
s_waitcnt lgkmcnt(4)
v_mfma_f32_16x16x32_bf16 v[96:99], v[72:75], v[20:23], v[96:99]
ds_read_b64_tr_b16 v[68:69], v6 offset:48
v_mfma_f32_16x16x32_bf16 v[132:135], v[72:75], v[24:27], v[132:135]
ds_read_b64_tr_b16 v[70:71], v6 offset:2352
v_mfma_f32_16x16x32_bf16 v[168:171], v[72:75], v[28:31], v[168:171]
v_mfma_f32_16x16x32_bf16 v[204:207], v[72:75], v[32:35], v[204:207]
s_waitcnt lgkmcnt(4)
v_mfma_f32_16x16x32_bf16 v[100:103], v[76:79], v[20:23], v[100:103]
ds_read_b64_tr_b16 v[72:73], v6 offset:56
v_mfma_f32_16x16x32_bf16 v[136:139], v[76:79], v[24:27], v[136:139]
ds_read_b64_tr_b16 v[74:75], v6 offset:2360
v_mfma_f32_16x16x32_bf16 v[172:175], v[76:79], v[28:31], v[172:175]
v_mfma_f32_16x16x32_bf16 v[208:211], v[76:79], v[32:35], v[208:211]
s_waitcnt lgkmcnt(4)
v_mfma_f32_16x16x32_bf16 v[104:107], v[80:83], v[20:23], v[104:107]
ds_read_b64_tr_b16 v[76:77], v6 offset:64
v_mfma_f32_16x16x32_bf16 v[140:143], v[80:83], v[24:27], v[140:143]
ds_read_b64_tr_b16 v[78:79], v6 offset:2368
v_mfma_f32_16x16x32_bf16 v[176:179], v[80:83], v[28:31], v[176:179]
v_mfma_f32_16x16x32_bf16 v[212:215], v[80:83], v[32:35], v[212:215]
s_waitcnt lgkmcnt(4)
v_mfma_f32_16x16x32_bf16 v[108:111], v[68:71], v[20:23], v[108:111]
ds_read_b128 v[36:39], v2 offset:16384
ds_read_b128 v[40:43], v2 offset:18432
v_mfma_f32_16x16x32_bf16 v[144:147], v[68:71], v[24:27], v[144:147]
ds_read_b128 v[44:47], v2 offset:20480
ds_read_b128 v[48:51], v2 offset:22528
v_mfma_f32_16x16x32_bf16 v[180:183], v[68:71], v[28:31], v[180:183]
ds_read_b64_tr_b16 v[80:81], v5 offset:18432
v_mfma_f32_16x16x32_bf16 v[216:219], v[68:71], v[32:35], v[216:219]
ds_read_b64_tr_b16 v[82:83], v5 offset:20736
s_waitcnt lgkmcnt(8)
v_mfma_f32_16x16x32_bf16 v[112:115], v[72:75], v[20:23], v[112:115]
ds_read_b64_tr_b16 v[68:69], v5 offset:18440
v_mfma_f32_16x16x32_bf16 v[148:151], v[72:75], v[24:27], v[148:151]
ds_read_b64_tr_b16 v[70:71], v5 offset:20744
v_mfma_f32_16x16x32_bf16 v[184:187], v[72:75], v[28:31], v[184:187]
v_mfma_f32_16x16x32_bf16 v[220:223], v[72:75], v[32:35], v[220:223]
s_waitcnt lgkmcnt(8)
v_mfma_f32_16x16x32_bf16 v[116:119], v[76:79], v[20:23], v[116:119]
ds_read_b64_tr_b16 v[72:73], v5 offset:18448
v_mfma_f32_16x16x32_bf16 v[152:155], v[76:79], v[24:27], v[152:155]
ds_read_b64_tr_b16 v[74:75], v5 offset:20752
v_mfma_f32_16x16x32_bf16 v[188:191], v[76:79], v[28:31], v[188:191]
v_mfma_f32_16x16x32_bf16 v[224:227], v[76:79], v[32:35], v[224:227]
s_waitcnt lgkmcnt(4)
v_mfma_f32_16x16x32_bf16 v[84:87], v[80:83], v[36:39], v[84:87]
ds_read_b64_tr_b16 v[76:77], v5 offset:18456
v_mfma_f32_16x16x32_bf16 v[120:123], v[80:83], v[40:43], v[120:123]
ds_read_b64_tr_b16 v[78:79], v5 offset:20760
v_mfma_f32_16x16x32_bf16 v[156:159], v[80:83], v[44:47], v[156:159]
v_mfma_f32_16x16x32_bf16 v[192:195], v[80:83], v[48:51], v[192:195]
s_waitcnt lgkmcnt(4)
v_mfma_f32_16x16x32_bf16 v[88:91], v[68:71], v[36:39], v[88:91]
ds_read_b64_tr_b16 v[80:81], v5 offset:18464
v_mfma_f32_16x16x32_bf16 v[124:127], v[68:71], v[40:43], v[124:127]
ds_read_b64_tr_b16 v[82:83], v5 offset:20768
v_mfma_f32_16x16x32_bf16 v[160:163], v[68:71], v[44:47], v[160:163]
v_mfma_f32_16x16x32_bf16 v[196:199], v[68:71], v[48:51], v[196:199]
s_waitcnt lgkmcnt(4)
v_mfma_f32_16x16x32_bf16 v[92:95], v[72:75], v[36:39], v[92:95]
ds_read_b64_tr_b16 v[68:69], v6 offset:18472
v_mfma_f32_16x16x32_bf16 v[128:131], v[72:75], v[40:43], v[128:131]
ds_read_b64_tr_b16 v[70:71], v6 offset:20776
v_mfma_f32_16x16x32_bf16 v[164:167], v[72:75], v[44:47], v[164:167]
v_mfma_f32_16x16x32_bf16 v[200:203], v[72:75], v[48:51], v[200:203]
s_waitcnt lgkmcnt(4)
v_mfma_f32_16x16x32_bf16 v[96:99], v[76:79], v[36:39], v[96:99]
ds_read_b64_tr_b16 v[72:73], v6 offset:18480
v_mfma_f32_16x16x32_bf16 v[132:135], v[76:79], v[40:43], v[132:135]
ds_read_b64_tr_b16 v[74:75], v6 offset:20784
v_mfma_f32_16x16x32_bf16 v[168:171], v[76:79], v[44:47], v[168:171]
v_mfma_f32_16x16x32_bf16 v[204:207], v[76:79], v[48:51], v[204:207]
s_waitcnt lgkmcnt(4)
v_mfma_f32_16x16x32_bf16 v[100:103], v[80:83], v[36:39], v[100:103]
ds_read_b64_tr_b16 v[76:77], v6 offset:18488
v_mfma_f32_16x16x32_bf16 v[136:139], v[80:83], v[40:43], v[136:139]
ds_read_b64_tr_b16 v[78:79], v6 offset:20792
v_mfma_f32_16x16x32_bf16 v[172:175], v[80:83], v[44:47], v[172:175]
v_mfma_f32_16x16x32_bf16 v[208:211], v[80:83], v[48:51], v[208:211]
s_waitcnt lgkmcnt(4)
v_mfma_f32_16x16x32_bf16 v[104:107], v[68:71], v[36:39], v[104:107]
ds_read_b64_tr_b16 v[80:81], v6 offset:18496
v_mfma_f32_16x16x32_bf16 v[140:143], v[68:71], v[40:43], v[140:143]
ds_read_b64_tr_b16 v[82:83], v6 offset:20800
v_mfma_f32_16x16x32_bf16 v[176:179], v[68:71], v[44:47], v[176:179]
v_mfma_f32_16x16x32_bf16 v[212:215], v[68:71], v[48:51], v[212:215]
s_waitcnt lgkmcnt(4)
v_mfma_f32_16x16x32_bf16 v[108:111], v[72:75], v[36:39], v[108:111]
s_barrier
ds_read_b128 v[20:23], v1 offset:32768
v_mfma_f32_16x16x32_bf16 v[144:147], v[72:75], v[40:43], v[144:147]
ds_read_b128 v[24:27], v1 offset:34816
ds_read_b128 v[28:31], v1 offset:36864
v_mfma_f32_16x16x32_bf16 v[180:183], v[72:75], v[44:47], v[180:183]
ds_read_b128 v[32:35], v1 offset:38912
ds_read_b64_tr_b16 v[68:69], v7 offset:0
v_mfma_f32_16x16x32_bf16 v[216:219], v[72:75], v[48:51], v[216:219]
ds_read_b64_tr_b16 v[70:71], v7 offset:2304
s_waitcnt lgkmcnt(8)
v_mfma_f32_16x16x32_bf16 v[112:115], v[76:79], v[36:39], v[112:115]
ds_read_b128 v[52:55], v2 offset:32768
ds_read_b128 v[56:59], v2 offset:34816
v_mfma_f32_16x16x32_bf16 v[148:151], v[76:79], v[40:43], v[148:151]
ds_read_b128 v[60:63], v2 offset:36864
ds_read_b128 v[64:67], v2 offset:38912
v_mfma_f32_16x16x32_bf16 v[184:187], v[76:79], v[44:47], v[184:187]
ds_read_b64_tr_b16 v[72:73], v7 offset:18432
v_mfma_f32_16x16x32_bf16 v[220:223], v[76:79], v[48:51], v[220:223]
ds_read_b64_tr_b16 v[74:75], v7 offset:20736
s_waitcnt lgkmcnt(12)
v_mfma_f32_16x16x32_bf16 v[116:119], v[80:83], v[36:39], v[116:119]
ds_read_b64_tr_b16 v[76:77], v7 offset:8
v_mfma_f32_16x16x32_bf16 v[152:155], v[80:83], v[40:43], v[152:155]
ds_read_b64_tr_b16 v[78:79], v7 offset:2312
v_mfma_f32_16x16x32_bf16 v[188:191], v[80:83], v[44:47], v[188:191]
v_mfma_f32_16x16x32_bf16 v[224:227], v[80:83], v[48:51], v[224:227]
s_cmp_eq_u32 s38, 2
s_cbranch_scc1 L_stv
s_cmp_lg_u32 s38, 1
s_cbranch_scc1 L_stq
s_waitcnt lgkmcnt(8)
v_mfma_f32_16x16x32_bf16 v[84:87], v[68:71], v[20:23], v[84:87]
ds_read_b64_tr_b16 v[80:81], v7 offset:18440
v_mfma_f32_16x16x32_bf16 v[120:123], v[68:71], v[24:27], v[120:123]
ds_read_b64_tr_b16 v[82:83], v7 offset:20744
v_mfma_f32_16x16x32_bf16 v[156:159], v[68:71], v[28:31], v[156:159]
v_mfma_f32_16x16x32_bf16 v[192:195], v[68:71], v[32:35], v[192:195]
s_waitcnt lgkmcnt(4)
v_mfma_f32_16x16x32_bf16 v[84:87], v[72:75], v[52:55], v[84:87]
ds_read_b64_tr_b16 v[68:69], v7 offset:16
v_mfma_f32_16x16x32_bf16 v[120:123], v[72:75], v[56:59], v[120:123]
ds_read_b64_tr_b16 v[70:71], v7 offset:2320
v_mfma_f32_16x16x32_bf16 v[156:159], v[72:75], v[60:63], v[156:159]
v_mfma_f32_16x16x32_bf16 v[192:195], v[72:75], v[64:67], v[192:195]
s_waitcnt lgkmcnt(4)
v_mfma_f32_16x16x32_bf16 v[88:91], v[76:79], v[20:23], v[88:91]
ds_read_b64_tr_b16 v[72:73], v7 offset:18448
v_mfma_f32_16x16x32_bf16 v[124:127], v[76:79], v[24:27], v[124:127]
ds_read_b64_tr_b16 v[74:75], v7 offset:20752
v_mfma_f32_16x16x32_bf16 v[160:163], v[76:79], v[28:31], v[160:163]
v_mfma_f32_16x16x32_bf16 v[196:199], v[76:79], v[32:35], v[196:199]
s_waitcnt lgkmcnt(4)
v_mfma_f32_16x16x32_bf16 v[88:91], v[80:83], v[52:55], v[88:91]
ds_read_b64_tr_b16 v[76:77], v7 offset:24
v_mfma_f32_16x16x32_bf16 v[124:127], v[80:83], v[56:59], v[124:127]
ds_read_b64_tr_b16 v[78:79], v7 offset:2328
v_mfma_f32_16x16x32_bf16 v[160:163], v[80:83], v[60:63], v[160:163]
v_mfma_f32_16x16x32_bf16 v[196:199], v[80:83], v[64:67], v[196:199]
s_waitcnt lgkmcnt(4)
v_mfma_f32_16x16x32_bf16 v[92:95], v[68:71], v[20:23], v[92:95]
ds_read_b64_tr_b16 v[80:81], v7 offset:18456
v_mfma_f32_16x16x32_bf16 v[128:131], v[68:71], v[24:27], v[128:131]
ds_read_b64_tr_b16 v[82:83], v7 offset:20760
v_mfma_f32_16x16x32_bf16 v[164:167], v[68:71], v[28:31], v[164:167]
v_cvt_pk_bf16_f32 v84, v84, v85
v_cvt_pk_bf16_f32 v85, v86, v87
v_cvt_pk_bf16_f32 v86, v88, v89
v_mfma_f32_16x16x32_bf16 v[200:203], v[68:71], v[32:35], v[200:203]
v_cvt_pk_bf16_f32 v87, v90, v91
buffer_store_dwordx4 v[84:87], v244, s[24:27], s56 offen offset:0 sc1
v_cvt_pk_bf16_f32 v120, v120, v121
s_waitcnt lgkmcnt(4)
s_nop 0
v_mfma_f32_16x16x32_bf16 v[92:95], v[72:75], v[52:55], v[92:95]
ds_read_b64_tr_b16 v[68:69], v7 offset:32
v_cvt_pk_bf16_f32 v121, v122, v123
v_cvt_pk_bf16_f32 v122, v124, v125
v_cvt_pk_bf16_f32 v123, v126, v127
v_mfma_f32_16x16x32_bf16 v[128:131], v[72:75], v[56:59], v[128:131]
ds_read_b64_tr_b16 v[70:71], v7 offset:2336
buffer_store_dwordx4 v[120:123], v244, s[24:27], s56 offen offset:128 sc1
v_cvt_pk_bf16_f32 v156, v156, v157
v_cvt_pk_bf16_f32 v157, v158, v159
v_mfma_f32_16x16x32_bf16 v[164:167], v[72:75], v[60:63], v[164:167]
v_cvt_pk_bf16_f32 v158, v160, v161
v_cvt_pk_bf16_f32 v159, v162, v163
buffer_store_dwordx4 v[156:159], v244, s[24:27], s56 offen offset:256 sc1
v_mfma_f32_16x16x32_bf16 v[200:203], v[72:75], v[64:67], v[200:203]
v_cvt_pk_bf16_f32 v192, v192, v193
v_cvt_pk_bf16_f32 v193, v194, v195
v_cvt_pk_bf16_f32 v194, v196, v197
s_waitcnt lgkmcnt(4)
v_mfma_f32_16x16x32_bf16 v[96:99], v[76:79], v[20:23], v[96:99]
ds_read_b64_tr_b16 v[72:73], v7 offset:18464
v_cvt_pk_bf16_f32 v195, v198, v199
buffer_store_dwordx4 v[192:195], v244, s[24:27], s56 offen offset:384 sc1
v_mfma_f32_16x16x32_bf16 v[132:135], v[76:79], v[24:27], v[132:135]
ds_read_b64_tr_b16 v[74:75], v7 offset:20768
v_mfma_f32_16x16x32_bf16 v[168:171], v[76:79], v[28:31], v[168:171]
v_mfma_f32_16x16x32_bf16 v[204:207], v[76:79], v[32:35], v[204:207]
s_waitcnt lgkmcnt(4)
v_mfma_f32_16x16x32_bf16 v[96:99], v[80:83], v[52:55], v[96:99]
ds_read_b64_tr_b16 v[76:77], v8 offset:40
v_mfma_f32_16x16x32_bf16 v[132:135], v[80:83], v[56:59], v[132:135]
ds_read_b64_tr_b16 v[78:79], v8 offset:2344
v_mfma_f32_16x16x32_bf16 v[168:171], v[80:83], v[60:63], v[168:171]
v_mfma_f32_16x16x32_bf16 v[204:207], v[80:83], v[64:67], v[204:207]
s_waitcnt lgkmcnt(4)
s_nop 0
v_mfma_f32_16x16x32_bf16 v[100:103], v[68:71], v[20:23], v[100:103]
ds_read_b64_tr_b16 v[80:81], v8 offset:18472
v_mfma_f32_16x16x32_bf16 v[136:139], v[68:71], v[24:27], v[136:139]
ds_read_b64_tr_b16 v[82:83], v8 offset:20776
v_mfma_f32_16x16x32_bf16 v[172:175], v[68:71], v[28:31], v[172:175]
v_cvt_pk_bf16_f32 v92, v92, v93
v_cvt_pk_bf16_f32 v93, v94, v95
v_cvt_pk_bf16_f32 v94, v96, v97
v_mfma_f32_16x16x32_bf16 v[208:211], v[68:71], v[32:35], v[208:211]
v_cvt_pk_bf16_f32 v95, v98, v99
buffer_store_dwordx4 v[92:95], v244, s[24:27], s56 offen offset:512 sc1
v_cvt_pk_bf16_f32 v128, v128, v129
s_waitcnt lgkmcnt(4)
s_nop 0
v_mfma_f32_16x16x32_bf16 v[100:103], v[72:75], v[52:55], v[100:103]
ds_read_b64_tr_b16 v[68:69], v8 offset:48
v_cvt_pk_bf16_f32 v129, v130, v131
v_cvt_pk_bf16_f32 v130, v132, v133
v_cvt_pk_bf16_f32 v131, v134, v135
v_mfma_f32_16x16x32_bf16 v[136:139], v[72:75], v[56:59], v[136:139]
ds_read_b64_tr_b16 v[70:71], v8 offset:2352
buffer_store_dwordx4 v[128:131], v244, s[24:27], s56 offen offset:640 sc1
v_cvt_pk_bf16_f32 v164, v164, v165
v_cvt_pk_bf16_f32 v165, v166, v167
v_mfma_f32_16x16x32_bf16 v[172:175], v[72:75], v[60:63], v[172:175]
v_cvt_pk_bf16_f32 v166, v168, v169
v_cvt_pk_bf16_f32 v167, v170, v171
buffer_store_dwordx4 v[164:167], v244, s[24:27], s56 offen offset:768 sc1
v_mfma_f32_16x16x32_bf16 v[208:211], v[72:75], v[64:67], v[208:211]
v_cvt_pk_bf16_f32 v200, v200, v201
v_cvt_pk_bf16_f32 v201, v202, v203
v_cvt_pk_bf16_f32 v202, v204, v205
s_waitcnt lgkmcnt(4)
s_nop 0
v_mfma_f32_16x16x32_bf16 v[104:107], v[76:79], v[20:23], v[104:107]
ds_read_b64_tr_b16 v[72:73], v8 offset:18480
v_cvt_pk_bf16_f32 v203, v206, v207
buffer_store_dwordx4 v[200:203], v244, s[24:27], s56 offen offset:896 sc1
v_mfma_f32_16x16x32_bf16 v[140:143], v[76:79], v[24:27], v[140:143]
ds_read_b64_tr_b16 v[74:75], v8 offset:20784
v_mfma_f32_16x16x32_bf16 v[176:179], v[76:79], v[28:31], v[176:179]
v_cvt_pk_bf16_f32 v228, v100, v101
v_cvt_pk_bf16_f32 v229, v136, v137
v_cvt_pk_bf16_f32 v230, v172, v173
v_mfma_f32_16x16x32_bf16 v[212:215], v[76:79], v[32:35], v[212:215]
v_cvt_pk_bf16_f32 v231, v208, v209
buffer_store_dwordx4 v[228:231], v244, s[24:27], s56 offen offset:1024 sc1
s_waitcnt lgkmcnt(4)
v_mfma_f32_16x16x32_bf16 v[104:107], v[80:83], v[52:55], v[104:107]
ds_read_b64_tr_b16 v[76:77], v8 offset:56
v_mfma_f32_16x16x32_bf16 v[140:143], v[80:83], v[56:59], v[140:143]
ds_read_b64_tr_b16 v[78:79], v8 offset:2360
v_mfma_f32_16x16x32_bf16 v[176:179], v[80:83], v[60:63], v[176:179]
v_mfma_f32_16x16x32_bf16 v[212:215], v[80:83], v[64:67], v[212:215]
s_waitcnt lgkmcnt(4)
v_mfma_f32_16x16x32_bf16 v[108:111], v[68:71], v[20:23], v[108:111]
ds_read_b64_tr_b16 v[80:81], v8 offset:18488
v_mfma_f32_16x16x32_bf16 v[144:147], v[68:71], v[24:27], v[144:147]
ds_read_b64_tr_b16 v[82:83], v8 offset:20792
v_mfma_f32_16x16x32_bf16 v[180:183], v[68:71], v[28:31], v[180:183]
v_mfma_f32_16x16x32_bf16 v[216:219], v[68:71], v[32:35], v[216:219]
s_waitcnt lgkmcnt(4)
v_mfma_f32_16x16x32_bf16 v[108:111], v[72:75], v[52:55], v[108:111]
ds_read_b64_tr_b16 v[68:69], v8 offset:64
v_mfma_f32_16x16x32_bf16 v[144:147], v[72:75], v[56:59], v[144:147]
ds_read_b64_tr_b16 v[70:71], v8 offset:2368
v_mfma_f32_16x16x32_bf16 v[180:183], v[72:75], v[60:63], v[180:183]
v_mfma_f32_16x16x32_bf16 v[216:219], v[72:75], v[64:67], v[216:219]
s_waitcnt lgkmcnt(4)
v_mfma_f32_16x16x32_bf16 v[112:115], v[76:79], v[20:23], v[112:115]
ds_read_b64_tr_b16 v[72:73], v8 offset:18496
v_mfma_f32_16x16x32_bf16 v[148:151], v[76:79], v[24:27], v[148:151]
ds_read_b64_tr_b16 v[74:75], v8 offset:20800
v_mfma_f32_16x16x32_bf16 v[184:187], v[76:79], v[28:31], v[184:187]
v_cvt_pk_bf16_f32 v102, v102, v103
v_cvt_pk_bf16_f32 v103, v104, v105
v_cvt_pk_bf16_f32 v104, v106, v107
v_mfma_f32_16x16x32_bf16 v[220:223], v[76:79], v[32:35], v[220:223]
v_cvt_pk_bf16_f32 v105, v108, v109
buffer_store_dwordx4 v[102:105], v244, s[24:27], s57 offen offset:0 sc1
v_cvt_pk_bf16_f32 v138, v138, v139
s_waitcnt lgkmcnt(4)
s_nop 0
v_mfma_f32_16x16x32_bf16 v[112:115], v[80:83], v[52:55], v[112:115]
v_cvt_pk_bf16_f32 v139, v140, v141
v_cvt_pk_bf16_f32 v140, v142, v143
v_cvt_pk_bf16_f32 v141, v144, v145
v_mfma_f32_16x16x32_bf16 v[148:151], v[80:83], v[56:59], v[148:151]
buffer_store_dwordx4 v[138:141], v244, s[24:27], s57 offen offset:128 sc1
v_cvt_pk_bf16_f32 v174, v174, v175
v_cvt_pk_bf16_f32 v175, v176, v177
v_mfma_f32_16x16x32_bf16 v[184:187], v[80:83], v[60:63], v[184:187]
v_cvt_pk_bf16_f32 v176, v178, v179
v_cvt_pk_bf16_f32 v177, v180, v181
buffer_store_dwordx4 v[174:177], v244, s[24:27], s57 offen offset:256 sc1
v_mfma_f32_16x16x32_bf16 v[220:223], v[80:83], v[64:67], v[220:223]
v_cvt_pk_bf16_f32 v210, v210, v211
v_cvt_pk_bf16_f32 v211, v212, v213
v_cvt_pk_bf16_f32 v212, v214, v215
s_waitcnt lgkmcnt(2)
v_mfma_f32_16x16x32_bf16 v[116:119], v[68:71], v[20:23], v[116:119]
v_cvt_pk_bf16_f32 v213, v216, v217
buffer_store_dwordx4 v[210:213], v244, s[24:27], s57 offen offset:384 sc1
v_mfma_f32_16x16x32_bf16 v[152:155], v[68:71], v[24:27], v[152:155]
v_mfma_f32_16x16x32_bf16 v[188:191], v[68:71], v[28:31], v[188:191]
v_mfma_f32_16x16x32_bf16 v[224:227], v[68:71], v[32:35], v[224:227]
s_waitcnt lgkmcnt(0)
v_mfma_f32_16x16x32_bf16 v[116:119], v[72:75], v[52:55], v[116:119]
v_mfma_f32_16x16x32_bf16 v[152:155], v[72:75], v[56:59], v[152:155]
v_mfma_f32_16x16x32_bf16 v[188:191], v[72:75], v[60:63], v[188:191]
v_mfma_f32_16x16x32_bf16 v[224:227], v[72:75], v[64:67], v[224:227]
v_cvt_pk_bf16_f32 v110, v110, v111
v_cvt_pk_bf16_f32 v111, v112, v113
v_cvt_pk_bf16_f32 v112, v114, v115
s_nop 1
s_nop 0
v_cvt_pk_bf16_f32 v113, v116, v117
buffer_store_dwordx4 v[110:113], v244, s[24:27], s57 offen offset:512 sc1
v_cvt_pk_bf16_f32 v146, v146, v147
v_cvt_pk_bf16_f32 v147, v148, v149
v_cvt_pk_bf16_f32 v148, v150, v151
v_cvt_pk_bf16_f32 v149, v152, v153
buffer_store_dwordx4 v[146:149], v244, s[24:27], s57 offen offset:640 sc1
v_cvt_pk_bf16_f32 v182, v182, v183
v_cvt_pk_bf16_f32 v183, v184, v185
v_cvt_pk_bf16_f32 v184, v186, v187
v_cvt_pk_bf16_f32 v185, v188, v189
buffer_store_dwordx4 v[182:185], v244, s[24:27], s57 offen offset:768 sc1
v_cvt_pk_bf16_f32 v218, v218, v219
v_cvt_pk_bf16_f32 v219, v220, v221
v_cvt_pk_bf16_f32 v220, v222, v223
v_cvt_pk_bf16_f32 v221, v224, v225
buffer_store_dwordx4 v[218:221], v244, s[24:27], s57 offen offset:896 sc1
v_cvt_pk_bf16_f32 v236, v118, v119
v_cvt_pk_bf16_f32 v237, v154, v155
v_cvt_pk_bf16_f32 v238, v190, v191
v_cvt_pk_bf16_f32 v239, v226, v227
buffer_store_dwordx4 v[236:239], v244, s[24:27], s57 offen offset:1024 sc1
s_branch L_p2C
L_stv:
L_pdR3_0:
s_cbranch_execz L_retR
s_waitcnt lgkmcnt(8)
v_mfma_f32_16x16x32_bf16 v[84:87], v[68:71], v[20:23], v[84:87]
ds_read_b64_tr_b16 v[80:81], v7 offset:18440
v_mfma_f32_16x16x32_bf16 v[120:123], v[68:71], v[24:27], v[120:123]
ds_read_b64_tr_b16 v[82:83], v7 offset:20744
v_mfma_f32_16x16x32_bf16 v[156:159], v[68:71], v[28:31], v[156:159]
v_mfma_f32_16x16x32_bf16 v[192:195], v[68:71], v[32:35], v[192:195]
s_waitcnt lgkmcnt(4)
v_mfma_f32_16x16x32_bf16 v[84:87], v[72:75], v[52:55], v[84:87]
ds_read_b64_tr_b16 v[68:69], v7 offset:16
v_mfma_f32_16x16x32_bf16 v[120:123], v[72:75], v[56:59], v[120:123]
ds_read_b64_tr_b16 v[70:71], v7 offset:2320
v_mfma_f32_16x16x32_bf16 v[156:159], v[72:75], v[60:63], v[156:159]
v_mfma_f32_16x16x32_bf16 v[192:195], v[72:75], v[64:67], v[192:195]
s_waitcnt lgkmcnt(4)
v_mfma_f32_16x16x32_bf16 v[88:91], v[76:79], v[20:23], v[88:91]
ds_read_b64_tr_b16 v[72:73], v7 offset:18448
v_mfma_f32_16x16x32_bf16 v[124:127], v[76:79], v[24:27], v[124:127]
ds_read_b64_tr_b16 v[74:75], v7 offset:20752
v_mfma_f32_16x16x32_bf16 v[160:163], v[76:79], v[28:31], v[160:163]
v_mfma_f32_16x16x32_bf16 v[196:199], v[76:79], v[32:35], v[196:199]
s_waitcnt lgkmcnt(4)
v_mfma_f32_16x16x32_bf16 v[88:91], v[80:83], v[52:55], v[88:91]
ds_read_b64_tr_b16 v[76:77], v7 offset:24
v_mfma_f32_16x16x32_bf16 v[124:127], v[80:83], v[56:59], v[124:127]
ds_read_b64_tr_b16 v[78:79], v7 offset:2328
v_mfma_f32_16x16x32_bf16 v[160:163], v[80:83], v[60:63], v[160:163]
v_mfma_f32_16x16x32_bf16 v[196:199], v[80:83], v[64:67], v[196:199]
s_waitcnt lgkmcnt(4)
s_nop 0
v_mfma_f32_16x16x32_bf16 v[92:95], v[68:71], v[20:23], v[92:95]
ds_read_b64_tr_b16 v[80:81], v7 offset:18456
v_mfma_f32_16x16x32_bf16 v[128:131], v[68:71], v[24:27], v[128:131]
ds_read_b64_tr_b16 v[82:83], v7 offset:20760
v_mfma_f32_16x16x32_bf16 v[164:167], v[68:71], v[28:31], v[164:167]
v_cvt_pk_bf16_f32 v84, v84, v85
v_cvt_pk_bf16_f32 v85, v86, v87
v_cvt_pk_bf16_f32 v86, v88, v89
v_mfma_f32_16x16x32_bf16 v[200:203], v[68:71], v[32:35], v[200:203]
v_cvt_pk_bf16_f32 v87, v90, v91
buffer_store_dwordx4 v[84:87], v244, s[24:27], s56 offen offset:0 sc1
v_cvt_pk_bf16_f32 v120, v120, v121
s_waitcnt lgkmcnt(4)
s_nop 0
v_mfma_f32_16x16x32_bf16 v[92:95], v[72:75], v[52:55], v[92:95]
ds_read_b64_tr_b16 v[68:69], v7 offset:32
v_cvt_pk_bf16_f32 v121, v122, v123
v_cvt_pk_bf16_f32 v122, v124, v125
v_cvt_pk_bf16_f32 v123, v126, v127
v_mfma_f32_16x16x32_bf16 v[128:131], v[72:75], v[56:59], v[128:131]
ds_read_b64_tr_b16 v[70:71], v7 offset:2336
buffer_store_dwordx4 v[120:123], v244, s[24:27], s56 offen offset:128 sc1
v_cvt_pk_bf16_f32 v156, v156, v157
v_cvt_pk_bf16_f32 v157, v158, v159
v_mfma_f32_16x16x32_bf16 v[164:167], v[72:75], v[60:63], v[164:167]
v_cvt_pk_bf16_f32 v158, v160, v161
v_cvt_pk_bf16_f32 v159, v162, v163
buffer_store_dwordx4 v[156:159], v244, s[24:27], s56 offen offset:256 sc1
v_mfma_f32_16x16x32_bf16 v[200:203], v[72:75], v[64:67], v[200:203]
v_cvt_pk_bf16_f32 v192, v192, v193
v_cvt_pk_bf16_f32 v193, v194, v195
v_cvt_pk_bf16_f32 v194, v196, v197
s_waitcnt lgkmcnt(4)
v_mfma_f32_16x16x32_bf16 v[96:99], v[76:79], v[20:23], v[96:99]
ds_read_b64_tr_b16 v[72:73], v7 offset:18464
v_cvt_pk_bf16_f32 v195, v198, v199
buffer_store_dwordx4 v[192:195], v244, s[24:27], s56 offen offset:384 sc1
v_mfma_f32_16x16x32_bf16 v[132:135], v[76:79], v[24:27], v[132:135]
ds_read_b64_tr_b16 v[74:75], v7 offset:20768
v_mfma_f32_16x16x32_bf16 v[168:171], v[76:79], v[28:31], v[168:171]
v_mfma_f32_16x16x32_bf16 v[204:207], v[76:79], v[32:35], v[204:207]
s_waitcnt lgkmcnt(4)
v_mfma_f32_16x16x32_bf16 v[96:99], v[80:83], v[52:55], v[96:99]
ds_read_b64_tr_b16 v[76:77], v8 offset:40
v_mfma_f32_16x16x32_bf16 v[132:135], v[80:83], v[56:59], v[132:135]
ds_read_b64_tr_b16 v[78:79], v8 offset:2344
v_mfma_f32_16x16x32_bf16 v[168:171], v[80:83], v[60:63], v[168:171]
v_mfma_f32_16x16x32_bf16 v[204:207], v[80:83], v[64:67], v[204:207]
s_waitcnt lgkmcnt(4)
s_nop 0
v_mfma_f32_16x16x32_bf16 v[100:103], v[68:71], v[20:23], v[100:103]
ds_read_b64_tr_b16 v[80:81], v8 offset:18472
v_mfma_f32_16x16x32_bf16 v[136:139], v[68:71], v[24:27], v[136:139]
ds_read_b64_tr_b16 v[82:83], v8 offset:20776
v_mfma_f32_16x16x32_bf16 v[172:175], v[68:71], v[28:31], v[172:175]
v_cvt_pk_bf16_f32 v92, v92, v93
v_cvt_pk_bf16_f32 v93, v94, v95
v_cvt_pk_bf16_f32 v94, v96, v97
v_mfma_f32_16x16x32_bf16 v[208:211], v[68:71], v[32:35], v[208:211]
v_cvt_pk_bf16_f32 v95, v98, v99
buffer_store_dwordx4 v[92:95], v245, s[24:27], s56 offen offset:512 sc1
v_cvt_pk_bf16_f32 v128, v128, v129
s_waitcnt lgkmcnt(4)
s_nop 0
v_mfma_f32_16x16x32_bf16 v[100:103], v[72:75], v[52:55], v[100:103]
ds_read_b64_tr_b16 v[68:69], v8 offset:48
v_cvt_pk_bf16_f32 v129, v130, v131
v_cvt_pk_bf16_f32 v130, v132, v133
v_cvt_pk_bf16_f32 v131, v134, v135
v_mfma_f32_16x16x32_bf16 v[136:139], v[72:75], v[56:59], v[136:139]
ds_read_b64_tr_b16 v[70:71], v8 offset:2352
buffer_store_dwordx4 v[128:131], v245, s[24:27], s56 offen offset:640 sc1
v_cvt_pk_bf16_f32 v164, v164, v165
v_cvt_pk_bf16_f32 v165, v166, v167
v_mfma_f32_16x16x32_bf16 v[172:175], v[72:75], v[60:63], v[172:175]
v_cvt_pk_bf16_f32 v166, v168, v169
v_cvt_pk_bf16_f32 v167, v170, v171
buffer_store_dwordx4 v[164:167], v245, s[24:27], s56 offen offset:768 sc1
v_mfma_f32_16x16x32_bf16 v[208:211], v[72:75], v[64:67], v[208:211]
v_cvt_pk_bf16_f32 v200, v200, v201
v_cvt_pk_bf16_f32 v201, v202, v203
v_cvt_pk_bf16_f32 v202, v204, v205
s_waitcnt lgkmcnt(4)
s_nop 0
v_mfma_f32_16x16x32_bf16 v[104:107], v[76:79], v[20:23], v[104:107]
L_pdR0_1:
s_cbranch_execz L_retR
s_nop 0
ds_read_b64_tr_b16 v[72:73], v8 offset:18480
v_cvt_pk_bf16_f32 v203, v206, v207
buffer_store_dwordx4 v[200:203], v245, s[24:27], s56 offen offset:896 sc1
v_mfma_f32_16x16x32_bf16 v[140:143], v[76:79], v[24:27], v[140:143]
ds_read_b64_tr_b16 v[74:75], v8 offset:20784
v_mfma_f32_16x16x32_bf16 v[176:179], v[76:79], v[28:31], v[176:179]
v_cvt_pk_bf16_f32 v228, v100, v101
v_cvt_pk_bf16_f32 v232, v136, v137
v_cvt_pk_bf16_f32 v230, v172, v173
v_mfma_f32_16x16x32_bf16 v[212:215], v[76:79], v[32:35], v[212:215]
v_cvt_pk_bf16_f32 v234, v208, v209
buffer_store_dwordx4 v[228:231], v244, s[24:27], s56 offen offset:1152 sc1
buffer_store_dwordx4 v[232:235], v244, s[24:27], s56 offen offset:1024 sc1
s_waitcnt lgkmcnt(4)
v_mfma_f32_16x16x32_bf16 v[104:107], v[80:83], v[52:55], v[104:107]
ds_read_b64_tr_b16 v[76:77], v8 offset:56
v_mfma_f32_16x16x32_bf16 v[140:143], v[80:83], v[56:59], v[140:143]
ds_read_b64_tr_b16 v[78:79], v8 offset:2360
v_mfma_f32_16x16x32_bf16 v[176:179], v[80:83], v[60:63], v[176:179]
v_mfma_f32_16x16x32_bf16 v[212:215], v[80:83], v[64:67], v[212:215]
s_waitcnt lgkmcnt(4)
v_mfma_f32_16x16x32_bf16 v[108:111], v[68:71], v[20:23], v[108:111]
ds_read_b64_tr_b16 v[80:81], v8 offset:18488
v_mfma_f32_16x16x32_bf16 v[144:147], v[68:71], v[24:27], v[144:147]
ds_read_b64_tr_b16 v[82:83], v8 offset:20792
v_mfma_f32_16x16x32_bf16 v[180:183], v[68:71], v[28:31], v[180:183]
v_mfma_f32_16x16x32_bf16 v[216:219], v[68:71], v[32:35], v[216:219]
s_waitcnt lgkmcnt(4)
v_mfma_f32_16x16x32_bf16 v[108:111], v[72:75], v[52:55], v[108:111]
ds_read_b64_tr_b16 v[68:69], v8 offset:64
v_mfma_f32_16x16x32_bf16 v[144:147], v[72:75], v[56:59], v[144:147]
ds_read_b64_tr_b16 v[70:71], v8 offset:2368
v_mfma_f32_16x16x32_bf16 v[180:183], v[72:75], v[60:63], v[180:183]
v_mfma_f32_16x16x32_bf16 v[216:219], v[72:75], v[64:67], v[216:219]
s_waitcnt lgkmcnt(4)
v_mfma_f32_16x16x32_bf16 v[112:115], v[76:79], v[20:23], v[112:115]
ds_read_b64_tr_b16 v[72:73], v8 offset:18496
v_mfma_f32_16x16x32_bf16 v[148:151], v[76:79], v[24:27], v[148:151]
ds_read_b64_tr_b16 v[74:75], v8 offset:20800
v_mfma_f32_16x16x32_bf16 v[184:187], v[76:79], v[28:31], v[184:187]
v_cvt_pk_bf16_f32 v102, v102, v103
v_cvt_pk_bf16_f32 v103, v104, v105
v_cvt_pk_bf16_f32 v104, v106, v107
v_mfma_f32_16x16x32_bf16 v[220:223], v[76:79], v[32:35], v[220:223]
v_cvt_pk_bf16_f32 v105, v108, v109
buffer_store_dwordx4 v[102:105], v244, s[24:27], s57 offen offset:0 sc1
v_cvt_pk_bf16_f32 v138, v138, v139
s_waitcnt lgkmcnt(4)
s_nop 0
v_mfma_f32_16x16x32_bf16 v[112:115], v[80:83], v[52:55], v[112:115]
v_cvt_pk_bf16_f32 v139, v140, v141
v_cvt_pk_bf16_f32 v140, v142, v143
v_cvt_pk_bf16_f32 v141, v144, v145
v_mfma_f32_16x16x32_bf16 v[148:151], v[80:83], v[56:59], v[148:151]
buffer_store_dwordx4 v[138:141], v244, s[24:27], s57 offen offset:128 sc1
v_cvt_pk_bf16_f32 v174, v174, v175
v_cvt_pk_bf16_f32 v175, v176, v177
v_mfma_f32_16x16x32_bf16 v[184:187], v[80:83], v[60:63], v[184:187]
v_cvt_pk_bf16_f32 v176, v178, v179
v_cvt_pk_bf16_f32 v177, v180, v181
buffer_store_dwordx4 v[174:177], v244, s[24:27], s57 offen offset:256 sc1
v_mfma_f32_16x16x32_bf16 v[220:223], v[80:83], v[64:67], v[220:223]
v_cvt_pk_bf16_f32 v210, v210, v211
v_cvt_pk_bf16_f32 v211, v212, v213
v_cvt_pk_bf16_f32 v212, v214, v215
s_waitcnt lgkmcnt(2)
v_mfma_f32_16x16x32_bf16 v[116:119], v[68:71], v[20:23], v[116:119]
v_cvt_pk_bf16_f32 v213, v216, v217
buffer_store_dwordx4 v[210:213], v244, s[24:27], s57 offen offset:384 sc1
v_mfma_f32_16x16x32_bf16 v[152:155], v[68:71], v[24:27], v[152:155]
v_mfma_f32_16x16x32_bf16 v[188:191], v[68:71], v[28:31], v[188:191]
v_mfma_f32_16x16x32_bf16 v[224:227], v[68:71], v[32:35], v[224:227]
s_waitcnt lgkmcnt(0)
v_mfma_f32_16x16x32_bf16 v[116:119], v[72:75], v[52:55], v[116:119]
v_mfma_f32_16x16x32_bf16 v[152:155], v[72:75], v[56:59], v[152:155]
v_mfma_f32_16x16x32_bf16 v[188:191], v[72:75], v[60:63], v[188:191]
v_mfma_f32_16x16x32_bf16 v[224:227], v[72:75], v[64:67], v[224:227]
v_cvt_pk_bf16_f32 v110, v110, v111
v_cvt_pk_bf16_f32 v111, v112, v113
v_cvt_pk_bf16_f32 v112, v114, v115
s_nop 1
s_nop 0
v_cvt_pk_bf16_f32 v113, v116, v117
buffer_store_dwordx4 v[110:113], v245, s[24:27], s57 offen offset:512 sc1
v_cvt_pk_bf16_f32 v146, v146, v147
v_cvt_pk_bf16_f32 v147, v148, v149
v_cvt_pk_bf16_f32 v148, v150, v151
v_cvt_pk_bf16_f32 v149, v152, v153
buffer_store_dwordx4 v[146:149], v245, s[24:27], s57 offen offset:640 sc1
v_cvt_pk_bf16_f32 v182, v182, v183
v_cvt_pk_bf16_f32 v183, v184, v185
v_cvt_pk_bf16_f32 v184, v186, v187
v_cvt_pk_bf16_f32 v185, v188, v189
buffer_store_dwordx4 v[182:185], v245, s[24:27], s57 offen offset:768 sc1
v_cvt_pk_bf16_f32 v218, v218, v219
v_cvt_pk_bf16_f32 v219, v220, v221
v_cvt_pk_bf16_f32 v220, v222, v223
v_cvt_pk_bf16_f32 v221, v224, v225
buffer_store_dwordx4 v[218:221], v245, s[24:27], s57 offen offset:896 sc1
v_cvt_pk_bf16_f32 v236, v118, v119
v_cvt_pk_bf16_f32 v240, v154, v155
v_cvt_pk_bf16_f32 v238, v190, v191
v_cvt_pk_bf16_f32 v242, v226, v227
buffer_store_dwordx4 v[236:239], v244, s[24:27], s57 offen offset:1152 sc1
buffer_store_dwordx4 v[240:243], v244, s[24:27], s57 offen offset:1024 sc1
s_branch L_p2C
L_stq:
L_pdR1_1:
s_cbranch_execz L_retR
s_waitcnt lgkmcnt(8)
v_mfma_f32_16x16x32_bf16 v[84:87], v[68:71], v[20:23], v[84:87]
ds_read_b64_tr_b16 v[80:81], v7 offset:18440
v_mfma_f32_16x16x32_bf16 v[120:123], v[68:71], v[24:27], v[120:123]
ds_read_b64_tr_b16 v[82:83], v7 offset:20744
v_mfma_f32_16x16x32_bf16 v[156:159], v[68:71], v[28:31], v[156:159]
v_mfma_f32_16x16x32_bf16 v[192:195], v[68:71], v[32:35], v[192:195]
s_waitcnt lgkmcnt(4)
v_mfma_f32_16x16x32_bf16 v[84:87], v[72:75], v[52:55], v[84:87]
ds_read_b64_tr_b16 v[68:69], v7 offset:16
v_mfma_f32_16x16x32_bf16 v[120:123], v[72:75], v[56:59], v[120:123]
ds_read_b64_tr_b16 v[70:71], v7 offset:2320
v_mfma_f32_16x16x32_bf16 v[156:159], v[72:75], v[60:63], v[156:159]
v_mfma_f32_16x16x32_bf16 v[192:195], v[72:75], v[64:67], v[192:195]
s_waitcnt lgkmcnt(4)
v_mfma_f32_16x16x32_bf16 v[88:91], v[76:79], v[20:23], v[88:91]
ds_read_b64_tr_b16 v[72:73], v7 offset:18448
v_mfma_f32_16x16x32_bf16 v[124:127], v[76:79], v[24:27], v[124:127]
ds_read_b64_tr_b16 v[74:75], v7 offset:20752
v_mfma_f32_16x16x32_bf16 v[160:163], v[76:79], v[28:31], v[160:163]
v_mfma_f32_16x16x32_bf16 v[196:199], v[76:79], v[32:35], v[196:199]
s_waitcnt lgkmcnt(4)
v_mfma_f32_16x16x32_bf16 v[88:91], v[80:83], v[52:55], v[88:91]
ds_read_b64_tr_b16 v[76:77], v7 offset:24
v_mfma_f32_16x16x32_bf16 v[124:127], v[80:83], v[56:59], v[124:127]
ds_read_b64_tr_b16 v[78:79], v7 offset:2328
v_mfma_f32_16x16x32_bf16 v[160:163], v[80:83], v[60:63], v[160:163]
v_mfma_f32_16x16x32_bf16 v[196:199], v[80:83], v[64:67], v[196:199]
s_waitcnt lgkmcnt(4)
v_mfma_f32_16x16x32_bf16 v[92:95], v[68:71], v[20:23], v[92:95]
ds_read_b64_tr_b16 v[80:81], v7 offset:18456
v_mfma_f32_16x16x32_bf16 v[128:131], v[68:71], v[24:27], v[128:131]
ds_read_b64_tr_b16 v[82:83], v7 offset:20760
v_mfma_f32_16x16x32_bf16 v[164:167], v[68:71], v[28:31], v[164:167]
v_mul_f32 v84, s62, v84
v_mul_f32_e64 v85, s62, v85
v_cvt_pk_bf16_f32 v84, v84, v85
v_mfma_f32_16x16x32_bf16 v[200:203], v[68:71], v[32:35], v[200:203]
v_mul_f32 v86, s62, v86
v_mul_f32 v87, s62, v87
v_cvt_pk_bf16_f32 v85, v86, v87
s_waitcnt lgkmcnt(4)
v_mfma_f32_16x16x32_bf16 v[92:95], v[72:75], v[52:55], v[92:95]
ds_read_b64_tr_b16 v[68:69], v7 offset:32
v_mul_f32 v88, s62, v88
v_mul_f32_e64 v89, s62, v89
v_cvt_pk_bf16_f32 v86, v88, v89
v_mfma_f32_16x16x32_bf16 v[128:131], v[72:75], v[56:59], v[128:131]
ds_read_b64_tr_b16 v[70:71], v7 offset:2336
v_mul_f32 v90, s62, v90
v_mul_f32 v91, s62, v91
v_cvt_pk_bf16_f32 v87, v90, v91
v_mfma_f32_16x16x32_bf16 v[164:167], v[72:75], v[60:63], v[164:167]
buffer_store_dwordx4 v[84:87], v244, s[24:27], s56 offen offset:0 sc1
v_mul_f32 v120, s62, v120
v_mul_f32 v121, s62, v121
v_mfma_f32_16x16x32_bf16 v[200:203], v[72:75], v[64:67], v[200:203]
v_cvt_pk_bf16_f32 v120, v120, v121
v_mul_f32 v122, s62, v122
v_mul_f32_e64 v123, s62, v123
s_waitcnt lgkmcnt(4)
v_mfma_f32_16x16x32_bf16 v[96:99], v[76:79], v[20:23], v[96:99]
ds_read_b64_tr_b16 v[72:73], v7 offset:18464
v_cvt_pk_bf16_f32 v121, v122, v123
v_mul_f32 v124, s62, v124
v_mul_f32 v125, s62, v125
v_mfma_f32_16x16x32_bf16 v[132:135], v[76:79], v[24:27], v[132:135]
ds_read_b64_tr_b16 v[74:75], v7 offset:20768
v_cvt_pk_bf16_f32 v122, v124, v125
v_mul_f32 v126, s62, v126
v_mul_f32 v127, s62, v127
v_mfma_f32_16x16x32_bf16 v[168:171], v[76:79], v[28:31], v[168:171]
v_cvt_pk_bf16_f32 v123, v126, v127
buffer_store_dwordx4 v[120:123], v244, s[24:27], s56 offen offset:128 sc1
v_mul_f32_e64 v156, s62, v156
v_mfma_f32_16x16x32_bf16 v[204:207], v[76:79], v[32:35], v[204:207]
v_mul_f32_e64 v157, s62, v157
v_cvt_pk_bf16_f32 v156, v156, v157
v_mul_f32 v158, s62, v158
s_waitcnt lgkmcnt(4)
v_mfma_f32_16x16x32_bf16 v[96:99], v[80:83], v[52:55], v[96:99]
ds_read_b64_tr_b16 v[76:77], v8 offset:40
v_mul_f32_e64 v159, s62, v159
v_cvt_pk_bf16_f32 v157, v158, v159
v_mul_f32_e64 v160, s62, v160
v_mfma_f32_16x16x32_bf16 v[132:135], v[80:83], v[56:59], v[132:135]
ds_read_b64_tr_b16 v[78:79], v8 offset:2344
v_mul_f32_e64 v161, s62, v161
v_cvt_pk_bf16_f32 v158, v160, v161
v_mul_f32_e64 v162, s62, v162
v_mfma_f32_16x16x32_bf16 v[168:171], v[80:83], v[60:63], v[168:171]
v_mul_f32_e64 v163, s62, v163
v_cvt_pk_bf16_f32 v159, v162, v163
buffer_store_dwordx4 v[156:159], v244, s[24:27], s56 offen offset:256 sc1
v_mfma_f32_16x16x32_bf16 v[204:207], v[80:83], v[64:67], v[204:207]
v_mul_f32 v192, s62, v192
v_mul_f32 v193, s62, v193
v_cvt_pk_bf16_f32 v192, v192, v193
s_waitcnt lgkmcnt(4)
v_mfma_f32_16x16x32_bf16 v[100:103], v[68:71], v[20:23], v[100:103]
ds_read_b64_tr_b16 v[80:81], v8 offset:18472
v_mul_f32 v194, s62, v194
v_mul_f32_e64 v195, s62, v195
v_cvt_pk_bf16_f32 v193, v194, v195
v_mfma_f32_16x16x32_bf16 v[136:139], v[68:71], v[24:27], v[136:139]
ds_read_b64_tr_b16 v[82:83], v8 offset:20776
v_mul_f32 v196, s62, v196
v_mul_f32 v197, s62, v197
v_cvt_pk_bf16_f32 v194, v196, v197
v_mfma_f32_16x16x32_bf16 v[172:175], v[68:71], v[28:31], v[172:175]
v_mul_f32 v198, s62, v198
v_mul_f32 v199, s62, v199
v_cvt_pk_bf16_f32 v195, v198, v199
v_mfma_f32_16x16x32_bf16 v[208:211], v[68:71], v[32:35], v[208:211]
buffer_store_dwordx4 v[192:195], v244, s[24:27], s56 offen offset:384 sc1
v_mul_f32 v92, s62, v92
v_mul_f32_e64 v93, s62, v93
s_waitcnt lgkmcnt(4)
v_mfma_f32_16x16x32_bf16 v[100:103], v[72:75], v[52:55], v[100:103]
ds_read_b64_tr_b16 v[68:69], v8 offset:48
v_cvt_pk_bf16_f32 v92, v92, v93
v_mul_f32 v94, s62, v94
v_mul_f32 v95, s62, v95
v_mfma_f32_16x16x32_bf16 v[136:139], v[72:75], v[56:59], v[136:139]
ds_read_b64_tr_b16 v[70:71], v8 offset:2352
v_cvt_pk_bf16_f32 v93, v94, v95
v_mul_f32 v96, s62, v96
v_mul_f32 v97, s62, v97
v_mfma_f32_16x16x32_bf16 v[172:175], v[72:75], v[60:63], v[172:175]
v_cvt_pk_bf16_f32 v94, v96, v97
v_mul_f32 v98, s62, v98
v_mul_f32 v99, s62, v99
v_mfma_f32_16x16x32_bf16 v[208:211], v[72:75], v[64:67], v[208:211]
v_cvt_pk_bf16_f32 v95, v98, v99
buffer_store_dwordx4 v[92:95], v244, s[24:27], s56 offen offset:512 sc1
v_mul_f32 v128, s62, v128
s_waitcnt lgkmcnt(4)
v_mfma_f32_16x16x32_bf16 v[104:107], v[76:79], v[20:23], v[104:107]
ds_read_b64_tr_b16 v[72:73], v8 offset:18480
v_mul_f32_e64 v129, s62, v129
v_cvt_pk_bf16_f32 v128, v128, v129
v_mul_f32_e64 v130, s62, v130
v_mfma_f32_16x16x32_bf16 v[140:143], v[76:79], v[24:27], v[140:143]
ds_read_b64_tr_b16 v[74:75], v8 offset:20784
v_mul_f32_e64 v131, s62, v131
v_cvt_pk_bf16_f32 v129, v130, v131
v_mul_f32_e64 v132, s62, v132
v_mfma_f32_16x16x32_bf16 v[176:179], v[76:79], v[28:31], v[176:179]
v_mul_f32_e64 v133, s62, v133
v_cvt_pk_bf16_f32 v130, v132, v133
v_mul_f32_e64 v134, s62, v134
v_mfma_f32_16x16x32_bf16 v[212:215], v[76:79], v[32:35], v[212:215]
v_mul_f32_e64 v135, s62, v135
v_cvt_pk_bf16_f32 v131, v134, v135
buffer_store_dwordx4 v[128:131], v244, s[24:27], s56 offen offset:640 sc1
s_waitcnt lgkmcnt(4)
v_mfma_f32_16x16x32_bf16 v[104:107], v[80:83], v[52:55], v[104:107]
ds_read_b64_tr_b16 v[76:77], v8 offset:56
v_mul_f32 v164, s62, v164
v_mul_f32_e64 v165, s62, v165
v_cvt_pk_bf16_f32 v164, v164, v165
v_mfma_f32_16x16x32_bf16 v[140:143], v[80:83], v[56:59], v[140:143]
ds_read_b64_tr_b16 v[78:79], v8 offset:2360
v_mul_f32 v166, s62, v166
v_mul_f32 v167, s62, v167
v_cvt_pk_bf16_f32 v165, v166, v167
v_mfma_f32_16x16x32_bf16 v[176:179], v[80:83], v[60:63], v[176:179]
v_mul_f32 v168, s62, v168
v_mul_f32 v169, s62, v169
v_cvt_pk_bf16_f32 v166, v168, v169
v_mfma_f32_16x16x32_bf16 v[212:215], v[80:83], v[64:67], v[212:215]
v_mul_f32 v170, s62, v170
v_mul_f32 v171, s62, v171
v_cvt_pk_bf16_f32 v167, v170, v171
s_waitcnt lgkmcnt(4)
v_mfma_f32_16x16x32_bf16 v[108:111], v[68:71], v[20:23], v[108:111]
ds_read_b64_tr_b16 v[80:81], v8 offset:18488
buffer_store_dwordx4 v[164:167], v244, s[24:27], s56 offen offset:768 sc1
v_mul_f32 v200, s62, v200
v_mul_f32_e64 v201, s62, v201
v_mfma_f32_16x16x32_bf16 v[144:147], v[68:71], v[24:27], v[144:147]
ds_read_b64_tr_b16 v[82:83], v8 offset:20792
v_cvt_pk_bf16_f32 v200, v200, v201
v_mul_f32 v202, s62, v202
v_mul_f32 v203, s62, v203
v_mfma_f32_16x16x32_bf16 v[180:183], v[68:71], v[28:31], v[180:183]
v_cvt_pk_bf16_f32 v201, v202, v203
v_mul_f32 v204, s62, v204
v_mul_f32 v205, s62, v205
v_mfma_f32_16x16x32_bf16 v[216:219], v[68:71], v[32:35], v[216:219]
v_cvt_pk_bf16_f32 v202, v204, v205
v_mul_f32 v206, s62, v206
v_mul_f32_e64 v207, s62, v207
s_waitcnt lgkmcnt(4)
v_mfma_f32_16x16x32_bf16 v[108:111], v[72:75], v[52:55], v[108:111]
ds_read_b64_tr_b16 v[68:69], v8 offset:64
v_cvt_pk_bf16_f32 v203, v206, v207
buffer_store_dwordx4 v[200:203], v244, s[24:27], s56 offen offset:896 sc1
v_mul_f32_e64 v100, s62, v100
v_mfma_f32_16x16x32_bf16 v[144:147], v[72:75], v[56:59], v[144:147]
ds_read_b64_tr_b16 v[70:71], v8 offset:2368
v_mul_f32_e64 v101, s62, v101
v_cvt_pk_bf16_f32 v228, v100, v101
v_mul_f32_e64 v136, s62, v136
v_mfma_f32_16x16x32_bf16 v[180:183], v[72:75], v[60:63], v[180:183]
v_mul_f32_e64 v137, s62, v137
v_cvt_pk_bf16_f32 v229, v136, v137
v_mul_f32_e64 v172, s62, v172
v_mfma_f32_16x16x32_bf16 v[216:219], v[72:75], v[64:67], v[216:219]
v_mul_f32_e64 v173, s62, v173
v_cvt_pk_bf16_f32 v230, v172, v173
v_mul_f32 v208, s62, v208
s_waitcnt lgkmcnt(4)
v_mfma_f32_16x16x32_bf16 v[112:115], v[76:79], v[20:23], v[112:115]
ds_read_b64_tr_b16 v[72:73], v8 offset:18496
v_mul_f32_e64 v209, s62, v209
v_cvt_pk_bf16_f32 v231, v208, v209
buffer_store_dwordx4 v[228:231], v244, s[24:27], s56 offen offset:1024 sc1
v_mfma_f32_16x16x32_bf16 v[148:151], v[76:79], v[24:27], v[148:151]
ds_read_b64_tr_b16 v[74:75], v8 offset:20800
v_mfma_f32_16x16x32_bf16 v[184:187], v[76:79], v[28:31], v[184:187]
v_mul_f32 v102, s62, v102
v_mul_f32 v103, s62, v103
v_cvt_pk_bf16_f32 v102, v102, v103
v_mfma_f32_16x16x32_bf16 v[220:223], v[76:79], v[32:35], v[220:223]
v_mul_f32 v104, s62, v104
v_mul_f32 v105, s62, v105
v_cvt_pk_bf16_f32 v103, v104, v105
s_waitcnt lgkmcnt(4)
v_mfma_f32_16x16x32_bf16 v[112:115], v[80:83], v[52:55], v[112:115]
v_mul_f32 v106, s62, v106
v_mul_f32_e64 v107, s62, v107
v_cvt_pk_bf16_f32 v104, v106, v107
v_mfma_f32_16x16x32_bf16 v[148:151], v[80:83], v[56:59], v[148:151]
v_mul_f32 v108, s62, v108
v_mul_f32 v109, s62, v109
v_cvt_pk_bf16_f32 v105, v108, v109
v_mfma_f32_16x16x32_bf16 v[184:187], v[80:83], v[60:63], v[184:187]
buffer_store_dwordx4 v[102:105], v244, s[24:27], s57 offen offset:0 sc1
v_mul_f32 v138, s62, v138
v_mul_f32 v139, s62, v139
v_mfma_f32_16x16x32_bf16 v[220:223], v[80:83], v[64:67], v[220:223]
v_cvt_pk_bf16_f32 v138, v138, v139
v_mul_f32 v140, s62, v140
v_mul_f32_e64 v141, s62, v141
s_waitcnt lgkmcnt(2)
v_mfma_f32_16x16x32_bf16 v[116:119], v[68:71], v[20:23], v[116:119]
v_cvt_pk_bf16_f32 v139, v140, v141
v_mul_f32 v142, s62, v142
v_mul_f32 v143, s62, v143
v_mfma_f32_16x16x32_bf16 v[152:155], v[68:71], v[24:27], v[152:155]
v_cvt_pk_bf16_f32 v140, v142, v143
v_mul_f32 v144, s62, v144
v_mul_f32 v145, s62, v145
v_mfma_f32_16x16x32_bf16 v[188:191], v[68:71], v[28:31], v[188:191]
v_cvt_pk_bf16_f32 v141, v144, v145
buffer_store_dwordx4 v[138:141], v244, s[24:27], s57 offen offset:128 sc1
v_mul_f32_e64 v174, s62, v174
v_mfma_f32_16x16x32_bf16 v[224:227], v[68:71], v[32:35], v[224:227]
v_mul_f32_e64 v175, s62, v175
v_cvt_pk_bf16_f32 v174, v174, v175
v_mul_f32 v176, s62, v176
s_waitcnt lgkmcnt(0)
v_mfma_f32_16x16x32_bf16 v[116:119], v[72:75], v[52:55], v[116:119]
v_mul_f32_e64 v177, s62, v177
v_cvt_pk_bf16_f32 v175, v176, v177
v_mul_f32_e64 v178, s62, v178
v_mfma_f32_16x16x32_bf16 v[152:155], v[72:75], v[56:59], v[152:155]
v_mul_f32_e64 v179, s62, v179
v_cvt_pk_bf16_f32 v176, v178, v179
v_mul_f32_e64 v180, s62, v180
v_mfma_f32_16x16x32_bf16 v[188:191], v[72:75], v[60:63], v[188:191]
v_mul_f32_e64 v181, s62, v181
v_cvt_pk_bf16_f32 v177, v180, v181
buffer_store_dwordx4 v[174:177], v244, s[24:27], s57 offen offset:256 sc1
v_mfma_f32_16x16x32_bf16 v[224:227], v[72:75], v[64:67], v[224:227]
v_mul_f32 v210, s62, v210
v_mul_f32 v211, s62, v211
v_cvt_pk_bf16_f32 v210, v210, v211
v_mul_f32 v212, s62, v212
v_mul_f32 v213, s62, v213
v_cvt_pk_bf16_f32 v211, v212, v213
v_mul_f32 v214, s62, v214
v_mul_f32 v215, s62, v215
v_cvt_pk_bf16_f32 v212, v214, v215
v_mul_f32 v216, s62, v216
v_mul_f32 v217, s62, v217
v_cvt_pk_bf16_f32 v213, v216, v217
buffer_store_dwordx4 v[210:213], v244, s[24:27], s57 offen offset:384 sc1
v_mul_f32 v110, s62, v110
v_mul_f32 v111, s62, v111
v_cvt_pk_bf16_f32 v110, v110, v111
v_mul_f32 v112, s62, v112
v_mul_f32 v113, s62, v113
v_cvt_pk_bf16_f32 v111, v112, v113
v_mul_f32 v114, s62, v114
v_mul_f32 v115, s62, v115
v_cvt_pk_bf16_f32 v112, v114, v115
v_mul_f32 v116, s62, v116
v_mul_f32 v117, s62, v117
v_cvt_pk_bf16_f32 v113, v116, v117
buffer_store_dwordx4 v[110:113], v244, s[24:27], s57 offen offset:512 sc1
v_mul_f32 v146, s62, v146
v_mul_f32 v147, s62, v147
v_cvt_pk_bf16_f32 v146, v146, v147
v_mul_f32 v148, s62, v148
v_mul_f32 v149, s62, v149
v_cvt_pk_bf16_f32 v147, v148, v149
v_mul_f32 v150, s62, v150
v_mul_f32 v151, s62, v151
v_cvt_pk_bf16_f32 v148, v150, v151
v_mul_f32 v152, s62, v152
v_mul_f32 v153, s62, v153
v_cvt_pk_bf16_f32 v149, v152, v153
buffer_store_dwordx4 v[146:149], v244, s[24:27], s57 offen offset:640 sc1
v_mul_f32 v182, s62, v182
v_mul_f32 v183, s62, v183
v_cvt_pk_bf16_f32 v182, v182, v183
v_mul_f32 v184, s62, v184
v_mul_f32 v185, s62, v185
v_cvt_pk_bf16_f32 v183, v184, v185
v_mul_f32 v186, s62, v186
v_mul_f32 v187, s62, v187
v_cvt_pk_bf16_f32 v184, v186, v187
v_mul_f32 v188, s62, v188
v_mul_f32 v189, s62, v189
v_cvt_pk_bf16_f32 v185, v188, v189
buffer_store_dwordx4 v[182:185], v244, s[24:27], s57 offen offset:768 sc1
v_mul_f32 v218, s62, v218
v_mul_f32 v219, s62, v219
v_cvt_pk_bf16_f32 v218, v218, v219
v_mul_f32 v220, s62, v220
v_mul_f32 v221, s62, v221
v_cvt_pk_bf16_f32 v219, v220, v221
v_mul_f32 v222, s62, v222
v_mul_f32 v223, s62, v223
v_cvt_pk_bf16_f32 v220, v222, v223
v_mul_f32 v224, s62, v224
v_mul_f32 v225, s62, v225
v_cvt_pk_bf16_f32 v221, v224, v225
buffer_store_dwordx4 v[218:221], v244, s[24:27], s57 offen offset:896 sc1
v_mul_f32 v118, s62, v118
v_mul_f32 v119, s62, v119
v_cvt_pk_bf16_f32 v236, v118, v119
v_mul_f32 v154, s62, v154
v_mul_f32 v155, s62, v155
v_cvt_pk_bf16_f32 v237, v154, v155
v_mul_f32 v190, s62, v190
v_mul_f32 v191, s62, v191
v_cvt_pk_bf16_f32 v238, v190, v191
v_mul_f32 v226, s62, v226
v_mul_f32 v227, s62, v227
v_cvt_pk_bf16_f32 v239, v226, v227
buffer_store_dwordx4 v[236:239], v244, s[24:27], s57 offen offset:1024 sc1
s_branch L_p2C
L_V:
s_lshl_b32 s40, s39, 2
s_add_u32 s38, s38, s40
s_lshl_b32 s42, s52, 12
v_add_u32 v1, s42, v1
v_xor_b32 v2, 64, v1
v_lshrrev_b32 v9, 1, v14
v_and_b32 v10, 1, v14
v_lshl_add_u32 v9, v9, 2, v10
v_lshl_add_u32 v9, v9, 2, v11
v_mul_u32_u24 v9, 288, v9
v_mul_u32_u24 v10, 72, v12
v_add_u32_e64 v9, v9, v10
v_add_u32 v3, 65536, v9
v_add_u32 v4, 86016, v9
v_add_u32 v5, 106496, v9
v_add_u32 v6, 126976, v9
v_bfe_u32 v9, v0, 1, 1
v_and_b32_e64 v10, 1, v0
v_lshl_add_u32 v231, v10, 1, v9
v_and_b32_e64 v9, 16, v0
v_cmp_ne_u32 vcc, 0, v9
s_nop 1
v_cndmask_b32 v231, v231, 4, vcc
v_bfe_u32 v9, v0, 2, 2
v_mul_u32_u24_e64 v9, 40, v9
v_lshl_add_u32 v231, v231, 3, v9
v_lshrrev_b32_e64 v9, 5, v0
v_mul_u32_u24 v9, 320, v9
v_add_u32_e64 v230, v231, v9
v_add_u32 v230, 151552, v230
v_add_u32 v231, 151552, v231
s_mov_b32 s60, 0
s_mov_b32 s61, -1
s_mov_b32 s62, 1069066811
s_mov_b32 s63, 3216550459
v_and_b32 v9, 31, v0
s_lshl_b32 s41, s52, 5
v_add_u32_e64 v9, s41, v9
v_mul_u32_u24 v9, 120, v9
v_lshrrev_b32_e64 v10, 5, v0
v_mad_u32_u24 v232, v10, 40, v9
v_lshl_add_u32 v233, v10, 4, v9
v_mul_u32_u24 v10, 15360, v10
v_add3_u32 v234, v10, v9, 64
v_add_u32_e64 v234, 48, v234
v_mov_b32 v235, 0x3f80
v_mov_b32 v228, 0
v_mov_b32_e64 v229, 0
s_waitcnt lgkmcnt(0)
s_lshl_b32 s40, s2, 2
s_add_u32 s40, s40, s52
s_mul_i32 s41, s40, 2304
s_add_u32 s41, s41, 0
s_add_u32 s16, s4, s41
s_addc_u32 s17, s5, 0
s_min_u32 s41, s40, 863
s_cmp_lt_u32 s41, 432
s_cselect_b32 s18, s6, s8
s_cselect_b32 s19, s7, s9
s_cselect_b32 s42, 0, 432
s_sub_u32 s41, s41, s42
s_lshl_b32 s42, s41, 9
s_add_u32 s42, s42, 0
s_add_u32 s18, s18, s42
s_addc_u32 s19, s19, 0
s_sub_u32 s18, s18, 256
s_subb_u32 s19, s19, 0
s_min_u32 s41, s40, 575
s_cmp_lt_u32 s41, 288
s_cselect_b32 s20, s20, s22
s_cselect_b32 s21, s21, s23
s_cselect_b32 s42, 0, 288
s_sub_u32 s41, s41, s42
s_mul_i32 s42, s41, 2304
s_add_u32 s20, s20, s42
s_addc_u32 s21, s21, 0
s_sub_u32 s20, s20, 768
s_subb_u32 s21, s21, 0
v_min_u32 v9, 7, v0
v_mul_u32_u24 v10, 1152, v9
v_lshlrev_b32 v9, 7, v9
v_cmp_gt_u32 vcc, 2, v0
v_cmp_gt_u32 s[22:23], 6, v0
s_nop 0
v_cndmask_b32 v9, v9, v10, vcc
v_mov_b32 v16, s20
v_mov_b32 v10, s18
v_cndmask_b32 v16, v16, v10, s[22:23]
v_mov_b32 v10, s16
v_cndmask_b32 v16, v16, v10, vcc
v_mov_b32 v17, s21
v_mov_b32 v10, s19
v_cndmask_b32 v17, v17, v10, s[22:23]
v_mov_b32 v10, s17
v_cndmask_b32 v17, v17, v10, vcc
v_mov_b32 v18, 256
v_mov_b32 v10, 221184
v_cndmask_b32 v18, v18, v10, s[22:23]
v_mov_b32 v10, 128
v_cndmask_b32 v18, v18, v10, vcc
v_add_co_u32 v16, vcc, v16, v9
s_nop 1
v_addc_co_u32 v17, vcc, 0, v17, vcc
global_load_dword v19, v[16:17], off
v_add_co_u32 v16, vcc, v16, v18
s_nop 1
v_addc_co_u32 v17, vcc, 0, v17, vcc
global_load_dword v19, v[16:17], off
v_add_co_u32 v16, vcc, v16, v18
s_nop 1
v_addc_co_u32 v17, vcc, 0, v17, vcc
global_load_dword v19, v[16:17], off
v_add_co_u32 v16, vcc, v16, v18
s_nop 1
v_addc_co_u32 v17, vcc, 0, v17, vcc
global_load_dword v19, v[16:17], off
v_add_co_u32 v16, vcc, v16, v18
s_nop 1
v_addc_co_u32 v17, vcc, 0, v17, vcc
s_and_b32 s40, s2, 7
s_lshr_b32 s41, s2, 3
s_mul_i32 s40, s40, 30
s_add_u32 s40, s40, s41
s_cmp_lt_u32 s41, 30
s_cselect_b32 s40, s40, 255
s_cmp_lt_u32 s40, 234
s_cselect_b32 s30, 1, 0
s_cselect_b32 s40, s40, 0
s_mul_i32 s28, s40, 7282
s_lshr_b32 s28, s28, 16
s_mul_i32 s41, s28, 9
s_sub_u32 s29, s40, s41
s_mul_i32 s28, s28, 9
s_add_u32 s28, s28, s29
s_lshl_b32 s28, s28, 8
s_add_u32 s28, s28, 65536
s_and_b32 s40, s2, 7
s_lshr_b32 s41, s2, 3
s_and_b32 s29, s40, 1
s_lshl_b32 s29, s29, 4
s_lshr_b32 s42, s41, 1
s_add_u32 s29, s29, s42
s_and_b32 s30, s40, 6
s_and_b32 s41, s41, 1
s_add_u32 s30, s30, s41
s_lshl_b32 s30, s30, 5
s_add_u32 s29, s29, s30
s_lshl_b32 s29, s29, 8
s_add_u32 s16, s14, 15347712
s_addc_u32 s17, s15, 0
s_mov_b32 s18, 196608
s_mov_b32 s19, 0x20000
v_and_b32 v9, 1, v0
v_lshlrev_b32 v9, 7, v9
v_bfe_u32 v10, v0, 1, 1
v_lshl_add_u32 v10, v10, 16, s28
v_mov_b32 v11, s29
v_cmp_gt_u32 vcc, 4, v0
s_nop 1
v_cndmask_b32 v10, v11, v10, vcc
v_add_u32_e64 v9, v9, v10
s_cmp_lg_u32 s52, 1
s_cbranch_scc1 L_nmb1
buffer_load_dword v19, v9, s[16:19], 0 offen
L_nmb1:
s_mov_b32 s16, s10
s_mov_b32 s17, s11
s_mov_b32 s18, 20736
s_mov_b32 s19, 0x20000
v_add_u32_e64 v9, 0, v0
v_mul_u32_u24 v10, 6554, v9
v_lshrrev_b32 v10, 16, v10
v_mul_u32_u24 v20, 10, v10
v_sub_u32 v20, v9, v20
v_cmp_eq_u32 vcc, 9, v20
v_sub_u32 v9, v9, v10
v_lshlrev_b32 v9, 2, v9
v_mov_b32 v10, s58
v_cndmask_b32 v20, v9, v10, vcc
v_add_u32_e64 v9, 64, v0
v_mul_u32_u24 v10, 6554, v9
v_lshrrev_b32 v10, 16, v10
v_mul_u32_u24 v21, 10, v10
v_sub_u32 v21, v9, v21
v_cmp_eq_u32 vcc, 9, v21
v_sub_u32 v9, v9, v10
v_lshlrev_b32 v9, 2, v9
v_mov_b32 v10, s58
v_cndmask_b32 v21, v9, v10, vcc
v_add_u32 v9, 128, v0
v_mul_u32_u24 v10, 6554, v9
v_lshrrev_b32 v10, 16, v10
v_mul_u32_u24 v22, 10, v10
v_sub_u32 v22, v9, v22
v_cmp_eq_u32 vcc, 9, v22
v_sub_u32 v9, v9, v10
v_lshlrev_b32 v9, 2, v9
v_mov_b32 v10, s58
v_cndmask_b32 v22, v9, v10, vcc
v_cmp_lt_u32 vcc, 51, v0
s_nop 1
v_cndmask_b32_e64 v22, v22, v10, vcc
s_and_b32 s40, s2, 1
s_lshl_b32 s40, s40, 4
s_lshr_b32 s41, s2, 4
s_add_u32 s40, s40, s41
s_mul_i32 s40, s40, 648
s_cmp_eq_u32 s52, 0
s_cselect_b32 s41, 0, 768
s_cselect_b32 s18, s18, 0
s_add_u32 m0, s41, 162048
s_nop 0
buffer_load_dword v20, s[16:19], s40 offen lds
s_add_u32 m0, s41, 162304
s_nop 0
buffer_load_dword v21, s[16:19], s40 offen lds
s_add_u32 m0, s41, 162560
s_nop 0
buffer_load_dword v22, s[16:19], s40 offen lds
s_mov_b32 s18, 20736
s_lshl_b32 s40, s38, 2
s_add_u32 s40, s40, s52
s_mul_i32 s40, s40, 648
s_mul_i32 s41, s52, 768
s_add_u32 m0, s41, 151552
s_nop 0
buffer_load_dword v20, s[16:19], s40 offen lds
s_add_u32 m0, s41, 151808
s_nop 0
buffer_load_dword v21, s[16:19], s40 offen lds
s_add_u32 m0, s41, 152064
s_nop 0
buffer_load_dword v22, s[16:19], s40 offen lds
s_mov_b64 exec, 0
s_cmp_eq_u32 s52, 0
s_cbranch_scc1 L_pdV0_0
s_cmp_eq_u32 s52, 1
s_cbranch_scc1 L_pdV1_0
s_cmp_eq_u32 s52, 2
s_cbranch_scc1 L_pdV2_0
s_branch L_pdV3_0
L_pdV3_0:
L_retV:
s_mov_b64 exec, -1
L_Vgo:
L_pdV0_0:
s_cbranch_execz L_retV
s_barrier
ds_read_b128 v[20:23], v1 offset:0
ds_read_b128 v[24:27], v1 offset:2048
ds_read_b64_tr_b16 v[36:37], v3 offset:0
ds_read_b64_tr_b16 v[38:39], v3 offset:2304
ds_read_b64_tr_b16 v[40:41], v3 offset:8
ds_read_b64_tr_b16 v[42:43], v3 offset:2312
ds_read_b64_tr_b16 v[44:45], v3 offset:16
ds_read_b64_tr_b16 v[46:47], v3 offset:2320
ds_read_b64_tr_b16 v[48:49], v3 offset:24
ds_read_b64_tr_b16 v[50:51], v3 offset:2328
ds_read_b64_tr_b16 v[52:53], v3 offset:32
ds_read_b64_tr_b16 v[54:55], v3 offset:2336
ds_read_b64_tr_b16 v[56:57], v3 offset:40
ds_read_b64_tr_b16 v[58:59], v3 offset:2344
s_waitcnt lgkmcnt(10)
v_mfma_f32_16x16x32_bf16 v[68:71], v[36:39], v[20:23], 0
ds_read_b64_tr_b16 v[60:61], v3 offset:48
v_mfma_f32_16x16x32_bf16 v[104:107], v[36:39], v[24:27], 0
ds_read_b64_tr_b16 v[62:63], v3 offset:2352
s_waitcnt lgkmcnt(10)
v_mfma_f32_16x16x32_bf16 v[72:75], v[40:43], v[20:23], 0
ds_read_b64_tr_b16 v[64:65], v3 offset:56
v_mfma_f32_16x16x32_bf16 v[108:111], v[40:43], v[24:27], 0
ds_read_b64_tr_b16 v[66:67], v3 offset:2360
s_waitcnt lgkmcnt(10)
v_mfma_f32_16x16x32_bf16 v[76:79], v[44:47], v[20:23], 0
ds_read_b64_tr_b16 v[36:37], v3 offset:64
v_mfma_f32_16x16x32_bf16 v[112:115], v[44:47], v[24:27], 0
ds_read_b64_tr_b16 v[38:39], v3 offset:2368
s_waitcnt lgkmcnt(10)
v_mfma_f32_16x16x32_bf16 v[80:83], v[48:51], v[20:23], 0
s_barrier
ds_read_b128 v[28:31], v2 offset:0
ds_read_b128 v[32:35], v2 offset:2048
v_mfma_f32_16x16x32_bf16 v[116:119], v[48:51], v[24:27], 0
ds_read_b64_tr_b16 v[40:41], v3 offset:9216
ds_read_b64_tr_b16 v[42:43], v3 offset:11520
s_waitcnt lgkmcnt(12)
v_mfma_f32_16x16x32_bf16 v[84:87], v[52:55], v[20:23], 0
ds_read_b64_tr_b16 v[44:45], v3 offset:9224
v_mfma_f32_16x16x32_bf16 v[120:123], v[52:55], v[24:27], 0
ds_read_b64_tr_b16 v[46:47], v3 offset:11528
s_waitcnt lgkmcnt(12)
v_mfma_f32_16x16x32_bf16 v[88:91], v[56:59], v[20:23], 0
ds_read_b64_tr_b16 v[48:49], v3 offset:9232
v_mfma_f32_16x16x32_bf16 v[124:127], v[56:59], v[24:27], 0
ds_read_b64_tr_b16 v[50:51], v3 offset:11536
s_waitcnt lgkmcnt(12)
v_mfma_f32_16x16x32_bf16 v[92:95], v[60:63], v[20:23], 0
ds_read_b64_tr_b16 v[52:53], v3 offset:9240
v_mfma_f32_16x16x32_bf16 v[128:131], v[60:63], v[24:27], 0
ds_read_b64_tr_b16 v[54:55], v3 offset:11544
s_waitcnt lgkmcnt(12)
v_mfma_f32_16x16x32_bf16 v[96:99], v[64:67], v[20:23], 0
ds_read_b64_tr_b16 v[56:57], v3 offset:9248
v_mfma_f32_16x16x32_bf16 v[132:135], v[64:67], v[24:27], 0
ds_read_b64_tr_b16 v[58:59], v3 offset:11552
s_waitcnt lgkmcnt(12)
v_mfma_f32_16x16x32_bf16 v[100:103], v[36:39], v[20:23], 0
ds_read_b64_tr_b16 v[60:61], v3 offset:9256
v_mfma_f32_16x16x32_bf16 v[136:139], v[36:39], v[24:27], 0
ds_read_b64_tr_b16 v[62:63], v3 offset:11560
s_waitcnt lgkmcnt(10)
v_mfma_f32_16x16x32_bf16 v[68:71], v[40:43], v[28:31], v[68:71]
ds_read_b64_tr_b16 v[64:65], v3 offset:9264
v_mfma_f32_16x16x32_bf16 v[104:107], v[40:43], v[32:35], v[104:107]
ds_read_b64_tr_b16 v[66:67], v3 offset:11568
s_waitcnt lgkmcnt(10)
v_mfma_f32_16x16x32_bf16 v[72:75], v[44:47], v[28:31], v[72:75]
ds_read_b64_tr_b16 v[36:37], v3 offset:9272
v_mfma_f32_16x16x32_bf16 v[108:111], v[44:47], v[32:35], v[108:111]
ds_read_b64_tr_b16 v[38:39], v3 offset:11576
s_waitcnt lgkmcnt(10)
v_mfma_f32_16x16x32_bf16 v[76:79], v[48:51], v[28:31], v[76:79]
ds_read_b64_tr_b16 v[40:41], v3 offset:9280
v_mfma_f32_16x16x32_bf16 v[112:115], v[48:51], v[32:35], v[112:115]
ds_read_b64_tr_b16 v[42:43], v3 offset:11584
s_waitcnt lgkmcnt(10)
v_mfma_f32_16x16x32_bf16 v[80:83], v[52:55], v[28:31], v[80:83]
s_barrier
ds_read_b128 v[20:23], v1 offset:16384
ds_read_b128 v[24:27], v1 offset:18432
v_mfma_f32_16x16x32_bf16 v[116:119], v[52:55], v[32:35], v[116:119]
ds_read_b64_tr_b16 v[44:45], v4 offset:0
ds_read_b64_tr_b16 v[46:47], v4 offset:2304
s_waitcnt lgkmcnt(12)
v_mfma_f32_16x16x32_bf16 v[84:87], v[56:59], v[28:31], v[84:87]
ds_read_b64_tr_b16 v[48:49], v4 offset:8
v_mfma_f32_16x16x32_bf16 v[120:123], v[56:59], v[32:35], v[120:123]
ds_read_b64_tr_b16 v[50:51], v4 offset:2312
s_waitcnt lgkmcnt(12)
v_mfma_f32_16x16x32_bf16 v[88:91], v[60:63], v[28:31], v[88:91]
ds_read_b64_tr_b16 v[52:53], v4 offset:16
v_mfma_f32_16x16x32_bf16 v[124:127], v[60:63], v[32:35], v[124:127]
ds_read_b64_tr_b16 v[54:55], v4 offset:2320
s_waitcnt lgkmcnt(12)
v_mfma_f32_16x16x32_bf16 v[92:95], v[64:67], v[28:31], v[92:95]
ds_read_b64_tr_b16 v[56:57], v4 offset:24
v_mfma_f32_16x16x32_bf16 v[128:131], v[64:67], v[32:35], v[128:131]
ds_read_b64_tr_b16 v[58:59], v4 offset:2328
s_waitcnt lgkmcnt(12)
v_mfma_f32_16x16x32_bf16 v[96:99], v[36:39], v[28:31], v[96:99]
ds_read_b64_tr_b16 v[60:61], v4 offset:32
v_mfma_f32_16x16x32_bf16 v[132:135], v[36:39], v[32:35], v[132:135]
ds_read_b64_tr_b16 v[62:63], v4 offset:2336
s_waitcnt lgkmcnt(12)
v_mfma_f32_16x16x32_bf16 v[100:103], v[40:43], v[28:31], v[100:103]
ds_read_b64_tr_b16 v[64:65], v4 offset:40
v_mfma_f32_16x16x32_bf16 v[136:139], v[40:43], v[32:35], v[136:139]
ds_read_b64_tr_b16 v[66:67], v4 offset:2344
global_load_dword v19, v[16:17], off
v_add_co_u32 v16, vcc, v16, v18
s_nop 1
v_addc_co_u32 v17, vcc, 0, v17, vcc
s_waitcnt lgkmcnt(10)
v_mfma_f32_16x16x32_bf16 v[68:71], v[44:47], v[20:23], v[68:71]
ds_read_b64_tr_b16 v[36:37], v4 offset:48
v_mfma_f32_16x16x32_bf16 v[104:107], v[44:47], v[24:27], v[104:107]
ds_read_b64_tr_b16 v[38:39], v4 offset:2352
s_waitcnt lgkmcnt(10)
v_mfma_f32_16x16x32_bf16 v[72:75], v[48:51], v[20:23], v[72:75]
ds_read_b64_tr_b16 v[40:41], v4 offset:56
v_mfma_f32_16x16x32_bf16 v[108:111], v[48:51], v[24:27], v[108:111]
ds_read_b64_tr_b16 v[42:43], v4 offset:2360
s_waitcnt lgkmcnt(10)
v_mfma_f32_16x16x32_bf16 v[76:79], v[52:55], v[20:23], v[76:79]
ds_read_b64_tr_b16 v[44:45], v4 offset:64
v_mfma_f32_16x16x32_bf16 v[112:115], v[52:55], v[24:27], v[112:115]
ds_read_b64_tr_b16 v[46:47], v4 offset:2368
s_waitcnt lgkmcnt(10)
v_mfma_f32_16x16x32_bf16 v[80:83], v[56:59], v[20:23], v[80:83]
s_barrier
ds_read_b128 v[28:31], v2 offset:16384
ds_read_b128 v[32:35], v2 offset:18432
v_mfma_f32_16x16x32_bf16 v[116:119], v[56:59], v[24:27], v[116:119]
ds_read_b64_tr_b16 v[48:49], v4 offset:9216
ds_read_b64_tr_b16 v[50:51], v4 offset:11520
s_waitcnt lgkmcnt(12)
v_mfma_f32_16x16x32_bf16 v[84:87], v[60:63], v[20:23], v[84:87]
ds_read_b64_tr_b16 v[52:53], v4 offset:9224
v_mfma_f32_16x16x32_bf16 v[120:123], v[60:63], v[24:27], v[120:123]
ds_read_b64_tr_b16 v[54:55], v4 offset:11528
s_waitcnt lgkmcnt(12)
v_mfma_f32_16x16x32_bf16 v[88:91], v[64:67], v[20:23], v[88:91]
ds_read_b64_tr_b16 v[56:57], v4 offset:9232
v_mfma_f32_16x16x32_bf16 v[124:127], v[64:67], v[24:27], v[124:127]
ds_read_b64_tr_b16 v[58:59], v4 offset:11536
s_waitcnt lgkmcnt(12)
v_mfma_f32_16x16x32_bf16 v[92:95], v[36:39], v[20:23], v[92:95]
ds_read_b64_tr_b16 v[60:61], v4 offset:9240
v_mfma_f32_16x16x32_bf16 v[128:131], v[36:39], v[24:27], v[128:131]
ds_read_b64_tr_b16 v[62:63], v4 offset:11544
s_waitcnt lgkmcnt(12)
v_mfma_f32_16x16x32_bf16 v[96:99], v[40:43], v[20:23], v[96:99]
ds_read_b64_tr_b16 v[64:65], v4 offset:9248
v_mfma_f32_16x16x32_bf16 v[132:135], v[40:43], v[24:27], v[132:135]
ds_read_b64_tr_b16 v[66:67], v4 offset:11552
s_waitcnt lgkmcnt(12)
v_mfma_f32_16x16x32_bf16 v[100:103], v[44:47], v[20:23], v[100:103]
ds_read_b64_tr_b16 v[36:37], v4 offset:9256
v_mfma_f32_16x16x32_bf16 v[136:139], v[44:47], v[24:27], v[136:139]
ds_read_b64_tr_b16 v[38:39], v4 offset:11560
s_waitcnt lgkmcnt(10)
v_mfma_f32_16x16x32_bf16 v[68:71], v[48:51], v[28:31], v[68:71]
ds_read_b64_tr_b16 v[40:41], v4 offset:9264
v_mfma_f32_16x16x32_bf16 v[104:107], v[48:51], v[32:35], v[104:107]
ds_read_b64_tr_b16 v[42:43], v4 offset:11568
s_waitcnt lgkmcnt(10)
v_mfma_f32_16x16x32_bf16 v[72:75], v[52:55], v[28:31], v[72:75]
ds_read_b64_tr_b16 v[44:45], v4 offset:9272
v_mfma_f32_16x16x32_bf16 v[108:111], v[52:55], v[32:35], v[108:111]
ds_read_b64_tr_b16 v[46:47], v4 offset:11576
s_waitcnt lgkmcnt(10)
v_mfma_f32_16x16x32_bf16 v[76:79], v[56:59], v[28:31], v[76:79]
ds_read_b64_tr_b16 v[48:49], v4 offset:9280
v_mfma_f32_16x16x32_bf16 v[112:115], v[56:59], v[32:35], v[112:115]
ds_read_b64_tr_b16 v[50:51], v4 offset:11584
s_waitcnt lgkmcnt(10)
v_mfma_f32_16x16x32_bf16 v[80:83], v[60:63], v[28:31], v[80:83]
s_barrier
ds_read_b128 v[20:23], v1 offset:32768
ds_read_b128 v[24:27], v1 offset:34816
v_mfma_f32_16x16x32_bf16 v[116:119], v[60:63], v[32:35], v[116:119]
ds_read_b64_tr_b16 v[52:53], v5 offset:0
ds_read_b64_tr_b16 v[54:55], v5 offset:2304
s_waitcnt lgkmcnt(12)
v_mfma_f32_16x16x32_bf16 v[84:87], v[64:67], v[28:31], v[84:87]
ds_read_b64_tr_b16 v[56:57], v5 offset:8
v_mfma_f32_16x16x32_bf16 v[120:123], v[64:67], v[32:35], v[120:123]
ds_read_b64_tr_b16 v[58:59], v5 offset:2312
s_waitcnt lgkmcnt(12)
v_mfma_f32_16x16x32_bf16 v[88:91], v[36:39], v[28:31], v[88:91]
ds_read_b64_tr_b16 v[60:61], v5 offset:16
v_mfma_f32_16x16x32_bf16 v[124:127], v[36:39], v[32:35], v[124:127]
ds_read_b64_tr_b16 v[62:63], v5 offset:2320
s_waitcnt lgkmcnt(12)
v_mfma_f32_16x16x32_bf16 v[92:95], v[40:43], v[28:31], v[92:95]
ds_read_b64_tr_b16 v[64:65], v5 offset:24
v_mfma_f32_16x16x32_bf16 v[128:131], v[40:43], v[32:35], v[128:131]
ds_read_b64_tr_b16 v[66:67], v5 offset:2328
s_waitcnt lgkmcnt(12)
v_mfma_f32_16x16x32_bf16 v[96:99], v[44:47], v[28:31], v[96:99]
ds_read_b64_tr_b16 v[36:37], v5 offset:32
v_mfma_f32_16x16x32_bf16 v[132:135], v[44:47], v[32:35], v[132:135]
ds_read_b64_tr_b16 v[38:39], v5 offset:2336
s_waitcnt lgkmcnt(12)
v_mfma_f32_16x16x32_bf16 v[100:103], v[48:51], v[28:31], v[100:103]
ds_read_b64_tr_b16 v[40:41], v5 offset:40
v_mfma_f32_16x16x32_bf16 v[136:139], v[48:51], v[32:35], v[136:139]
ds_read_b64_tr_b16 v[42:43], v5 offset:2344
global_load_dword v19, v[16:17], off
v_add_co_u32 v16, vcc, v16, v18
s_nop 1
v_addc_co_u32 v17, vcc, 0, v17, vcc
s_waitcnt lgkmcnt(10)
v_mfma_f32_16x16x32_bf16 v[68:71], v[52:55], v[20:23], v[68:71]
ds_read_b64_tr_b16 v[44:45], v5 offset:48
v_mfma_f32_16x16x32_bf16 v[104:107], v[52:55], v[24:27], v[104:107]
ds_read_b64_tr_b16 v[46:47], v5 offset:2352
s_waitcnt lgkmcnt(10)
v_mfma_f32_16x16x32_bf16 v[72:75], v[56:59], v[20:23], v[72:75]
ds_read_b64_tr_b16 v[48:49], v5 offset:56
v_mfma_f32_16x16x32_bf16 v[108:111], v[56:59], v[24:27], v[108:111]
ds_read_b64_tr_b16 v[50:51], v5 offset:2360
s_waitcnt lgkmcnt(10)
v_mfma_f32_16x16x32_bf16 v[76:79], v[60:63], v[20:23], v[76:79]
ds_read_b64_tr_b16 v[52:53], v5 offset:64
v_mfma_f32_16x16x32_bf16 v[112:115], v[60:63], v[24:27], v[112:115]
ds_read_b64_tr_b16 v[54:55], v5 offset:2368
s_waitcnt lgkmcnt(10)
v_mfma_f32_16x16x32_bf16 v[80:83], v[64:67], v[20:23], v[80:83]
ds_read_b128 v[28:31], v2 offset:32768
ds_read_b128 v[32:35], v2 offset:34816
v_mfma_f32_16x16x32_bf16 v[116:119], v[64:67], v[24:27], v[116:119]
ds_read_b64_tr_b16 v[56:57], v5 offset:9216
ds_read_b64_tr_b16 v[58:59], v5 offset:11520
s_waitcnt lgkmcnt(12)
v_mfma_f32_16x16x32_bf16 v[84:87], v[36:39], v[20:23], v[84:87]
ds_read_b64_tr_b16 v[60:61], v5 offset:9224
v_mfma_f32_16x16x32_bf16 v[120:123], v[36:39], v[24:27], v[120:123]
ds_read_b64_tr_b16 v[62:63], v5 offset:11528
s_waitcnt lgkmcnt(12)
v_mfma_f32_16x16x32_bf16 v[88:91], v[40:43], v[20:23], v[88:91]
ds_read_b64_tr_b16 v[64:65], v5 offset:9232
v_mfma_f32_16x16x32_bf16 v[124:127], v[40:43], v[24:27], v[124:127]
ds_read_b64_tr_b16 v[66:67], v5 offset:11536
s_waitcnt lgkmcnt(12)
v_mfma_f32_16x16x32_bf16 v[92:95], v[44:47], v[20:23], v[92:95]
ds_read_b64_tr_b16 v[36:37], v5 offset:9240
v_mfma_f32_16x16x32_bf16 v[128:131], v[44:47], v[24:27], v[128:131]
ds_read_b64_tr_b16 v[38:39], v5 offset:11544
s_waitcnt lgkmcnt(12)
v_mfma_f32_16x16x32_bf16 v[96:99], v[48:51], v[20:23], v[96:99]
ds_read_b64_tr_b16 v[40:41], v5 offset:9248
v_mfma_f32_16x16x32_bf16 v[132:135], v[48:51], v[24:27], v[132:135]
ds_read_b64_tr_b16 v[42:43], v5 offset:11552
s_waitcnt lgkmcnt(12)
v_mfma_f32_16x16x32_bf16 v[100:103], v[52:55], v[20:23], v[100:103]
ds_read_b64_tr_b16 v[44:45], v5 offset:9256
v_mfma_f32_16x16x32_bf16 v[136:139], v[52:55], v[24:27], v[136:139]
ds_read_b64_tr_b16 v[46:47], v5 offset:11560
s_waitcnt lgkmcnt(10)
v_mfma_f32_16x16x32_bf16 v[68:71], v[56:59], v[28:31], v[68:71]
ds_read_b64_tr_b16 v[48:49], v5 offset:9264
v_mfma_f32_16x16x32_bf16 v[104:107], v[56:59], v[32:35], v[104:107]
ds_read_b64_tr_b16 v[50:51], v5 offset:11568
s_waitcnt lgkmcnt(10)
v_mfma_f32_16x16x32_bf16 v[72:75], v[60:63], v[28:31], v[72:75]
ds_read_b64_tr_b16 v[52:53], v5 offset:9272
v_mfma_f32_16x16x32_bf16 v[108:111], v[60:63], v[32:35], v[108:111]
ds_read_b64_tr_b16 v[54:55], v5 offset:11576
s_waitcnt lgkmcnt(10)
v_mfma_f32_16x16x32_bf16 v[76:79], v[64:67], v[28:31], v[76:79]
ds_read_b64_tr_b16 v[56:57], v5 offset:9280
v_mfma_f32_16x16x32_bf16 v[112:115], v[64:67], v[32:35], v[112:115]
ds_read_b64_tr_b16 v[58:59], v5 offset:11584
s_waitcnt lgkmcnt(10)
v_mfma_f32_16x16x32_bf16 v[80:83], v[36:39], v[28:31], v[80:83]
s_barrier
ds_read_b128 v[20:23], v1 offset:49152
ds_read_b128 v[24:27], v1 offset:51200
v_mfma_f32_16x16x32_bf16 v[116:119], v[36:39], v[32:35], v[116:119]
ds_read_b64_tr_b16 v[60:61], v6 offset:0
ds_read_b64_tr_b16 v[62:63], v6 offset:2304
s_waitcnt lgkmcnt(12)
v_mfma_f32_16x16x32_bf16 v[84:87], v[40:43], v[28:31], v[84:87]
ds_read_b64_tr_b16 v[64:65], v6 offset:8
v_mfma_f32_16x16x32_bf16 v[120:123], v[40:43], v[32:35], v[120:123]
ds_read_b64_tr_b16 v[66:67], v6 offset:2312
s_waitcnt lgkmcnt(12)
v_mfma_f32_16x16x32_bf16 v[88:91], v[44:47], v[28:31], v[88:91]
ds_read_b64_tr_b16 v[36:37], v6 offset:16
v_mfma_f32_16x16x32_bf16 v[124:127], v[44:47], v[32:35], v[124:127]
ds_read_b64_tr_b16 v[38:39], v6 offset:2320
s_waitcnt lgkmcnt(12)
v_mfma_f32_16x16x32_bf16 v[92:95], v[48:51], v[28:31], v[92:95]
ds_read_b64_tr_b16 v[40:41], v6 offset:24
v_mfma_f32_16x16x32_bf16 v[128:131], v[48:51], v[32:35], v[128:131]
ds_read_b64_tr_b16 v[42:43], v6 offset:2328
s_waitcnt lgkmcnt(12)
v_mfma_f32_16x16x32_bf16 v[96:99], v[52:55], v[28:31], v[96:99]
ds_read_b64_tr_b16 v[44:45], v6 offset:32
v_mfma_f32_16x16x32_bf16 v[132:135], v[52:55], v[32:35], v[132:135]
ds_read_b64_tr_b16 v[46:47], v6 offset:2336
s_waitcnt lgkmcnt(12)
v_mfma_f32_16x16x32_bf16 v[100:103], v[56:59], v[28:31], v[100:103]
ds_read_b64_tr_b16 v[48:49], v6 offset:40
v_mfma_f32_16x16x32_bf16 v[136:139], v[56:59], v[32:35], v[136:139]
ds_read_b64_tr_b16 v[50:51], v6 offset:2344
global_load_dword v19, v[16:17], off
v_add_co_u32 v16, vcc, v16, v18
s_nop 1
v_addc_co_u32 v17, vcc, 0, v17, vcc
s_waitcnt lgkmcnt(10)
v_mfma_f32_16x16x32_bf16 v[68:71], v[60:63], v[20:23], v[68:71]
ds_read_b64_tr_b16 v[52:53], v6 offset:48
v_mfma_f32_16x16x32_bf16 v[104:107], v[60:63], v[24:27], v[104:107]
ds_read_b64_tr_b16 v[54:55], v6 offset:2352
s_waitcnt lgkmcnt(10)
v_mfma_f32_16x16x32_bf16 v[72:75], v[64:67], v[20:23], v[72:75]
ds_read_b64_tr_b16 v[56:57], v6 offset:56
v_mfma_f32_16x16x32_bf16 v[108:111], v[64:67], v[24:27], v[108:111]
ds_read_b64_tr_b16 v[58:59], v6 offset:2360
s_waitcnt lgkmcnt(10)
v_mfma_f32_16x16x32_bf16 v[76:79], v[36:39], v[20:23], v[76:79]
ds_read_b64_tr_b16 v[60:61], v6 offset:64
v_mfma_f32_16x16x32_bf16 v[112:115], v[36:39], v[24:27], v[112:115]
ds_read_b64_tr_b16 v[62:63], v6 offset:2368
s_waitcnt lgkmcnt(10)
v_mfma_f32_16x16x32_bf16 v[80:83], v[40:43], v[20:23], v[80:83]
ds_read_b128 v[28:31], v2 offset:49152
ds_read_b128 v[32:35], v2 offset:51200
v_mfma_f32_16x16x32_bf16 v[116:119], v[40:43], v[24:27], v[116:119]
ds_read_b64_tr_b16 v[64:65], v6 offset:9216
ds_read_b64_tr_b16 v[66:67], v6 offset:11520
s_waitcnt lgkmcnt(12)
v_mfma_f32_16x16x32_bf16 v[84:87], v[44:47], v[20:23], v[84:87]
ds_read_b64_tr_b16 v[36:37], v6 offset:9224
v_mfma_f32_16x16x32_bf16 v[120:123], v[44:47], v[24:27], v[120:123]
ds_read_b64_tr_b16 v[38:39], v6 offset:11528
s_waitcnt lgkmcnt(12)
v_mfma_f32_16x16x32_bf16 v[88:91], v[48:51], v[20:23], v[88:91]
ds_read_b64_tr_b16 v[40:41], v6 offset:9232
v_mfma_f32_16x16x32_bf16 v[124:127], v[48:51], v[24:27], v[124:127]
ds_read_b64_tr_b16 v[42:43], v6 offset:11536
s_waitcnt lgkmcnt(12)
v_mfma_f32_16x16x32_bf16 v[92:95], v[52:55], v[20:23], v[92:95]
ds_read_b64_tr_b16 v[44:45], v6 offset:9240
v_mfma_f32_16x16x32_bf16 v[128:131], v[52:55], v[24:27], v[128:131]
ds_read_b64_tr_b16 v[46:47], v6 offset:11544
s_waitcnt lgkmcnt(12)
v_mfma_f32_16x16x32_bf16 v[96:99], v[56:59], v[20:23], v[96:99]
ds_read_b64_tr_b16 v[48:49], v6 offset:9248
v_mfma_f32_16x16x32_bf16 v[132:135], v[56:59], v[24:27], v[132:135]
ds_read_b64_tr_b16 v[50:51], v6 offset:11552
s_waitcnt lgkmcnt(12)
v_mfma_f32_16x16x32_bf16 v[100:103], v[60:63], v[20:23], v[100:103]
ds_read_b64_tr_b16 v[52:53], v6 offset:9256
v_mfma_f32_16x16x32_bf16 v[136:139], v[60:63], v[24:27], v[136:139]
ds_read_b64_tr_b16 v[54:55], v6 offset:11560
s_waitcnt lgkmcnt(10)
v_mfma_f32_16x16x32_bf16 v[68:71], v[64:67], v[28:31], v[68:71]
ds_read_b64_tr_b16 v[56:57], v6 offset:9264
v_mfma_f32_16x16x32_bf16 v[104:107], v[64:67], v[32:35], v[104:107]
ds_read_b64_tr_b16 v[58:59], v6 offset:11568
s_waitcnt lgkmcnt(10)
v_mfma_f32_16x16x32_bf16 v[72:75], v[36:39], v[28:31], v[72:75]
ds_read_b64_tr_b16 v[60:61], v6 offset:9272
v_mfma_f32_16x16x32_bf16 v[108:111], v[36:39], v[32:35], v[108:111]
ds_read_b64_tr_b16 v[62:63], v6 offset:11576
s_waitcnt lgkmcnt(10)
v_mfma_f32_16x16x32_bf16 v[76:79], v[40:43], v[28:31], v[76:79]
ds_read_b64_tr_b16 v[64:65], v6 offset:9280
v_mfma_f32_16x16x32_bf16 v[112:115], v[40:43], v[32:35], v[112:115]
ds_read_b64_tr_b16 v[66:67], v6 offset:11584
s_waitcnt lgkmcnt(10)
v_mfma_f32_16x16x32_bf16 v[80:83], v[44:47], v[28:31], v[80:83]
s_barrier
ds_read_b128 v[20:23], v1 offset:0
ds_read_b128 v[24:27], v1 offset:2048
v_mfma_f32_16x16x32_bf16 v[116:119], v[44:47], v[32:35], v[116:119]
ds_read_b64_tr_b16 v[36:37], v3 offset:0
ds_read_b64_tr_b16 v[38:39], v3 offset:2304
s_waitcnt lgkmcnt(12)
v_mfma_f32_16x16x32_bf16 v[84:87], v[48:51], v[28:31], v[84:87]
ds_read_b64_tr_b16 v[40:41], v3 offset:8
v_mfma_f32_16x16x32_bf16 v[120:123], v[48:51], v[32:35], v[120:123]
ds_read_b64_tr_b16 v[42:43], v3 offset:2312
s_waitcnt lgkmcnt(12)
v_mfma_f32_16x16x32_bf16 v[88:91], v[52:55], v[28:31], v[88:91]
ds_read_b64_tr_b16 v[44:45], v3 offset:16
v_mfma_f32_16x16x32_bf16 v[124:127], v[52:55], v[32:35], v[124:127]
ds_read_b64_tr_b16 v[46:47], v3 offset:2320
s_waitcnt lgkmcnt(12)
v_mfma_f32_16x16x32_bf16 v[92:95], v[56:59], v[28:31], v[92:95]
ds_read_b64_tr_b16 v[48:49], v3 offset:24
v_mfma_f32_16x16x32_bf16 v[128:131], v[56:59], v[32:35], v[128:131]
ds_read_b64_tr_b16 v[50:51], v3 offset:2328
s_waitcnt lgkmcnt(12)
v_mfma_f32_16x16x32_bf16 v[96:99], v[60:63], v[28:31], v[96:99]
ds_read_b64_tr_b16 v[52:53], v3 offset:32
v_mfma_f32_16x16x32_bf16 v[132:135], v[60:63], v[32:35], v[132:135]
ds_read_b64_tr_b16 v[54:55], v3 offset:2336
s_waitcnt lgkmcnt(12)
v_mfma_f32_16x16x32_bf16 v[100:103], v[64:67], v[28:31], v[100:103]
ds_read_b64_tr_b16 v[56:57], v3 offset:40
v_mfma_f32_16x16x32_bf16 v[136:139], v[64:67], v[32:35], v[136:139]
ds_read_b64_tr_b16 v[58:59], v3 offset:2344
global_load_dword v19, v[16:17], off
v_add_co_u32 v16, vcc, v16, v18
s_nop 1
v_addc_co_u32 v17, vcc, 0, v17, vcc
s_waitcnt lgkmcnt(10)
v_mfma_f32_16x16x32_bf16 v[68:71], v[36:39], v[20:23], v[68:71]
ds_read_b64_tr_b16 v[60:61], v3 offset:48
v_mfma_f32_16x16x32_bf16 v[104:107], v[36:39], v[24:27], v[104:107]
ds_read_b64_tr_b16 v[62:63], v3 offset:2352
s_waitcnt lgkmcnt(10)
v_mfma_f32_16x16x32_bf16 v[72:75], v[40:43], v[20:23], v[72:75]
ds_read_b64_tr_b16 v[64:65], v3 offset:56
v_mfma_f32_16x16x32_bf16 v[108:111], v[40:43], v[24:27], v[108:111]
ds_read_b64_tr_b16 v[66:67], v3 offset:2360
s_waitcnt lgkmcnt(10)
v_mfma_f32_16x16x32_bf16 v[76:79], v[44:47], v[20:23], v[76:79]
ds_read_b64_tr_b16 v[36:37], v3 offset:64
v_mfma_f32_16x16x32_bf16 v[112:115], v[44:47], v[24:27], v[112:115]
ds_read_b64_tr_b16 v[38:39], v3 offset:2368
s_waitcnt lgkmcnt(10)
v_mfma_f32_16x16x32_bf16 v[80:83], v[48:51], v[20:23], v[80:83]
ds_read_b128 v[28:31], v2 offset:0
ds_read_b128 v[32:35], v2 offset:2048
v_mfma_f32_16x16x32_bf16 v[116:119], v[48:51], v[24:27], v[116:119]
ds_read_b64_tr_b16 v[40:41], v3 offset:9216
ds_read_b64_tr_b16 v[42:43], v3 offset:11520
s_waitcnt lgkmcnt(12)
v_mfma_f32_16x16x32_bf16 v[84:87], v[52:55], v[20:23], v[84:87]
ds_read_b64_tr_b16 v[44:45], v3 offset:9224
v_mfma_f32_16x16x32_bf16 v[120:123], v[52:55], v[24:27], v[120:123]
ds_read_b64_tr_b16 v[46:47], v3 offset:11528
s_waitcnt lgkmcnt(12)
v_mfma_f32_16x16x32_bf16 v[88:91], v[56:59], v[20:23], v[88:91]
ds_read_b64_tr_b16 v[48:49], v3 offset:9232
v_mfma_f32_16x16x32_bf16 v[124:127], v[56:59], v[24:27], v[124:127]
ds_read_b64_tr_b16 v[50:51], v3 offset:11536
s_waitcnt lgkmcnt(12)
v_mfma_f32_16x16x32_bf16 v[92:95], v[60:63], v[20:23], v[92:95]
ds_read_b64_tr_b16 v[52:53], v3 offset:9240
v_mfma_f32_16x16x32_bf16 v[128:131], v[60:63], v[24:27], v[128:131]
ds_read_b64_tr_b16 v[54:55], v3 offset:11544
s_waitcnt lgkmcnt(12)
v_mfma_f32_16x16x32_bf16 v[96:99], v[64:67], v[20:23], v[96:99]
ds_read_b64_tr_b16 v[56:57], v3 offset:9248
v_mfma_f32_16x16x32_bf16 v[132:135], v[64:67], v[24:27], v[132:135]
ds_read_b64_tr_b16 v[58:59], v3 offset:11552
s_waitcnt lgkmcnt(12)
v_mfma_f32_16x16x32_bf16 v[100:103], v[36:39], v[20:23], v[100:103]
ds_read_b64_tr_b16 v[60:61], v3 offset:9256
v_mfma_f32_16x16x32_bf16 v[136:139], v[36:39], v[24:27], v[136:139]
ds_read_b64_tr_b16 v[62:63], v3 offset:11560
s_waitcnt lgkmcnt(10)
v_mfma_f32_16x16x32_bf16 v[68:71], v[40:43], v[28:31], v[68:71]
ds_read_b64_tr_b16 v[64:65], v3 offset:9264
v_mfma_f32_16x16x32_bf16 v[104:107], v[40:43], v[32:35], v[104:107]
ds_read_b64_tr_b16 v[66:67], v3 offset:11568
s_waitcnt lgkmcnt(10)
v_mfma_f32_16x16x32_bf16 v[72:75], v[44:47], v[28:31], v[72:75]
ds_read_b64_tr_b16 v[36:37], v3 offset:9272
v_mfma_f32_16x16x32_bf16 v[108:111], v[44:47], v[32:35], v[108:111]
ds_read_b64_tr_b16 v[38:39], v3 offset:11576
s_waitcnt lgkmcnt(10)
v_mfma_f32_16x16x32_bf16 v[76:79], v[48:51], v[28:31], v[76:79]
ds_read_b64_tr_b16 v[40:41], v3 offset:9280
v_mfma_f32_16x16x32_bf16 v[112:115], v[48:51], v[32:35], v[112:115]
ds_read_b64_tr_b16 v[42:43], v3 offset:11584
s_waitcnt lgkmcnt(10)
v_mfma_f32_16x16x32_bf16 v[80:83], v[52:55], v[28:31], v[80:83]
s_barrier
ds_read_b128 v[20:23], v1 offset:16384
ds_read_b128 v[24:27], v1 offset:18432
v_mfma_f32_16x16x32_bf16 v[116:119], v[52:55], v[32:35], v[116:119]
ds_read_b64_tr_b16 v[44:45], v4 offset:0
ds_read_b64_tr_b16 v[46:47], v4 offset:2304
s_waitcnt lgkmcnt(12)
v_mfma_f32_16x16x32_bf16 v[84:87], v[56:59], v[28:31], v[84:87]
ds_read_b64_tr_b16 v[48:49], v4 offset:8
v_mfma_f32_16x16x32_bf16 v[120:123], v[56:59], v[32:35], v[120:123]
ds_read_b64_tr_b16 v[50:51], v4 offset:2312
s_waitcnt lgkmcnt(12)
v_mfma_f32_16x16x32_bf16 v[88:91], v[60:63], v[28:31], v[88:91]
ds_read_b64_tr_b16 v[52:53], v4 offset:16
v_mfma_f32_16x16x32_bf16 v[124:127], v[60:63], v[32:35], v[124:127]
ds_read_b64_tr_b16 v[54:55], v4 offset:2320
s_waitcnt lgkmcnt(12)
v_mfma_f32_16x16x32_bf16 v[92:95], v[64:67], v[28:31], v[92:95]
ds_read_b64_tr_b16 v[56:57], v4 offset:24
v_mfma_f32_16x16x32_bf16 v[128:131], v[64:67], v[32:35], v[128:131]
ds_read_b64_tr_b16 v[58:59], v4 offset:2328
s_waitcnt lgkmcnt(12)
v_mfma_f32_16x16x32_bf16 v[96:99], v[36:39], v[28:31], v[96:99]
ds_read_b64_tr_b16 v[60:61], v4 offset:32
v_mfma_f32_16x16x32_bf16 v[132:135], v[36:39], v[32:35], v[132:135]
ds_read_b64_tr_b16 v[62:63], v4 offset:2336
s_waitcnt lgkmcnt(12)
v_mfma_f32_16x16x32_bf16 v[100:103], v[40:43], v[28:31], v[100:103]
ds_read_b64_tr_b16 v[64:65], v4 offset:40
v_mfma_f32_16x16x32_bf16 v[136:139], v[40:43], v[32:35], v[136:139]
ds_read_b64_tr_b16 v[66:67], v4 offset:2344
global_load_dword v19, v[16:17], off
v_add_co_u32 v16, vcc, v16, v18
s_nop 1
v_addc_co_u32 v17, vcc, 0, v17, vcc
s_waitcnt lgkmcnt(10)
v_mfma_f32_16x16x32_bf16 v[68:71], v[44:47], v[20:23], v[68:71]
ds_read_b64_tr_b16 v[36:37], v4 offset:48
v_mfma_f32_16x16x32_bf16 v[104:107], v[44:47], v[24:27], v[104:107]
ds_read_b64_tr_b16 v[38:39], v4 offset:2352
s_waitcnt lgkmcnt(10)
v_mfma_f32_16x16x32_bf16 v[72:75], v[48:51], v[20:23], v[72:75]
L_pdV1_0:
s_cbranch_execz L_retV
ds_read_b64_tr_b16 v[40:41], v4 offset:56
v_mfma_f32_16x16x32_bf16 v[108:111], v[48:51], v[24:27], v[108:111]
ds_read_b64_tr_b16 v[42:43], v4 offset:2360
s_waitcnt lgkmcnt(10)
v_mfma_f32_16x16x32_bf16 v[76:79], v[52:55], v[20:23], v[76:79]
ds_read_b64_tr_b16 v[44:45], v4 offset:64
v_mfma_f32_16x16x32_bf16 v[112:115], v[52:55], v[24:27], v[112:115]
ds_read_b64_tr_b16 v[46:47], v4 offset:2368
s_waitcnt lgkmcnt(10)
v_mfma_f32_16x16x32_bf16 v[80:83], v[56:59], v[20:23], v[80:83]
ds_read_b128 v[28:31], v2 offset:16384
ds_read_b128 v[32:35], v2 offset:18432
v_mfma_f32_16x16x32_bf16 v[116:119], v[56:59], v[24:27], v[116:119]
ds_read_b64_tr_b16 v[48:49], v4 offset:9216
ds_read_b64_tr_b16 v[50:51], v4 offset:11520
s_waitcnt lgkmcnt(12)
v_mfma_f32_16x16x32_bf16 v[84:87], v[60:63], v[20:23], v[84:87]
ds_read_b64_tr_b16 v[52:53], v4 offset:9224
v_mfma_f32_16x16x32_bf16 v[120:123], v[60:63], v[24:27], v[120:123]
ds_read_b64_tr_b16 v[54:55], v4 offset:11528
s_waitcnt lgkmcnt(12)
v_mfma_f32_16x16x32_bf16 v[88:91], v[64:67], v[20:23], v[88:91]
ds_read_b64_tr_b16 v[56:57], v4 offset:9232
v_mfma_f32_16x16x32_bf16 v[124:127], v[64:67], v[24:27], v[124:127]
ds_read_b64_tr_b16 v[58:59], v4 offset:11536
s_waitcnt lgkmcnt(12)
v_mfma_f32_16x16x32_bf16 v[92:95], v[36:39], v[20:23], v[92:95]
ds_read_b64_tr_b16 v[60:61], v4 offset:9240
v_mfma_f32_16x16x32_bf16 v[128:131], v[36:39], v[24:27], v[128:131]
ds_read_b64_tr_b16 v[62:63], v4 offset:11544
s_waitcnt lgkmcnt(12)
v_mfma_f32_16x16x32_bf16 v[96:99], v[40:43], v[20:23], v[96:99]
ds_read_b64_tr_b16 v[64:65], v4 offset:9248
v_mfma_f32_16x16x32_bf16 v[132:135], v[40:43], v[24:27], v[132:135]
ds_read_b64_tr_b16 v[66:67], v4 offset:11552
s_waitcnt lgkmcnt(12)
v_mfma_f32_16x16x32_bf16 v[100:103], v[44:47], v[20:23], v[100:103]
ds_read_b64_tr_b16 v[36:37], v4 offset:9256
v_mfma_f32_16x16x32_bf16 v[136:139], v[44:47], v[24:27], v[136:139]
ds_read_b64_tr_b16 v[38:39], v4 offset:11560
s_waitcnt lgkmcnt(10)
v_mfma_f32_16x16x32_bf16 v[68:71], v[48:51], v[28:31], v[68:71]
ds_read_b64_tr_b16 v[40:41], v4 offset:9264
v_mfma_f32_16x16x32_bf16 v[104:107], v[48:51], v[32:35], v[104:107]
ds_read_b64_tr_b16 v[42:43], v4 offset:11568
s_waitcnt lgkmcnt(10)
v_mfma_f32_16x16x32_bf16 v[72:75], v[52:55], v[28:31], v[72:75]
ds_read_b64_tr_b16 v[44:45], v4 offset:9272
v_mfma_f32_16x16x32_bf16 v[108:111], v[52:55], v[32:35], v[108:111]
ds_read_b64_tr_b16 v[46:47], v4 offset:11576
s_waitcnt lgkmcnt(10)
v_mfma_f32_16x16x32_bf16 v[76:79], v[56:59], v[28:31], v[76:79]
ds_read_b64_tr_b16 v[48:49], v4 offset:9280
v_mfma_f32_16x16x32_bf16 v[112:115], v[56:59], v[32:35], v[112:115]
ds_read_b64_tr_b16 v[50:51], v4 offset:11584
s_waitcnt lgkmcnt(10)
v_mfma_f32_16x16x32_bf16 v[80:83], v[60:63], v[28:31], v[80:83]
s_barrier
ds_read_b128 v[20:23], v1 offset:32768
ds_read_b128 v[24:27], v1 offset:34816
v_mfma_f32_16x16x32_bf16 v[116:119], v[60:63], v[32:35], v[116:119]
ds_read_b64_tr_b16 v[52:53], v5 offset:0
ds_read_b64_tr_b16 v[54:55], v5 offset:2304
s_waitcnt lgkmcnt(12)
v_mfma_f32_16x16x32_bf16 v[84:87], v[64:67], v[28:31], v[84:87]
ds_read_b64_tr_b16 v[56:57], v5 offset:8
v_mfma_f32_16x16x32_bf16 v[120:123], v[64:67], v[32:35], v[120:123]
ds_read_b64_tr_b16 v[58:59], v5 offset:2312
s_waitcnt lgkmcnt(12)
v_mfma_f32_16x16x32_bf16 v[88:91], v[36:39], v[28:31], v[88:91]
ds_read_b64_tr_b16 v[60:61], v5 offset:16
v_mfma_f32_16x16x32_bf16 v[124:127], v[36:39], v[32:35], v[124:127]
ds_read_b64_tr_b16 v[62:63], v5 offset:2320
s_waitcnt lgkmcnt(12)
v_mfma_f32_16x16x32_bf16 v[92:95], v[40:43], v[28:31], v[92:95]
ds_read_b64_tr_b16 v[64:65], v5 offset:24
v_mfma_f32_16x16x32_bf16 v[128:131], v[40:43], v[32:35], v[128:131]
ds_read_b64_tr_b16 v[66:67], v5 offset:2328
s_waitcnt lgkmcnt(12)
v_mfma_f32_16x16x32_bf16 v[96:99], v[44:47], v[28:31], v[96:99]
ds_read_b64_tr_b16 v[36:37], v5 offset:32
v_mfma_f32_16x16x32_bf16 v[132:135], v[44:47], v[32:35], v[132:135]
ds_read_b64_tr_b16 v[38:39], v5 offset:2336
s_waitcnt lgkmcnt(12)
v_mfma_f32_16x16x32_bf16 v[100:103], v[48:51], v[28:31], v[100:103]
ds_read_b64_tr_b16 v[40:41], v5 offset:40
v_mfma_f32_16x16x32_bf16 v[136:139], v[48:51], v[32:35], v[136:139]
ds_read_b64_tr_b16 v[42:43], v5 offset:2344
s_waitcnt lgkmcnt(10)
v_mfma_f32_16x16x32_bf16 v[68:71], v[52:55], v[20:23], v[68:71]
ds_read_b64_tr_b16 v[44:45], v5 offset:48
v_mfma_f32_16x16x32_bf16 v[104:107], v[52:55], v[24:27], v[104:107]
ds_read_b64_tr_b16 v[46:47], v5 offset:2352
s_waitcnt lgkmcnt(10)
v_mfma_f32_16x16x32_bf16 v[72:75], v[56:59], v[20:23], v[72:75]
ds_read_b64_tr_b16 v[48:49], v5 offset:56
v_mfma_f32_16x16x32_bf16 v[108:111], v[56:59], v[24:27], v[108:111]
ds_read_b64_tr_b16 v[50:51], v5 offset:2360
s_waitcnt lgkmcnt(10)
v_mfma_f32_16x16x32_bf16 v[76:79], v[60:63], v[20:23], v[76:79]
ds_read_b64_tr_b16 v[52:53], v5 offset:64
v_mfma_f32_16x16x32_bf16 v[112:115], v[60:63], v[24:27], v[112:115]
ds_read_b64_tr_b16 v[54:55], v5 offset:2368
s_waitcnt lgkmcnt(10)
v_mfma_f32_16x16x32_bf16 v[80:83], v[64:67], v[20:23], v[80:83]
ds_read_b128 v[28:31], v2 offset:32768
ds_read_b128 v[32:35], v2 offset:34816
v_mfma_f32_16x16x32_bf16 v[116:119], v[64:67], v[24:27], v[116:119]
ds_read_b64_tr_b16 v[56:57], v5 offset:9216
ds_read_b64_tr_b16 v[58:59], v5 offset:11520
s_waitcnt lgkmcnt(12)
v_mfma_f32_16x16x32_bf16 v[84:87], v[36:39], v[20:23], v[84:87]
ds_read_b64_tr_b16 v[60:61], v5 offset:9224
v_mfma_f32_16x16x32_bf16 v[120:123], v[36:39], v[24:27], v[120:123]
ds_read_b64_tr_b16 v[62:63], v5 offset:11528
s_waitcnt lgkmcnt(12)
v_mfma_f32_16x16x32_bf16 v[88:91], v[40:43], v[20:23], v[88:91]
ds_read_b64_tr_b16 v[64:65], v5 offset:9232
v_mfma_f32_16x16x32_bf16 v[124:127], v[40:43], v[24:27], v[124:127]
ds_read_b64_tr_b16 v[66:67], v5 offset:11536
s_waitcnt lgkmcnt(12)
v_mfma_f32_16x16x32_bf16 v[92:95], v[44:47], v[20:23], v[92:95]
ds_read_b64_tr_b16 v[36:37], v5 offset:9240
v_mfma_f32_16x16x32_bf16 v[128:131], v[44:47], v[24:27], v[128:131]
ds_read_b64_tr_b16 v[38:39], v5 offset:11544
s_waitcnt lgkmcnt(12)
v_mfma_f32_16x16x32_bf16 v[96:99], v[48:51], v[20:23], v[96:99]
ds_read_b64_tr_b16 v[40:41], v5 offset:9248
v_mfma_f32_16x16x32_bf16 v[132:135], v[48:51], v[24:27], v[132:135]
ds_read_b64_tr_b16 v[42:43], v5 offset:11552
s_waitcnt lgkmcnt(12)
v_mfma_f32_16x16x32_bf16 v[100:103], v[52:55], v[20:23], v[100:103]
ds_read_b64_tr_b16 v[44:45], v5 offset:9256
v_mfma_f32_16x16x32_bf16 v[136:139], v[52:55], v[24:27], v[136:139]
ds_read_b64_tr_b16 v[46:47], v5 offset:11560
s_waitcnt lgkmcnt(10)
v_mfma_f32_16x16x32_bf16 v[68:71], v[56:59], v[28:31], v[68:71]
ds_read_b64_tr_b16 v[48:49], v5 offset:9264
v_mfma_f32_16x16x32_bf16 v[104:107], v[56:59], v[32:35], v[104:107]
ds_read_b64_tr_b16 v[50:51], v5 offset:11568
s_waitcnt lgkmcnt(10)
v_mfma_f32_16x16x32_bf16 v[72:75], v[60:63], v[28:31], v[72:75]
ds_read_b64_tr_b16 v[52:53], v5 offset:9272
v_mfma_f32_16x16x32_bf16 v[108:111], v[60:63], v[32:35], v[108:111]
ds_read_b64_tr_b16 v[54:55], v5 offset:11576
s_waitcnt lgkmcnt(10)
v_mfma_f32_16x16x32_bf16 v[76:79], v[64:67], v[28:31], v[76:79]
ds_read_b64_tr_b16 v[56:57], v5 offset:9280
v_mfma_f32_16x16x32_bf16 v[112:115], v[64:67], v[32:35], v[112:115]
ds_read_b64_tr_b16 v[58:59], v5 offset:11584
s_waitcnt lgkmcnt(10)
v_mfma_f32_16x16x32_bf16 v[80:83], v[36:39], v[28:31], v[80:83]
s_waitcnt vmcnt(0)
s_barrier
ds_read_b128 v[20:23], v1 offset:49152
ds_read_b128 v[24:27], v1 offset:51200
v_mfma_f32_16x16x32_bf16 v[116:119], v[36:39], v[32:35], v[116:119]
ds_read_b64_tr_b16 v[60:61], v6 offset:0
ds_read_b64_tr_b16 v[62:63], v6 offset:2304
s_waitcnt lgkmcnt(12)
v_mfma_f32_16x16x32_bf16 v[84:87], v[40:43], v[28:31], v[84:87]
ds_read_b64_tr_b16 v[64:65], v6 offset:8
v_mfma_f32_16x16x32_bf16 v[120:123], v[40:43], v[32:35], v[120:123]
ds_read_b64_tr_b16 v[66:67], v6 offset:2312
s_waitcnt lgkmcnt(12)
v_mfma_f32_16x16x32_bf16 v[88:91], v[44:47], v[28:31], v[88:91]
ds_read_b64_tr_b16 v[36:37], v6 offset:16
v_mfma_f32_16x16x32_bf16 v[124:127], v[44:47], v[32:35], v[124:127]
ds_read_b64_tr_b16 v[38:39], v6 offset:2320
s_waitcnt lgkmcnt(12)
v_mfma_f32_16x16x32_bf16 v[92:95], v[48:51], v[28:31], v[92:95]
ds_read_b64_tr_b16 v[40:41], v6 offset:24
v_mfma_f32_16x16x32_bf16 v[128:131], v[48:51], v[32:35], v[128:131]
ds_read_b64_tr_b16 v[42:43], v6 offset:2328
s_waitcnt lgkmcnt(12)
v_mfma_f32_16x16x32_bf16 v[96:99], v[52:55], v[28:31], v[96:99]
ds_read_b64_tr_b16 v[44:45], v6 offset:32
v_mfma_f32_16x16x32_bf16 v[132:135], v[52:55], v[32:35], v[132:135]
ds_read_b64_tr_b16 v[46:47], v6 offset:2336
s_waitcnt lgkmcnt(12)
v_mfma_f32_16x16x32_bf16 v[100:103], v[56:59], v[28:31], v[100:103]
ds_read_b64_tr_b16 v[48:49], v6 offset:40
v_mfma_f32_16x16x32_bf16 v[136:139], v[56:59], v[32:35], v[136:139]
ds_read_b64_tr_b16 v[50:51], v6 offset:2344
s_waitcnt lgkmcnt(10)
v_mfma_f32_16x16x32_bf16 v[68:71], v[60:63], v[20:23], v[68:71]
ds_read_b64_tr_b16 v[52:53], v6 offset:48
v_mfma_f32_16x16x32_bf16 v[104:107], v[60:63], v[24:27], v[104:107]
ds_read_b64_tr_b16 v[54:55], v6 offset:2352
s_waitcnt lgkmcnt(10)
v_mfma_f32_16x16x32_bf16 v[72:75], v[64:67], v[20:23], v[72:75]
ds_read_b64_tr_b16 v[56:57], v6 offset:56
v_mfma_f32_16x16x32_bf16 v[108:111], v[64:67], v[24:27], v[108:111]
ds_read_b64_tr_b16 v[58:59], v6 offset:2360
s_waitcnt lgkmcnt(10)
v_mfma_f32_16x16x32_bf16 v[76:79], v[36:39], v[20:23], v[76:79]
ds_read_b64_tr_b16 v[60:61], v6 offset:64
v_mfma_f32_16x16x32_bf16 v[112:115], v[36:39], v[24:27], v[112:115]
ds_read_b64_tr_b16 v[62:63], v6 offset:2368
s_waitcnt lgkmcnt(10)
v_mfma_f32_16x16x32_bf16 v[80:83], v[40:43], v[20:23], v[80:83]
ds_read_b128 v[28:31], v2 offset:49152
ds_read_b128 v[32:35], v2 offset:51200
v_mfma_f32_16x16x32_bf16 v[116:119], v[40:43], v[24:27], v[116:119]
ds_read_b64_tr_b16 v[64:65], v6 offset:9216
ds_read_b64_tr_b16 v[66:67], v6 offset:11520
s_waitcnt lgkmcnt(12)
v_mfma_f32_16x16x32_bf16 v[84:87], v[44:47], v[20:23], v[84:87]
ds_read_b64_tr_b16 v[36:37], v6 offset:9224
v_mfma_f32_16x16x32_bf16 v[120:123], v[44:47], v[24:27], v[120:123]
ds_read_b64_tr_b16 v[38:39], v6 offset:11528
s_waitcnt lgkmcnt(12)
v_mfma_f32_16x16x32_bf16 v[88:91], v[48:51], v[20:23], v[88:91]
ds_read_b64_tr_b16 v[40:41], v6 offset:9232
v_mfma_f32_16x16x32_bf16 v[124:127], v[48:51], v[24:27], v[124:127]
ds_read_b64_tr_b16 v[42:43], v6 offset:11536
s_waitcnt lgkmcnt(12)
v_mfma_f32_16x16x32_bf16 v[92:95], v[52:55], v[20:23], v[92:95]
ds_read_b64_tr_b16 v[44:45], v6 offset:9240
v_mfma_f32_16x16x32_bf16 v[128:131], v[52:55], v[24:27], v[128:131]
ds_read_b64_tr_b16 v[46:47], v6 offset:11544
s_waitcnt lgkmcnt(12)
v_mfma_f32_16x16x32_bf16 v[96:99], v[56:59], v[20:23], v[96:99]
ds_read_b64_tr_b16 v[48:49], v6 offset:9248
v_mfma_f32_16x16x32_bf16 v[132:135], v[56:59], v[24:27], v[132:135]
ds_read_b64_tr_b16 v[50:51], v6 offset:11552
s_waitcnt lgkmcnt(12)
v_mfma_f32_16x16x32_bf16 v[100:103], v[60:63], v[20:23], v[100:103]
ds_read_b64_tr_b16 v[52:53], v6 offset:9256
v_mfma_f32_16x16x32_bf16 v[136:139], v[60:63], v[24:27], v[136:139]
ds_read_b64_tr_b16 v[54:55], v6 offset:11560
s_waitcnt lgkmcnt(10)
v_mfma_f32_16x16x32_bf16 v[68:71], v[64:67], v[28:31], v[68:71]
ds_read_b64_tr_b16 v[56:57], v6 offset:9264
v_mfma_f32_16x16x32_bf16 v[104:107], v[64:67], v[32:35], v[104:107]
ds_read_b64_tr_b16 v[58:59], v6 offset:11568
s_waitcnt lgkmcnt(10)
v_mfma_f32_16x16x32_bf16 v[72:75], v[36:39], v[28:31], v[72:75]
ds_read_b64_tr_b16 v[60:61], v6 offset:9272
v_mfma_f32_16x16x32_bf16 v[108:111], v[36:39], v[32:35], v[108:111]
ds_read_b64_tr_b16 v[62:63], v6 offset:11576
s_waitcnt lgkmcnt(10)
v_mfma_f32_16x16x32_bf16 v[76:79], v[40:43], v[28:31], v[76:79]
ds_read_b64_tr_b16 v[64:65], v6 offset:9280
v_mfma_f32_16x16x32_bf16 v[112:115], v[40:43], v[32:35], v[112:115]
ds_read_b64_tr_b16 v[66:67], v6 offset:11584
s_waitcnt lgkmcnt(10)
v_mfma_f32_16x16x32_bf16 v[80:83], v[44:47], v[28:31], v[80:83]
s_barrier
ds_read_b128 v[20:23], v1 offset:0
ds_read_b128 v[24:27], v1 offset:2048
v_mfma_f32_16x16x32_bf16 v[116:119], v[44:47], v[32:35], v[116:119]
ds_read_b64_tr_b16 v[36:37], v3 offset:0
ds_read_b64_tr_b16 v[38:39], v3 offset:2304
s_waitcnt lgkmcnt(12)
v_mfma_f32_16x16x32_bf16 v[84:87], v[48:51], v[28:31], v[84:87]
ds_read_b64_tr_b16 v[40:41], v3 offset:8
v_mfma_f32_16x16x32_bf16 v[120:123], v[48:51], v[32:35], v[120:123]
ds_read_b64_tr_b16 v[42:43], v3 offset:2312
s_waitcnt lgkmcnt(12)
v_mfma_f32_16x16x32_bf16 v[88:91], v[52:55], v[28:31], v[88:91]
ds_read_b64_tr_b16 v[44:45], v3 offset:16
v_mfma_f32_16x16x32_bf16 v[124:127], v[52:55], v[32:35], v[124:127]
ds_read_b64_tr_b16 v[46:47], v3 offset:2320
s_waitcnt lgkmcnt(12)
v_mfma_f32_16x16x32_bf16 v[92:95], v[56:59], v[28:31], v[92:95]
ds_read_b64_tr_b16 v[48:49], v3 offset:24
v_mfma_f32_16x16x32_bf16 v[128:131], v[56:59], v[32:35], v[128:131]
ds_read_b64_tr_b16 v[50:51], v3 offset:2328
s_waitcnt lgkmcnt(12)
v_mfma_f32_16x16x32_bf16 v[96:99], v[60:63], v[28:31], v[96:99]
ds_read_b64_tr_b16 v[52:53], v3 offset:32
v_mfma_f32_16x16x32_bf16 v[132:135], v[60:63], v[32:35], v[132:135]
ds_read_b64_tr_b16 v[54:55], v3 offset:2336
s_waitcnt lgkmcnt(12)
v_mfma_f32_16x16x32_bf16 v[100:103], v[64:67], v[28:31], v[100:103]
ds_read_b64_tr_b16 v[56:57], v3 offset:40
v_mfma_f32_16x16x32_bf16 v[136:139], v[64:67], v[32:35], v[136:139]
ds_read_b64_tr_b16 v[58:59], v3 offset:2344
s_waitcnt lgkmcnt(10)
v_mfma_f32_16x16x32_bf16 v[68:71], v[36:39], v[20:23], v[68:71]
ds_read_b64_tr_b16 v[60:61], v3 offset:48
v_mfma_f32_16x16x32_bf16 v[104:107], v[36:39], v[24:27], v[104:107]
ds_read_b64_tr_b16 v[62:63], v3 offset:2352
s_waitcnt lgkmcnt(10)
v_mfma_f32_16x16x32_bf16 v[72:75], v[40:43], v[20:23], v[72:75]
ds_read_b64_tr_b16 v[64:65], v3 offset:56
v_mfma_f32_16x16x32_bf16 v[108:111], v[40:43], v[24:27], v[108:111]
ds_read_b64_tr_b16 v[66:67], v3 offset:2360
s_waitcnt lgkmcnt(10)
v_mfma_f32_16x16x32_bf16 v[76:79], v[44:47], v[20:23], v[76:79]
ds_read_b64_tr_b16 v[36:37], v3 offset:64
v_mfma_f32_16x16x32_bf16 v[112:115], v[44:47], v[24:27], v[112:115]
ds_read_b64_tr_b16 v[38:39], v3 offset:2368
s_waitcnt lgkmcnt(10)
v_mfma_f32_16x16x32_bf16 v[80:83], v[48:51], v[20:23], v[80:83]
ds_read_b128 v[28:31], v2 offset:0
ds_read_b128 v[32:35], v2 offset:2048
v_mfma_f32_16x16x32_bf16 v[116:119], v[48:51], v[24:27], v[116:119]
ds_read_b64_tr_b16 v[40:41], v3 offset:9216
ds_read_b64_tr_b16 v[42:43], v3 offset:11520
s_waitcnt lgkmcnt(12)
v_mfma_f32_16x16x32_bf16 v[84:87], v[52:55], v[20:23], v[84:87]
ds_read_b64_tr_b16 v[44:45], v3 offset:9224
v_mfma_f32_16x16x32_bf16 v[120:123], v[52:55], v[24:27], v[120:123]
ds_read_b64_tr_b16 v[46:47], v3 offset:11528
s_waitcnt lgkmcnt(12)
v_mfma_f32_16x16x32_bf16 v[88:91], v[56:59], v[20:23], v[88:91]
ds_read_b64_tr_b16 v[48:49], v3 offset:9232
v_mfma_f32_16x16x32_bf16 v[124:127], v[56:59], v[24:27], v[124:127]
ds_read_b64_tr_b16 v[50:51], v3 offset:11536
s_waitcnt lgkmcnt(12)
v_mfma_f32_16x16x32_bf16 v[92:95], v[60:63], v[20:23], v[92:95]
ds_read_b64_tr_b16 v[52:53], v3 offset:9240
v_mfma_f32_16x16x32_bf16 v[128:131], v[60:63], v[24:27], v[128:131]
ds_read_b64_tr_b16 v[54:55], v3 offset:11544
s_waitcnt lgkmcnt(12)
v_mfma_f32_16x16x32_bf16 v[96:99], v[64:67], v[20:23], v[96:99]
ds_read_b64_tr_b16 v[56:57], v3 offset:9248
v_mfma_f32_16x16x32_bf16 v[132:135], v[64:67], v[24:27], v[132:135]
ds_read_b64_tr_b16 v[58:59], v3 offset:11552
s_waitcnt lgkmcnt(12)
v_mfma_f32_16x16x32_bf16 v[100:103], v[36:39], v[20:23], v[100:103]
ds_read_b64_tr_b16 v[60:61], v3 offset:9256
v_mfma_f32_16x16x32_bf16 v[136:139], v[36:39], v[24:27], v[136:139]
ds_read_b64_tr_b16 v[62:63], v3 offset:11560
s_waitcnt lgkmcnt(10)
v_mfma_f32_16x16x32_bf16 v[68:71], v[40:43], v[28:31], v[68:71]
ds_read_b64_tr_b16 v[64:65], v3 offset:9264
v_mfma_f32_16x16x32_bf16 v[104:107], v[40:43], v[32:35], v[104:107]
ds_read_b64_tr_b16 v[66:67], v3 offset:11568
s_waitcnt lgkmcnt(10)
v_mfma_f32_16x16x32_bf16 v[72:75], v[44:47], v[28:31], v[72:75]
ds_read_b64_tr_b16 v[36:37], v3 offset:9272
v_mfma_f32_16x16x32_bf16 v[108:111], v[44:47], v[32:35], v[108:111]
ds_read_b64_tr_b16 v[38:39], v3 offset:11576
s_waitcnt lgkmcnt(10)
v_mfma_f32_16x16x32_bf16 v[76:79], v[48:51], v[28:31], v[76:79]
ds_read_b64_tr_b16 v[40:41], v3 offset:9280
v_mfma_f32_16x16x32_bf16 v[112:115], v[48:51], v[32:35], v[112:115]
ds_read_b64_tr_b16 v[42:43], v3 offset:11584
s_waitcnt lgkmcnt(10)
v_mfma_f32_16x16x32_bf16 v[80:83], v[52:55], v[28:31], v[80:83]
v_mfma_f32_16x16x32_bf16 v[116:119], v[52:55], v[32:35], v[116:119]
s_waitcnt lgkmcnt(8)
v_mfma_f32_16x16x32_bf16 v[84:87], v[56:59], v[28:31], v[84:87]
v_mfma_f32_16x16x32_bf16 v[120:123], v[56:59], v[32:35], v[120:123]
s_waitcnt lgkmcnt(6)
v_mfma_f32_16x16x32_bf16 v[88:91], v[60:63], v[28:31], v[88:91]
v_mfma_f32_16x16x32_bf16 v[124:127], v[60:63], v[32:35], v[124:127]
s_waitcnt lgkmcnt(4)
v_mfma_f32_16x16x32_bf16 v[92:95], v[64:67], v[28:31], v[92:95]
v_mfma_f32_16x16x32_bf16 v[128:131], v[64:67], v[32:35], v[128:131]
s_waitcnt lgkmcnt(2)
v_mfma_f32_16x16x32_bf16 v[96:99], v[36:39], v[28:31], v[96:99]
v_mfma_f32_16x16x32_bf16 v[132:135], v[36:39], v[32:35], v[132:135]
s_waitcnt lgkmcnt(0)
v_mfma_f32_16x16x32_bf16 v[100:103], v[40:43], v[28:31], v[100:103]
v_mfma_f32_16x16x32_bf16 v[136:139], v[40:43], v[32:35], v[136:139]
ds_read_b64_tr_b16 v[140:141], v230 offset:0
ds_read_b64_tr_b16 v[142:143], v230 offset:160
ds_read_b64_tr_b16 v[156:157], v231 offset:640
ds_read_b64_tr_b16 v[144:145], v230 offset:768
ds_read_b64_tr_b16 v[146:147], v230 offset:928
ds_read_b64_tr_b16 v[160:161], v231 offset:1408
ds_read_b64_tr_b16 v[148:149], v230 offset:1536
ds_read_b64_tr_b16 v[150:151], v230 offset:1696
ds_read_b64_tr_b16 v[164:165], v231 offset:2176
ds_read_b64_tr_b16 v[152:153], v230 offset:2304
ds_read_b64_tr_b16 v[154:155], v230 offset:2464
ds_read_b64_tr_b16 v[168:169], v231 offset:2944
s_barrier
s_nop 0
v_cvt_pk_bf16_f32 v192, v68, v69
v_cvt_pk_bf16_f32 v193, v70, v71
v_cvt_pk_bf16_f32 v194, v72, v73
v_cvt_pk_bf16_f32 v195, v74, v75
v_cvt_pk_bf16_f32 v196, v104, v105
v_cvt_pk_bf16_f32 v197, v106, v107
v_cvt_pk_bf16_f32 v198, v108, v109
v_cvt_pk_bf16_f32 v199, v110, v111
v_cvt_pk_bf16_f32 v200, v76, v77
v_cvt_pk_bf16_f32 v201, v78, v79
v_cvt_pk_bf16_f32 v202, v80, v81
v_cvt_pk_bf16_f32 v203, v82, v83
v_cvt_pk_bf16_f32 v204, v112, v113
v_cvt_pk_bf16_f32 v205, v114, v115
v_cvt_pk_bf16_f32 v206, v116, v117
v_cvt_pk_bf16_f32 v207, v118, v119
v_cvt_pk_bf16_f32 v224, v84, v85
v_cvt_pk_bf16_f32 v226, v120, v121
v_cvt_pk_bf16_f32 v208, v86, v87
v_cvt_pk_bf16_f32 v209, v88, v89
v_cvt_pk_bf16_f32 v210, v90, v91
v_cvt_pk_bf16_f32 v211, v92, v93
v_cvt_pk_bf16_f32 v212, v122, v123
v_cvt_pk_bf16_f32 v213, v124, v125
v_cvt_pk_bf16_f32 v214, v126, v127
v_cvt_pk_bf16_f32 v215, v128, v129
v_cvt_pk_bf16_f32 v216, v94, v95
v_cvt_pk_bf16_f32 v217, v96, v97
v_cvt_pk_bf16_f32 v218, v98, v99
v_cvt_pk_bf16_f32 v219, v100, v101
v_cvt_pk_bf16_f32 v220, v130, v131
v_cvt_pk_bf16_f32 v221, v132, v133
v_cvt_pk_bf16_f32 v222, v134, v135
v_cvt_pk_bf16_f32 v223, v136, v137
v_cvt_pk_bf16_f32 v225, v102, v103
v_cvt_pk_bf16_f32 v227, v138, v139
v_permlane32_swap_b32 v192, v200
v_permlane32_swap_b32 v196, v204
v_permlane32_swap_b32 v193, v201
v_permlane32_swap_b32 v197, v205
v_permlane32_swap_b32 v194, v202
v_permlane32_swap_b32 v198, v206
v_permlane32_swap_b32 v195, v203
v_permlane32_swap_b32 v199, v207
v_permlane32_swap_b32 v208, v216
v_permlane32_swap_b32 v212, v220
v_permlane32_swap_b32 v209, v217
v_permlane32_swap_b32 v213, v221
v_permlane32_swap_b32 v210, v218
v_permlane32_swap_b32 v214, v222
v_permlane32_swap_b32 v211, v219
v_permlane32_swap_b32 v215, v223
v_permlane32_swap_b32 v224, v225
v_permlane32_swap_b32 v226, v227
v_permlane16_swap_b32 v192, v196
v_permlane16_swap_b32 v200, v204
v_permlane16_swap_b32 v193, v197
v_permlane16_swap_b32 v201, v205
v_permlane16_swap_b32 v194, v198
v_permlane16_swap_b32 v202, v206
v_permlane16_swap_b32 v195, v199
v_permlane16_swap_b32 v203, v207
v_permlane16_swap_b32 v208, v212
v_permlane16_swap_b32 v216, v220
v_permlane16_swap_b32 v209, v213
v_permlane16_swap_b32 v217, v221
v_permlane16_swap_b32 v210, v214
v_permlane16_swap_b32 v218, v222
v_permlane16_swap_b32 v211, v215
v_permlane16_swap_b32 v219, v223
v_permlane16_swap_b32 v224, v226
v_permlane16_swap_b32 v225, v227
s_waitcnt lgkmcnt(0)
v_cndmask_b32 v156, v156, 0, s[60:61]
v_mov_b32 v157, 0
v_mov_b32 v158, 0
v_mov_b32 v159, 0
v_cndmask_b32 v160, 0, v160, s[60:61]
v_mov_b32 v161, 0
v_mov_b32 v162, 0
v_mov_b32_e64 v163, 0
v_cndmask_b32 v164, v164, 0, s[60:61]
v_mov_b32 v165, 0
v_mov_b32 v166, 0
v_mov_b32_e64 v167, 0
v_cndmask_b32 v168, 0, v168, s[60:61]
v_mov_b32 v169, 0
v_mov_b32 v170, 0
v_mov_b32_e64 v171, 0
v_mfma_f32_32x32x16_bf16 v[68:83], v[140:143], v[192:195], 0
v_mfma_f32_32x32x16_bf16 v[84:99], v[144:147], v[208:211], 0
v_mfma_f32_32x32x16_bf16 v[100:115], v[148:151], v[196:199], 0
v_mfma_f32_32x32x16_bf16 v[116:131], v[152:155], v[212:215], 0
v_mfma_f32_32x32x16_bf16 v[68:83], v[156:159], v[224:227], v[68:83]
v_mfma_f32_32x32x16_bf16 v[84:99], v[160:163], v[224:227], v[84:99]
v_mfma_f32_32x32x16_bf16 v[100:115], v[164:167], v[226:229], v[100:115]
v_mfma_f32_32x32x16_bf16 v[116:131], v[168:171], v[226:229], v[116:131]
ds_write_b64 v233, v[200:201] offset:80
ds_write_b64 v233, v[202:203] offset:88
ds_write_b64 v233, v[216:217] offset:15440
ds_write_b64 v233, v[218:219] offset:15448
ds_write_b64 v233, v[204:205] offset:30800
ds_write_b64 v233, v[206:207] offset:30808
ds_write_b64 v233, v[220:221] offset:46160
ds_write_b64 v233, v[222:223] offset:46168
ds_write2_b32 v234, v225, v235 offset0:0 offset1:1
v_add_u32 v234, 30720, v234
ds_write2_b32 v234, v227, v235 offset0:0 offset1:1
v_mov_b32 v29, 0
v_mov_b32 v39, 0
v_mov_b32 v49, 0
v_mov_b32 v59, 0
v_cndmask_b32 v76, v76, v77, s[60:61]
v_cndmask_b32 v92, v92, v93, s[60:61]
v_pk_mul_f32 v[140:141], v[68:69], s[62:63] op_sel:[0,0] op_sel_hi:[0,1]
v_pk_mul_f32 v[142:143], v[68:69], s[62:63] op_sel:[1,0] op_sel_hi:[1,1]
v_pk_mul_f32 v[144:145], v[70:71], s[62:63] op_sel:[0,0] op_sel_hi:[0,1]
v_pk_mul_f32 v[146:147], v[70:71], s[62:63] op_sel:[1,0] op_sel_hi:[1,1]
v_pk_mul_f32 v[148:149], v[72:73], s[62:63] op_sel:[0,0] op_sel_hi:[0,1]
v_pk_mul_f32 v[150:151], v[72:73], s[62:63] op_sel:[1,0] op_sel_hi:[1,1]
v_pk_mul_f32 v[152:153], v[74:75], s[62:63] op_sel:[0,0] op_sel_hi:[0,1]
v_pk_mul_f32 v[154:155], v[74:75], s[62:63] op_sel:[1,0] op_sel_hi:[1,1]
v_pk_mul_f32 v[156:157], v[76:77], s[62:63] op_sel:[0,0] op_sel_hi:[0,1]
v_exp_f32 v140, v140
v_exp_f32 v141, v141
v_exp_f32 v142, v142
v_exp_f32 v143, v143
v_exp_f32 v144, v144
v_exp_f32 v145, v145
v_exp_f32 v146, v146
v_exp_f32 v147, v147
v_exp_f32 v148, v148
v_exp_f32 v149, v149
v_exp_f32 v150, v150
v_exp_f32 v151, v151
v_exp_f32 v152, v152
v_exp_f32 v153, v153
v_exp_f32 v154, v154
v_exp_f32 v155, v155
v_exp_f32 v156, v156
v_exp_f32 v157, v157
v_pk_mul_f32 v[166:167], v[84:85], s[62:63] op_sel:[0,0] op_sel_hi:[0,1]
v_pk_mul_f32 v[168:169], v[84:85], s[62:63] op_sel:[1,0] op_sel_hi:[1,1]
v_pk_mul_f32 v[170:171], v[86:87], s[62:63] op_sel:[0,0] op_sel_hi:[0,1]
v_pk_mul_f32 v[172:173], v[86:87], s[62:63] op_sel:[1,0] op_sel_hi:[1,1]
v_pk_mul_f32 v[174:175], v[88:89], s[62:63] op_sel:[0,0] op_sel_hi:[0,1]
v_pk_mul_f32 v[176:177], v[88:89], s[62:63] op_sel:[1,0] op_sel_hi:[1,1]
v_pk_mul_f32 v[178:179], v[90:91], s[62:63] op_sel:[0,0] op_sel_hi:[0,1]
v_pk_mul_f32 v[180:181], v[90:91], s[62:63] op_sel:[1,0] op_sel_hi:[1,1]
v_pk_mul_f32 v[182:183], v[92:93], s[62:63] op_sel:[0,0] op_sel_hi:[0,1]
v_exp_f32 v166, v166
v_exp_f32 v167, v167
v_exp_f32 v168, v168
v_exp_f32 v169, v169
v_exp_f32 v170, v170
v_exp_f32 v171, v171
v_exp_f32 v172, v172
v_exp_f32 v173, v173
v_exp_f32 v174, v174
v_exp_f32 v175, v175
v_exp_f32 v176, v176
v_exp_f32 v177, v177
v_exp_f32 v178, v178
v_exp_f32 v179, v179
v_exp_f32 v180, v180
v_exp_f32 v181, v181
v_exp_f32 v182, v182
v_exp_f32 v183, v183
v_pk_add_f32 v[160:161], v[140:141], v[142:143]
v_pk_add_f32 v[162:163], v[144:145], v[146:147]
v_pk_add_f32 v[164:165], v[148:149], v[150:151]
v_pk_add_f32 v[160:161], v[160:161], v[152:153]
v_pk_add_f32 v[162:163], v[162:163], v[154:155]
v_pk_add_f32 v[164:165], v[164:165], v[156:157]
v_pk_add_f32 v[160:161], v[160:161], v[162:163]
v_pk_add_f32 v[160:161], v[160:161], v[164:165]
v_pk_add_f32 v[186:187], v[166:167], v[168:169]
v_pk_add_f32 v[188:189], v[170:171], v[172:173]
v_pk_add_f32 v[190:191], v[174:175], v[176:177]
v_pk_add_f32 v[186:187], v[186:187], v[178:179]
v_pk_add_f32 v[188:189], v[188:189], v[180:181]
v_pk_add_f32 v[190:191], v[190:191], v[182:183]
v_pk_add_f32 v[186:187], v[186:187], v[188:189]
v_pk_add_f32 v[186:187], v[186:187], v[190:191]
v_permlane32_swap_b32 v160, v161
s_nop 0
v_permlane32_swap_b32 v186, v187
v_add_f32 v160, v160, v161
v_add_f32 v186, v186, v187
v_add_f32 v162, v160, v186
v_rcp_f32 v160, v160
v_rcp_f32 v186, v186
v_cmp_nge_f32 vcc, 1568669696, v162
v_mov_b32 v161, v160
v_mov_b32 v187, v186
s_cmp_lg_u64 vcc, 0
s_cbranch_scc1 L_hk0_slow
v_permlane32_swap_b32 v160, v161
v_permlane32_swap_b32 v186, v187
v_pk_mul_f32 v[140:141], v[140:141], v[160:161]
v_pk_mul_f32 v[142:143], v[142:143], v[160:161]
v_pk_mul_f32 v[144:145], v[144:145], v[160:161]
v_pk_mul_f32 v[146:147], v[146:147], v[160:161]
v_pk_mul_f32 v[148:149], v[148:149], v[160:161]
v_pk_mul_f32 v[150:151], v[150:151], v[160:161]
v_pk_mul_f32 v[152:153], v[152:153], v[160:161]
v_pk_mul_f32 v[154:155], v[154:155], v[160:161]
v_pk_mul_f32 v[156:157], v[156:157], v[160:161]
v_cvt_pk_bf16_f32 v20, v140, v141
v_cvt_pk_bf16_f32 v21, v142, v143
v_cvt_pk_bf16_f32 v22, v144, v145
v_cvt_pk_bf16_f32 v23, v146, v147
v_cvt_pk_bf16_f32 v24, v148, v149
v_cvt_pk_bf16_f32 v25, v150, v151
v_cvt_pk_bf16_f32 v26, v152, v153
v_cvt_pk_bf16_f32 v27, v154, v155
v_cvt_pk_bf16_f32 v28, v156, v157
v_pk_mul_f32 v[166:167], v[166:167], v[186:187]
v_pk_mul_f32 v[168:169], v[168:169], v[186:187]
v_pk_mul_f32 v[170:171], v[170:171], v[186:187]
v_pk_mul_f32 v[172:173], v[172:173], v[186:187]
v_pk_mul_f32 v[174:175], v[174:175], v[186:187]
v_pk_mul_f32 v[176:177], v[176:177], v[186:187]
v_pk_mul_f32 v[178:179], v[178:179], v[186:187]
v_pk_mul_f32 v[180:181], v[180:181], v[186:187]
v_pk_mul_f32 v[182:183], v[182:183], v[186:187]
L_pdV2_0:
s_cbranch_execz L_retV
s_nop 0
v_cvt_pk_bf16_f32 v30, v166, v167
v_cvt_pk_bf16_f32 v31, v168, v169
v_cvt_pk_bf16_f32 v32, v170, v171
v_cvt_pk_bf16_f32 v33, v172, v173
v_cvt_pk_bf16_f32 v34, v174, v175
v_cvt_pk_bf16_f32 v35, v176, v177
v_cvt_pk_bf16_f32 v36, v178, v179
v_cvt_pk_bf16_f32 v37, v180, v181
v_cvt_pk_bf16_f32 v38, v182, v183
L_hk0_done:
ds_write_b64 v232, v[20:21] offset:0
ds_write_b64 v232, v[22:23] offset:8
ds_write_b64 v232, v[24:25] offset:16
ds_write_b64 v232, v[26:27] offset:24
ds_write_b64 v232, v[28:29] offset:32
ds_write_b64 v232, v[30:31] offset:15360
ds_write_b64 v232, v[32:33] offset:15368
ds_write_b64 v232, v[34:35] offset:15376
ds_write_b64 v232, v[36:37] offset:15384
ds_write_b64 v232, v[38:39] offset:15392
v_cndmask_b32 v108, v108, v109, s[60:61]
v_cndmask_b32 v124, v124, v125, s[60:61]
v_pk_mul_f32 v[140:141], v[100:101], s[62:63] op_sel:[0,0] op_sel_hi:[0,1]
v_pk_mul_f32 v[142:143], v[100:101], s[62:63] op_sel:[1,0] op_sel_hi:[1,1]
v_pk_mul_f32 v[144:145], v[102:103], s[62:63] op_sel:[0,0] op_sel_hi:[0,1]
v_pk_mul_f32 v[146:147], v[102:103], s[62:63] op_sel:[1,0] op_sel_hi:[1,1]
v_pk_mul_f32 v[148:149], v[104:105], s[62:63] op_sel:[0,0] op_sel_hi:[0,1]
v_pk_mul_f32 v[150:151], v[104:105], s[62:63] op_sel:[1,0] op_sel_hi:[1,1]
v_pk_mul_f32 v[152:153], v[106:107], s[62:63] op_sel:[0,0] op_sel_hi:[0,1]
v_pk_mul_f32 v[154:155], v[106:107], s[62:63] op_sel:[1,0] op_sel_hi:[1,1]
v_pk_mul_f32 v[156:157], v[108:109], s[62:63] op_sel:[0,0] op_sel_hi:[0,1]
v_exp_f32 v140, v140
v_exp_f32 v141, v141
v_exp_f32 v142, v142
v_exp_f32 v143, v143
v_exp_f32 v144, v144
v_exp_f32 v145, v145
v_exp_f32 v146, v146
v_exp_f32 v147, v147
v_exp_f32 v148, v148
v_exp_f32 v149, v149
v_exp_f32 v150, v150
v_exp_f32 v151, v151
v_exp_f32 v152, v152
v_exp_f32 v153, v153
v_exp_f32 v154, v154
v_exp_f32 v155, v155
v_exp_f32 v156, v156
v_exp_f32 v157, v157
v_pk_mul_f32 v[166:167], v[116:117], s[62:63] op_sel:[0,0] op_sel_hi:[0,1]
v_pk_mul_f32 v[168:169], v[116:117], s[62:63] op_sel:[1,0] op_sel_hi:[1,1]
v_pk_mul_f32 v[170:171], v[118:119], s[62:63] op_sel:[0,0] op_sel_hi:[0,1]
v_pk_mul_f32 v[172:173], v[118:119], s[62:63] op_sel:[1,0] op_sel_hi:[1,1]
v_pk_mul_f32 v[174:175], v[120:121], s[62:63] op_sel:[0,0] op_sel_hi:[0,1]
v_pk_mul_f32 v[176:177], v[120:121], s[62:63] op_sel:[1,0] op_sel_hi:[1,1]
v_pk_mul_f32 v[178:179], v[122:123], s[62:63] op_sel:[0,0] op_sel_hi:[0,1]
v_pk_mul_f32 v[180:181], v[122:123], s[62:63] op_sel:[1,0] op_sel_hi:[1,1]
v_pk_mul_f32 v[182:183], v[124:125], s[62:63] op_sel:[0,0] op_sel_hi:[0,1]
v_exp_f32 v166, v166
v_exp_f32 v167, v167
v_exp_f32 v168, v168
v_exp_f32 v169, v169
v_exp_f32 v170, v170
v_exp_f32 v171, v171
v_exp_f32 v172, v172
v_exp_f32 v173, v173
v_exp_f32 v174, v174
v_exp_f32 v175, v175
v_exp_f32 v176, v176
v_exp_f32 v177, v177
v_exp_f32 v178, v178
v_exp_f32 v179, v179
v_exp_f32 v180, v180
v_exp_f32 v181, v181
v_exp_f32 v182, v182
v_exp_f32 v183, v183
v_pk_add_f32 v[160:161], v[140:141], v[142:143]
v_pk_add_f32 v[162:163], v[144:145], v[146:147]
v_pk_add_f32 v[164:165], v[148:149], v[150:151]
v_pk_add_f32 v[160:161], v[160:161], v[152:153]
v_pk_add_f32 v[162:163], v[162:163], v[154:155]
v_pk_add_f32 v[164:165], v[164:165], v[156:157]
v_pk_add_f32 v[160:161], v[160:161], v[162:163]
v_pk_add_f32 v[160:161], v[160:161], v[164:165]
v_pk_add_f32 v[186:187], v[166:167], v[168:169]
v_pk_add_f32 v[188:189], v[170:171], v[172:173]
v_pk_add_f32 v[190:191], v[174:175], v[176:177]
v_pk_add_f32 v[186:187], v[186:187], v[178:179]
v_pk_add_f32 v[188:189], v[188:189], v[180:181]
v_pk_add_f32 v[190:191], v[190:191], v[182:183]
v_pk_add_f32 v[186:187], v[186:187], v[188:189]
v_pk_add_f32 v[186:187], v[186:187], v[190:191]
v_permlane32_swap_b32 v160, v161
s_nop 0
v_permlane32_swap_b32 v186, v187
v_add_f32 v160, v160, v161
v_add_f32 v186, v186, v187
v_add_f32 v162, v160, v186
v_rcp_f32 v160, v160
v_rcp_f32 v186, v186
v_cmp_nge_f32 vcc, 1568669696, v162
v_mov_b32 v161, v160
v_mov_b32 v187, v186
s_cmp_lg_u64 vcc, 0
s_cbranch_scc1 L_hk1_slow
v_permlane32_swap_b32 v160, v161
v_permlane32_swap_b32 v186, v187
v_pk_mul_f32 v[140:141], v[140:141], v[160:161]
v_pk_mul_f32 v[142:143], v[142:143], v[160:161]
v_pk_mul_f32 v[144:145], v[144:145], v[160:161]
v_pk_mul_f32 v[146:147], v[146:147], v[160:161]
v_pk_mul_f32 v[148:149], v[148:149], v[160:161]
v_pk_mul_f32 v[150:151], v[150:151], v[160:161]
v_pk_mul_f32 v[152:153], v[152:153], v[160:161]
v_pk_mul_f32 v[154:155], v[154:155], v[160:161]
v_pk_mul_f32 v[156:157], v[156:157], v[160:161]
v_cvt_pk_bf16_f32 v40, v140, v141
v_cvt_pk_bf16_f32 v41, v142, v143
v_cvt_pk_bf16_f32 v42, v144, v145
v_cvt_pk_bf16_f32 v43, v146, v147
v_cvt_pk_bf16_f32 v44, v148, v149
v_cvt_pk_bf16_f32 v45, v150, v151
v_cvt_pk_bf16_f32 v46, v152, v153
v_cvt_pk_bf16_f32 v47, v154, v155
v_cvt_pk_bf16_f32 v48, v156, v157
v_pk_mul_f32 v[166:167], v[166:167], v[186:187]
v_pk_mul_f32 v[168:169], v[168:169], v[186:187]
v_pk_mul_f32 v[170:171], v[170:171], v[186:187]
v_pk_mul_f32 v[172:173], v[172:173], v[186:187]
v_pk_mul_f32 v[174:175], v[174:175], v[186:187]
v_pk_mul_f32 v[176:177], v[176:177], v[186:187]
v_pk_mul_f32 v[178:179], v[178:179], v[186:187]
v_pk_mul_f32 v[180:181], v[180:181], v[186:187]
v_pk_mul_f32 v[182:183], v[182:183], v[186:187]
v_cvt_pk_bf16_f32 v50, v166, v167
v_cvt_pk_bf16_f32 v51, v168, v169
v_cvt_pk_bf16_f32 v52, v170, v171
v_cvt_pk_bf16_f32 v53, v172, v173
v_cvt_pk_bf16_f32 v54, v174, v175
v_cvt_pk_bf16_f32 v55, v176, v177
v_cvt_pk_bf16_f32 v56, v178, v179
v_cvt_pk_bf16_f32 v57, v180, v181
v_cvt_pk_bf16_f32 v58, v182, v183
L_hk1_done:
ds_write_b64 v232, v[40:41] offset:30720
ds_write_b64 v232, v[42:43] offset:30728
ds_write_b64 v232, v[44:45] offset:30736
ds_write_b64 v232, v[46:47] offset:30744
ds_write_b64 v232, v[48:49] offset:30752
ds_write_b64 v232, v[50:51] offset:46080
ds_write_b64 v232, v[52:53] offset:46088
ds_write_b64 v232, v[54:55] offset:46096
ds_write_b64 v232, v[56:57] offset:46104
ds_write_b64 v232, v[58:59] offset:46112
v_bfe_u32 v9, v0, 4, 1
v_bfe_u32 v10, v0, 2, 2
v_lshl_add_u32 v9, v9, 2, v10
v_lshrrev_b32 v10, 5, v0
v_lshlrev_b32 v10, 1, v10
v_lshl_add_u32 v9, v9, 2, v10
s_lshl_b32 s40, s52, 7
v_add_u32 v9, s40, v9
v_mul_u32_u24 v9, 120, v9
v_and_b32_e64 v10, 3, v0
v_lshl_add_u32 v9, v10, 3, v9
s_lshl_b32 s40, s38, 2
s_add_u32 s40, s40, s52
s_lshl_b32 s40, s40, 4
s_add_u32 s40, s40, s37
s_mul_i32 s40, s40, 1792
s_add_u32 s40, s40, 9699328
s_add_u32 s24, s14, s40
s_addc_u32 s25, s15, 0
s_mov_b32 s26, 1792
s_mov_b32 s27, 0x20000
v_lshlrev_b32 v10, 4, v0
v_mov_b32 v12, s58
v_cndmask_b32 v11, v10, v12, s[60:61]
v_lshl_add_u32 v230, v14, 2, v13
v_lshlrev_b32 v230, 4, v230
v_cmp_gt_u32 vcc, 4, v13
s_nop 1
v_cndmask_b32 v230, v12, v230, vcc
s_waitcnt lgkmcnt(0)
s_barrier
ds_read_b64_tr_b16 v[140:141], v9 offset:0
ds_read_b64_tr_b16 v[142:143], v9 offset:120
ds_read_b64_tr_b16 v[144:145], v9 offset:32
ds_read_b64_tr_b16 v[146:147], v9 offset:152
ds_read_b64_tr_b16 v[148:149], v9 offset:64
ds_read_b64_tr_b16 v[150:151], v9 offset:184
ds_read_b64_tr_b16 v[152:153], v9 offset:80
ds_read_b64_tr_b16 v[154:155], v9 offset:200
ds_read_b64_tr_b16 v[156:157], v9 offset:112
ds_read_b64_tr_b16 v[158:159], v9 offset:232
ds_read_b64_tr_b16 v[160:161], v9 offset:3840
ds_read_b64_tr_b16 v[162:163], v9 offset:3960
ds_read_b64_tr_b16 v[164:165], v9 offset:3872
ds_read_b64_tr_b16 v[166:167], v9 offset:3992
ds_read_b64_tr_b16 v[168:169], v9 offset:3904
ds_read_b64_tr_b16 v[170:171], v9 offset:4024
ds_read_b64_tr_b16 v[172:173], v9 offset:3920
ds_read_b64_tr_b16 v[174:175], v9 offset:4040
ds_read_b64_tr_b16 v[176:177], v9 offset:3952
ds_read_b64_tr_b16 v[178:179], v9 offset:4072
s_waitcnt lgkmcnt(10)
v_mfma_f32_16x16x32_bf16 v[68:71], v[140:143], v[152:155], 0
v_mfma_f32_16x16x32_bf16 v[72:75], v[140:143], v[156:159], 0
v_mfma_f32_16x16x32_bf16 v[76:79], v[144:147], v[152:155], 0
v_mfma_f32_16x16x32_bf16 v[80:83], v[144:147], v[156:159], 0
v_mfma_f32_16x16x32_bf16 v[84:87], v[148:151], v[152:155], 0
v_mfma_f32_16x16x32_bf16 v[88:91], v[148:151], v[156:159], 0
ds_read_b64_tr_b16 v[140:141], v9 offset:7680
ds_read_b64_tr_b16 v[142:143], v9 offset:7800
ds_read_b64_tr_b16 v[144:145], v9 offset:7712
ds_read_b64_tr_b16 v[146:147], v9 offset:7832
ds_read_b64_tr_b16 v[148:149], v9 offset:7744
ds_read_b64_tr_b16 v[150:151], v9 offset:7864
ds_read_b64_tr_b16 v[152:153], v9 offset:7760
ds_read_b64_tr_b16 v[154:155], v9 offset:7880
ds_read_b64_tr_b16 v[156:157], v9 offset:7792
ds_read_b64_tr_b16 v[158:159], v9 offset:7912
s_waitcnt lgkmcnt(10)
v_mfma_f32_16x16x32_bf16 v[68:71], v[160:163], v[172:175], v[68:71]
v_mfma_f32_16x16x32_bf16 v[72:75], v[160:163], v[176:179], v[72:75]
v_mfma_f32_16x16x32_bf16 v[76:79], v[164:167], v[172:175], v[76:79]
v_mfma_f32_16x16x32_bf16 v[80:83], v[164:167], v[176:179], v[80:83]
v_mfma_f32_16x16x32_bf16 v[84:87], v[168:171], v[172:175], v[84:87]
v_mfma_f32_16x16x32_bf16 v[88:91], v[168:171], v[176:179], v[88:91]
ds_read_b64_tr_b16 v[160:161], v9 offset:11520
ds_read_b64_tr_b16 v[162:163], v9 offset:11640
ds_read_b64_tr_b16 v[164:165], v9 offset:11552
ds_read_b64_tr_b16 v[166:167], v9 offset:11672
ds_read_b64_tr_b16 v[168:169], v9 offset:11584
ds_read_b64_tr_b16 v[170:171], v9 offset:11704
ds_read_b64_tr_b16 v[172:173], v9 offset:11600
ds_read_b64_tr_b16 v[174:175], v9 offset:11720
ds_read_b64_tr_b16 v[176:177], v9 offset:11632
ds_read_b64_tr_b16 v[178:179], v9 offset:11752
s_waitcnt lgkmcnt(10)
v_mfma_f32_16x16x32_bf16 v[68:71], v[140:143], v[152:155], v[68:71]
v_mfma_f32_16x16x32_bf16 v[72:75], v[140:143], v[156:159], v[72:75]
v_mfma_f32_16x16x32_bf16 v[76:79], v[144:147], v[152:155], v[76:79]
v_mfma_f32_16x16x32_bf16 v[80:83], v[144:147], v[156:159], v[80:83]
v_mfma_f32_16x16x32_bf16 v[84:87], v[148:151], v[152:155], v[84:87]
v_mfma_f32_16x16x32_bf16 v[88:91], v[148:151], v[156:159], v[88:91]
s_waitcnt lgkmcnt(0)
v_mfma_f32_16x16x32_bf16 v[68:71], v[160:163], v[172:175], v[68:71]
v_mfma_f32_16x16x32_bf16 v[72:75], v[160:163], v[176:179], v[72:75]
v_mfma_f32_16x16x32_bf16 v[76:79], v[164:167], v[172:175], v[76:79]
v_mfma_f32_16x16x32_bf16 v[80:83], v[164:167], v[176:179], v[80:83]
v_mfma_f32_16x16x32_bf16 v[84:87], v[168:171], v[172:175], v[84:87]
v_mfma_f32_16x16x32_bf16 v[88:91], v[168:171], v[176:179], v[88:91]
s_nop 2
s_nop 0
v_cvt_pk_bf16_f32 v92, v68, v69
v_cvt_pk_bf16_f32 v93, v70, v71
v_cvt_pk_bf16_f32 v94, v76, v77
v_cvt_pk_bf16_f32 v95, v78, v79
buffer_store_dwordx4 v[92:95], v10, s[24:27], 0 offen offset:0 sc1
v_cvt_pk_bf16_f32 v96, v72, v73
v_cvt_pk_bf16_f32 v97, v74, v75
v_cvt_pk_bf16_f32 v98, v80, v81
v_cvt_pk_bf16_f32 v99, v82, v83
buffer_store_dwordx4 v[96:99], v230, s[24:27], 0 offen offset:1024 sc1
v_cvt_pk_bf16_f32 v100, v84, v85
v_cvt_pk_bf16_f32 v101, v86, v87
v_cvt_pk_bf16_f32 v102, v88, v89
v_cvt_pk_bf16_f32 v103, v90, v91
buffer_store_dwordx4 v[100:103], v11, s[24:27], 0 offen offset:1280 sc1
L_p2C:
L_pdP0_0:
s_cbranch_execz L_pdP0_1
s_nop 1
v_bfe_u32 v5, v0, 1, 1
v_and_b32_e64 v6, 1, v0
v_lshl_add_u32 v100, v6, 1, v5
v_and_b32_e64 v5, 16, v0
v_cmp_ne_u32 vcc, 0, v5
s_nop 1
v_cndmask_b32 v100, v100, 4, vcc
v_bfe_u32 v5, v0, 2, 2
v_mul_u32_u24_e64 v5, 40, v5
v_lshl_add_u32 v100, v100, 3, v5
v_lshrrev_b32_e64 v5, 5, v0
v_mul_u32_u24 v5, 320, v5
v_add_u32_e64 v99, v100, v5
v_add_u32 v99, 162048, v99
v_add_u32 v100, 162048, v100
ds_read_b64_tr_b16 v[88:89], v99 offset:0
ds_read_b64_tr_b16 v[90:91], v99 offset:160
ds_read_b64_tr_b16 v[92:93], v100 offset:640
s_and_b32 s40, s2, 7
s_lshr_b32 s41, s2, 3
s_and_b32 s53, s40, 1
s_lshl_b32 s53, s53, 4
s_lshr_b32 s42, s41, 1
s_add_u32 s53, s53, s42
s_and_b32 s54, s40, 6
s_and_b32 s41, s41, 1
s_add_u32 s54, s54, s41
s_cmp_eq_u32 s54, 0
s_cselect_b32 s55, 8, 0
s_lshl_b32 s56, s54, 3
s_lshl_b32 s40, s52, 1
s_add_u32 s56, s56, s40
s_mov_b32 s62, 1065353216
s_mov_b32 s63, 3212836864
s_mov_b32 s60, 0
s_mov_b32 s61, -1
v_lshlrev_b32 v1, 4, v0
v_and_b32 v5, 7, v0
v_bfe_u32 v6, v0, 3, 2
v_lshl_add_u32 v2, v5, 2, v6
v_lshl_add_u32 v19, v6, 4, v5
s_lshl_b32 s42, s52, 8
s_add_u32 s42, s42, 43008
v_lshl_add_u32 v19, v19, 2, s42
v_lshrrev_b32 v6, 5, v0
v_mul_u32_u24 v5, 1152, v6
v_lshl_add_u32 v101, v2, 2, v5
s_mul_i32 s40, s53, 73728
s_add_u32 s20, s14, s40
s_addc_u32 s21, s15, 0
s_add_u32 s16, s20, 0
s_addc_u32 s17, s21, 0
s_add_u32 s20, s20, 2359296
s_addc_u32 s21, s21, 0
s_lshl_b32 s40, s56, 6
s_add_u32 s40, s40, s53
s_lshl_b32 s4, s40, 10
s_add_u32 s5, s4, 65536
s_add_u32 s6, s4, 32768
s_add_u32 s7, s4, 98304
s_lshl_b32 s8, s40, 7
s_add_u32 s9, s8, 4096
v_and_b32 v7, 31, v0
v_lshlrev_b32_e64 v7, 2, v7
v_lshl_add_u32 v7, v6, 13, v7
v_mov_b32 v8, s58
v_and_b32 v9, 3, v0
v_cmp_eq_u32 vcc, 0, v9
s_nop 1
v_cndmask_b32_e64 v18, v8, v7, vcc
s_mov_b32 s22, 73728
s_mov_b32 s23, 0x20000
s_mov_b32 s18, 73728
s_mov_b32 s19, 0x20000
s_add_u32 s28, s14, 10625024
s_addc_u32 s29, s15, 0
s_mov_b32 s30, 4194304
s_mov_b32 s31, 0x20000
s_add_u32 s32, s14, 14819328
s_addc_u32 s33, s15, 0
s_mov_b32 s34, 524288
s_mov_b32 s35, 0x20000
s_mov_b32 s10, 1431655765
s_mov_b32 s11, 1431655765
s_mov_b32 s100, 858993459
s_mov_b32 s101, 858993459
s_waitcnt lgkmcnt(0)
v_mov_b32 v93, 0
v_mov_b32 v94, 0
v_mov_b32 v95, 0
v_mov_b32 v29, 0
v_mov_b32 v77, 0
v_mov_b32 v30, 0
v_mov_b32 v78, 0
v_mov_b32 v31, 0
v_mov_b32 v79, 0
v_mov_b32 v233, 0
v_mov_b32 v234, 0
v_mov_b32 v235, 0
v_mov_b32 v37, 0
v_mov_b32 v85, 0
v_mov_b32 v38, 0
v_mov_b32 v86, 0
v_mov_b32 v39, 0
v_mov_b32 v87, 0
v_mov_b32 v245, 0
v_mov_b32 v246, 0
v_mov_b32 v247, 0
s_mul_i32 s41, s52, 4864
v_add_u32_e64 v11, s41, v1
s_add_u32 s42, s41, 1024
v_lshl_add_u32 v12, v2, 2, s42
s_add_u32 s41, s41, 1152
v_bfe_u32 v7, v0, 2, 2
v_and_b32_e64 v8, 1, v0
v_bfe_u32 v9, v0, 1, 1
v_bfe_u32 v10, v0, 4, 1
v_cmp_eq_u32 vcc, 1, v10
v_xor_b32 v40, v6, v8
v_lshl_add_u32 v40, v40, 2, v7
v_lshlrev_b32_e64 v40, 4, v40
v_lshl_add_u32 v40, v8, 9, v40
v_lshl_add_u32 v40, v9, 3, v40
v_add_u32_e64 v40, s41, v40
v_lshl_add_u32 v41, v6, 2, v7
v_lshlrev_b32 v41, 4, v41
v_add_u32 v41, s41, v41
v_add_u32_e64 v8, 0, v40
v_add_u32 v9, 1152, v41
v_cndmask_b32_e64 v13, v8, v9, vcc
v_add_u32 v8, 128, v40
v_add_u32 v9, 1024, v41
v_cndmask_b32_e64 v14, v8, v9, vcc
v_add_u32 v8, 256, v40
v_add_u32 v9, 1160, v41
v_cndmask_b32_e64 v15, v8, v9, vcc
v_add_u32 v8, 384, v40
v_add_u32 v9, 1032, v41
v_cndmask_b32_e64 v16, v8, v9, vcc
v_bfe_u32 v7, v0, 3, 2
v_bfe_u32 v8, v0, 2, 1
v_lshl_add_u32 v8, v8, 1, v7
v_cmp_lt_u32 vcc, 1, v7
s_nop 1
v_cndmask_b32 v8, v8, 4, vcc
v_and_b32_e64 v7, 3, v0
v_lshl_add_u32 v8, v8, 2, v7
v_mul_u32_u24 v8, 80, v8
v_mad_u32_u24 v17, v6, 40, v8
v_add_u32 v17, 40960, v17
v_lshlrev_b32 v8, 4, v6
v_sub_u32 v7, v2, v8
v_mov_b32 v8, 4048155338
v_cmp_le_i32 s[40:41], 0, v7
v_cmp_le_i32 s[42:43], 4, v7
v_cmp_le_i32 s[44:45], 8, v7
v_cmp_le_i32 s[46:47], 12, v7
v_cndmask_b32 v40, v8, 0, s[40:41]
v_cndmask_b32 v56, 0, v8, s[40:41]
v_cndmask_b32 v41, v8, 0, s[42:43]
v_cndmask_b32 v57, 0, v8, s[42:43]
v_cndmask_b32 v42, v8, 0, s[44:45]
v_cndmask_b32 v58, 0, v8, s[44:45]
v_cndmask_b32 v43, v8, 0, s[46:47]
v_cndmask_b32 v59, 0, v8, s[46:47]
v_cmp_le_i32 s[40:41], 1, v7
v_cmp_le_i32 s[42:43], 5, v7
v_cmp_le_i32 s[44:45], 9, v7
v_cmp_le_i32 s[46:47], 13, v7
v_cndmask_b32 v44, v8, 0, s[40:41]
v_cndmask_b32 v60, 0, v8, s[40:41]
v_cndmask_b32 v45, v8, 0, s[42:43]
v_cndmask_b32 v61, 0, v8, s[42:43]
v_cndmask_b32 v46, v8, 0, s[44:45]
v_cndmask_b32 v62, 0, v8, s[44:45]
v_cndmask_b32 v47, v8, 0, s[46:47]
v_cndmask_b32 v63, 0, v8, s[46:47]
v_cmp_le_i32 s[40:41], 2, v7
v_cmp_le_i32 s[42:43], 6, v7
v_cmp_le_i32 s[44:45], 10, v7
v_cmp_le_i32 s[46:47], 14, v7
v_cndmask_b32 v48, v8, 0, s[40:41]
v_cndmask_b32 v64, 0, v8, s[40:41]
v_cndmask_b32 v49, v8, 0, s[42:43]
v_cndmask_b32 v65, 0, v8, s[42:43]
v_cndmask_b32 v50, v8, 0, s[44:45]
v_cndmask_b32 v66, 0, v8, s[44:45]
v_cndmask_b32 v51, v8, 0, s[46:47]
v_cndmask_b32 v67, 0, v8, s[46:47]
v_cmp_le_i32 s[40:41], 3, v7
v_cmp_le_i32 s[42:43], 7, v7
v_cmp_le_i32 s[44:45], 11, v7
v_cmp_le_i32 s[46:47], 15, v7
v_cndmask_b32 v52, v8, 0, s[40:41]
v_cndmask_b32 v68, 0, v8, s[40:41]
v_cndmask_b32 v53, v8, 0, s[42:43]
v_cndmask_b32 v69, 0, v8, s[42:43]
v_cndmask_b32 v54, v8, 0, s[44:45]
v_cndmask_b32 v70, 0, v8, s[44:45]
v_cndmask_b32 v55, v8, 0, s[46:47]
v_cndmask_b32 v71, 0, v8, s[46:47]
v_mov_b32_e64 v6, 1
v_mov_b32 v5, 161792
s_waitcnt vmcnt(0)
s_mov_b64 exec, 1
ds_add_u32 v5, v6
s_mov_b64 exec, -1
s_mul_i32 s41, s56, 1152
s_add_u32 s42, s41, 1152
s_barrier
buffer_load_dwordx4 v[72:75], v1, s[20:23], s41 offen sc1
buffer_load_dwordx4 v[80:83], v1, s[20:23], s42 offen sc1
buffer_load_dword v102, v101, s[20:23], s41 offen offset:1024 sc1
buffer_load_dwordx4 v[24:27], v1, s[16:19], s41 offen sc1
buffer_load_dwordx4 v[32:35], v1, s[16:19], s42 offen sc1
buffer_load_dword v103, v101, s[16:19], s41 offen offset:1024 sc1
s_waitcnt vmcnt(3)
v_cndmask_b32 v76, v102, 0, s[60:61]
v_cndmask_b32 v84, 0, v102, s[60:61]
v_mfma_f32_32x32x16_bf16 v[104:119], v[88:91], v[72:75], 0
v_mfma_f32_32x32x16_bf16 v[120:135], v[88:91], v[80:83], 0
v_mfma_f32_32x32x16_bf16 v[104:119], v[92:95], v[76:79], v[104:119]
v_mfma_f32_32x32x16_bf16 v[120:135], v[92:95], v[84:87], v[120:135]
s_nop 10
v_cndmask_b32 v112, v112, v113, s[60:61]
v_cndmask_b32 v128, v128, v129, s[60:61]
v_exp_f32_e64 v136, v104
v_exp_f32 v137, -v104
v_exp_f32_e64 v138, v105
v_exp_f32 v139, -v105
v_exp_f32_e64 v140, v106
v_exp_f32 v141, -v106
v_exp_f32_e64 v142, v107
v_exp_f32 v143, -v107
v_exp_f32_e64 v144, v108
v_exp_f32 v145, -v108
v_exp_f32_e64 v146, v109
v_exp_f32 v147, -v109
v_exp_f32_e64 v148, v110
v_exp_f32 v149, -v110
v_exp_f32_e64 v150, v111
v_exp_f32 v151, -v111
v_exp_f32_e64 v152, v112
v_exp_f32 v153, -v112
v_exp_f32_e64 v162, v120
v_exp_f32 v163, -v120
v_exp_f32_e64 v164, v121
v_exp_f32 v165, -v121
v_exp_f32_e64 v166, v122
v_exp_f32 v167, -v122
v_exp_f32_e64 v168, v123
v_exp_f32 v169, -v123
v_exp_f32_e64 v170, v124
v_exp_f32 v171, -v124
v_exp_f32_e64 v172, v125
v_exp_f32 v173, -v125
v_exp_f32_e64 v174, v126
v_exp_f32 v175, -v126
v_exp_f32_e64 v176, v127
v_exp_f32 v177, -v127
v_exp_f32_e64 v178, v128
v_exp_f32 v179, -v128
v_pk_add_f32 v[156:157], v[136:137], v[138:139]
v_pk_add_f32 v[158:159], v[140:141], v[142:143]
v_pk_add_f32 v[160:161], v[144:145], v[146:147]
v_pk_add_f32 v[156:157], v[156:157], v[148:149]
v_pk_add_f32 v[158:159], v[158:159], v[150:151]
v_pk_add_f32 v[160:161], v[160:161], v[152:153]
v_pk_add_f32 v[156:157], v[156:157], v[158:159]
v_pk_add_f32 v[156:157], v[156:157], v[160:161]
v_pk_add_f32 v[182:183], v[162:163], v[164:165]
v_pk_add_f32 v[184:185], v[166:167], v[168:169]
v_pk_add_f32 v[186:187], v[170:171], v[172:173]
v_pk_add_f32 v[182:183], v[182:183], v[174:175]
v_pk_add_f32 v[184:185], v[184:185], v[176:177]
v_pk_add_f32 v[186:187], v[186:187], v[178:179]
v_pk_add_f32 v[182:183], v[182:183], v[184:185]
v_pk_add_f32 v[182:183], v[182:183], v[186:187]
v_permlane32_swap_b32 v156, v157
s_nop 0
v_permlane32_swap_b32 v182, v183
v_add_f32 v156, v156, v157
v_add_f32 v182, v182, v183
v_add_f32 v158, v156, v182
v_rcp_f32 v156, v156
v_rcp_f32 v182, v182
v_cmp_nge_f32 vcc, 1568669696, v158
v_mov_b32 v157, v156
v_mov_b32 v183, v182
s_cmp_lg_u64 vcc, 0
s_cbranch_scc1 L_hq_slow
v_permlane32_swap_b32 v156, v157
v_permlane32_swap_b32 v182, v183
v_pk_mul_f32 v[136:137], v[136:137], v[156:157]
v_pk_mul_f32 v[138:139], v[138:139], v[156:157]
v_pk_mul_f32 v[140:141], v[140:141], v[156:157]
v_pk_mul_f32 v[142:143], v[142:143], v[156:157]
v_pk_mul_f32 v[144:145], v[144:145], v[156:157]
v_pk_mul_f32 v[146:147], v[146:147], v[156:157]
v_pk_mul_f32 v[148:149], v[148:149], v[156:157]
v_pk_mul_f32 v[150:151], v[150:151], v[156:157]
v_pk_mul_f32 v[152:153], v[152:153], v[156:157]
v_cvt_pk_bf16_f32 v224, v136, v137
v_cvt_pk_bf16_f32 v225, v138, v139
v_cvt_pk_bf16_f32 v226, v140, v141
v_cvt_pk_bf16_f32 v227, v142, v143
v_cvt_pk_bf16_f32 v228, v144, v145
v_cvt_pk_bf16_f32 v229, v146, v147
v_cvt_pk_bf16_f32 v230, v148, v149
v_cvt_pk_bf16_f32 v231, v150, v151
v_cvt_pk_bf16_f32 v232, v152, v153
v_pk_mul_f32 v[162:163], v[162:163], v[182:183]
v_pk_mul_f32 v[164:165], v[164:165], v[182:183]
v_pk_mul_f32 v[166:167], v[166:167], v[182:183]
v_pk_mul_f32 v[168:169], v[168:169], v[182:183]
v_pk_mul_f32 v[170:171], v[170:171], v[182:183]
v_pk_mul_f32 v[172:173], v[172:173], v[182:183]
v_pk_mul_f32 v[174:175], v[174:175], v[182:183]
v_pk_mul_f32 v[176:177], v[176:177], v[182:183]
v_pk_mul_f32 v[178:179], v[178:179], v[182:183]
v_cvt_pk_bf16_f32 v236, v162, v163
v_cvt_pk_bf16_f32 v237, v164, v165
v_cvt_pk_bf16_f32 v238, v166, v167
v_cvt_pk_bf16_f32 v239, v168, v169
L_pdP1_0:
s_cbranch_execz L_pdP1_1
s_nop 0
v_cvt_pk_bf16_f32 v240, v170, v171
v_cvt_pk_bf16_f32 v241, v172, v173
v_cvt_pk_bf16_f32 v242, v174, v175
v_cvt_pk_bf16_f32 v243, v176, v177
v_cvt_pk_bf16_f32 v244, v178, v179
L_hq_done:
s_waitcnt vmcnt(0)
v_cndmask_b32 v28, v103, 0, s[60:61]
v_cndmask_b32 v36, 0, v103, s[60:61]
s_barrier
v_mov_b32 v209, 0
v_mov_b32 v210, 0
v_mov_b32_e64 v211, 0
s_cmp_eq_u32 s52, 0
s_cbranch_scc1 L_att0
s_cmp_eq_u32 s52, 1
s_cbranch_scc1 L_att1
s_cmp_eq_u32 s52, 2
s_cbranch_scc1 L_att2
ds_read_b128 v[72:75], v11 offset:0
ds_read_b32 v76, v12 offset:0
ds_read_b128 v[80:83], v11 offset:2432
ds_read_b32 v84, v12 offset:2432
ds_read_b64_tr_b16 v[88:89], v13 offset:0
ds_read_b64_tr_b16 v[90:91], v14 offset:0
ds_read_b64_tr_b16 v[92:93], v15 offset:0
ds_read_b64_tr_b16 v[94:95], v16 offset:0
ds_read_b64_tr_b16 v[96:97], v13 offset:2432
ds_read_b64_tr_b16 v[98:99], v14 offset:2432
ds_read_b64_tr_b16 v[100:101], v15 offset:2432
ds_read_b64_tr_b16 v[102:103], v16 offset:2432
s_waitcnt lgkmcnt(10)
v_mfma_f32_32x32x16_bf16 v[104:119], v[72:75], v[24:27], v[56:71]
v_mfma_f32_32x32x16_bf16 v[104:119], v[76:79], v[28:31], v[104:119]
ds_read_b128 v[72:75], v11 offset:4864
ds_read_b32 v76, v12 offset:4864
s_nop 9
v_exp_f32 v104, v104
v_exp_f32 v105, v105
v_exp_f32 v106, v106
v_exp_f32 v107, v107
v_exp_f32 v108, v108
s_waitcnt lgkmcnt(10)
v_mfma_f32_32x32x16_bf16 v[120:135], v[80:83], v[24:27], 0
v_exp_f32_e64 v109, v109
v_cvt_pk_bf16_f32 v104, v104, v105
v_cvt_pk_bf16_f32 v105, v106, v107
v_exp_f32 v110, v110
v_exp_f32 v111, v111
v_mfma_f32_32x32x16_bf16 v[120:135], v[84:87], v[28:31], v[120:135]
v_exp_f32_e64 v112, v112
v_cvt_pk_bf16_f32 v106, v108, v109
v_cvt_pk_bf16_f32 v107, v110, v111
v_exp_f32 v113, v113
v_exp_f32_e64 v114, v114
s_waitcnt lgkmcnt(6)
v_mfma_f32_32x32x16_bf16 v[136:151], v[88:91], v[104:107], 0
v_exp_f32 v115, v115
v_exp_f32 v116, v116
v_exp_f32_e64 v117, v117
v_cvt_pk_bf16_f32 v112, v112, v113
v_cvt_pk_bf16_f32 v113, v114, v115
v_exp_f32 v118, v118
v_exp_f32 v119, v119
v_cvt_pk_bf16_f32 v114, v116, v117
v_cvt_pk_bf16_f32 v115, v118, v119
v_exp_f32 v120, v120
v_exp_f32 v121, v121
v_mfma_f32_32x32x16_bf16 v[136:151], v[92:95], v[112:115], v[136:151]
ds_read_b64_tr_b16 v[88:89], v13 offset:4864
ds_read_b64_tr_b16 v[90:91], v14 offset:4864
ds_read_b64_tr_b16 v[92:93], v15 offset:4864
ds_read_b64_tr_b16 v[94:95], v16 offset:4864
v_exp_f32 v122, v122
v_exp_f32 v123, v123
v_exp_f32_e64 v124, v124
v_mfma_f32_32x32x16_bf16 v[104:119], v[80:83], v[32:35], v[56:71]
v_exp_f32_e64 v125, v125
v_cvt_pk_bf16_f32 v120, v120, v121
v_cvt_pk_bf16_f32 v121, v122, v123
v_exp_f32 v126, v126
v_exp_f32 v127, v127
v_mfma_f32_32x32x16_bf16 v[104:119], v[84:87], v[36:39], v[104:119]
ds_read_b128 v[80:83], v11 offset:7296
ds_read_b32 v84, v12 offset:7296
v_exp_f32_e64 v128, v128
v_cvt_pk_bf16_f32 v122, v124, v125
v_cvt_pk_bf16_f32 v123, v126, v127
v_exp_f32 v129, v129
v_exp_f32_e64 v130, v130
s_waitcnt lgkmcnt(8)
v_mfma_f32_32x32x16_bf16 v[136:151], v[96:99], v[120:123], v[136:151]
v_exp_f32 v131, v131
v_exp_f32 v132, v132
v_exp_f32_e64 v133, v133
v_cvt_pk_bf16_f32 v128, v128, v129
v_cvt_pk_bf16_f32 v129, v130, v131
v_exp_f32 v134, v134
v_exp_f32 v135, v135
v_cvt_pk_bf16_f32 v130, v132, v133
v_cvt_pk_bf16_f32 v131, v134, v135
v_exp_f32 v104, v104
v_exp_f32 v105, v105
v_mfma_f32_32x32x16_bf16 v[136:151], v[100:103], v[128:131], v[136:151]
v_exp_f32 v106, v106
v_exp_f32 v107, v107
v_exp_f32 v108, v108
s_waitcnt lgkmcnt(6)
v_mfma_f32_32x32x16_bf16 v[120:135], v[72:75], v[24:27], 0
v_exp_f32_e64 v109, v109
v_cvt_pk_bf16_f32 v104, v104, v105
v_cvt_pk_bf16_f32 v105, v106, v107
v_exp_f32 v110, v110
v_exp_f32 v111, v111
v_mfma_f32_32x32x16_bf16 v[120:135], v[76:79], v[28:31], v[120:135]
v_exp_f32_e64 v112, v112
v_cvt_pk_bf16_f32 v106, v108, v109
v_cvt_pk_bf16_f32 v107, v110, v111
v_exp_f32 v113, v113
v_exp_f32 v114, v114
v_mfma_f32_32x32x16_bf16 v[152:167], v[96:99], v[104:107], 0
v_exp_f32 v115, v115
v_exp_f32 v116, v116
v_exp_f32_e64 v117, v117
v_cvt_pk_bf16_f32 v112, v112, v113
v_cvt_pk_bf16_f32 v113, v114, v115
v_exp_f32 v118, v118
v_exp_f32 v119, v119
v_cvt_pk_bf16_f32 v114, v116, v117
v_cvt_pk_bf16_f32 v115, v118, v119
v_exp_f32 v120, v120
v_exp_f32 v121, v121
v_mfma_f32_32x32x16_bf16 v[152:167], v[100:103], v[112:115], v[152:167]
ds_read_b64_tr_b16 v[96:97], v13 offset:7296
ds_read_b64_tr_b16 v[98:99], v14 offset:7296
ds_read_b64_tr_b16 v[100:101], v15 offset:7296
ds_read_b64_tr_b16 v[102:103], v16 offset:7296
v_exp_f32 v122, v122
v_exp_f32 v123, v123
v_exp_f32_e64 v124, v124
v_mfma_f32_32x32x16_bf16 v[104:119], v[72:75], v[32:35], 0
v_exp_f32_e64 v125, v125
v_cvt_pk_bf16_f32 v120, v120, v121
v_cvt_pk_bf16_f32 v121, v122, v123
v_exp_f32 v126, v126
v_exp_f32 v127, v127
v_mfma_f32_32x32x16_bf16 v[104:119], v[76:79], v[36:39], v[104:119]
s_barrier
ds_read_b128 v[72:75], v11 offset:9728
ds_read_b32 v76, v12 offset:9728
v_exp_f32 v128, v128
v_cvt_pk_bf16_f32 v122, v124, v125
v_cvt_pk_bf16_f32 v123, v126, v127
v_exp_f32 v129, v129
v_exp_f32_e64 v130, v130
s_waitcnt lgkmcnt(8)
v_mfma_f32_32x32x16_bf16 v[136:151], v[88:91], v[120:123], v[136:151]
v_exp_f32 v131, v131
v_exp_f32 v132, v132
v_exp_f32_e64 v133, v133
v_cvt_pk_bf16_f32 v128, v128, v129
v_cvt_pk_bf16_f32 v129, v130, v131
v_exp_f32 v134, v134
v_exp_f32 v135, v135
v_cvt_pk_bf16_f32 v130, v132, v133
v_cvt_pk_bf16_f32 v131, v134, v135
v_exp_f32 v104, v104
v_exp_f32 v105, v105
v_mfma_f32_32x32x16_bf16 v[136:151], v[92:95], v[128:131], v[136:151]
v_exp_f32 v106, v106
v_exp_f32 v107, v107
v_exp_f32 v108, v108
s_waitcnt lgkmcnt(6)
v_mfma_f32_32x32x16_bf16 v[120:135], v[80:83], v[24:27], 0
v_exp_f32_e64 v109, v109
v_cvt_pk_bf16_f32 v104, v104, v105
v_cvt_pk_bf16_f32 v105, v106, v107
v_exp_f32 v110, v110
v_exp_f32 v111, v111
v_mfma_f32_32x32x16_bf16 v[120:135], v[84:87], v[28:31], v[120:135]
v_exp_f32_e64 v112, v112
v_cvt_pk_bf16_f32 v106, v108, v109
v_cvt_pk_bf16_f32 v107, v110, v111
v_exp_f32 v113, v113
v_exp_f32 v114, v114
v_mfma_f32_32x32x16_bf16 v[152:167], v[88:91], v[104:107], v[152:167]
v_exp_f32 v115, v115
v_exp_f32 v116, v116
v_exp_f32_e64 v117, v117
v_cvt_pk_bf16_f32 v112, v112, v113
v_cvt_pk_bf16_f32 v113, v114, v115
v_exp_f32 v118, v118
v_exp_f32 v119, v119
v_cvt_pk_bf16_f32 v114, v116, v117
v_cvt_pk_bf16_f32 v115, v118, v119
v_exp_f32 v120, v120
v_exp_f32 v121, v121
v_mfma_f32_32x32x16_bf16 v[152:167], v[92:95], v[112:115], v[152:167]
ds_read_b64_tr_b16 v[88:89], v13 offset:9728
ds_read_b64_tr_b16 v[90:91], v14 offset:9728
ds_read_b64_tr_b16 v[92:93], v15 offset:9728
ds_read_b64_tr_b16 v[94:95], v16 offset:9728
v_exp_f32 v122, v122
v_exp_f32 v123, v123
v_exp_f32_e64 v124, v124
v_mfma_f32_32x32x16_bf16 v[104:119], v[80:83], v[32:35], 0
v_exp_f32_e64 v125, v125
v_cvt_pk_bf16_f32 v120, v120, v121
v_cvt_pk_bf16_f32 v121, v122, v123
v_exp_f32 v126, v126
v_exp_f32 v127, v127
v_mfma_f32_32x32x16_bf16 v[104:119], v[84:87], v[36:39], v[104:119]
ds_read_b128 v[80:83], v11 offset:12160
ds_read_b32 v84, v12 offset:12160
v_exp_f32_e64 v128, v128
v_cvt_pk_bf16_f32 v122, v124, v125
v_cvt_pk_bf16_f32 v123, v126, v127
v_exp_f32 v129, v129
v_exp_f32_e64 v130, v130
s_waitcnt lgkmcnt(8)
v_mfma_f32_32x32x16_bf16 v[136:151], v[96:99], v[120:123], v[136:151]
s_barrier
ds_read_b64 v[200:201], v17 offset:0
ds_read_b64 v[202:203], v17 offset:8
ds_read_b64 v[204:205], v17 offset:16
ds_read_b64 v[206:207], v17 offset:24
ds_read_b32 v208, v17 offset:32
ds_read_b32 v20, v19
ds_read_b32 v21, v19 offset:32
v_exp_f32 v131, v131
v_exp_f32 v132, v132
v_exp_f32 v133, v133
v_cvt_pk_bf16_f32 v128, v128, v129
v_cvt_pk_bf16_f32 v129, v130, v131
v_exp_f32 v134, v134
v_exp_f32 v135, v135
v_cvt_pk_bf16_f32 v130, v132, v133
v_cvt_pk_bf16_f32 v131, v134, v135
v_exp_f32 v104, v104
v_exp_f32 v105, v105
v_mfma_f32_32x32x16_bf16 v[136:151], v[100:103], v[128:131], v[136:151]
v_exp_f32 v106, v106
v_exp_f32 v107, v107
v_exp_f32 v108, v108
s_waitcnt lgkmcnt(13)
v_mfma_f32_32x32x16_bf16 v[120:135], v[72:75], v[24:27], 0
v_exp_f32_e64 v109, v109
v_cvt_pk_bf16_f32 v104, v104, v105
v_cvt_pk_bf16_f32 v105, v106, v107
v_exp_f32 v110, v110
v_exp_f32 v111, v111
v_mfma_f32_32x32x16_bf16 v[120:135], v[76:79], v[28:31], v[120:135]
v_exp_f32_e64 v112, v112
v_cvt_pk_bf16_f32 v106, v108, v109
v_cvt_pk_bf16_f32 v107, v110, v111
v_exp_f32 v113, v113
v_exp_f32 v114, v114
v_mfma_f32_32x32x16_bf16 v[152:167], v[96:99], v[104:107], v[152:167]
v_exp_f32 v115, v115
v_exp_f32_e64 v116, v116
s_waitcnt lgkmcnt(0)
v_mfma_f32_32x32x16_bf16 v[168:183], v[200:203], v[224:227], 0
v_exp_f32_e64 v117, v117
v_cvt_pk_bf16_f32 v112, v112, v113
v_cvt_pk_bf16_f32 v113, v114, v115
v_mfma_f32_32x32x16_bf16 v[184:199], v[200:203], v[236:239], 0
v_exp_f32 v118, v118
v_exp_f32 v119, v119
v_mfma_f32_32x32x16_bf16 v[168:183], v[204:207], v[228:231], v[168:183]
v_cvt_pk_bf16_f32 v114, v116, v117
v_cvt_pk_bf16_f32 v115, v118, v119
v_exp_f32 v120, v120
v_exp_f32 v121, v121
v_mfma_f32_32x32x16_bf16 v[152:167], v[100:103], v[112:115], v[152:167]
ds_read_b64_tr_b16 v[96:97], v13 offset:12160
ds_read_b64_tr_b16 v[98:99], v14 offset:12160
ds_read_b64_tr_b16 v[100:101], v15 offset:12160
ds_read_b64_tr_b16 v[102:103], v16 offset:12160
v_exp_f32 v122, v122
v_exp_f32 v123, v123
v_exp_f32_e64 v124, v124
v_mfma_f32_32x32x16_bf16 v[104:119], v[72:75], v[32:35], 0
v_exp_f32_e64 v125, v125
v_cvt_pk_bf16_f32 v120, v120, v121
v_cvt_pk_bf16_f32 v121, v122, v123
v_exp_f32 v126, v126
v_exp_f32 v127, v127
v_mfma_f32_32x32x16_bf16 v[104:119], v[76:79], v[36:39], v[104:119]
ds_read_b128 v[72:75], v11 offset:14592
ds_read_b32 v76, v12 offset:14592
v_exp_f32_e64 v128, v128
v_cvt_pk_bf16_f32 v122, v124, v125
v_cvt_pk_bf16_f32 v123, v126, v127
v_exp_f32 v129, v129
v_exp_f32 v130, v130
v_mfma_f32_32x32x16_bf16 v[136:151], v[88:91], v[120:123], v[136:151]
v_exp_f32 v131, v131
v_exp_f32 v132, v132
v_mfma_f32_32x32x16_bf16 v[184:199], v[204:207], v[240:243], v[184:199]
v_exp_f32_e64 v133, v133
v_cvt_pk_bf16_f32 v128, v128, v129
v_cvt_pk_bf16_f32 v129, v130, v131
v_mfma_f32_32x32x16_bf16 v[168:183], v[208:211], v[232:235], v[168:183]
v_exp_f32 v134, v134
v_exp_f32 v135, v135
v_mfma_f32_32x32x16_bf16 v[184:199], v[208:211], v[244:247], v[184:199]
v_cvt_pk_bf16_f32 v130, v132, v133
v_cvt_pk_bf16_f32 v131, v134, v135
v_exp_f32 v104, v104
v_exp_f32 v105, v105
v_mfma_f32_32x32x16_bf16 v[136:151], v[92:95], v[128:131], v[136:151]
v_exp_f32 v106, v106
v_exp_f32 v107, v107
v_exp_f32_e64 v108, v108
v_mfma_f32_32x32x16_bf16 v[120:135], v[80:83], v[24:27], 0
v_exp_f32_e64 v109, v109
v_cvt_pk_bf16_f32 v104, v104, v105
v_cvt_pk_bf16_f32 v105, v106, v107
v_exp_f32 v110, v110
v_exp_f32 v111, v111
v_mfma_f32_32x32x16_bf16 v[120:135], v[84:87], v[28:31], v[120:135]
v_exp_f32_e64 v112, v112
v_cvt_pk_bf16_f32 v106, v108, v109
v_cvt_pk_bf16_f32 v107, v110, v111
v_exp_f32 v113, v113
v_exp_f32 v114, v114
v_mfma_f32_32x32x16_bf16 v[152:167], v[88:91], v[104:107], v[152:167]
v_exp_f32 v115, v115
v_exp_f32 v116, v116
v_exp_f32_e64 v117, v117
v_cvt_pk_bf16_f32 v112, v112, v113
v_cvt_pk_bf16_f32 v113, v114, v115
v_exp_f32 v118, v118
v_exp_f32 v119, v119
v_cvt_pk_bf16_f32 v114, v116, v117
v_cvt_pk_bf16_f32 v115, v118, v119
v_add_f32 v212, 897988541, v178
v_rcp_f32 v212, v212
v_sub_f32 v213, 1.0, v20
v_mul_f32_e64 v212, v212, v213
v_pk_mul_f32 v[168:169], v[168:169], v[212:213] op_sel_hi:[1,0]
v_pk_mul_f32 v[170:171], v[170:171], v[212:213] op_sel_hi:[1,0]
v_pk_mul_f32 v[172:173], v[172:173], v[212:213] op_sel_hi:[1,0]
v_pk_mul_f32 v[174:175], v[174:175], v[212:213] op_sel_hi:[1,0]
v_pk_mul_f32 v[176:177], v[176:177], v[212:213] op_sel_hi:[1,0]
v_cvt_pk_bf16_f32 v168, v168, v169
v_cvt_pk_bf16_f32 v169, v170, v171
v_cvt_pk_bf16_f32 v170, v172, v173
v_cvt_pk_bf16_f32 v171, v174, v175
buffer_store_dwordx4 v[168:171], v1, s[28:31], s6 offen sc1
v_cvt_pk_bf16_f32 v252, v176, v177
v_add_f32 v214, 897988541, v194
v_rcp_f32 v214, v214
v_sub_f32 v215, 1.0, v21
v_mul_f32_e64 v214, v214, v215
v_pk_mul_f32 v[184:185], v[184:185], v[214:215] op_sel_hi:[1,0]
v_pk_mul_f32 v[186:187], v[186:187], v[214:215] op_sel_hi:[1,0]
v_pk_mul_f32 v[188:189], v[188:189], v[214:215] op_sel_hi:[1,0]
v_pk_mul_f32 v[190:191], v[190:191], v[214:215] op_sel_hi:[1,0]
v_pk_mul_f32 v[192:193], v[192:193], v[214:215] op_sel_hi:[1,0]
v_cvt_pk_bf16_f32 v184, v184, v185
v_cvt_pk_bf16_f32 v185, v186, v187
v_cvt_pk_bf16_f32 v186, v188, v189
v_cvt_pk_bf16_f32 v187, v190, v191
buffer_store_dwordx4 v[184:187], v1, s[28:31], s7 offen sc1
v_cvt_pk_bf16_f32 v253, v192, v193
v_cndmask_b32 v248, v252, v253, s[60:61]
s_nop 1
v_mov_b32_dpp v249, v248 quad_perm:[1,1,1,1] row_mask:0xf bank_mask:0xf
v_mov_b32_dpp v250, v248 quad_perm:[2,2,2,2] row_mask:0xf bank_mask:0xf
v_mov_b32_dpp v251, v248 quad_perm:[3,3,3,3] row_mask:0xf bank_mask:0xf
buffer_store_dwordx4 v[248:251], v18, s[32:35], s9 offen sc1
v_exp_f32 v120, v120
v_exp_f32_e64 v121, v121
v_mfma_f32_32x32x16_bf16 v[152:167], v[92:95], v[112:115], v[152:167]
ds_read_b64_tr_b16 v[88:89], v13 offset:14592
ds_read_b64_tr_b16 v[90:91], v14 offset:14592
ds_read_b64_tr_b16 v[92:93], v15 offset:14592
ds_read_b64_tr_b16 v[94:95], v16 offset:14592
v_exp_f32 v122, v122
v_exp_f32 v123, v123
v_exp_f32_e64 v124, v124
v_mfma_f32_32x32x16_bf16 v[104:119], v[80:83], v[32:35], 0
v_exp_f32_e64 v125, v125
v_cvt_pk_bf16_f32 v120, v120, v121
v_cvt_pk_bf16_f32 v121, v122, v123
v_exp_f32 v126, v126
v_exp_f32 v127, v127
v_mfma_f32_32x32x16_bf16 v[104:119], v[84:87], v[36:39], v[104:119]
ds_read_b128 v[80:83], v11 offset:17024
ds_read_b32 v84, v12 offset:17024
v_exp_f32_e64 v128, v128
v_cvt_pk_bf16_f32 v122, v124, v125
v_cvt_pk_bf16_f32 v123, v126, v127
v_exp_f32 v129, v129
v_exp_f32_e64 v130, v130
s_waitcnt lgkmcnt(8)
v_mfma_f32_32x32x16_bf16 v[136:151], v[96:99], v[120:123], v[136:151]
v_exp_f32 v131, v131
v_exp_f32 v132, v132
v_exp_f32_e64 v133, v133
v_cvt_pk_bf16_f32 v128, v128, v129
v_cvt_pk_bf16_f32 v129, v130, v131
v_exp_f32 v134, v134
v_exp_f32 v135, v135
v_cvt_pk_bf16_f32 v130, v132, v133
v_cvt_pk_bf16_f32 v131, v134, v135
v_exp_f32 v104, v104
v_exp_f32 v105, v105
v_mfma_f32_32x32x16_bf16 v[136:151], v[100:103], v[128:131], v[136:151]
v_exp_f32 v106, v106
v_exp_f32 v107, v107
v_exp_f32 v108, v108
s_waitcnt lgkmcnt(6)
v_mfma_f32_32x32x16_bf16 v[120:135], v[72:75], v[24:27], 0
v_exp_f32_e64 v109, v109
v_cvt_pk_bf16_f32 v104, v104, v105
v_cvt_pk_bf16_f32 v105, v106, v107
v_exp_f32 v110, v110
v_exp_f32 v111, v111
v_mfma_f32_32x32x16_bf16 v[120:135], v[76:79], v[28:31], v[120:135]
v_exp_f32_e64 v112, v112
v_cvt_pk_bf16_f32 v106, v108, v109
v_cvt_pk_bf16_f32 v107, v110, v111
v_exp_f32 v113, v113
v_exp_f32 v114, v114
v_mfma_f32_32x32x16_bf16 v[152:167], v[96:99], v[104:107], v[152:167]
v_exp_f32 v115, v115
v_exp_f32 v116, v116
v_exp_f32_e64 v117, v117
v_cvt_pk_bf16_f32 v112, v112, v113
v_cvt_pk_bf16_f32 v113, v114, v115
v_exp_f32 v118, v118
v_exp_f32 v119, v119
v_cvt_pk_bf16_f32 v114, v116, v117
v_cvt_pk_bf16_f32 v115, v118, v119
v_exp_f32 v120, v120
v_exp_f32 v121, v121
v_mfma_f32_32x32x16_bf16 v[152:167], v[100:103], v[112:115], v[152:167]
ds_read_b64_tr_b16 v[96:97], v13 offset:17024
ds_read_b64_tr_b16 v[98:99], v14 offset:17024
ds_read_b64_tr_b16 v[100:101], v15 offset:17024
ds_read_b64_tr_b16 v[102:103], v16 offset:17024
v_exp_f32 v122, v122
v_exp_f32 v123, v123
v_exp_f32_e64 v124, v124
v_mfma_f32_32x32x16_bf16 v[104:119], v[72:75], v[32:35], 0
v_exp_f32_e64 v125, v125
v_cvt_pk_bf16_f32 v120, v120, v121
v_cvt_pk_bf16_f32 v121, v122, v123
v_exp_f32 v126, v126
v_exp_f32 v127, v127
v_mfma_f32_32x32x16_bf16 v[104:119], v[76:79], v[36:39], v[104:119]
ds_read_b128 v[72:75], v11 offset:19456
ds_read_b32 v76, v12 offset:19456
v_exp_f32_e64 v128, v128
v_cvt_pk_bf16_f32 v122, v124, v125
v_cvt_pk_bf16_f32 v123, v126, v127
v_exp_f32 v129, v129
v_exp_f32_e64 v130, v130
s_waitcnt lgkmcnt(8)
v_mfma_f32_32x32x16_bf16 v[136:151], v[88:91], v[120:123], v[136:151]
v_exp_f32 v131, v131
v_exp_f32 v132, v132
v_exp_f32_e64 v133, v133
v_cvt_pk_bf16_f32 v128, v128, v129
v_cvt_pk_bf16_f32 v129, v130, v131
v_exp_f32 v134, v134
v_exp_f32 v135, v135
v_cvt_pk_bf16_f32 v130, v132, v133
v_cvt_pk_bf16_f32 v131, v134, v135
v_exp_f32 v104, v104
v_exp_f32 v105, v105
v_mfma_f32_32x32x16_bf16 v[136:151], v[92:95], v[128:131], v[136:151]
v_exp_f32 v106, v106
v_exp_f32 v107, v107
v_exp_f32 v108, v108
s_waitcnt lgkmcnt(6)
v_mfma_f32_32x32x16_bf16 v[120:135], v[80:83], v[24:27], 0
v_exp_f32_e64 v109, v109
v_cvt_pk_bf16_f32 v104, v104, v105
v_cvt_pk_bf16_f32 v105, v106, v107
v_exp_f32 v110, v110
v_exp_f32 v111, v111
v_mfma_f32_32x32x16_bf16 v[120:135], v[84:87], v[28:31], v[120:135]
v_exp_f32_e64 v112, v112
v_cvt_pk_bf16_f32 v106, v108, v109
v_cvt_pk_bf16_f32 v107, v110, v111
v_exp_f32 v113, v113
v_exp_f32 v114, v114
v_mfma_f32_32x32x16_bf16 v[152:167], v[88:91], v[104:107], v[152:167]
v_exp_f32 v115, v115
v_exp_f32 v116, v116
v_exp_f32_e64 v117, v117
v_cvt_pk_bf16_f32 v112, v112, v113
v_cvt_pk_bf16_f32 v113, v114, v115
v_exp_f32 v118, v118
v_exp_f32 v119, v119
v_cvt_pk_bf16_f32 v114, v116, v117
v_cvt_pk_bf16_f32 v115, v118, v119
v_exp_f32 v120, v120
v_exp_f32 v121, v121
v_mfma_f32_32x32x16_bf16 v[152:167], v[92:95], v[112:115], v[152:167]
ds_read_b64_tr_b16 v[88:89], v13 offset:19456
ds_read_b64_tr_b16 v[90:91], v14 offset:19456
ds_read_b64_tr_b16 v[92:93], v15 offset:19456
ds_read_b64_tr_b16 v[94:95], v16 offset:19456
v_exp_f32 v122, v122
v_exp_f32 v123, v123
v_exp_f32_e64 v124, v124
v_mfma_f32_32x32x16_bf16 v[104:119], v[80:83], v[32:35], 0
v_exp_f32_e64 v125, v125
v_cvt_pk_bf16_f32 v120, v120, v121
v_cvt_pk_bf16_f32 v121, v122, v123
v_exp_f32 v126, v126
v_exp_f32 v127, v127
v_mfma_f32_32x32x16_bf16 v[104:119], v[84:87], v[36:39], v[104:119]
ds_read_b128 v[80:83], v11 offset:21888
ds_read_b32 v84, v12 offset:21888
v_exp_f32_e64 v128, v128
v_cvt_pk_bf16_f32 v122, v124, v125
v_cvt_pk_bf16_f32 v123, v126, v127
v_exp_f32 v129, v129
v_exp_f32_e64 v130, v130
s_waitcnt lgkmcnt(8)
v_mfma_f32_32x32x16_bf16 v[136:151], v[96:99], v[120:123], v[136:151]
v_exp_f32 v131, v131
v_exp_f32 v132, v132
v_exp_f32_e64 v133, v133
v_cvt_pk_bf16_f32 v128, v128, v129
v_cvt_pk_bf16_f32 v129, v130, v131
v_exp_f32 v134, v134
v_exp_f32 v135, v135
v_cvt_pk_bf16_f32 v130, v132, v133
v_cvt_pk_bf16_f32 v131, v134, v135
v_mov_b32_e64 v6, 1
v_mov_b32 v5, 161800
s_waitcnt vmcnt(0)
s_mov_b64 exec, 1
ds_add_u32 v5, v6
s_mov_b64 exec, -1
v_exp_f32 v104, v104
v_exp_f32_e64 v105, v105
v_mfma_f32_32x32x16_bf16 v[136:151], v[100:103], v[128:131], v[136:151]
v_exp_f32 v106, v106
v_exp_f32 v107, v107
v_exp_f32 v108, v108
s_waitcnt lgkmcnt(7)
v_mfma_f32_32x32x16_bf16 v[120:135], v[72:75], v[24:27], v[40:55]
v_exp_f32_e64 v109, v109
v_cvt_pk_bf16_f32 v104, v104, v105
v_cvt_pk_bf16_f32 v105, v106, v107
v_exp_f32 v110, v110
v_exp_f32 v111, v111
v_mfma_f32_32x32x16_bf16 v[120:135], v[76:79], v[28:31], v[120:135]
v_exp_f32_e64 v112, v112
v_cvt_pk_bf16_f32 v106, v108, v109
v_cvt_pk_bf16_f32 v107, v110, v111
v_exp_f32 v113, v113
v_exp_f32 v114, v114
v_mfma_f32_32x32x16_bf16 v[152:167], v[96:99], v[104:107], v[152:167]
v_exp_f32 v115, v115
v_exp_f32 v116, v116
v_exp_f32_e64 v117, v117
v_cvt_pk_bf16_f32 v112, v112, v113
v_cvt_pk_bf16_f32 v113, v114, v115
v_exp_f32 v118, v118
v_exp_f32 v119, v119
v_cvt_pk_bf16_f32 v114, v116, v117
v_cvt_pk_bf16_f32 v115, v118, v119
v_exp_f32 v120, v120
v_exp_f32 v121, v121
v_mfma_f32_32x32x16_bf16 v[152:167], v[100:103], v[112:115], v[152:167]
ds_read_b64_tr_b16 v[96:97], v13 offset:21888
ds_read_b64_tr_b16 v[98:99], v14 offset:21888
ds_read_b64_tr_b16 v[100:101], v15 offset:21888
ds_read_b64_tr_b16 v[102:103], v16 offset:21888
v_exp_f32 v122, v122
v_exp_f32 v123, v123
v_exp_f32_e64 v124, v124
v_mfma_f32_32x32x16_bf16 v[104:119], v[72:75], v[32:35], 0
v_exp_f32_e64 v125, v125
v_cvt_pk_bf16_f32 v120, v120, v121
v_cvt_pk_bf16_f32 v121, v122, v123
v_exp_f32 v126, v126
v_exp_f32 v127, v127
v_mfma_f32_32x32x16_bf16 v[104:119], v[76:79], v[36:39], v[104:119]
v_exp_f32_e64 v128, v128
v_cvt_pk_bf16_f32 v122, v124, v125
v_cvt_pk_bf16_f32 v123, v126, v127
v_exp_f32 v129, v129
v_exp_f32_e64 v130, v130
s_waitcnt lgkmcnt(7)
v_mfma_f32_32x32x16_bf16 v[136:151], v[88:91], v[120:123], v[136:151]
v_exp_f32 v131, v131
v_exp_f32 v132, v132
v_exp_f32_e64 v133, v133
v_cvt_pk_bf16_f32 v128, v128, v129
v_cvt_pk_bf16_f32 v129, v130, v131
v_exp_f32 v134, v134
v_exp_f32 v135, v135
v_cvt_pk_bf16_f32 v130, v132, v133
v_cvt_pk_bf16_f32 v131, v134, v135
v_exp_f32 v104, v104
v_exp_f32 v105, v105
v_mfma_f32_32x32x16_bf16 v[136:151], v[92:95], v[128:131], v[136:151]
v_exp_f32 v106, v106
v_exp_f32 v107, v107
v_exp_f32 v108, v108
s_waitcnt lgkmcnt(5)
v_mfma_f32_32x32x16_bf16 v[120:135], v[80:83], v[32:35], v[40:55]
v_exp_f32_e64 v109, v109
v_cvt_pk_bf16_f32 v104, v104, v105
v_cvt_pk_bf16_f32 v105, v106, v107
v_exp_f32 v110, v110
v_exp_f32 v111, v111
v_mfma_f32_32x32x16_bf16 v[120:135], v[84:87], v[36:39], v[120:135]
v_exp_f32_e64 v112, v112
v_cvt_pk_bf16_f32 v106, v108, v109
v_cvt_pk_bf16_f32 v107, v110, v111
v_exp_f32 v113, v113
v_exp_f32 v114, v114
v_mfma_f32_32x32x16_bf16 v[152:167], v[88:91], v[104:107], v[152:167]
v_exp_f32 v115, v115
v_exp_f32 v116, v116
v_exp_f32_e64 v117, v117
v_cvt_pk_bf16_f32 v112, v112, v113
v_cvt_pk_bf16_f32 v113, v114, v115
v_exp_f32 v118, v118
v_exp_f32 v119, v119
v_cvt_pk_bf16_f32 v114, v116, v117
v_cvt_pk_bf16_f32 v115, v118, v119
v_exp_f32 v120, v120
v_exp_f32_e64 v121, v121
L_pdP2_0:
s_cbranch_execz L_pdP2_1
v_mfma_f32_32x32x16_bf16 v[152:167], v[92:95], v[112:115], v[152:167]
v_exp_f32 v122, v122
v_exp_f32 v123, v123
v_exp_f32 v124, v124
v_exp_f32 v125, v125
v_cvt_pk_bf16_f32 v120, v120, v121
v_cvt_pk_bf16_f32 v121, v122, v123
v_exp_f32 v126, v126
v_exp_f32 v127, v127
v_exp_f32_e64 v128, v128
v_cvt_pk_bf16_f32 v122, v124, v125
v_cvt_pk_bf16_f32 v123, v126, v127
v_exp_f32 v129, v129
v_exp_f32_e64 v130, v130
s_waitcnt lgkmcnt(0)
v_mfma_f32_32x32x16_bf16 v[152:167], v[96:99], v[120:123], v[152:167]
v_exp_f32 v131, v131
v_exp_f32 v132, v132
v_exp_f32_e64 v133, v133
v_cvt_pk_bf16_f32 v128, v128, v129
v_cvt_pk_bf16_f32 v129, v130, v131
v_exp_f32 v134, v134
v_exp_f32 v135, v135
v_cvt_pk_bf16_f32 v130, v132, v133
v_cvt_pk_bf16_f32 v131, v134, v135
s_nop 1
v_mfma_f32_32x32x16_bf16 v[152:167], v[100:103], v[128:131], v[152:167]
L_attd:
L_pdP3_0:
s_cbranch_execz L_pdP3_1
s_nop 11
v_min_f32 v6, v146, v162
v_max_f32 v7, v146, v162
v_add_f32 v8, v146, v162
v_rcp_f32 v216, v146
v_rcp_f32 v218, v162
v_cmp_nle_f32 vcc, 813694976, v6
s_nop 0
s_mov_b64 s[24:25], vcc
v_cmp_nge_f32 vcc, 1317011456, v7
s_nop 0
s_or_b64 s[24:25], s[24:25], vcc
v_cmp_u_f32 vcc, v8, v8
s_nop 0
s_or_b64 s[24:25], s[24:25], vcc
s_cbranch_scc1 L_exact
v_mul_f32_e64 v216, v216, v20
v_pk_mul_f32 v[136:137], v[136:137], v[216:217] op_sel_hi:[1,0]
v_pk_mul_f32 v[138:139], v[138:139], v[216:217] op_sel_hi:[1,0]
v_pk_mul_f32 v[140:141], v[140:141], v[216:217] op_sel_hi:[1,0]
v_pk_mul_f32 v[142:143], v[142:143], v[216:217] op_sel_hi:[1,0]
v_pk_mul_f32 v[144:145], v[144:145], v[216:217] op_sel_hi:[1,0]
v_cvt_pk_bf16_f32 v136, v136, v137
v_cvt_pk_bf16_f32 v137, v138, v139
v_cvt_pk_bf16_f32 v138, v140, v141
v_cvt_pk_bf16_f32 v139, v142, v143
buffer_store_dwordx4 v[136:139], v1, s[28:31], s4 offen sc1
v_cvt_pk_bf16_f32 v252, v144, v145
v_mul_f32_e64 v218, v218, v21
v_pk_mul_f32 v[152:153], v[152:153], v[218:219] op_sel_hi:[1,0]
v_pk_mul_f32 v[154:155], v[154:155], v[218:219] op_sel_hi:[1,0]
v_pk_mul_f32 v[156:157], v[156:157], v[218:219] op_sel_hi:[1,0]
v_pk_mul_f32 v[158:159], v[158:159], v[218:219] op_sel_hi:[1,0]
v_pk_mul_f32 v[160:161], v[160:161], v[218:219] op_sel_hi:[1,0]
v_cvt_pk_bf16_f32 v152, v152, v153
v_cvt_pk_bf16_f32 v153, v154, v155
v_cvt_pk_bf16_f32 v154, v156, v157
v_cvt_pk_bf16_f32 v155, v158, v159
buffer_store_dwordx4 v[152:155], v1, s[28:31], s5 offen sc1
v_cvt_pk_bf16_f32 v253, v160, v161
L_p3C:
v_cndmask_b32 v248, v252, v253, s[60:61]
s_nop 1
v_mov_b32_dpp v249, v248 quad_perm:[1,1,1,1] row_mask:0xf bank_mask:0xf
v_mov_b32_dpp v250, v248 quad_perm:[2,2,2,2] row_mask:0xf bank_mask:0xf
v_mov_b32_dpp v251, v248 quad_perm:[3,3,3,3] row_mask:0xf bank_mask:0xf
buffer_store_dwordx4 v[248:251], v18, s[32:35], s8 offen sc1
s_barrier
s_and_b32 s40, s2, 7
s_lshr_b32 s41, s2, 3
s_mul_i32 s40, s40, 30
s_add_u32 s40, s40, s41
s_cmp_lt_u32 s41, 30
s_cselect_b32 s40, s40, 255
s_cmp_lt_u32 s40, 234
s_cselect_b32 s18, 1, 0
s_cselect_b32 s40, s40, 0
s_mul_i32 s16, s40, 7282
s_lshr_b32 s16, s16, 16
s_mul_i32 s41, s16, 9
s_sub_u32 s17, s40, s41
s_mul_i32 s19, s16, 5
s_lshr_b32 s41, s19, 1
s_lshl_b32 s42, s41, 16
s_add_u32 s20, s28, s42
s_addc_u32 s21, s29, 0
s_sub_u32 s22, 4194304, s42
s_mov_b32 s23, 0x20000
s_lshl_b32 s42, s41, 13
s_add_u32 s36, s32, s42
s_addc_u32 s37, s33, 0
s_sub_u32 s38, 524288, s42
s_mov_b32 s39, 0x20000
s_and_b32 s19, s19, 1
s_add_u32 s40, s19, 0
s_lshr_b32 s41, s40, 1
s_and_b32 s40, s40, 1
s_lshl_b32 s42, s41, 16
s_lshl_b32 s43, s40, 8
s_add_u32 s4, s42, s43
s_lshl_b32 s42, s41, 13
s_lshl_b32 s43, s40, 6
s_add_u32 s28, s42, s43
s_add_u32 s40, s19, 1
s_lshr_b32 s41, s40, 1
s_and_b32 s40, s40, 1
s_lshl_b32 s42, s41, 16
s_lshl_b32 s43, s40, 8
s_add_u32 s5, s42, s43
s_lshl_b32 s42, s41, 13
s_lshl_b32 s43, s40, 6
s_add_u32 s29, s42, s43
s_add_u32 s40, s19, 2
s_lshr_b32 s41, s40, 1
s_and_b32 s40, s40, 1
s_lshl_b32 s42, s41, 16
s_lshl_b32 s43, s40, 8
s_add_u32 s6, s42, s43
s_lshl_b32 s42, s41, 13
s_lshl_b32 s43, s40, 6
s_add_u32 s30, s42, s43
s_add_u32 s40, s19, 3
s_lshr_b32 s41, s40, 1
s_and_b32 s40, s40, 1
s_lshl_b32 s42, s41, 16
s_lshl_b32 s43, s40, 8
s_add_u32 s7, s42, s43
s_lshl_b32 s42, s41, 13
s_lshl_b32 s43, s40, 6
s_add_u32 s31, s42, s43
s_add_u32 s40, s19, 4
s_lshr_b32 s41, s40, 1
s_and_b32 s40, s40, 1
s_lshl_b32 s42, s41, 16
s_lshl_b32 s43, s40, 8
s_add_u32 s8, s42, s43
s_lshl_b32 s42, s41, 13
s_lshl_b32 s43, s40, 6
s_add_u32 s32, s42, s43
s_and_b32 s56, s17, 3
s_lshr_b32 s63, s52, 1
s_mov_b32 s57, 120832
s_mov_b32 s59, 4294926336
v_lshrrev_b32 v5, 4, v0
v_and_b32 v10, 15, v0
v_bfe_u32 v6, v0, 2, 2
v_lshl_add_u32 v7, v5, 3, v6
v_lshlrev_b32 v7, 7, v7
v_and_b32 v8, 1, v5
v_lshrrev_b32_e64 v9, 1, v6
v_lshl_add_u32 v8, v8, 1, v9
v_lshl_add_u32 v7, v8, 5, v7
v_and_b32_e64 v8, 3, v0
v_lshl_add_u32 v7, v8, 3, v7
s_and_b32 s40, s52, 1
s_lshl_b32 s41, s40, 12
v_add_u32 v24, s41, v7
v_xor_b32 v25, 32, v24
v_xor_b32_e64 v26, 64, v24
v_xor_b32 v27, 96, v24
v_lshlrev_b32_e64 v32, 9, v5
v_lshl_add_u32 v32, v10, 4, v32
s_lshl_b32 s41, s52, 11
v_add_u32 v32, s41, v32
v_lshl_add_u32 v8, v5, 2, v8
v_lshlrev_b32_e64 v8, 7, v8
v_lshl_add_u32 v8, v6, 4, v8
s_lshl_b32 s41, s40, 11
v_add_u32 v33, s41, v8
v_xor_b32 v7, v5, v10
v_lshlrev_b32 v7, 4, v7
v_lshl_add_u32 v7, v10, 8, v7
s_mul_i32 s40, s52, 20480
s_add_u32 s40, s40, 32768
v_add_u32_e64 v34, s40, v7
s_add_u32 s48, s14, 15347712
s_addc_u32 s49, s15, 0
s_mov_b32 s50, 196608
s_mov_b32 s51, 0x20000
v_lshlrev_b32 v5, 3, v0
ds_read_b64 v[36:37], v5 offset:44032
v_mov_b32_e64 v6, 1
v_mov_b32 v5, 161796
s_waitcnt vmcnt(0)
s_mov_b64 exec, 1
ds_add_rtn_u32 v5, v5, v6
s_mov_b64 exec, -1
s_waitcnt lgkmcnt(0)
v_readfirstlane_b32 s40, v5
s_nop 0
s_cmp_lg_u32 s40, 3
s_cbranch_scc1 L_nsa
buffer_store_dword v37, v36, s[48:51], 0 offen sc1
L_nsa:
s_cmp_eq_u32 s18, 0
s_cbranch_scc1 L_fin
s_barrier
s_cmp_eq_u32 s63, 0
s_cbranch_scc1 L_g3b
s_lshl_b32 s53, s56, 13
s_add_u32 s43, s53, 32768
s_add_u32 s42, s43, s4
buffer_load_dwordx4 v[40:43], v32, s[20:23], s42 offen sc1
s_add_u32 s42, s43, s5
buffer_load_dwordx4 v[44:47], v32, s[20:23], s42 offen sc1
s_add_u32 s42, s43, s6
buffer_load_dwordx4 v[48:51], v32, s[20:23], s42 offen sc1
s_add_u32 s42, s43, s7
buffer_load_dwordx4 v[52:55], v32, s[20:23], s42 offen sc1
s_add_u32 s42, s43, s8
buffer_load_dwordx4 v[56:59], v32, s[20:23], s42 offen sc1
s_add_u32 s53, s53, 8192
s_and_b32 s53, s53, 32767
s_add_u32 s43, s53, 32768
s_add_u32 s42, s43, s4
buffer_load_dwordx4 v[60:63], v32, s[20:23], s42 offen sc1
s_add_u32 s42, s43, s5
buffer_load_dwordx4 v[64:67], v32, s[20:23], s42 offen sc1
s_add_u32 s42, s43, s6
buffer_load_dwordx4 v[68:71], v32, s[20:23], s42 offen sc1
s_add_u32 s42, s43, s7
buffer_load_dwordx4 v[72:75], v32, s[20:23], s42 offen sc1
s_add_u32 s42, s43, s8
buffer_load_dwordx4 v[76:79], v32, s[20:23], s42 offen sc1
s_add_u32 s53, s53, 8192
s_and_b32 s53, s53, 32767
s_add_u32 s43, s53, 32768
s_add_u32 s42, s43, s4
buffer_load_dwordx4 v[80:83], v32, s[20:23], s42 offen sc1
s_add_u32 s42, s43, s5
buffer_load_dwordx4 v[84:87], v32, s[20:23], s42 offen sc1
s_add_u32 s42, s43, s6
buffer_load_dwordx4 v[88:91], v32, s[20:23], s42 offen sc1
s_add_u32 s42, s43, s7
buffer_load_dwordx4 v[92:95], v32, s[20:23], s42 offen sc1
s_add_u32 s42, s43, s8
buffer_load_dwordx4 v[96:99], v32, s[20:23], s42 offen sc1
s_add_u32 s53, s53, 8192
s_and_b32 s53, s53, 32767
s_lshl_b32 s54, s56, 1
s_add_u32 s54, s54, s63
s_lshl_b32 s55, s54, 13
s_add_u32 s55, s55, 47104
v_add_u32_e64 v28, s55, v24
ds_read_b64_tr_b16 v[100:101], v28 offset:0
ds_read_b64_tr_b16 v[102:103], v28 offset:512
v_add_u32_e64 v29, s55, v25
ds_read_b64_tr_b16 v[104:105], v29 offset:0
ds_read_b64_tr_b16 v[106:107], v29 offset:512
v_add_u32_e64 v30, s55, v26
ds_read_b64_tr_b16 v[108:109], v30 offset:0
ds_read_b64_tr_b16 v[110:111], v30 offset:512
v_add_u32_e64 v31, s55, v27
ds_read_b64_tr_b16 v[112:113], v31 offset:0
ds_read_b64_tr_b16 v[114:115], v31 offset:512
s_waitcnt vmcnt(14)
s_waitcnt lgkmcnt(6)
v_mfma_f32_16x16x32_bf16 v[132:135], v[100:103], v[40:43], 0
s_waitcnt lgkmcnt(4)
v_mfma_f32_16x16x32_bf16 v[136:139], v[104:107], v[40:43], 0
s_waitcnt lgkmcnt(2)
v_mfma_f32_16x16x32_bf16 v[140:143], v[108:111], v[40:43], 0
s_waitcnt lgkmcnt(0)
v_mfma_f32_16x16x32_bf16 v[144:147], v[112:115], v[40:43], 0
s_waitcnt vmcnt(13)
v_mfma_f32_16x16x32_bf16 v[148:151], v[100:103], v[44:47], 0
s_add_u32 s54, s54, 2
s_and_b32 s54, s54, 7
s_lshl_b32 s55, s54, 13
s_add_u32 s55, s55, 47104
v_add_u32 v28, s55, v24
ds_read_b64_tr_b16 v[116:117], v28 offset:0
ds_read_b64_tr_b16 v[118:119], v28 offset:512
v_mfma_f32_16x16x32_bf16 v[152:155], v[104:107], v[44:47], 0
v_add_u32_e64 v29, s55, v25
ds_read_b64_tr_b16 v[120:121], v29 offset:0
ds_read_b64_tr_b16 v[122:123], v29 offset:512
v_mfma_f32_16x16x32_bf16 v[156:159], v[108:111], v[44:47], 0
v_add_u32_e64 v30, s55, v26
ds_read_b64_tr_b16 v[124:125], v30 offset:0
ds_read_b64_tr_b16 v[126:127], v30 offset:512
v_mfma_f32_16x16x32_bf16 v[160:163], v[112:115], v[44:47], 0
v_add_u32_e64 v31, s55, v27
ds_read_b64_tr_b16 v[128:129], v31 offset:0
ds_read_b64_tr_b16 v[130:131], v31 offset:512
s_waitcnt vmcnt(12)
v_mfma_f32_16x16x32_bf16 v[164:167], v[100:103], v[48:51], 0
v_mfma_f32_16x16x32_bf16 v[168:171], v[104:107], v[48:51], 0
v_mfma_f32_16x16x32_bf16 v[172:175], v[108:111], v[48:51], 0
v_mfma_f32_16x16x32_bf16 v[176:179], v[112:115], v[48:51], 0
s_waitcnt vmcnt(11)
v_mfma_f32_16x16x32_bf16 v[180:183], v[100:103], v[52:55], 0
v_mfma_f32_16x16x32_bf16 v[184:187], v[104:107], v[52:55], 0
v_mfma_f32_16x16x32_bf16 v[188:191], v[108:111], v[52:55], 0
v_mfma_f32_16x16x32_bf16 v[192:195], v[112:115], v[52:55], 0
s_waitcnt vmcnt(10)
v_mfma_f32_16x16x32_bf16 v[196:199], v[100:103], v[56:59], 0
v_mfma_f32_16x16x32_bf16 v[200:203], v[104:107], v[56:59], 0
v_mfma_f32_16x16x32_bf16 v[204:207], v[108:111], v[56:59], 0
v_mfma_f32_16x16x32_bf16 v[208:211], v[112:115], v[56:59], 0
s_add_u32 s43, s53, 32768
s_add_u32 s42, s43, s4
buffer_load_dwordx4 v[40:43], v32, s[20:23], s42 offen sc1
s_add_u32 s42, s43, s5
buffer_load_dwordx4 v[44:47], v32, s[20:23], s42 offen sc1
s_add_u32 s42, s43, s6
buffer_load_dwordx4 v[48:51], v32, s[20:23], s42 offen sc1
s_add_u32 s42, s43, s7
buffer_load_dwordx4 v[52:55], v32, s[20:23], s42 offen sc1
s_add_u32 s42, s43, s8
buffer_load_dwordx4 v[56:59], v32, s[20:23], s42 offen sc1
s_add_u32 s53, s53, 8192
s_and_b32 s53, s53, 32767
s_waitcnt vmcnt(14)
s_waitcnt lgkmcnt(6)
v_mfma_f32_16x16x32_bf16 v[132:135], v[116:119], v[60:63], v[132:135]
s_waitcnt lgkmcnt(4)
v_mfma_f32_16x16x32_bf16 v[136:139], v[120:123], v[60:63], v[136:139]
s_waitcnt lgkmcnt(2)
v_mfma_f32_16x16x32_bf16 v[140:143], v[124:127], v[60:63], v[140:143]
s_waitcnt lgkmcnt(0)
v_mfma_f32_16x16x32_bf16 v[144:147], v[128:131], v[60:63], v[144:147]
s_waitcnt vmcnt(13)
v_mfma_f32_16x16x32_bf16 v[148:151], v[116:119], v[64:67], v[148:151]
s_add_u32 s54, s54, 2
s_and_b32 s54, s54, 7
s_lshl_b32 s55, s54, 13
s_add_u32 s55, s55, 47104
v_add_u32 v28, s55, v24
ds_read_b64_tr_b16 v[100:101], v28 offset:0
ds_read_b64_tr_b16 v[102:103], v28 offset:512
v_mfma_f32_16x16x32_bf16 v[152:155], v[120:123], v[64:67], v[152:155]
v_add_u32_e64 v29, s55, v25
ds_read_b64_tr_b16 v[104:105], v29 offset:0
ds_read_b64_tr_b16 v[106:107], v29 offset:512
v_mfma_f32_16x16x32_bf16 v[156:159], v[124:127], v[64:67], v[156:159]
v_add_u32_e64 v30, s55, v26
ds_read_b64_tr_b16 v[108:109], v30 offset:0
ds_read_b64_tr_b16 v[110:111], v30 offset:512
v_mfma_f32_16x16x32_bf16 v[160:163], v[128:131], v[64:67], v[160:163]
v_add_u32_e64 v31, s55, v27
ds_read_b64_tr_b16 v[112:113], v31 offset:0
ds_read_b64_tr_b16 v[114:115], v31 offset:512
s_waitcnt vmcnt(12)
v_mfma_f32_16x16x32_bf16 v[164:167], v[116:119], v[68:71], v[164:167]
v_mfma_f32_16x16x32_bf16 v[168:171], v[120:123], v[68:71], v[168:171]
v_mfma_f32_16x16x32_bf16 v[172:175], v[124:127], v[68:71], v[172:175]
v_mfma_f32_16x16x32_bf16 v[176:179], v[128:131], v[68:71], v[176:179]
s_waitcnt vmcnt(11)
v_mfma_f32_16x16x32_bf16 v[180:183], v[116:119], v[72:75], v[180:183]
v_mfma_f32_16x16x32_bf16 v[184:187], v[120:123], v[72:75], v[184:187]
v_mfma_f32_16x16x32_bf16 v[188:191], v[124:127], v[72:75], v[188:191]
v_mfma_f32_16x16x32_bf16 v[192:195], v[128:131], v[72:75], v[192:195]
s_waitcnt vmcnt(10)
v_mfma_f32_16x16x32_bf16 v[196:199], v[116:119], v[76:79], v[196:199]
v_mfma_f32_16x16x32_bf16 v[200:203], v[120:123], v[76:79], v[200:203]
v_mfma_f32_16x16x32_bf16 v[204:207], v[124:127], v[76:79], v[204:207]
v_mfma_f32_16x16x32_bf16 v[208:211], v[128:131], v[76:79], v[208:211]
s_waitcnt vmcnt(9)
s_waitcnt lgkmcnt(6)
v_mfma_f32_16x16x32_bf16 v[132:135], v[100:103], v[80:83], v[132:135]
s_barrier
s_lshl_b32 s53, s56, 13
s_add_u32 s43, s53, 0
s_add_u32 s42, s43, s4
buffer_load_dwordx4 v[60:63], v32, s[20:23], s42 offen sc1
s_add_u32 s42, s43, s5
buffer_load_dwordx4 v[64:67], v32, s[20:23], s42 offen sc1
s_add_u32 s42, s43, s6
buffer_load_dwordx4 v[68:71], v32, s[20:23], s42 offen sc1
s_add_u32 s42, s43, s7
buffer_load_dwordx4 v[72:75], v32, s[20:23], s42 offen sc1
s_add_u32 s42, s43, s8
buffer_load_dwordx4 v[76:79], v32, s[20:23], s42 offen sc1
s_add_u32 s53, s53, 8192
s_and_b32 s53, s53, 32767
s_waitcnt lgkmcnt(4)
v_mfma_f32_16x16x32_bf16 v[136:139], v[104:107], v[80:83], v[136:139]
s_waitcnt lgkmcnt(2)
v_mfma_f32_16x16x32_bf16 v[140:143], v[108:111], v[80:83], v[140:143]
s_waitcnt lgkmcnt(0)
v_mfma_f32_16x16x32_bf16 v[144:147], v[112:115], v[80:83], v[144:147]
s_waitcnt vmcnt(13)
v_mfma_f32_16x16x32_bf16 v[148:151], v[100:103], v[84:87], v[148:151]
s_add_u32 s54, s54, 2
s_and_b32 s54, s54, 7
s_lshl_b32 s55, s54, 13
s_add_u32 s55, s55, 47104
v_add_u32_e64 v28, s55, v24
ds_read_b64_tr_b16 v[116:117], v28 offset:0
ds_read_b64_tr_b16 v[118:119], v28 offset:512
v_mfma_f32_16x16x32_bf16 v[152:155], v[104:107], v[84:87], v[152:155]
v_add_u32_e64 v29, s55, v25
ds_read_b64_tr_b16 v[120:121], v29 offset:0
ds_read_b64_tr_b16 v[122:123], v29 offset:512
v_mfma_f32_16x16x32_bf16 v[156:159], v[108:111], v[84:87], v[156:159]
v_add_u32_e64 v30, s55, v26
ds_read_b64_tr_b16 v[124:125], v30 offset:0
ds_read_b64_tr_b16 v[126:127], v30 offset:512
v_mfma_f32_16x16x32_bf16 v[160:163], v[112:115], v[84:87], v[160:163]
v_add_u32_e64 v31, s55, v27
ds_read_b64_tr_b16 v[128:129], v31 offset:0
ds_read_b64_tr_b16 v[130:131], v31 offset:512
s_waitcnt vmcnt(12)
v_mfma_f32_16x16x32_bf16 v[164:167], v[100:103], v[88:91], v[164:167]
v_mfma_f32_16x16x32_bf16 v[168:171], v[104:107], v[88:91], v[168:171]
v_mfma_f32_16x16x32_bf16 v[172:175], v[108:111], v[88:91], v[172:175]
v_mfma_f32_16x16x32_bf16 v[176:179], v[112:115], v[88:91], v[176:179]
s_waitcnt vmcnt(11)
v_mfma_f32_16x16x32_bf16 v[180:183], v[100:103], v[92:95], v[180:183]
v_mfma_f32_16x16x32_bf16 v[184:187], v[104:107], v[92:95], v[184:187]
v_mfma_f32_16x16x32_bf16 v[188:191], v[108:111], v[92:95], v[188:191]
v_mfma_f32_16x16x32_bf16 v[192:195], v[112:115], v[92:95], v[192:195]
s_waitcnt vmcnt(10)
v_mfma_f32_16x16x32_bf16 v[196:199], v[100:103], v[96:99], v[196:199]
v_mfma_f32_16x16x32_bf16 v[200:203], v[104:107], v[96:99], v[200:203]
v_mfma_f32_16x16x32_bf16 v[204:207], v[108:111], v[96:99], v[204:207]
v_mfma_f32_16x16x32_bf16 v[208:211], v[112:115], v[96:99], v[208:211]
s_add_u32 s43, s53, 0
s_add_u32 s42, s43, s4
buffer_load_dwordx4 v[80:83], v32, s[20:23], s42 offen sc1
s_add_u32 s42, s43, s5
buffer_load_dwordx4 v[84:87], v32, s[20:23], s42 offen sc1
s_add_u32 s42, s43, s6
buffer_load_dwordx4 v[88:91], v32, s[20:23], s42 offen sc1
s_add_u32 s42, s43, s7
buffer_load_dwordx4 v[92:95], v32, s[20:23], s42 offen sc1
s_add_u32 s42, s43, s8
buffer_load_dwordx4 v[96:99], v32, s[20:23], s42 offen sc1
s_add_u32 s53, s53, 8192
s_and_b32 s53, s53, 32767
s_waitcnt vmcnt(14)
s_waitcnt lgkmcnt(6)
v_mfma_f32_16x16x32_bf16 v[132:135], v[116:119], v[40:43], v[132:135]
s_waitcnt lgkmcnt(4)
v_mfma_f32_16x16x32_bf16 v[136:139], v[120:123], v[40:43], v[136:139]
s_waitcnt lgkmcnt(2)
v_mfma_f32_16x16x32_bf16 v[140:143], v[124:127], v[40:43], v[140:143]
s_waitcnt lgkmcnt(0)
v_mfma_f32_16x16x32_bf16 v[144:147], v[128:131], v[40:43], v[144:147]
s_waitcnt vmcnt(13)
v_mfma_f32_16x16x32_bf16 v[148:151], v[116:119], v[44:47], v[148:151]
s_lshl_b32 s54, s56, 1
s_add_u32 s54, s54, s63
s_lshl_b32 s55, s54, 13
s_cmp_lt_u32 s54, 5
s_cselect_b32 s42, s57, s59
s_add_u32 s55, s55, s42
v_add_u32 v28, s55, v24
ds_read_b64_tr_b16 v[100:101], v28 offset:0
ds_read_b64_tr_b16 v[102:103], v28 offset:512
v_mfma_f32_16x16x32_bf16 v[152:155], v[120:123], v[44:47], v[152:155]
v_add_u32_e64 v29, s55, v25
ds_read_b64_tr_b16 v[104:105], v29 offset:0
ds_read_b64_tr_b16 v[106:107], v29 offset:512
v_mfma_f32_16x16x32_bf16 v[156:159], v[124:127], v[44:47], v[156:159]
v_add_u32_e64 v30, s55, v26
ds_read_b64_tr_b16 v[108:109], v30 offset:0
ds_read_b64_tr_b16 v[110:111], v30 offset:512
v_mfma_f32_16x16x32_bf16 v[160:163], v[128:131], v[44:47], v[160:163]
v_add_u32_e64 v31, s55, v27
ds_read_b64_tr_b16 v[112:113], v31 offset:0
ds_read_b64_tr_b16 v[114:115], v31 offset:512
s_waitcnt vmcnt(12)
v_mfma_f32_16x16x32_bf16 v[164:167], v[116:119], v[48:51], v[164:167]
v_mfma_f32_16x16x32_bf16 v[168:171], v[120:123], v[48:51], v[168:171]
v_mfma_f32_16x16x32_bf16 v[172:175], v[124:127], v[48:51], v[172:175]
v_mfma_f32_16x16x32_bf16 v[176:179], v[128:131], v[48:51], v[176:179]
s_waitcnt vmcnt(11)
v_mfma_f32_16x16x32_bf16 v[180:183], v[116:119], v[52:55], v[180:183]
v_mfma_f32_16x16x32_bf16 v[184:187], v[120:123], v[52:55], v[184:187]
v_mfma_f32_16x16x32_bf16 v[188:191], v[124:127], v[52:55], v[188:191]
v_mfma_f32_16x16x32_bf16 v[192:195], v[128:131], v[52:55], v[192:195]
s_waitcnt vmcnt(10)
v_mfma_f32_16x16x32_bf16 v[196:199], v[116:119], v[56:59], v[196:199]
v_mfma_f32_16x16x32_bf16 v[200:203], v[120:123], v[56:59], v[200:203]
v_mfma_f32_16x16x32_bf16 v[204:207], v[124:127], v[56:59], v[204:207]
v_mfma_f32_16x16x32_bf16 v[208:211], v[128:131], v[56:59], v[208:211]
s_add_u32 s43, s53, 0
s_add_u32 s42, s43, s4
buffer_load_dwordx4 v[40:43], v32, s[20:23], s42 offen sc1
s_add_u32 s42, s43, s5
buffer_load_dwordx4 v[44:47], v32, s[20:23], s42 offen sc1
s_add_u32 s42, s43, s6
buffer_load_dwordx4 v[48:51], v32, s[20:23], s42 offen sc1
s_add_u32 s42, s43, s7
buffer_load_dwordx4 v[52:55], v32, s[20:23], s42 offen sc1
s_add_u32 s42, s43, s8
buffer_load_dwordx4 v[56:59], v32, s[20:23], s42 offen sc1
s_add_u32 s53, s53, 8192
s_and_b32 s53, s53, 32767
s_waitcnt vmcnt(14)
s_waitcnt lgkmcnt(6)
v_mfma_f32_16x16x32_bf16 v[132:135], v[100:103], v[60:63], v[132:135]
s_waitcnt lgkmcnt(4)
v_mfma_f32_16x16x32_bf16 v[136:139], v[104:107], v[60:63], v[136:139]
s_waitcnt lgkmcnt(2)
v_mfma_f32_16x16x32_bf16 v[140:143], v[108:111], v[60:63], v[140:143]
s_waitcnt lgkmcnt(0)
v_mfma_f32_16x16x32_bf16 v[144:147], v[112:115], v[60:63], v[144:147]
s_waitcnt vmcnt(13)
v_mfma_f32_16x16x32_bf16 v[148:151], v[100:103], v[64:67], v[148:151]
s_add_u32 s54, s54, 2
s_and_b32 s54, s54, 7
s_lshl_b32 s55, s54, 13
s_cmp_lt_u32 s54, 5
s_cselect_b32 s42, s57, s59
s_add_u32 s55, s55, s42
v_add_u32 v28, s55, v24
ds_read_b64_tr_b16 v[116:117], v28 offset:0
ds_read_b64_tr_b16 v[118:119], v28 offset:512
v_mfma_f32_16x16x32_bf16 v[152:155], v[104:107], v[64:67], v[152:155]
v_add_u32_e64 v29, s55, v25
ds_read_b64_tr_b16 v[120:121], v29 offset:0
ds_read_b64_tr_b16 v[122:123], v29 offset:512
v_mfma_f32_16x16x32_bf16 v[156:159], v[108:111], v[64:67], v[156:159]
v_add_u32_e64 v30, s55, v26
ds_read_b64_tr_b16 v[124:125], v30 offset:0
ds_read_b64_tr_b16 v[126:127], v30 offset:512
v_mfma_f32_16x16x32_bf16 v[160:163], v[112:115], v[64:67], v[160:163]
v_add_u32_e64 v31, s55, v27
ds_read_b64_tr_b16 v[128:129], v31 offset:0
ds_read_b64_tr_b16 v[130:131], v31 offset:512
s_waitcnt vmcnt(12)
v_mfma_f32_16x16x32_bf16 v[164:167], v[100:103], v[68:71], v[164:167]
v_mfma_f32_16x16x32_bf16 v[168:171], v[104:107], v[68:71], v[168:171]
v_mfma_f32_16x16x32_bf16 v[172:175], v[108:111], v[68:71], v[172:175]
v_mfma_f32_16x16x32_bf16 v[176:179], v[112:115], v[68:71], v[176:179]
s_waitcnt vmcnt(11)
v_mfma_f32_16x16x32_bf16 v[180:183], v[100:103], v[72:75], v[180:183]
v_mfma_f32_16x16x32_bf16 v[184:187], v[104:107], v[72:75], v[184:187]
v_mfma_f32_16x16x32_bf16 v[188:191], v[108:111], v[72:75], v[188:191]
v_mfma_f32_16x16x32_bf16 v[192:195], v[112:115], v[72:75], v[192:195]
s_waitcnt vmcnt(10)
v_mfma_f32_16x16x32_bf16 v[196:199], v[100:103], v[76:79], v[196:199]
v_mfma_f32_16x16x32_bf16 v[200:203], v[104:107], v[76:79], v[200:203]
v_mfma_f32_16x16x32_bf16 v[204:207], v[108:111], v[76:79], v[204:207]
v_mfma_f32_16x16x32_bf16 v[208:211], v[112:115], v[76:79], v[208:211]
s_add_u32 s43, s53, 0
s_add_u32 s42, s43, s4
buffer_load_dwordx4 v[60:63], v32, s[20:23], s42 offen sc1
s_add_u32 s42, s43, s5
buffer_load_dwordx4 v[64:67], v32, s[20:23], s42 offen sc1
s_add_u32 s42, s43, s6
buffer_load_dwordx4 v[68:71], v32, s[20:23], s42 offen sc1
s_add_u32 s42, s43, s7
buffer_load_dwordx4 v[72:75], v32, s[20:23], s42 offen sc1
s_add_u32 s42, s43, s8
buffer_load_dwordx4 v[76:79], v32, s[20:23], s42 offen sc1
s_add_u32 s53, s53, 8192
s_and_b32 s53, s53, 32767
s_barrier
s_waitcnt vmcnt(14)
s_waitcnt lgkmcnt(6)
v_mfma_f32_16x16x32_bf16 v[132:135], v[116:119], v[80:83], v[132:135]
s_waitcnt lgkmcnt(4)
v_mfma_f32_16x16x32_bf16 v[136:139], v[120:123], v[80:83], v[136:139]
s_waitcnt lgkmcnt(2)
v_mfma_f32_16x16x32_bf16 v[140:143], v[124:127], v[80:83], v[140:143]
s_waitcnt lgkmcnt(0)
v_mfma_f32_16x16x32_bf16 v[144:147], v[128:131], v[80:83], v[144:147]
s_waitcnt vmcnt(13)
v_mfma_f32_16x16x32_bf16 v[148:151], v[116:119], v[84:87], v[148:151]
s_add_u32 s54, s54, 2
s_and_b32 s54, s54, 7
s_lshl_b32 s55, s54, 13
s_cmp_lt_u32 s54, 5
s_cselect_b32 s42, s57, s59
s_add_u32 s55, s55, s42
v_add_u32_e64 v28, s55, v24
ds_read_b64_tr_b16 v[100:101], v28 offset:0
ds_read_b64_tr_b16 v[102:103], v28 offset:512
v_mfma_f32_16x16x32_bf16 v[152:155], v[120:123], v[84:87], v[152:155]
v_add_u32_e64 v29, s55, v25
ds_read_b64_tr_b16 v[104:105], v29 offset:0
ds_read_b64_tr_b16 v[106:107], v29 offset:512
v_mfma_f32_16x16x32_bf16 v[156:159], v[124:127], v[84:87], v[156:159]
v_add_u32_e64 v30, s55, v26
ds_read_b64_tr_b16 v[108:109], v30 offset:0
ds_read_b64_tr_b16 v[110:111], v30 offset:512
v_mfma_f32_16x16x32_bf16 v[160:163], v[128:131], v[84:87], v[160:163]
v_add_u32_e64 v31, s55, v27
ds_read_b64_tr_b16 v[112:113], v31 offset:0
ds_read_b64_tr_b16 v[114:115], v31 offset:512
s_waitcnt vmcnt(12)
v_mfma_f32_16x16x32_bf16 v[164:167], v[116:119], v[88:91], v[164:167]
v_mfma_f32_16x16x32_bf16 v[168:171], v[120:123], v[88:91], v[168:171]
v_mfma_f32_16x16x32_bf16 v[172:175], v[124:127], v[88:91], v[172:175]
v_mfma_f32_16x16x32_bf16 v[176:179], v[128:131], v[88:91], v[176:179]
s_waitcnt vmcnt(11)
v_mfma_f32_16x16x32_bf16 v[180:183], v[116:119], v[92:95], v[180:183]
v_mfma_f32_16x16x32_bf16 v[184:187], v[120:123], v[92:95], v[184:187]
v_mfma_f32_16x16x32_bf16 v[188:191], v[124:127], v[92:95], v[188:191]
v_mfma_f32_16x16x32_bf16 v[192:195], v[128:131], v[92:95], v[192:195]
s_waitcnt vmcnt(10)
v_mfma_f32_16x16x32_bf16 v[196:199], v[116:119], v[96:99], v[196:199]
v_mfma_f32_16x16x32_bf16 v[200:203], v[120:123], v[96:99], v[200:203]
v_mfma_f32_16x16x32_bf16 v[204:207], v[124:127], v[96:99], v[204:207]
v_mfma_f32_16x16x32_bf16 v[208:211], v[128:131], v[96:99], v[208:211]
s_add_u32 s42, s28, 0
buffer_load_dwordx4 v[80:83], v33, s[36:39], s42 offen sc1
s_add_u32 s42, s29, 0
buffer_load_dwordx4 v[84:87], v33, s[36:39], s42 offen sc1
s_add_u32 s42, s30, 0
buffer_load_dwordx4 v[88:91], v33, s[36:39], s42 offen sc1
s_add_u32 s42, s31, 0
buffer_load_dwordx4 v[92:95], v33, s[36:39], s42 offen sc1
s_add_u32 s42, s32, 0
buffer_load_dwordx4 v[96:99], v33, s[36:39], s42 offen sc1
s_waitcnt vmcnt(14)
s_waitcnt lgkmcnt(6)
v_mfma_f32_16x16x32_bf16 v[132:135], v[100:103], v[40:43], v[132:135]
s_waitcnt lgkmcnt(4)
v_mfma_f32_16x16x32_bf16 v[136:139], v[104:107], v[40:43], v[136:139]
s_waitcnt lgkmcnt(2)
v_mfma_f32_16x16x32_bf16 v[140:143], v[108:111], v[40:43], v[140:143]
s_waitcnt lgkmcnt(0)
v_mfma_f32_16x16x32_bf16 v[144:147], v[112:115], v[40:43], v[144:147]
s_waitcnt vmcnt(13)
v_mfma_f32_16x16x32_bf16 v[148:151], v[100:103], v[44:47], v[148:151]
s_add_u32 s54, s54, 2
s_and_b32 s54, s54, 7
s_lshl_b32 s55, s54, 13
s_cmp_lt_u32 s54, 5
s_cselect_b32 s42, s57, s59
s_add_u32 s55, s55, s42
v_add_u32_e64 v28, s55, v24
ds_read_b64_tr_b16 v[116:117], v28 offset:0
ds_read_b64_tr_b16 v[118:119], v28 offset:512
v_mfma_f32_16x16x32_bf16 v[152:155], v[104:107], v[44:47], v[152:155]
v_add_u32_e64 v29, s55, v25
ds_read_b64_tr_b16 v[120:121], v29 offset:0
ds_read_b64_tr_b16 v[122:123], v29 offset:512
v_mfma_f32_16x16x32_bf16 v[156:159], v[108:111], v[44:47], v[156:159]
v_add_u32_e64 v30, s55, v26
ds_read_b64_tr_b16 v[124:125], v30 offset:0
ds_read_b64_tr_b16 v[126:127], v30 offset:512
v_mfma_f32_16x16x32_bf16 v[160:163], v[112:115], v[44:47], v[160:163]
v_add_u32_e64 v31, s55, v27
ds_read_b64_tr_b16 v[128:129], v31 offset:0
ds_read_b64_tr_b16 v[130:131], v31 offset:512
s_waitcnt vmcnt(12)
v_mfma_f32_16x16x32_bf16 v[164:167], v[100:103], v[48:51], v[164:167]
v_mfma_f32_16x16x32_bf16 v[168:171], v[104:107], v[48:51], v[168:171]
v_mfma_f32_16x16x32_bf16 v[172:175], v[108:111], v[48:51], v[172:175]
L_pdP0_1:
s_cbranch_execz L_pdP0_2
v_mfma_f32_16x16x32_bf16 v[176:179], v[112:115], v[48:51], v[176:179]
s_waitcnt vmcnt(11)
v_mfma_f32_16x16x32_bf16 v[180:183], v[100:103], v[52:55], v[180:183]
v_mfma_f32_16x16x32_bf16 v[184:187], v[104:107], v[52:55], v[184:187]
v_mfma_f32_16x16x32_bf16 v[188:191], v[108:111], v[52:55], v[188:191]
v_mfma_f32_16x16x32_bf16 v[192:195], v[112:115], v[52:55], v[192:195]
s_waitcnt vmcnt(10)
v_mfma_f32_16x16x32_bf16 v[196:199], v[100:103], v[56:59], v[196:199]
v_mfma_f32_16x16x32_bf16 v[200:203], v[104:107], v[56:59], v[200:203]
v_mfma_f32_16x16x32_bf16 v[204:207], v[108:111], v[56:59], v[204:207]
v_mfma_f32_16x16x32_bf16 v[208:211], v[112:115], v[56:59], v[208:211]
s_mov_b32 s55, 24576
v_add_u32_e64 v28, s55, v24
ds_read_b64_tr_b16 v[100:101], v28 offset:0
ds_read_b64_tr_b16 v[102:103], v28 offset:512
v_add_u32_e64 v29, s55, v25
ds_read_b64_tr_b16 v[104:105], v29 offset:0
ds_read_b64_tr_b16 v[106:107], v29 offset:512
v_add_u32_e64 v30, s55, v26
ds_read_b64_tr_b16 v[108:109], v30 offset:0
ds_read_b64_tr_b16 v[110:111], v30 offset:512
v_add_u32_e64 v31, s55, v27
ds_read_b64_tr_b16 v[112:113], v31 offset:0
ds_read_b64_tr_b16 v[114:115], v31 offset:512
s_waitcnt vmcnt(9)
s_waitcnt lgkmcnt(14)
v_mfma_f32_16x16x32_bf16 v[132:135], v[116:119], v[60:63], v[132:135]
s_waitcnt lgkmcnt(12)
v_mfma_f32_16x16x32_bf16 v[136:139], v[120:123], v[60:63], v[136:139]
s_waitcnt lgkmcnt(10)
v_mfma_f32_16x16x32_bf16 v[140:143], v[124:127], v[60:63], v[140:143]
s_waitcnt lgkmcnt(8)
v_mfma_f32_16x16x32_bf16 v[144:147], v[128:131], v[60:63], v[144:147]
s_waitcnt vmcnt(4)
s_mov_b64 vcc, s[10:11]
v_cndmask_b32_dpp v36, v81, v80, vcc quad_perm:[1,0,3,2] row_mask:0xf bank_mask:0xf
v_cndmask_b32_dpp v38, v83, v82, vcc quad_perm:[1,0,3,2] row_mask:0xf bank_mask:0xf
s_not_b64 vcc, vcc
v_cndmask_b32_dpp v37, v80, v81, vcc quad_perm:[1,0,3,2] row_mask:0xf bank_mask:0xf
v_cndmask_b32_dpp v39, v82, v83, vcc quad_perm:[1,0,3,2] row_mask:0xf bank_mask:0xf
s_mov_b64 vcc, s[100:101]
v_cndmask_b32_dpp v80, v38, v36, vcc quad_perm:[2,3,0,1] row_mask:0xf bank_mask:0xf
v_cndmask_b32_dpp v81, v39, v37, vcc quad_perm:[2,3,0,1] row_mask:0xf bank_mask:0xf
s_not_b64 vcc, vcc
v_cndmask_b32_dpp v82, v36, v38, vcc quad_perm:[2,3,0,1] row_mask:0xf bank_mask:0xf
v_cndmask_b32_dpp v83, v37, v39, vcc quad_perm:[2,3,0,1] row_mask:0xf bank_mask:0xf
s_waitcnt lgkmcnt(6)
s_nop 0
v_mfma_f32_16x16x32_bf16 v[132:135], v[100:103], v[80:83], v[132:135]
s_waitcnt lgkmcnt(4)
v_mfma_f32_16x16x32_bf16 v[136:139], v[104:107], v[80:83], v[136:139]
s_waitcnt lgkmcnt(2)
v_mfma_f32_16x16x32_bf16 v[140:143], v[108:111], v[80:83], v[140:143]
s_waitcnt lgkmcnt(0)
v_mfma_f32_16x16x32_bf16 v[144:147], v[112:115], v[80:83], v[144:147]
v_mfma_f32_16x16x32_bf16 v[148:151], v[116:119], v[64:67], v[148:151]
v_mfma_f32_16x16x32_bf16 v[152:155], v[120:123], v[64:67], v[152:155]
v_mfma_f32_16x16x32_bf16 v[156:159], v[124:127], v[64:67], v[156:159]
v_mfma_f32_16x16x32_bf16 v[160:163], v[128:131], v[64:67], v[160:163]
s_waitcnt vmcnt(3)
s_mov_b64 vcc, s[10:11]
v_cndmask_b32_dpp v36, v85, v84, vcc quad_perm:[1,0,3,2] row_mask:0xf bank_mask:0xf
v_cndmask_b32_dpp v38, v87, v86, vcc quad_perm:[1,0,3,2] row_mask:0xf bank_mask:0xf
s_not_b64 vcc, vcc
v_cndmask_b32_dpp v37, v84, v85, vcc quad_perm:[1,0,3,2] row_mask:0xf bank_mask:0xf
v_cndmask_b32_dpp v39, v86, v87, vcc quad_perm:[1,0,3,2] row_mask:0xf bank_mask:0xf
s_mov_b64 vcc, s[100:101]
v_cndmask_b32_dpp v84, v38, v36, vcc quad_perm:[2,3,0,1] row_mask:0xf bank_mask:0xf
v_cndmask_b32_dpp v85, v39, v37, vcc quad_perm:[2,3,0,1] row_mask:0xf bank_mask:0xf
s_not_b64 vcc, vcc
v_cndmask_b32_dpp v86, v36, v38, vcc quad_perm:[2,3,0,1] row_mask:0xf bank_mask:0xf
v_cndmask_b32_dpp v87, v37, v39, vcc quad_perm:[2,3,0,1] row_mask:0xf bank_mask:0xf
s_nop 1
v_mfma_f32_16x16x32_bf16 v[148:151], v[100:103], v[84:87], v[148:151]
v_mov_b32 v5, v34
ds_write_b128 v5, v[132:135] offset:0
v_mfma_f32_16x16x32_bf16 v[152:155], v[104:107], v[84:87], v[152:155]
v_xor_b32_e64 v6, 64, v34
ds_write_b128 v6, v[136:139] offset:0
v_mfma_f32_16x16x32_bf16 v[156:159], v[108:111], v[84:87], v[156:159]
v_xor_b32 v5, 128, v34
ds_write_b128 v5, v[140:143] offset:0
v_mfma_f32_16x16x32_bf16 v[160:163], v[112:115], v[84:87], v[160:163]
v_xor_b32 v6, 192, v34
ds_write_b128 v6, v[144:147] offset:0
v_mfma_f32_16x16x32_bf16 v[164:167], v[116:119], v[68:71], v[164:167]
v_mfma_f32_16x16x32_bf16 v[168:171], v[120:123], v[68:71], v[168:171]
v_mfma_f32_16x16x32_bf16 v[172:175], v[124:127], v[68:71], v[172:175]
v_mfma_f32_16x16x32_bf16 v[176:179], v[128:131], v[68:71], v[176:179]
s_waitcnt vmcnt(2)
s_mov_b64 vcc, s[10:11]
v_cndmask_b32_dpp v36, v89, v88, vcc quad_perm:[1,0,3,2] row_mask:0xf bank_mask:0xf
v_cndmask_b32_dpp v38, v91, v90, vcc quad_perm:[1,0,3,2] row_mask:0xf bank_mask:0xf
s_not_b64 vcc, vcc
v_cndmask_b32_dpp v37, v88, v89, vcc quad_perm:[1,0,3,2] row_mask:0xf bank_mask:0xf
v_cndmask_b32_dpp v39, v90, v91, vcc quad_perm:[1,0,3,2] row_mask:0xf bank_mask:0xf
s_mov_b64 vcc, s[100:101]
v_cndmask_b32_dpp v88, v38, v36, vcc quad_perm:[2,3,0,1] row_mask:0xf bank_mask:0xf
v_cndmask_b32_dpp v89, v39, v37, vcc quad_perm:[2,3,0,1] row_mask:0xf bank_mask:0xf
s_not_b64 vcc, vcc
v_cndmask_b32_dpp v90, v36, v38, vcc quad_perm:[2,3,0,1] row_mask:0xf bank_mask:0xf
v_cndmask_b32_dpp v91, v37, v39, vcc quad_perm:[2,3,0,1] row_mask:0xf bank_mask:0xf
s_nop 1
v_mfma_f32_16x16x32_bf16 v[164:167], v[100:103], v[88:91], v[164:167]
v_mov_b32_e64 v5, v34
ds_write_b128 v5, v[148:151] offset:4096
v_mfma_f32_16x16x32_bf16 v[168:171], v[104:107], v[88:91], v[168:171]
v_xor_b32_e64 v6, 64, v34
ds_write_b128 v6, v[152:155] offset:4096
v_mfma_f32_16x16x32_bf16 v[172:175], v[108:111], v[88:91], v[172:175]
v_xor_b32 v5, 128, v34
ds_write_b128 v5, v[156:159] offset:4096
v_mfma_f32_16x16x32_bf16 v[176:179], v[112:115], v[88:91], v[176:179]
v_xor_b32 v6, 192, v34
ds_write_b128 v6, v[160:163] offset:4096
v_mfma_f32_16x16x32_bf16 v[180:183], v[116:119], v[72:75], v[180:183]
v_mfma_f32_16x16x32_bf16 v[184:187], v[120:123], v[72:75], v[184:187]
v_mfma_f32_16x16x32_bf16 v[188:191], v[124:127], v[72:75], v[188:191]
v_mfma_f32_16x16x32_bf16 v[192:195], v[128:131], v[72:75], v[192:195]
s_waitcnt vmcnt(1)
s_mov_b64 vcc, s[10:11]
v_cndmask_b32_dpp v36, v93, v92, vcc quad_perm:[1,0,3,2] row_mask:0xf bank_mask:0xf
v_cndmask_b32_dpp v38, v95, v94, vcc quad_perm:[1,0,3,2] row_mask:0xf bank_mask:0xf
s_not_b64 vcc, vcc
v_cndmask_b32_dpp v37, v92, v93, vcc quad_perm:[1,0,3,2] row_mask:0xf bank_mask:0xf
v_cndmask_b32_dpp v39, v94, v95, vcc quad_perm:[1,0,3,2] row_mask:0xf bank_mask:0xf
s_mov_b64 vcc, s[100:101]
v_cndmask_b32_dpp v92, v38, v36, vcc quad_perm:[2,3,0,1] row_mask:0xf bank_mask:0xf
v_cndmask_b32_dpp v93, v39, v37, vcc quad_perm:[2,3,0,1] row_mask:0xf bank_mask:0xf
s_not_b64 vcc, vcc
v_cndmask_b32_dpp v94, v36, v38, vcc quad_perm:[2,3,0,1] row_mask:0xf bank_mask:0xf
v_cndmask_b32_dpp v95, v37, v39, vcc quad_perm:[2,3,0,1] row_mask:0xf bank_mask:0xf
s_nop 1
v_mfma_f32_16x16x32_bf16 v[180:183], v[100:103], v[92:95], v[180:183]
v_mov_b32_e64 v5, v34
ds_write_b128 v5, v[164:167] offset:8192
v_mfma_f32_16x16x32_bf16 v[184:187], v[104:107], v[92:95], v[184:187]
v_xor_b32_e64 v6, 64, v34
ds_write_b128 v6, v[168:171] offset:8192
v_mfma_f32_16x16x32_bf16 v[188:191], v[108:111], v[92:95], v[188:191]
v_xor_b32 v5, 128, v34
ds_write_b128 v5, v[172:175] offset:8192
v_mfma_f32_16x16x32_bf16 v[192:195], v[112:115], v[92:95], v[192:195]
v_xor_b32 v6, 192, v34
ds_write_b128 v6, v[176:179] offset:8192
v_mfma_f32_16x16x32_bf16 v[196:199], v[116:119], v[76:79], v[196:199]
v_mfma_f32_16x16x32_bf16 v[200:203], v[120:123], v[76:79], v[200:203]
v_mfma_f32_16x16x32_bf16 v[204:207], v[124:127], v[76:79], v[204:207]
v_mfma_f32_16x16x32_bf16 v[208:211], v[128:131], v[76:79], v[208:211]
s_waitcnt vmcnt(0)
s_mov_b64 vcc, s[10:11]
v_cndmask_b32_dpp v36, v97, v96, vcc quad_perm:[1,0,3,2] row_mask:0xf bank_mask:0xf
v_cndmask_b32_dpp v38, v99, v98, vcc quad_perm:[1,0,3,2] row_mask:0xf bank_mask:0xf
s_not_b64 vcc, vcc
v_cndmask_b32_dpp v37, v96, v97, vcc quad_perm:[1,0,3,2] row_mask:0xf bank_mask:0xf
v_cndmask_b32_dpp v39, v98, v99, vcc quad_perm:[1,0,3,2] row_mask:0xf bank_mask:0xf
s_mov_b64 vcc, s[100:101]
v_cndmask_b32_dpp v96, v38, v36, vcc quad_perm:[2,3,0,1] row_mask:0xf bank_mask:0xf
v_cndmask_b32_dpp v97, v39, v37, vcc quad_perm:[2,3,0,1] row_mask:0xf bank_mask:0xf
s_not_b64 vcc, vcc
v_cndmask_b32_dpp v98, v36, v38, vcc quad_perm:[2,3,0,1] row_mask:0xf bank_mask:0xf
v_cndmask_b32_dpp v99, v37, v39, vcc quad_perm:[2,3,0,1] row_mask:0xf bank_mask:0xf
s_nop 1
v_mfma_f32_16x16x32_bf16 v[196:199], v[100:103], v[96:99], v[196:199]
v_mov_b32_e64 v5, v34
ds_write_b128 v5, v[180:183] offset:12288
v_mfma_f32_16x16x32_bf16 v[200:203], v[104:107], v[96:99], v[200:203]
v_xor_b32_e64 v6, 64, v34
ds_write_b128 v6, v[184:187] offset:12288
v_mfma_f32_16x16x32_bf16 v[204:207], v[108:111], v[96:99], v[204:207]
v_xor_b32 v5, 128, v34
ds_write_b128 v5, v[188:191] offset:12288
v_mfma_f32_16x16x32_bf16 v[208:211], v[112:115], v[96:99], v[208:211]
v_xor_b32 v6, 192, v34
ds_write_b128 v6, v[192:195] offset:12288
v_mov_b32_e64 v5, v34
ds_write_b128 v5, v[196:199] offset:16384
v_xor_b32_e64 v6, 64, v34
ds_write_b128 v6, v[200:203] offset:16384
v_xor_b32 v5, 128, v34
ds_write_b128 v5, v[204:207] offset:16384
v_xor_b32 v6, 192, v34
ds_write_b128 v6, v[208:211] offset:16384
s_waitcnt lgkmcnt(0)
L_p3F:
L_pdP1_1:
s_cbranch_execz L_pdP1_2
s_load_dwordx2 s[12:13], s[0:1], 64
v_lshrrev_b32 v3, 3, v0
v_and_b32 v4, 7, v0
v_lshlrev_b32 v5, 1, v4
s_and_b32 s40, s3, 1
s_lshl_b32 s41, s40, 3
v_add_u32 v6, s41, v3
v_xor_b32 v5, v5, v6
v_lshlrev_b32 v5, 4, v5
v_lshl_add_u32 v5, v3, 8, v5
s_lshl_b32 s41, s3, 11
s_add_u32 s41, s41, 32768
v_add_u32 v1, s41, v5
v_xor_b32_e64 v7, 16, v1
v_add_u32 v40, 40960, v1
v_add_u32 v41, 40960, v7
v_mul_u32_u24 v3, 4608, v3
v_lshl_add_u32 v2, v4, 4, v3
s_mul_i32 s41, s16, 5
s_lshr_b32 s42, s3, 1
s_add_u32 s41, s41, s42
s_add_u32 s42, s41, 4
s_lshr_b32 s43, s41, 1
s_lshl_b32 s43, s43, 4
s_and_b32 s41, s41, 1
s_add_u32 s41, s41, s43
s_lshl_b32 s41, s41, 1
s_add_u32 s41, s41, s40
s_mul_i32 s41, s41, 1152
s_lshr_b32 s43, s42, 1
s_lshl_b32 s43, s43, 4
s_and_b32 s42, s42, 1
s_add_u32 s42, s42, s43
s_lshl_b32 s42, s42, 1
s_add_u32 s42, s42, s40
s_mul_i32 s42, s42, 1152
v_add_u32 v42, s42, v2
v_add_u32 v2, s41, v2
s_lshl_b32 s41, s17, 7
s_waitcnt lgkmcnt(0)
s_add_u32 s24, s12, s41
s_addc_u32 s25, s13, 0
s_sub_u32 s26, 2359296, s41
s_mov_b32 s27, 0x20000
s_barrier
ds_read_b128 v[8:11], v1 offset:0
ds_read_b128 v[12:15], v7 offset:0
ds_read_b128 v[16:19], v1 offset:20480
ds_read_b128 v[20:23], v7 offset:20480
ds_read_b128 v[24:27], v40 offset:0
ds_read_b128 v[28:31], v41 offset:0
ds_read_b128 v[32:35], v40 offset:20480
ds_read_b128 v[36:39], v41 offset:20480
s_waitcnt lgkmcnt(4)
v_pk_add_f32 v[8:9], v[8:9], v[16:17]
v_pk_add_f32 v[10:11], v[10:11], v[18:19]
v_pk_add_f32 v[12:13], v[12:13], v[20:21]
v_pk_add_f32 v[14:15], v[14:15], v[22:23]
s_waitcnt lgkmcnt(0)
s_nop 0
v_pk_add_f32 v[24:25], v[24:25], v[32:33]
v_pk_add_f32 v[26:27], v[26:27], v[34:35]
v_pk_add_f32 v[28:29], v[28:29], v[36:37]
v_pk_add_f32 v[30:31], v[30:31], v[38:39]
v_pk_add_f32 v[8:9], v[8:9], v[24:25]
v_pk_add_f32 v[10:11], v[10:11], v[26:27]
v_pk_add_f32 v[12:13], v[12:13], v[28:29]
v_pk_add_f32 v[14:15], v[14:15], v[30:31]
v_cvt_pk_bf16_f32 v44, v8, v9
v_cvt_pk_bf16_f32 v45, v10, v11
v_cvt_pk_bf16_f32 v46, v12, v13
v_cvt_pk_bf16_f32 v47, v14, v15
buffer_store_dwordx4 v[44:47], v2, s[24:27], 0 offen sc1
s_cmp_ge_u32 s3, 2
s_cbranch_scc1 L_fin
ds_read_b128 v[8:11], v1 offset:16384
ds_read_b128 v[12:15], v7 offset:16384
ds_read_b128 v[16:19], v1 offset:36864
ds_read_b128 v[20:23], v7 offset:36864
ds_read_b128 v[24:27], v40 offset:16384
ds_read_b128 v[28:31], v41 offset:16384
ds_read_b128 v[32:35], v40 offset:36864
ds_read_b128 v[36:39], v41 offset:36864
s_waitcnt lgkmcnt(4)
s_nop 0
v_pk_add_f32 v[8:9], v[8:9], v[16:17]
v_pk_add_f32 v[10:11], v[10:11], v[18:19]
v_pk_add_f32 v[12:13], v[12:13], v[20:21]
v_pk_add_f32 v[14:15], v[14:15], v[22:23]
s_waitcnt lgkmcnt(0)
s_nop 0
v_pk_add_f32 v[24:25], v[24:25], v[32:33]
v_pk_add_f32 v[26:27], v[26:27], v[34:35]
v_pk_add_f32 v[28:29], v[28:29], v[36:37]
v_pk_add_f32 v[30:31], v[30:31], v[38:39]
v_pk_add_f32 v[8:9], v[8:9], v[24:25]
v_pk_add_f32 v[10:11], v[10:11], v[26:27]
v_pk_add_f32 v[12:13], v[12:13], v[28:29]
v_pk_add_f32 v[14:15], v[14:15], v[30:31]
v_cvt_pk_bf16_f32 v44, v8, v9
v_cvt_pk_bf16_f32 v45, v10, v11
v_cvt_pk_bf16_f32 v46, v12, v13
v_cvt_pk_bf16_f32 v47, v14, v15
buffer_store_dwordx4 v[44:47], v42, s[24:27], 0 offen sc1
L_fin:
s_endpgm
L_g3b:
L_pdP2_1:
s_cbranch_execz L_pdP2_2
s_lshl_b32 s53, s56, 13
s_add_u32 s43, s53, 32768
s_add_u32 s42, s43, s4
buffer_load_dwordx4 v[40:43], v32, s[20:23], s42 offen sc1
s_add_u32 s42, s43, s5
buffer_load_dwordx4 v[44:47], v32, s[20:23], s42 offen sc1
s_add_u32 s42, s43, s6
buffer_load_dwordx4 v[48:51], v32, s[20:23], s42 offen sc1
s_add_u32 s42, s43, s7
buffer_load_dwordx4 v[52:55], v32, s[20:23], s42 offen sc1
s_add_u32 s42, s43, s8
buffer_load_dwordx4 v[56:59], v32, s[20:23], s42 offen sc1
s_add_u32 s53, s53, 8192
s_and_b32 s53, s53, 32767
s_add_u32 s43, s53, 32768
s_add_u32 s42, s43, s4
buffer_load_dwordx4 v[60:63], v32, s[20:23], s42 offen sc1
s_add_u32 s42, s43, s5
buffer_load_dwordx4 v[64:67], v32, s[20:23], s42 offen sc1
s_add_u32 s42, s43, s6
buffer_load_dwordx4 v[68:71], v32, s[20:23], s42 offen sc1
s_add_u32 s42, s43, s7
buffer_load_dwordx4 v[72:75], v32, s[20:23], s42 offen sc1
s_add_u32 s42, s43, s8
buffer_load_dwordx4 v[76:79], v32, s[20:23], s42 offen sc1
s_add_u32 s53, s53, 8192
s_and_b32 s53, s53, 32767
s_add_u32 s43, s53, 32768
s_add_u32 s42, s43, s4
buffer_load_dwordx4 v[80:83], v32, s[20:23], s42 offen sc1
s_add_u32 s42, s43, s5
buffer_load_dwordx4 v[84:87], v32, s[20:23], s42 offen sc1
s_add_u32 s42, s43, s6
buffer_load_dwordx4 v[88:91], v32, s[20:23], s42 offen sc1
s_add_u32 s42, s43, s7
buffer_load_dwordx4 v[92:95], v32, s[20:23], s42 offen sc1
s_add_u32 s42, s43, s8
buffer_load_dwordx4 v[96:99], v32, s[20:23], s42 offen sc1
s_add_u32 s53, s53, 8192
s_and_b32 s53, s53, 32767
s_lshl_b32 s54, s56, 1
s_add_u32 s54, s54, s63
s_lshl_b32 s55, s54, 13
s_add_u32 s55, s55, 47104
v_add_u32 v28, s55, v24
ds_read_b64_tr_b16 v[100:101], v28 offset:0
ds_read_b64_tr_b16 v[102:103], v28 offset:512
v_add_u32_e64 v29, s55, v25
ds_read_b64_tr_b16 v[104:105], v29 offset:0
ds_read_b64_tr_b16 v[106:107], v29 offset:512
v_add_u32_e64 v30, s55, v26
ds_read_b64_tr_b16 v[108:109], v30 offset:0
ds_read_b64_tr_b16 v[110:111], v30 offset:512
v_add_u32_e64 v31, s55, v27
ds_read_b64_tr_b16 v[112:113], v31 offset:0
ds_read_b64_tr_b16 v[114:115], v31 offset:512
s_waitcnt vmcnt(14)
s_waitcnt lgkmcnt(6)
v_mfma_f32_16x16x32_bf16 v[132:135], v[100:103], v[40:43], 0
s_waitcnt lgkmcnt(4)
v_mfma_f32_16x16x32_bf16 v[136:139], v[104:107], v[40:43], 0
s_waitcnt lgkmcnt(2)
v_mfma_f32_16x16x32_bf16 v[140:143], v[108:111], v[40:43], 0
s_waitcnt lgkmcnt(0)
v_mfma_f32_16x16x32_bf16 v[144:147], v[112:115], v[40:43], 0
s_waitcnt vmcnt(13)
v_mfma_f32_16x16x32_bf16 v[148:151], v[100:103], v[44:47], 0
s_add_u32 s54, s54, 2
s_and_b32 s54, s54, 7
s_lshl_b32 s55, s54, 13
s_add_u32 s55, s55, 47104
v_add_u32 v28, s55, v24
ds_read_b64_tr_b16 v[116:117], v28 offset:0
ds_read_b64_tr_b16 v[118:119], v28 offset:512
v_mfma_f32_16x16x32_bf16 v[152:155], v[104:107], v[44:47], 0
v_add_u32_e64 v29, s55, v25
ds_read_b64_tr_b16 v[120:121], v29 offset:0
ds_read_b64_tr_b16 v[122:123], v29 offset:512
v_mfma_f32_16x16x32_bf16 v[156:159], v[108:111], v[44:47], 0
v_add_u32_e64 v30, s55, v26
ds_read_b64_tr_b16 v[124:125], v30 offset:0
ds_read_b64_tr_b16 v[126:127], v30 offset:512
v_mfma_f32_16x16x32_bf16 v[160:163], v[112:115], v[44:47], 0
v_add_u32_e64 v31, s55, v27
ds_read_b64_tr_b16 v[128:129], v31 offset:0
ds_read_b64_tr_b16 v[130:131], v31 offset:512
s_waitcnt vmcnt(12)
v_mfma_f32_16x16x32_bf16 v[164:167], v[100:103], v[48:51], 0
v_mfma_f32_16x16x32_bf16 v[168:171], v[104:107], v[48:51], 0
v_mfma_f32_16x16x32_bf16 v[172:175], v[108:111], v[48:51], 0
v_mfma_f32_16x16x32_bf16 v[176:179], v[112:115], v[48:51], 0
s_waitcnt vmcnt(11)
v_mfma_f32_16x16x32_bf16 v[180:183], v[100:103], v[52:55], 0
v_mfma_f32_16x16x32_bf16 v[184:187], v[104:107], v[52:55], 0
v_mfma_f32_16x16x32_bf16 v[188:191], v[108:111], v[52:55], 0
v_mfma_f32_16x16x32_bf16 v[192:195], v[112:115], v[52:55], 0
s_waitcnt vmcnt(10)
v_mfma_f32_16x16x32_bf16 v[196:199], v[100:103], v[56:59], 0
v_mfma_f32_16x16x32_bf16 v[200:203], v[104:107], v[56:59], 0
v_mfma_f32_16x16x32_bf16 v[204:207], v[108:111], v[56:59], 0
v_mfma_f32_16x16x32_bf16 v[208:211], v[112:115], v[56:59], 0
s_add_u32 s43, s53, 32768
s_add_u32 s42, s43, s4
buffer_load_dwordx4 v[40:43], v32, s[20:23], s42 offen sc1
s_add_u32 s42, s43, s5
buffer_load_dwordx4 v[44:47], v32, s[20:23], s42 offen sc1
s_add_u32 s42, s43, s6
buffer_load_dwordx4 v[48:51], v32, s[20:23], s42 offen sc1
s_add_u32 s42, s43, s7
buffer_load_dwordx4 v[52:55], v32, s[20:23], s42 offen sc1
s_add_u32 s42, s43, s8
buffer_load_dwordx4 v[56:59], v32, s[20:23], s42 offen sc1
s_add_u32 s53, s53, 8192
s_and_b32 s53, s53, 32767
s_waitcnt vmcnt(14)
s_waitcnt lgkmcnt(6)
v_mfma_f32_16x16x32_bf16 v[132:135], v[116:119], v[60:63], v[132:135]
s_waitcnt lgkmcnt(4)
v_mfma_f32_16x16x32_bf16 v[136:139], v[120:123], v[60:63], v[136:139]
s_waitcnt lgkmcnt(2)
v_mfma_f32_16x16x32_bf16 v[140:143], v[124:127], v[60:63], v[140:143]
s_waitcnt lgkmcnt(0)
v_mfma_f32_16x16x32_bf16 v[144:147], v[128:131], v[60:63], v[144:147]
s_waitcnt vmcnt(13)
v_mfma_f32_16x16x32_bf16 v[148:151], v[116:119], v[64:67], v[148:151]
s_add_u32 s54, s54, 2
s_and_b32 s54, s54, 7
s_lshl_b32 s55, s54, 13
s_add_u32 s55, s55, 47104
v_add_u32 v28, s55, v24
ds_read_b64_tr_b16 v[100:101], v28 offset:0
ds_read_b64_tr_b16 v[102:103], v28 offset:512
v_mfma_f32_16x16x32_bf16 v[152:155], v[120:123], v[64:67], v[152:155]
v_add_u32_e64 v29, s55, v25
ds_read_b64_tr_b16 v[104:105], v29 offset:0
ds_read_b64_tr_b16 v[106:107], v29 offset:512
v_mfma_f32_16x16x32_bf16 v[156:159], v[124:127], v[64:67], v[156:159]
v_add_u32_e64 v30, s55, v26
ds_read_b64_tr_b16 v[108:109], v30 offset:0
ds_read_b64_tr_b16 v[110:111], v30 offset:512
v_mfma_f32_16x16x32_bf16 v[160:163], v[128:131], v[64:67], v[160:163]
v_add_u32_e64 v31, s55, v27
ds_read_b64_tr_b16 v[112:113], v31 offset:0
ds_read_b64_tr_b16 v[114:115], v31 offset:512
s_waitcnt vmcnt(12)
v_mfma_f32_16x16x32_bf16 v[164:167], v[116:119], v[68:71], v[164:167]
v_mfma_f32_16x16x32_bf16 v[168:171], v[120:123], v[68:71], v[168:171]
v_mfma_f32_16x16x32_bf16 v[172:175], v[124:127], v[68:71], v[172:175]
v_mfma_f32_16x16x32_bf16 v[176:179], v[128:131], v[68:71], v[176:179]
s_waitcnt vmcnt(11)
v_mfma_f32_16x16x32_bf16 v[180:183], v[116:119], v[72:75], v[180:183]
v_mfma_f32_16x16x32_bf16 v[184:187], v[120:123], v[72:75], v[184:187]
v_mfma_f32_16x16x32_bf16 v[188:191], v[124:127], v[72:75], v[188:191]
v_mfma_f32_16x16x32_bf16 v[192:195], v[128:131], v[72:75], v[192:195]
s_waitcnt vmcnt(10)
v_mfma_f32_16x16x32_bf16 v[196:199], v[116:119], v[76:79], v[196:199]
v_mfma_f32_16x16x32_bf16 v[200:203], v[120:123], v[76:79], v[200:203]
v_mfma_f32_16x16x32_bf16 v[204:207], v[124:127], v[76:79], v[204:207]
v_mfma_f32_16x16x32_bf16 v[208:211], v[128:131], v[76:79], v[208:211]
s_add_u32 s42, s28, 4096
buffer_load_dwordx4 v[60:63], v33, s[36:39], s42 offen sc1
s_add_u32 s42, s29, 4096
buffer_load_dwordx4 v[64:67], v33, s[36:39], s42 offen sc1
s_add_u32 s42, s30, 4096
buffer_load_dwordx4 v[68:71], v33, s[36:39], s42 offen sc1
s_add_u32 s42, s31, 4096
buffer_load_dwordx4 v[72:75], v33, s[36:39], s42 offen sc1
s_add_u32 s42, s32, 4096
buffer_load_dwordx4 v[76:79], v33, s[36:39], s42 offen sc1
s_waitcnt vmcnt(14)
s_waitcnt lgkmcnt(6)
v_mfma_f32_16x16x32_bf16 v[132:135], v[100:103], v[80:83], v[132:135]
s_waitcnt lgkmcnt(4)
v_mfma_f32_16x16x32_bf16 v[136:139], v[104:107], v[80:83], v[136:139]
s_waitcnt lgkmcnt(2)
v_mfma_f32_16x16x32_bf16 v[140:143], v[108:111], v[80:83], v[140:143]
s_waitcnt lgkmcnt(0)
v_mfma_f32_16x16x32_bf16 v[144:147], v[112:115], v[80:83], v[144:147]
s_waitcnt vmcnt(13)
v_mfma_f32_16x16x32_bf16 v[148:151], v[100:103], v[84:87], v[148:151]
s_add_u32 s54, s54, 2
s_and_b32 s54, s54, 7
s_lshl_b32 s55, s54, 13
s_add_u32 s55, s55, 47104
v_add_u32_e64 v28, s55, v24
ds_read_b64_tr_b16 v[116:117], v28 offset:0
ds_read_b64_tr_b16 v[118:119], v28 offset:512
v_mfma_f32_16x16x32_bf16 v[152:155], v[104:107], v[84:87], v[152:155]
v_add_u32_e64 v29, s55, v25
ds_read_b64_tr_b16 v[120:121], v29 offset:0
ds_read_b64_tr_b16 v[122:123], v29 offset:512
v_mfma_f32_16x16x32_bf16 v[156:159], v[108:111], v[84:87], v[156:159]
v_add_u32_e64 v30, s55, v26
ds_read_b64_tr_b16 v[124:125], v30 offset:0
ds_read_b64_tr_b16 v[126:127], v30 offset:512
v_mfma_f32_16x16x32_bf16 v[160:163], v[112:115], v[84:87], v[160:163]
v_add_u32_e64 v31, s55, v27
ds_read_b64_tr_b16 v[128:129], v31 offset:0
ds_read_b64_tr_b16 v[130:131], v31 offset:512
s_waitcnt vmcnt(12)
v_mfma_f32_16x16x32_bf16 v[164:167], v[100:103], v[88:91], v[164:167]
v_mfma_f32_16x16x32_bf16 v[168:171], v[104:107], v[88:91], v[168:171]
v_mfma_f32_16x16x32_bf16 v[172:175], v[108:111], v[88:91], v[172:175]
v_mfma_f32_16x16x32_bf16 v[176:179], v[112:115], v[88:91], v[176:179]
s_waitcnt vmcnt(11)
v_mfma_f32_16x16x32_bf16 v[180:183], v[100:103], v[92:95], v[180:183]
v_mfma_f32_16x16x32_bf16 v[184:187], v[104:107], v[92:95], v[184:187]
v_mfma_f32_16x16x32_bf16 v[188:191], v[108:111], v[92:95], v[188:191]
v_mfma_f32_16x16x32_bf16 v[192:195], v[112:115], v[92:95], v[192:195]
s_waitcnt vmcnt(10)
v_mfma_f32_16x16x32_bf16 v[196:199], v[100:103], v[96:99], v[196:199]
v_mfma_f32_16x16x32_bf16 v[200:203], v[104:107], v[96:99], v[200:203]
v_mfma_f32_16x16x32_bf16 v[204:207], v[108:111], v[96:99], v[204:207]
v_mfma_f32_16x16x32_bf16 v[208:211], v[112:115], v[96:99], v[208:211]
s_waitcnt vmcnt(9)
s_waitcnt lgkmcnt(6)
v_mfma_f32_16x16x32_bf16 v[132:135], v[116:119], v[40:43], v[132:135]
s_barrier
s_lshl_b32 s53, s56, 13
s_add_u32 s43, s53, 0
s_add_u32 s42, s43, s4
buffer_load_dwordx4 v[80:83], v32, s[20:23], s42 offen sc1
s_add_u32 s42, s43, s5
buffer_load_dwordx4 v[84:87], v32, s[20:23], s42 offen sc1
s_add_u32 s42, s43, s6
buffer_load_dwordx4 v[88:91], v32, s[20:23], s42 offen sc1
s_add_u32 s42, s43, s7
buffer_load_dwordx4 v[92:95], v32, s[20:23], s42 offen sc1
s_add_u32 s42, s43, s8
buffer_load_dwordx4 v[96:99], v32, s[20:23], s42 offen sc1
s_add_u32 s53, s53, 8192
s_and_b32 s53, s53, 32767
s_waitcnt lgkmcnt(4)
v_mfma_f32_16x16x32_bf16 v[136:139], v[120:123], v[40:43], v[136:139]
s_waitcnt lgkmcnt(2)
v_mfma_f32_16x16x32_bf16 v[140:143], v[124:127], v[40:43], v[140:143]
s_waitcnt lgkmcnt(0)
v_mfma_f32_16x16x32_bf16 v[144:147], v[128:131], v[40:43], v[144:147]
s_waitcnt vmcnt(13)
v_mfma_f32_16x16x32_bf16 v[148:151], v[116:119], v[44:47], v[148:151]
s_mov_b32 s55, 112640
v_add_u32 v28, s55, v24
ds_read_b64_tr_b16 v[100:101], v28 offset:0
ds_read_b64_tr_b16 v[102:103], v28 offset:512
v_mfma_f32_16x16x32_bf16 v[152:155], v[120:123], v[44:47], v[152:155]
v_add_u32_e64 v29, s55, v25
ds_read_b64_tr_b16 v[104:105], v29 offset:0
ds_read_b64_tr_b16 v[106:107], v29 offset:512
v_mfma_f32_16x16x32_bf16 v[156:159], v[124:127], v[44:47], v[156:159]
v_add_u32_e64 v30, s55, v26
ds_read_b64_tr_b16 v[108:109], v30 offset:0
ds_read_b64_tr_b16 v[110:111], v30 offset:512
v_mfma_f32_16x16x32_bf16 v[160:163], v[128:131], v[44:47], v[160:163]
v_add_u32_e64 v31, s55, v27
ds_read_b64_tr_b16 v[112:113], v31 offset:0
ds_read_b64_tr_b16 v[114:115], v31 offset:512
s_waitcnt vmcnt(12)
v_mfma_f32_16x16x32_bf16 v[164:167], v[116:119], v[48:51], v[164:167]
v_mfma_f32_16x16x32_bf16 v[168:171], v[120:123], v[48:51], v[168:171]
v_mfma_f32_16x16x32_bf16 v[172:175], v[124:127], v[48:51], v[172:175]
v_mfma_f32_16x16x32_bf16 v[176:179], v[128:131], v[48:51], v[176:179]
s_waitcnt vmcnt(11)
v_mfma_f32_16x16x32_bf16 v[180:183], v[116:119], v[52:55], v[180:183]
v_mfma_f32_16x16x32_bf16 v[184:187], v[120:123], v[52:55], v[184:187]
v_mfma_f32_16x16x32_bf16 v[188:191], v[124:127], v[52:55], v[188:191]
v_mfma_f32_16x16x32_bf16 v[192:195], v[128:131], v[52:55], v[192:195]
s_waitcnt vmcnt(10)
v_mfma_f32_16x16x32_bf16 v[196:199], v[116:119], v[56:59], v[196:199]
v_mfma_f32_16x16x32_bf16 v[200:203], v[120:123], v[56:59], v[200:203]
v_mfma_f32_16x16x32_bf16 v[204:207], v[124:127], v[56:59], v[204:207]
v_mfma_f32_16x16x32_bf16 v[208:211], v[128:131], v[56:59], v[208:211]
s_add_u32 s43, s53, 0
s_add_u32 s42, s43, s4
buffer_load_dwordx4 v[40:43], v32, s[20:23], s42 offen sc1
s_add_u32 s42, s43, s5
buffer_load_dwordx4 v[44:47], v32, s[20:23], s42 offen sc1
s_add_u32 s42, s43, s6
buffer_load_dwordx4 v[48:51], v32, s[20:23], s42 offen sc1
s_add_u32 s42, s43, s7
buffer_load_dwordx4 v[52:55], v32, s[20:23], s42 offen sc1
s_add_u32 s42, s43, s8
buffer_load_dwordx4 v[56:59], v32, s[20:23], s42 offen sc1
s_add_u32 s53, s53, 8192
s_and_b32 s53, s53, 32767
s_waitcnt vmcnt(14)
s_mov_b64 vcc, s[10:11]
v_cndmask_b32_dpp v36, v61, v60, vcc quad_perm:[1,0,3,2] row_mask:0xf bank_mask:0xf
v_cndmask_b32_dpp v38, v63, v62, vcc quad_perm:[1,0,3,2] row_mask:0xf bank_mask:0xf
s_not_b64 vcc, vcc
v_cndmask_b32_dpp v37, v60, v61, vcc quad_perm:[1,0,3,2] row_mask:0xf bank_mask:0xf
v_cndmask_b32_dpp v39, v62, v63, vcc quad_perm:[1,0,3,2] row_mask:0xf bank_mask:0xf
s_mov_b64 vcc, s[100:101]
v_cndmask_b32_dpp v60, v38, v36, vcc quad_perm:[2,3,0,1] row_mask:0xf bank_mask:0xf
v_cndmask_b32_dpp v61, v39, v37, vcc quad_perm:[2,3,0,1] row_mask:0xf bank_mask:0xf
s_not_b64 vcc, vcc
v_cndmask_b32_dpp v62, v36, v38, vcc quad_perm:[2,3,0,1] row_mask:0xf bank_mask:0xf
v_cndmask_b32_dpp v63, v37, v39, vcc quad_perm:[2,3,0,1] row_mask:0xf bank_mask:0xf
s_waitcnt lgkmcnt(6)
s_nop 0
v_mfma_f32_16x16x32_bf16 v[132:135], v[100:103], v[60:63], v[132:135]
s_waitcnt lgkmcnt(4)
v_mfma_f32_16x16x32_bf16 v[136:139], v[104:107], v[60:63], v[136:139]
s_waitcnt lgkmcnt(2)
v_mfma_f32_16x16x32_bf16 v[140:143], v[108:111], v[60:63], v[140:143]
s_waitcnt lgkmcnt(0)
v_mfma_f32_16x16x32_bf16 v[144:147], v[112:115], v[60:63], v[144:147]
s_waitcnt vmcnt(13)
s_mov_b64 vcc, s[10:11]
v_cndmask_b32_dpp v36, v65, v64, vcc quad_perm:[1,0,3,2] row_mask:0xf bank_mask:0xf
v_cndmask_b32_dpp v38, v67, v66, vcc quad_perm:[1,0,3,2] row_mask:0xf bank_mask:0xf
s_not_b64 vcc, vcc
v_cndmask_b32_dpp v37, v64, v65, vcc quad_perm:[1,0,3,2] row_mask:0xf bank_mask:0xf
v_cndmask_b32_dpp v39, v66, v67, vcc quad_perm:[1,0,3,2] row_mask:0xf bank_mask:0xf
s_mov_b64 vcc, s[100:101]
v_cndmask_b32_dpp v64, v38, v36, vcc quad_perm:[2,3,0,1] row_mask:0xf bank_mask:0xf
L_pdP3_1:
s_cbranch_execz L_pdP3_2
v_cndmask_b32_dpp v65, v39, v37, vcc quad_perm:[2,3,0,1] row_mask:0xf bank_mask:0xf
s_not_b64 vcc, vcc
v_cndmask_b32_dpp v66, v36, v38, vcc quad_perm:[2,3,0,1] row_mask:0xf bank_mask:0xf
v_cndmask_b32_dpp v67, v37, v39, vcc quad_perm:[2,3,0,1] row_mask:0xf bank_mask:0xf
s_nop 1
v_mfma_f32_16x16x32_bf16 v[148:151], v[100:103], v[64:67], v[148:151]
s_lshl_b32 s54, s56, 1
s_add_u32 s54, s54, s63
s_lshl_b32 s55, s54, 13
s_cmp_lt_u32 s54, 5
s_cselect_b32 s42, s57, s59
s_add_u32 s55, s55, s42
v_add_u32_e64 v28, s55, v24
ds_read_b64_tr_b16 v[116:117], v28 offset:0
ds_read_b64_tr_b16 v[118:119], v28 offset:512
v_mfma_f32_16x16x32_bf16 v[152:155], v[104:107], v[64:67], v[152:155]
v_add_u32_e64 v29, s55, v25
ds_read_b64_tr_b16 v[120:121], v29 offset:0
ds_read_b64_tr_b16 v[122:123], v29 offset:512
v_mfma_f32_16x16x32_bf16 v[156:159], v[108:111], v[64:67], v[156:159]
v_add_u32_e64 v30, s55, v26
ds_read_b64_tr_b16 v[124:125], v30 offset:0
ds_read_b64_tr_b16 v[126:127], v30 offset:512
v_mfma_f32_16x16x32_bf16 v[160:163], v[112:115], v[64:67], v[160:163]
v_add_u32_e64 v31, s55, v27
ds_read_b64_tr_b16 v[128:129], v31 offset:0
ds_read_b64_tr_b16 v[130:131], v31 offset:512
s_waitcnt vmcnt(12)
s_mov_b64 vcc, s[10:11]
v_cndmask_b32_dpp v36, v69, v68, vcc quad_perm:[1,0,3,2] row_mask:0xf bank_mask:0xf
v_cndmask_b32_dpp v38, v71, v70, vcc quad_perm:[1,0,3,2] row_mask:0xf bank_mask:0xf
s_not_b64 vcc, vcc
v_cndmask_b32_dpp v37, v68, v69, vcc quad_perm:[1,0,3,2] row_mask:0xf bank_mask:0xf
v_cndmask_b32_dpp v39, v70, v71, vcc quad_perm:[1,0,3,2] row_mask:0xf bank_mask:0xf
s_mov_b64 vcc, s[100:101]
v_cndmask_b32_dpp v68, v38, v36, vcc quad_perm:[2,3,0,1] row_mask:0xf bank_mask:0xf
v_cndmask_b32_dpp v69, v39, v37, vcc quad_perm:[2,3,0,1] row_mask:0xf bank_mask:0xf
s_not_b64 vcc, vcc
v_cndmask_b32_dpp v70, v36, v38, vcc quad_perm:[2,3,0,1] row_mask:0xf bank_mask:0xf
v_cndmask_b32_dpp v71, v37, v39, vcc quad_perm:[2,3,0,1] row_mask:0xf bank_mask:0xf
s_nop 1
v_mfma_f32_16x16x32_bf16 v[164:167], v[100:103], v[68:71], v[164:167]
v_mfma_f32_16x16x32_bf16 v[168:171], v[104:107], v[68:71], v[168:171]
v_mfma_f32_16x16x32_bf16 v[172:175], v[108:111], v[68:71], v[172:175]
v_mfma_f32_16x16x32_bf16 v[176:179], v[112:115], v[68:71], v[176:179]
s_waitcnt vmcnt(11)
s_mov_b64 vcc, s[10:11]
v_cndmask_b32_dpp v36, v73, v72, vcc quad_perm:[1,0,3,2] row_mask:0xf bank_mask:0xf
v_cndmask_b32_dpp v38, v75, v74, vcc quad_perm:[1,0,3,2] row_mask:0xf bank_mask:0xf
s_not_b64 vcc, vcc
v_cndmask_b32_dpp v37, v72, v73, vcc quad_perm:[1,0,3,2] row_mask:0xf bank_mask:0xf
v_cndmask_b32_dpp v39, v74, v75, vcc quad_perm:[1,0,3,2] row_mask:0xf bank_mask:0xf
s_mov_b64 vcc, s[100:101]
v_cndmask_b32_dpp v72, v38, v36, vcc quad_perm:[2,3,0,1] row_mask:0xf bank_mask:0xf
v_cndmask_b32_dpp v73, v39, v37, vcc quad_perm:[2,3,0,1] row_mask:0xf bank_mask:0xf
s_not_b64 vcc, vcc
v_cndmask_b32_dpp v74, v36, v38, vcc quad_perm:[2,3,0,1] row_mask:0xf bank_mask:0xf
v_cndmask_b32_dpp v75, v37, v39, vcc quad_perm:[2,3,0,1] row_mask:0xf bank_mask:0xf
s_nop 1
v_mfma_f32_16x16x32_bf16 v[180:183], v[100:103], v[72:75], v[180:183]
v_mfma_f32_16x16x32_bf16 v[184:187], v[104:107], v[72:75], v[184:187]
v_mfma_f32_16x16x32_bf16 v[188:191], v[108:111], v[72:75], v[188:191]
v_mfma_f32_16x16x32_bf16 v[192:195], v[112:115], v[72:75], v[192:195]
s_waitcnt vmcnt(10)
s_mov_b64 vcc, s[10:11]
v_cndmask_b32_dpp v36, v77, v76, vcc quad_perm:[1,0,3,2] row_mask:0xf bank_mask:0xf
v_cndmask_b32_dpp v38, v79, v78, vcc quad_perm:[1,0,3,2] row_mask:0xf bank_mask:0xf
s_not_b64 vcc, vcc
v_cndmask_b32_dpp v37, v76, v77, vcc quad_perm:[1,0,3,2] row_mask:0xf bank_mask:0xf
v_cndmask_b32_dpp v39, v78, v79, vcc quad_perm:[1,0,3,2] row_mask:0xf bank_mask:0xf
s_mov_b64 vcc, s[100:101]
v_cndmask_b32_dpp v76, v38, v36, vcc quad_perm:[2,3,0,1] row_mask:0xf bank_mask:0xf
v_cndmask_b32_dpp v77, v39, v37, vcc quad_perm:[2,3,0,1] row_mask:0xf bank_mask:0xf
s_not_b64 vcc, vcc
v_cndmask_b32_dpp v78, v36, v38, vcc quad_perm:[2,3,0,1] row_mask:0xf bank_mask:0xf
v_cndmask_b32_dpp v79, v37, v39, vcc quad_perm:[2,3,0,1] row_mask:0xf bank_mask:0xf
s_nop 1
v_mfma_f32_16x16x32_bf16 v[196:199], v[100:103], v[76:79], v[196:199]
v_mfma_f32_16x16x32_bf16 v[200:203], v[104:107], v[76:79], v[200:203]
v_mfma_f32_16x16x32_bf16 v[204:207], v[108:111], v[76:79], v[204:207]
v_mfma_f32_16x16x32_bf16 v[208:211], v[112:115], v[76:79], v[208:211]
s_add_u32 s43, s53, 0
s_add_u32 s42, s43, s4
buffer_load_dwordx4 v[60:63], v32, s[20:23], s42 offen sc1
s_add_u32 s42, s43, s5
buffer_load_dwordx4 v[64:67], v32, s[20:23], s42 offen sc1
s_add_u32 s42, s43, s6
buffer_load_dwordx4 v[68:71], v32, s[20:23], s42 offen sc1
s_add_u32 s42, s43, s7
buffer_load_dwordx4 v[72:75], v32, s[20:23], s42 offen sc1
s_add_u32 s42, s43, s8
buffer_load_dwordx4 v[76:79], v32, s[20:23], s42 offen sc1
s_add_u32 s53, s53, 8192
s_and_b32 s53, s53, 32767
s_barrier
s_waitcnt vmcnt(14)
s_waitcnt lgkmcnt(6)
v_mfma_f32_16x16x32_bf16 v[132:135], v[116:119], v[80:83], v[132:135]
s_waitcnt lgkmcnt(4)
v_mfma_f32_16x16x32_bf16 v[136:139], v[120:123], v[80:83], v[136:139]
s_waitcnt lgkmcnt(2)
v_mfma_f32_16x16x32_bf16 v[140:143], v[124:127], v[80:83], v[140:143]
s_waitcnt lgkmcnt(0)
v_mfma_f32_16x16x32_bf16 v[144:147], v[128:131], v[80:83], v[144:147]
s_waitcnt vmcnt(13)
v_mfma_f32_16x16x32_bf16 v[148:151], v[116:119], v[84:87], v[148:151]
s_add_u32 s54, s54, 2
s_and_b32 s54, s54, 7
s_lshl_b32 s55, s54, 13
s_cmp_lt_u32 s54, 5
s_cselect_b32 s42, s57, s59
s_add_u32 s55, s55, s42
v_add_u32 v28, s55, v24
ds_read_b64_tr_b16 v[100:101], v28 offset:0
ds_read_b64_tr_b16 v[102:103], v28 offset:512
v_mfma_f32_16x16x32_bf16 v[152:155], v[120:123], v[84:87], v[152:155]
v_add_u32_e64 v29, s55, v25
ds_read_b64_tr_b16 v[104:105], v29 offset:0
ds_read_b64_tr_b16 v[106:107], v29 offset:512
v_mfma_f32_16x16x32_bf16 v[156:159], v[124:127], v[84:87], v[156:159]
v_add_u32_e64 v30, s55, v26
ds_read_b64_tr_b16 v[108:109], v30 offset:0
ds_read_b64_tr_b16 v[110:111], v30 offset:512
v_mfma_f32_16x16x32_bf16 v[160:163], v[128:131], v[84:87], v[160:163]
v_add_u32_e64 v31, s55, v27
ds_read_b64_tr_b16 v[112:113], v31 offset:0
ds_read_b64_tr_b16 v[114:115], v31 offset:512
s_waitcnt vmcnt(12)
v_mfma_f32_16x16x32_bf16 v[164:167], v[116:119], v[88:91], v[164:167]
v_mfma_f32_16x16x32_bf16 v[168:171], v[120:123], v[88:91], v[168:171]
v_mfma_f32_16x16x32_bf16 v[172:175], v[124:127], v[88:91], v[172:175]
v_mfma_f32_16x16x32_bf16 v[176:179], v[128:131], v[88:91], v[176:179]
s_waitcnt vmcnt(11)
v_mfma_f32_16x16x32_bf16 v[180:183], v[116:119], v[92:95], v[180:183]
v_mfma_f32_16x16x32_bf16 v[184:187], v[120:123], v[92:95], v[184:187]
v_mfma_f32_16x16x32_bf16 v[188:191], v[124:127], v[92:95], v[188:191]
v_mfma_f32_16x16x32_bf16 v[192:195], v[128:131], v[92:95], v[192:195]
s_waitcnt vmcnt(10)
v_mfma_f32_16x16x32_bf16 v[196:199], v[116:119], v[96:99], v[196:199]
v_mfma_f32_16x16x32_bf16 v[200:203], v[120:123], v[96:99], v[200:203]
v_mfma_f32_16x16x32_bf16 v[204:207], v[124:127], v[96:99], v[204:207]
v_mfma_f32_16x16x32_bf16 v[208:211], v[128:131], v[96:99], v[208:211]
s_add_u32 s43, s53, 0
s_add_u32 s42, s43, s4
buffer_load_dwordx4 v[80:83], v32, s[20:23], s42 offen sc1
s_add_u32 s42, s43, s5
buffer_load_dwordx4 v[84:87], v32, s[20:23], s42 offen sc1
s_add_u32 s42, s43, s6
buffer_load_dwordx4 v[88:91], v32, s[20:23], s42 offen sc1
s_add_u32 s42, s43, s7
buffer_load_dwordx4 v[92:95], v32, s[20:23], s42 offen sc1
s_add_u32 s42, s43, s8
buffer_load_dwordx4 v[96:99], v32, s[20:23], s42 offen sc1
s_add_u32 s53, s53, 8192
s_and_b32 s53, s53, 32767
s_waitcnt vmcnt(14)
s_waitcnt lgkmcnt(6)
v_mfma_f32_16x16x32_bf16 v[132:135], v[100:103], v[40:43], v[132:135]
s_waitcnt lgkmcnt(4)
v_mfma_f32_16x16x32_bf16 v[136:139], v[104:107], v[40:43], v[136:139]
s_waitcnt lgkmcnt(2)
v_mfma_f32_16x16x32_bf16 v[140:143], v[108:111], v[40:43], v[140:143]
s_waitcnt lgkmcnt(0)
v_mfma_f32_16x16x32_bf16 v[144:147], v[112:115], v[40:43], v[144:147]
s_waitcnt vmcnt(13)
v_mfma_f32_16x16x32_bf16 v[148:151], v[100:103], v[44:47], v[148:151]
s_add_u32 s54, s54, 2
s_and_b32 s54, s54, 7
s_lshl_b32 s55, s54, 13
s_cmp_lt_u32 s54, 5
s_cselect_b32 s42, s57, s59
s_add_u32 s55, s55, s42
v_add_u32 v28, s55, v24
ds_read_b64_tr_b16 v[116:117], v28 offset:0
ds_read_b64_tr_b16 v[118:119], v28 offset:512
v_mfma_f32_16x16x32_bf16 v[152:155], v[104:107], v[44:47], v[152:155]
v_add_u32_e64 v29, s55, v25
ds_read_b64_tr_b16 v[120:121], v29 offset:0
ds_read_b64_tr_b16 v[122:123], v29 offset:512
v_mfma_f32_16x16x32_bf16 v[156:159], v[108:111], v[44:47], v[156:159]
v_add_u32_e64 v30, s55, v26
ds_read_b64_tr_b16 v[124:125], v30 offset:0
ds_read_b64_tr_b16 v[126:127], v30 offset:512
v_mfma_f32_16x16x32_bf16 v[160:163], v[112:115], v[44:47], v[160:163]
v_add_u32_e64 v31, s55, v27
ds_read_b64_tr_b16 v[128:129], v31 offset:0
ds_read_b64_tr_b16 v[130:131], v31 offset:512
s_waitcnt vmcnt(12)
v_mfma_f32_16x16x32_bf16 v[164:167], v[100:103], v[48:51], v[164:167]
v_mfma_f32_16x16x32_bf16 v[168:171], v[104:107], v[48:51], v[168:171]
v_mfma_f32_16x16x32_bf16 v[172:175], v[108:111], v[48:51], v[172:175]
v_mfma_f32_16x16x32_bf16 v[176:179], v[112:115], v[48:51], v[176:179]
s_waitcnt vmcnt(11)
v_mfma_f32_16x16x32_bf16 v[180:183], v[100:103], v[52:55], v[180:183]
v_mfma_f32_16x16x32_bf16 v[184:187], v[104:107], v[52:55], v[184:187]
v_mfma_f32_16x16x32_bf16 v[188:191], v[108:111], v[52:55], v[188:191]
v_mfma_f32_16x16x32_bf16 v[192:195], v[112:115], v[52:55], v[192:195]
s_waitcnt vmcnt(10)
v_mfma_f32_16x16x32_bf16 v[196:199], v[100:103], v[56:59], v[196:199]
v_mfma_f32_16x16x32_bf16 v[200:203], v[104:107], v[56:59], v[200:203]
v_mfma_f32_16x16x32_bf16 v[204:207], v[108:111], v[56:59], v[204:207]
v_mfma_f32_16x16x32_bf16 v[208:211], v[112:115], v[56:59], v[208:211]
s_add_u32 s54, s54, 2
s_and_b32 s54, s54, 7
s_lshl_b32 s55, s54, 13
s_cmp_lt_u32 s54, 5
s_cselect_b32 s42, s57, s59
s_add_u32 s55, s55, s42
v_add_u32 v28, s55, v24
ds_read_b64_tr_b16 v[100:101], v28 offset:0
ds_read_b64_tr_b16 v[102:103], v28 offset:512
v_add_u32_e64 v29, s55, v25
ds_read_b64_tr_b16 v[104:105], v29 offset:0
ds_read_b64_tr_b16 v[106:107], v29 offset:512
v_add_u32_e64 v30, s55, v26
ds_read_b64_tr_b16 v[108:109], v30 offset:0
ds_read_b64_tr_b16 v[110:111], v30 offset:512
v_add_u32_e64 v31, s55, v27
ds_read_b64_tr_b16 v[112:113], v31 offset:0
ds_read_b64_tr_b16 v[114:115], v31 offset:512
s_waitcnt vmcnt(9)
s_waitcnt lgkmcnt(14)
v_mfma_f32_16x16x32_bf16 v[132:135], v[116:119], v[60:63], v[132:135]
s_waitcnt lgkmcnt(12)
v_mfma_f32_16x16x32_bf16 v[136:139], v[120:123], v[60:63], v[136:139]
s_waitcnt lgkmcnt(10)
v_mfma_f32_16x16x32_bf16 v[140:143], v[124:127], v[60:63], v[140:143]
s_waitcnt lgkmcnt(8)
v_mfma_f32_16x16x32_bf16 v[144:147], v[128:131], v[60:63], v[144:147]
s_waitcnt vmcnt(4)
s_waitcnt lgkmcnt(6)
v_mfma_f32_16x16x32_bf16 v[132:135], v[100:103], v[80:83], v[132:135]
s_waitcnt lgkmcnt(4)
v_mfma_f32_16x16x32_bf16 v[136:139], v[104:107], v[80:83], v[136:139]
s_waitcnt lgkmcnt(2)
v_mfma_f32_16x16x32_bf16 v[140:143], v[108:111], v[80:83], v[140:143]
s_waitcnt lgkmcnt(0)
v_mfma_f32_16x16x32_bf16 v[144:147], v[112:115], v[80:83], v[144:147]
v_mfma_f32_16x16x32_bf16 v[148:151], v[116:119], v[64:67], v[148:151]
v_mfma_f32_16x16x32_bf16 v[152:155], v[120:123], v[64:67], v[152:155]
v_mfma_f32_16x16x32_bf16 v[156:159], v[124:127], v[64:67], v[156:159]
v_mfma_f32_16x16x32_bf16 v[160:163], v[128:131], v[64:67], v[160:163]
s_waitcnt vmcnt(3)
v_mfma_f32_16x16x32_bf16 v[148:151], v[100:103], v[84:87], v[148:151]
v_mov_b32 v5, v34
ds_write_b128 v5, v[132:135] offset:0
v_mfma_f32_16x16x32_bf16 v[152:155], v[104:107], v[84:87], v[152:155]
v_xor_b32_e64 v6, 64, v34
ds_write_b128 v6, v[136:139] offset:0
v_mfma_f32_16x16x32_bf16 v[156:159], v[108:111], v[84:87], v[156:159]
v_xor_b32 v5, 128, v34
ds_write_b128 v5, v[140:143] offset:0
v_mfma_f32_16x16x32_bf16 v[160:163], v[112:115], v[84:87], v[160:163]
v_xor_b32 v6, 192, v34
ds_write_b128 v6, v[144:147] offset:0
v_mfma_f32_16x16x32_bf16 v[164:167], v[116:119], v[68:71], v[164:167]
v_mfma_f32_16x16x32_bf16 v[168:171], v[120:123], v[68:71], v[168:171]
v_mfma_f32_16x16x32_bf16 v[172:175], v[124:127], v[68:71], v[172:175]
v_mfma_f32_16x16x32_bf16 v[176:179], v[128:131], v[68:71], v[176:179]
s_waitcnt vmcnt(2)
v_mfma_f32_16x16x32_bf16 v[164:167], v[100:103], v[88:91], v[164:167]
v_mov_b32 v5, v34
ds_write_b128 v5, v[148:151] offset:4096
v_mfma_f32_16x16x32_bf16 v[168:171], v[104:107], v[88:91], v[168:171]
v_xor_b32_e64 v6, 64, v34
ds_write_b128 v6, v[152:155] offset:4096
v_mfma_f32_16x16x32_bf16 v[172:175], v[108:111], v[88:91], v[172:175]
v_xor_b32 v5, 128, v34
ds_write_b128 v5, v[156:159] offset:4096
v_mfma_f32_16x16x32_bf16 v[176:179], v[112:115], v[88:91], v[176:179]
v_xor_b32 v6, 192, v34
ds_write_b128 v6, v[160:163] offset:4096
v_mfma_f32_16x16x32_bf16 v[180:183], v[116:119], v[72:75], v[180:183]
v_mfma_f32_16x16x32_bf16 v[184:187], v[120:123], v[72:75], v[184:187]
v_mfma_f32_16x16x32_bf16 v[188:191], v[124:127], v[72:75], v[188:191]
v_mfma_f32_16x16x32_bf16 v[192:195], v[128:131], v[72:75], v[192:195]
s_waitcnt vmcnt(1)
v_mfma_f32_16x16x32_bf16 v[180:183], v[100:103], v[92:95], v[180:183]
v_mov_b32 v5, v34
ds_write_b128 v5, v[164:167] offset:8192
v_mfma_f32_16x16x32_bf16 v[184:187], v[104:107], v[92:95], v[184:187]
v_xor_b32_e64 v6, 64, v34
ds_write_b128 v6, v[168:171] offset:8192
v_mfma_f32_16x16x32_bf16 v[188:191], v[108:111], v[92:95], v[188:191]
v_xor_b32 v5, 128, v34
ds_write_b128 v5, v[172:175] offset:8192
v_mfma_f32_16x16x32_bf16 v[192:195], v[112:115], v[92:95], v[192:195]
v_xor_b32 v6, 192, v34
ds_write_b128 v6, v[176:179] offset:8192
v_mfma_f32_16x16x32_bf16 v[196:199], v[116:119], v[76:79], v[196:199]
v_mfma_f32_16x16x32_bf16 v[200:203], v[120:123], v[76:79], v[200:203]
v_mfma_f32_16x16x32_bf16 v[204:207], v[124:127], v[76:79], v[204:207]
v_mfma_f32_16x16x32_bf16 v[208:211], v[128:131], v[76:79], v[208:211]
s_waitcnt vmcnt(0)
v_mfma_f32_16x16x32_bf16 v[196:199], v[100:103], v[96:99], v[196:199]
v_mov_b32 v5, v34
ds_write_b128 v5, v[180:183] offset:12288
v_mfma_f32_16x16x32_bf16 v[200:203], v[104:107], v[96:99], v[200:203]
v_xor_b32_e64 v6, 64, v34
ds_write_b128 v6, v[184:187] offset:12288
v_mfma_f32_16x16x32_bf16 v[204:207], v[108:111], v[96:99], v[204:207]
v_xor_b32 v5, 128, v34
ds_write_b128 v5, v[188:191] offset:12288
v_mfma_f32_16x16x32_bf16 v[208:211], v[112:115], v[96:99], v[208:211]
v_xor_b32 v6, 192, v34
ds_write_b128 v6, v[192:195] offset:12288
v_mov_b32_e64 v5, v34
ds_write_b128 v5, v[196:199] offset:16384
v_xor_b32_e64 v6, 64, v34
ds_write_b128 v6, v[200:203] offset:16384
v_xor_b32 v5, 128, v34
ds_write_b128 v5, v[204:207] offset:16384
v_xor_b32 v6, 192, v34
ds_write_b128 v6, v[208:211] offset:16384
s_waitcnt lgkmcnt(0)
s_branch L_p3F
L_hk0_slow:
v_cndmask_b32 v76, v76, v77, s[60:61]
v_cndmask_b32 v92, v92, v93, s[60:61]
v_max3_f32 v158, v68, v69, v70
v_max3_f32 v159, -v68, -v69, -v70
v_max3_f32 v158, v158, v71, v72
v_max3_f32 v159, v159, -v71, -v72
v_max3_f32 v158, v158, v73, v74
v_max3_f32 v159, v159, -v73, -v74
v_max3_f32 v158, v158, v75, v76
v_max3_f32 v159, v159, -v75, -v76
v_max3_f32 v184, v84, v85, v86
v_max3_f32 v185, -v84, -v85, -v86
v_max3_f32 v184, v184, v87, v88
v_max3_f32 v185, v185, -v87, -v88
v_max3_f32 v184, v184, v89, v90
v_max3_f32 v185, v185, -v89, -v90
v_max3_f32 v184, v184, v91, v92
v_max3_f32 v185, v185, -v91, -v92
v_permlane32_swap_b32 v158, v159
s_nop 0
v_permlane32_swap_b32 v184, v185
v_max_f32 v158, v158, v159
v_max_f32 v184, v184, v185
v_mul_f32 v158, s63, v158
v_mul_f32 v184, s63, v184
v_mov_b32 v159, v158
v_mov_b32 v185, v184
s_nop 0
v_permlane32_swap_b32 v158, v159
v_permlane32_swap_b32 v184, v185
v_pk_fma_f32 v[140:141], v[68:69], s[62:63], v[158:159] op_sel:[0,0,0] op_sel_hi:[0,1,1]
v_pk_fma_f32 v[142:143], v[68:69], s[62:63], v[158:159] op_sel:[1,0,0] op_sel_hi:[1,1,1]
v_pk_fma_f32 v[144:145], v[70:71], s[62:63], v[158:159] op_sel:[0,0,0] op_sel_hi:[0,1,1]
v_pk_fma_f32 v[146:147], v[70:71], s[62:63], v[158:159] op_sel:[1,0,0] op_sel_hi:[1,1,1]
v_pk_fma_f32 v[148:149], v[72:73], s[62:63], v[158:159] op_sel:[0,0,0] op_sel_hi:[0,1,1]
v_pk_fma_f32 v[150:151], v[72:73], s[62:63], v[158:159] op_sel:[1,0,0] op_sel_hi:[1,1,1]
v_pk_fma_f32 v[152:153], v[74:75], s[62:63], v[158:159] op_sel:[0,0,0] op_sel_hi:[0,1,1]
v_pk_fma_f32 v[154:155], v[74:75], s[62:63], v[158:159] op_sel:[1,0,0] op_sel_hi:[1,1,1]
v_pk_fma_f32 v[156:157], v[76:77], s[62:63], v[158:159] op_sel:[0,0,0] op_sel_hi:[0,1,1]
v_exp_f32 v140, v140
v_exp_f32 v141, v141
v_exp_f32 v142, v142
v_exp_f32 v143, v143
v_exp_f32 v144, v144
v_exp_f32 v145, v145
v_exp_f32 v146, v146
v_exp_f32 v147, v147
v_exp_f32 v148, v148
v_exp_f32 v149, v149
v_exp_f32 v150, v150
v_exp_f32 v151, v151
v_exp_f32 v152, v152
v_exp_f32 v153, v153
v_exp_f32 v154, v154
v_exp_f32 v155, v155
v_exp_f32 v156, v156
v_exp_f32 v157, v157
v_pk_fma_f32 v[166:167], v[84:85], s[62:63], v[184:185] op_sel:[0,0,0] op_sel_hi:[0,1,1]
v_pk_fma_f32 v[168:169], v[84:85], s[62:63], v[184:185] op_sel:[1,0,0] op_sel_hi:[1,1,1]
v_pk_fma_f32 v[170:171], v[86:87], s[62:63], v[184:185] op_sel:[0,0,0] op_sel_hi:[0,1,1]
v_pk_fma_f32 v[172:173], v[86:87], s[62:63], v[184:185] op_sel:[1,0,0] op_sel_hi:[1,1,1]
v_pk_fma_f32 v[174:175], v[88:89], s[62:63], v[184:185] op_sel:[0,0,0] op_sel_hi:[0,1,1]
v_pk_fma_f32 v[176:177], v[88:89], s[62:63], v[184:185] op_sel:[1,0,0] op_sel_hi:[1,1,1]
v_pk_fma_f32 v[178:179], v[90:91], s[62:63], v[184:185] op_sel:[0,0,0] op_sel_hi:[0,1,1]
v_pk_fma_f32 v[180:181], v[90:91], s[62:63], v[184:185] op_sel:[1,0,0] op_sel_hi:[1,1,1]
v_pk_fma_f32 v[182:183], v[92:93], s[62:63], v[184:185] op_sel:[0,0,0] op_sel_hi:[0,1,1]
v_exp_f32 v166, v166
v_exp_f32 v167, v167
v_exp_f32 v168, v168
v_exp_f32 v169, v169
v_exp_f32 v170, v170
v_exp_f32 v171, v171
v_exp_f32 v172, v172
v_exp_f32 v173, v173
v_exp_f32 v174, v174
v_exp_f32 v175, v175
v_exp_f32 v176, v176
v_exp_f32 v177, v177
v_exp_f32 v178, v178
v_exp_f32 v179, v179
v_exp_f32 v180, v180
v_exp_f32 v181, v181
v_exp_f32 v182, v182
v_exp_f32 v183, v183
v_pk_add_f32 v[160:161], v[140:141], v[142:143]
v_pk_add_f32 v[162:163], v[144:145], v[146:147]
v_pk_add_f32 v[164:165], v[148:149], v[150:151]
v_pk_add_f32 v[160:161], v[160:161], v[152:153]
v_pk_add_f32 v[162:163], v[162:163], v[154:155]
v_pk_add_f32 v[164:165], v[164:165], v[156:157]
v_pk_add_f32 v[160:161], v[160:161], v[162:163]
v_pk_add_f32 v[160:161], v[160:161], v[164:165]
v_pk_add_f32 v[186:187], v[166:167], v[168:169]
v_pk_add_f32 v[188:189], v[170:171], v[172:173]
v_pk_add_f32 v[190:191], v[174:175], v[176:177]
v_pk_add_f32 v[186:187], v[186:187], v[178:179]
v_pk_add_f32 v[188:189], v[188:189], v[180:181]
v_pk_add_f32 v[190:191], v[190:191], v[182:183]
v_pk_add_f32 v[186:187], v[186:187], v[188:189]
v_pk_add_f32 v[186:187], v[186:187], v[190:191]
v_permlane32_swap_b32 v160, v161
s_nop 0
v_permlane32_swap_b32 v186, v187
v_add_f32 v160, v160, v161
v_add_f32 v186, v186, v187
v_rcp_f32 v160, v160
v_rcp_f32 v186, v186
v_mov_b32 v161, v160
v_mov_b32 v187, v186
s_nop 0
v_permlane32_swap_b32 v160, v161
v_permlane32_swap_b32 v186, v187
v_pk_mul_f32 v[140:141], v[140:141], v[160:161]
v_pk_mul_f32 v[142:143], v[142:143], v[160:161]
v_pk_mul_f32 v[144:145], v[144:145], v[160:161]
v_pk_mul_f32 v[146:147], v[146:147], v[160:161]
v_pk_mul_f32 v[148:149], v[148:149], v[160:161]
v_pk_mul_f32 v[150:151], v[150:151], v[160:161]
v_pk_mul_f32 v[152:153], v[152:153], v[160:161]
v_pk_mul_f32 v[154:155], v[154:155], v[160:161]
v_pk_mul_f32 v[156:157], v[156:157], v[160:161]
v_cvt_pk_bf16_f32 v20, v140, v141
v_cvt_pk_bf16_f32 v21, v142, v143
v_cvt_pk_bf16_f32 v22, v144, v145
v_cvt_pk_bf16_f32 v23, v146, v147
v_cvt_pk_bf16_f32 v24, v148, v149
v_cvt_pk_bf16_f32 v25, v150, v151
v_cvt_pk_bf16_f32 v26, v152, v153
v_cvt_pk_bf16_f32 v27, v154, v155
v_cvt_pk_bf16_f32 v28, v156, v157
v_pk_mul_f32 v[166:167], v[166:167], v[186:187]
v_pk_mul_f32 v[168:169], v[168:169], v[186:187]
v_pk_mul_f32 v[170:171], v[170:171], v[186:187]
v_pk_mul_f32 v[172:173], v[172:173], v[186:187]
v_pk_mul_f32 v[174:175], v[174:175], v[186:187]
v_pk_mul_f32 v[176:177], v[176:177], v[186:187]
v_pk_mul_f32 v[178:179], v[178:179], v[186:187]
v_pk_mul_f32 v[180:181], v[180:181], v[186:187]
v_pk_mul_f32 v[182:183], v[182:183], v[186:187]
v_cvt_pk_bf16_f32 v30, v166, v167
v_cvt_pk_bf16_f32 v31, v168, v169
v_cvt_pk_bf16_f32 v32, v170, v171
v_cvt_pk_bf16_f32 v33, v172, v173
v_cvt_pk_bf16_f32 v34, v174, v175
v_cvt_pk_bf16_f32 v35, v176, v177
v_cvt_pk_bf16_f32 v36, v178, v179
v_cvt_pk_bf16_f32 v37, v180, v181
v_cvt_pk_bf16_f32 v38, v182, v183
s_nop 1
s_branch L_hk0_done
L_hk1_slow:
v_cndmask_b32 v108, v108, v109, s[60:61]
v_cndmask_b32 v124, v124, v125, s[60:61]
v_max3_f32 v158, v100, v101, v102
v_max3_f32 v159, -v100, -v101, -v102
v_max3_f32 v158, v158, v103, v104
v_max3_f32 v159, v159, -v103, -v104
v_max3_f32 v158, v158, v105, v106
v_max3_f32 v159, v159, -v105, -v106
v_max3_f32 v158, v158, v107, v108
v_max3_f32 v159, v159, -v107, -v108
v_max3_f32 v184, v116, v117, v118
v_max3_f32 v185, -v116, -v117, -v118
v_max3_f32 v184, v184, v119, v120
v_max3_f32 v185, v185, -v119, -v120
v_max3_f32 v184, v184, v121, v122
v_max3_f32 v185, v185, -v121, -v122
v_max3_f32 v184, v184, v123, v124
v_max3_f32 v185, v185, -v123, -v124
v_permlane32_swap_b32 v158, v159
s_nop 0
v_permlane32_swap_b32 v184, v185
v_max_f32 v158, v158, v159
v_max_f32 v184, v184, v185
v_mul_f32 v158, s63, v158
v_mul_f32 v184, s63, v184
v_mov_b32 v159, v158
v_mov_b32 v185, v184
s_nop 0
v_permlane32_swap_b32 v158, v159
v_permlane32_swap_b32 v184, v185
v_pk_fma_f32 v[140:141], v[100:101], s[62:63], v[158:159] op_sel:[0,0,0] op_sel_hi:[0,1,1]
v_pk_fma_f32 v[142:143], v[100:101], s[62:63], v[158:159] op_sel:[1,0,0] op_sel_hi:[1,1,1]
v_pk_fma_f32 v[144:145], v[102:103], s[62:63], v[158:159] op_sel:[0,0,0] op_sel_hi:[0,1,1]
v_pk_fma_f32 v[146:147], v[102:103], s[62:63], v[158:159] op_sel:[1,0,0] op_sel_hi:[1,1,1]
v_pk_fma_f32 v[148:149], v[104:105], s[62:63], v[158:159] op_sel:[0,0,0] op_sel_hi:[0,1,1]
v_pk_fma_f32 v[150:151], v[104:105], s[62:63], v[158:159] op_sel:[1,0,0] op_sel_hi:[1,1,1]
v_pk_fma_f32 v[152:153], v[106:107], s[62:63], v[158:159] op_sel:[0,0,0] op_sel_hi:[0,1,1]
v_pk_fma_f32 v[154:155], v[106:107], s[62:63], v[158:159] op_sel:[1,0,0] op_sel_hi:[1,1,1]
v_pk_fma_f32 v[156:157], v[108:109], s[62:63], v[158:159] op_sel:[0,0,0] op_sel_hi:[0,1,1]
v_exp_f32 v140, v140
v_exp_f32 v141, v141
v_exp_f32 v142, v142
v_exp_f32 v143, v143
v_exp_f32 v144, v144
v_exp_f32 v145, v145
v_exp_f32 v146, v146
v_exp_f32 v147, v147
v_exp_f32 v148, v148
v_exp_f32 v149, v149
v_exp_f32 v150, v150
v_exp_f32 v151, v151
v_exp_f32 v152, v152
v_exp_f32 v153, v153
v_exp_f32 v154, v154
v_exp_f32 v155, v155
v_exp_f32 v156, v156
v_exp_f32 v157, v157
v_pk_fma_f32 v[166:167], v[116:117], s[62:63], v[184:185] op_sel:[0,0,0] op_sel_hi:[0,1,1]
v_pk_fma_f32 v[168:169], v[116:117], s[62:63], v[184:185] op_sel:[1,0,0] op_sel_hi:[1,1,1]
v_pk_fma_f32 v[170:171], v[118:119], s[62:63], v[184:185] op_sel:[0,0,0] op_sel_hi:[0,1,1]
v_pk_fma_f32 v[172:173], v[118:119], s[62:63], v[184:185] op_sel:[1,0,0] op_sel_hi:[1,1,1]
v_pk_fma_f32 v[174:175], v[120:121], s[62:63], v[184:185] op_sel:[0,0,0] op_sel_hi:[0,1,1]
v_pk_fma_f32 v[176:177], v[120:121], s[62:63], v[184:185] op_sel:[1,0,0] op_sel_hi:[1,1,1]
v_pk_fma_f32 v[178:179], v[122:123], s[62:63], v[184:185] op_sel:[0,0,0] op_sel_hi:[0,1,1]
v_pk_fma_f32 v[180:181], v[122:123], s[62:63], v[184:185] op_sel:[1,0,0] op_sel_hi:[1,1,1]
v_pk_fma_f32 v[182:183], v[124:125], s[62:63], v[184:185] op_sel:[0,0,0] op_sel_hi:[0,1,1]
v_exp_f32 v166, v166
v_exp_f32 v167, v167
v_exp_f32 v168, v168
v_exp_f32 v169, v169
v_exp_f32 v170, v170
v_exp_f32 v171, v171
v_exp_f32 v172, v172
v_exp_f32 v173, v173
v_exp_f32 v174, v174
v_exp_f32 v175, v175
v_exp_f32 v176, v176
v_exp_f32 v177, v177
v_exp_f32 v178, v178
v_exp_f32 v179, v179
v_exp_f32 v180, v180
v_exp_f32 v181, v181
v_exp_f32 v182, v182
v_exp_f32 v183, v183
v_pk_add_f32 v[160:161], v[140:141], v[142:143]
v_pk_add_f32 v[162:163], v[144:145], v[146:147]
v_pk_add_f32 v[164:165], v[148:149], v[150:151]
v_pk_add_f32 v[160:161], v[160:161], v[152:153]
v_pk_add_f32 v[162:163], v[162:163], v[154:155]
v_pk_add_f32 v[164:165], v[164:165], v[156:157]
v_pk_add_f32 v[160:161], v[160:161], v[162:163]
v_pk_add_f32 v[160:161], v[160:161], v[164:165]
v_pk_add_f32 v[186:187], v[166:167], v[168:169]
v_pk_add_f32 v[188:189], v[170:171], v[172:173]
v_pk_add_f32 v[190:191], v[174:175], v[176:177]
v_pk_add_f32 v[186:187], v[186:187], v[178:179]
v_pk_add_f32 v[188:189], v[188:189], v[180:181]
v_pk_add_f32 v[190:191], v[190:191], v[182:183]
v_pk_add_f32 v[186:187], v[186:187], v[188:189]
v_pk_add_f32 v[186:187], v[186:187], v[190:191]
v_permlane32_swap_b32 v160, v161
s_nop 0
v_permlane32_swap_b32 v186, v187
v_add_f32 v160, v160, v161
v_add_f32 v186, v186, v187
v_rcp_f32 v160, v160
v_rcp_f32 v186, v186
v_mov_b32 v161, v160
v_mov_b32 v187, v186
s_nop 0
v_permlane32_swap_b32 v160, v161
v_permlane32_swap_b32 v186, v187
v_pk_mul_f32 v[140:141], v[140:141], v[160:161]
v_pk_mul_f32 v[142:143], v[142:143], v[160:161]
v_pk_mul_f32 v[144:145], v[144:145], v[160:161]
v_pk_mul_f32 v[146:147], v[146:147], v[160:161]
v_pk_mul_f32 v[148:149], v[148:149], v[160:161]
v_pk_mul_f32 v[150:151], v[150:151], v[160:161]
v_pk_mul_f32 v[152:153], v[152:153], v[160:161]
v_pk_mul_f32 v[154:155], v[154:155], v[160:161]
v_pk_mul_f32 v[156:157], v[156:157], v[160:161]
v_cvt_pk_bf16_f32 v40, v140, v141
v_cvt_pk_bf16_f32 v41, v142, v143
v_cvt_pk_bf16_f32 v42, v144, v145
v_cvt_pk_bf16_f32 v43, v146, v147
v_cvt_pk_bf16_f32 v44, v148, v149
v_cvt_pk_bf16_f32 v45, v150, v151
v_cvt_pk_bf16_f32 v46, v152, v153
v_cvt_pk_bf16_f32 v47, v154, v155
v_cvt_pk_bf16_f32 v48, v156, v157
v_pk_mul_f32 v[166:167], v[166:167], v[186:187]
v_pk_mul_f32 v[168:169], v[168:169], v[186:187]
v_pk_mul_f32 v[170:171], v[170:171], v[186:187]
v_pk_mul_f32 v[172:173], v[172:173], v[186:187]
v_pk_mul_f32 v[174:175], v[174:175], v[186:187]
v_pk_mul_f32 v[176:177], v[176:177], v[186:187]
v_pk_mul_f32 v[178:179], v[178:179], v[186:187]
v_pk_mul_f32 v[180:181], v[180:181], v[186:187]
v_pk_mul_f32 v[182:183], v[182:183], v[186:187]
v_cvt_pk_bf16_f32 v50, v166, v167
v_cvt_pk_bf16_f32 v51, v168, v169
v_cvt_pk_bf16_f32 v52, v170, v171
v_cvt_pk_bf16_f32 v53, v172, v173
v_cvt_pk_bf16_f32 v54, v174, v175
v_cvt_pk_bf16_f32 v55, v176, v177
v_cvt_pk_bf16_f32 v56, v178, v179
v_cvt_pk_bf16_f32 v57, v180, v181
v_cvt_pk_bf16_f32 v58, v182, v183
s_nop 1
s_branch L_hk1_done
L_hq_slow:
v_cndmask_b32 v112, v112, v113, s[60:61]
v_cndmask_b32 v128, v128, v129, s[60:61]
v_max3_f32 v154, v104, v105, v106
v_max3_f32 v155, -v104, -v105, -v106
v_max3_f32 v154, v154, v107, v108
v_max3_f32 v155, v155, -v107, -v108
v_max3_f32 v154, v154, v109, v110
v_max3_f32 v155, v155, -v109, -v110
v_max3_f32 v154, v154, v111, v112
v_max3_f32 v155, v155, -v111, -v112
v_max3_f32 v180, v120, v121, v122
v_max3_f32 v181, -v120, -v121, -v122
v_max3_f32 v180, v180, v123, v124
v_max3_f32 v181, v181, -v123, -v124
v_max3_f32 v180, v180, v125, v126
v_max3_f32 v181, v181, -v125, -v126
v_max3_f32 v180, v180, v127, v128
v_max3_f32 v181, v181, -v127, -v128
v_permlane32_swap_b32 v154, v155
s_nop 0
v_permlane32_swap_b32 v180, v181
v_max_f32 v154, v154, v155
v_max_f32 v180, v180, v181
v_mul_f32 v154, s63, v154
v_mul_f32 v180, s63, v180
v_mov_b32 v155, v154
v_mov_b32 v181, v180
s_nop 0
v_permlane32_swap_b32 v154, v155
v_permlane32_swap_b32 v180, v181
v_pk_fma_f32 v[136:137], v[104:105], s[62:63], v[154:155] op_sel:[0,0,0] op_sel_hi:[0,1,1]
v_pk_fma_f32 v[138:139], v[104:105], s[62:63], v[154:155] op_sel:[1,0,0] op_sel_hi:[1,1,1]
v_pk_fma_f32 v[140:141], v[106:107], s[62:63], v[154:155] op_sel:[0,0,0] op_sel_hi:[0,1,1]
v_pk_fma_f32 v[142:143], v[106:107], s[62:63], v[154:155] op_sel:[1,0,0] op_sel_hi:[1,1,1]
v_pk_fma_f32 v[144:145], v[108:109], s[62:63], v[154:155] op_sel:[0,0,0] op_sel_hi:[0,1,1]
v_pk_fma_f32 v[146:147], v[108:109], s[62:63], v[154:155] op_sel:[1,0,0] op_sel_hi:[1,1,1]
v_pk_fma_f32 v[148:149], v[110:111], s[62:63], v[154:155] op_sel:[0,0,0] op_sel_hi:[0,1,1]
v_pk_fma_f32 v[150:151], v[110:111], s[62:63], v[154:155] op_sel:[1,0,0] op_sel_hi:[1,1,1]
v_pk_fma_f32 v[152:153], v[112:113], s[62:63], v[154:155] op_sel:[0,0,0] op_sel_hi:[0,1,1]
v_exp_f32 v136, v136
v_exp_f32 v137, v137
v_exp_f32 v138, v138
v_exp_f32 v139, v139
v_exp_f32 v140, v140
v_exp_f32 v141, v141
v_exp_f32 v142, v142
v_exp_f32 v143, v143
v_exp_f32 v144, v144
v_exp_f32 v145, v145
v_exp_f32 v146, v146
v_exp_f32 v147, v147
v_exp_f32 v148, v148
v_exp_f32 v149, v149
v_exp_f32 v150, v150
v_exp_f32 v151, v151
v_exp_f32 v152, v152
v_exp_f32 v153, v153
v_pk_fma_f32 v[162:163], v[120:121], s[62:63], v[180:181] op_sel:[0,0,0] op_sel_hi:[0,1,1]
v_pk_fma_f32 v[164:165], v[120:121], s[62:63], v[180:181] op_sel:[1,0,0] op_sel_hi:[1,1,1]
v_pk_fma_f32 v[166:167], v[122:123], s[62:63], v[180:181] op_sel:[0,0,0] op_sel_hi:[0,1,1]
v_pk_fma_f32 v[168:169], v[122:123], s[62:63], v[180:181] op_sel:[1,0,0] op_sel_hi:[1,1,1]
v_pk_fma_f32 v[170:171], v[124:125], s[62:63], v[180:181] op_sel:[0,0,0] op_sel_hi:[0,1,1]
v_pk_fma_f32 v[172:173], v[124:125], s[62:63], v[180:181] op_sel:[1,0,0] op_sel_hi:[1,1,1]
v_pk_fma_f32 v[174:175], v[126:127], s[62:63], v[180:181] op_sel:[0,0,0] op_sel_hi:[0,1,1]
v_pk_fma_f32 v[176:177], v[126:127], s[62:63], v[180:181] op_sel:[1,0,0] op_sel_hi:[1,1,1]
v_pk_fma_f32 v[178:179], v[128:129], s[62:63], v[180:181] op_sel:[0,0,0] op_sel_hi:[0,1,1]
v_exp_f32 v162, v162
v_exp_f32 v163, v163
v_exp_f32 v164, v164
v_exp_f32 v165, v165
v_exp_f32 v166, v166
v_exp_f32 v167, v167
v_exp_f32 v168, v168
v_exp_f32 v169, v169
v_exp_f32 v170, v170
v_exp_f32 v171, v171
v_exp_f32 v172, v172
v_exp_f32 v173, v173
v_exp_f32 v174, v174
v_exp_f32 v175, v175
v_exp_f32 v176, v176
v_exp_f32 v177, v177
v_exp_f32 v178, v178
v_exp_f32 v179, v179
v_pk_add_f32 v[156:157], v[136:137], v[138:139]
v_pk_add_f32 v[158:159], v[140:141], v[142:143]
v_pk_add_f32 v[160:161], v[144:145], v[146:147]
v_pk_add_f32 v[156:157], v[156:157], v[148:149]
v_pk_add_f32 v[158:159], v[158:159], v[150:151]
v_pk_add_f32 v[160:161], v[160:161], v[152:153]
v_pk_add_f32 v[156:157], v[156:157], v[158:159]
v_pk_add_f32 v[156:157], v[156:157], v[160:161]
v_pk_add_f32 v[182:183], v[162:163], v[164:165]
v_pk_add_f32 v[184:185], v[166:167], v[168:169]
v_pk_add_f32 v[186:187], v[170:171], v[172:173]
v_pk_add_f32 v[182:183], v[182:183], v[174:175]
v_pk_add_f32 v[184:185], v[184:185], v[176:177]
v_pk_add_f32 v[186:187], v[186:187], v[178:179]
v_pk_add_f32 v[182:183], v[182:183], v[184:185]
v_pk_add_f32 v[182:183], v[182:183], v[186:187]
v_permlane32_swap_b32 v156, v157
s_nop 0
v_permlane32_swap_b32 v182, v183
v_add_f32 v156, v156, v157
v_add_f32 v182, v182, v183
v_rcp_f32 v156, v156
v_rcp_f32 v182, v182
v_mov_b32 v157, v156
v_mov_b32 v183, v182
s_nop 0
v_permlane32_swap_b32 v156, v157
v_permlane32_swap_b32 v182, v183
v_pk_mul_f32 v[136:137], v[136:137], v[156:157]
v_pk_mul_f32 v[138:139], v[138:139], v[156:157]
v_pk_mul_f32 v[140:141], v[140:141], v[156:157]
v_pk_mul_f32 v[142:143], v[142:143], v[156:157]
v_pk_mul_f32 v[144:145], v[144:145], v[156:157]
v_pk_mul_f32 v[146:147], v[146:147], v[156:157]
v_pk_mul_f32 v[148:149], v[148:149], v[156:157]
v_pk_mul_f32 v[150:151], v[150:151], v[156:157]
v_pk_mul_f32 v[152:153], v[152:153], v[156:157]
v_cvt_pk_bf16_f32 v224, v136, v137
v_cvt_pk_bf16_f32 v225, v138, v139
v_cvt_pk_bf16_f32 v226, v140, v141
v_cvt_pk_bf16_f32 v227, v142, v143
v_cvt_pk_bf16_f32 v228, v144, v145
v_cvt_pk_bf16_f32 v229, v146, v147
v_cvt_pk_bf16_f32 v230, v148, v149
v_cvt_pk_bf16_f32 v231, v150, v151
v_cvt_pk_bf16_f32 v232, v152, v153
v_pk_mul_f32 v[162:163], v[162:163], v[182:183]
v_pk_mul_f32 v[164:165], v[164:165], v[182:183]
v_pk_mul_f32 v[166:167], v[166:167], v[182:183]
v_pk_mul_f32 v[168:169], v[168:169], v[182:183]
v_pk_mul_f32 v[170:171], v[170:171], v[182:183]
v_pk_mul_f32 v[172:173], v[172:173], v[182:183]
v_pk_mul_f32 v[174:175], v[174:175], v[182:183]
v_pk_mul_f32 v[176:177], v[176:177], v[182:183]
v_pk_mul_f32 v[178:179], v[178:179], v[182:183]
v_cvt_pk_bf16_f32 v236, v162, v163
v_cvt_pk_bf16_f32 v237, v164, v165
v_cvt_pk_bf16_f32 v238, v166, v167
v_cvt_pk_bf16_f32 v239, v168, v169
v_cvt_pk_bf16_f32 v240, v170, v171
v_cvt_pk_bf16_f32 v241, v172, v173
v_cvt_pk_bf16_f32 v242, v174, v175
v_cvt_pk_bf16_f32 v243, v176, v177
v_cvt_pk_bf16_f32 v244, v178, v179
s_nop 1
s_branch L_hq_done
L_att0:
L_pdP0_2:
s_cbranch_execz L_pdP0_3
ds_read_b128 v[72:75], v11 offset:14592
ds_read_b32 v76, v12 offset:14592
ds_read_b128 v[80:83], v11 offset:17024
ds_read_b32 v84, v12 offset:17024
ds_read_b64_tr_b16 v[88:89], v13 offset:14592
ds_read_b64_tr_b16 v[90:91], v14 offset:14592
ds_read_b64_tr_b16 v[92:93], v15 offset:14592
ds_read_b64_tr_b16 v[94:95], v16 offset:14592
ds_read_b64_tr_b16 v[96:97], v13 offset:17024
ds_read_b64_tr_b16 v[98:99], v14 offset:17024
ds_read_b64_tr_b16 v[100:101], v15 offset:17024
ds_read_b64_tr_b16 v[102:103], v16 offset:17024
s_waitcnt lgkmcnt(10)
v_mfma_f32_32x32x16_bf16 v[104:119], v[72:75], v[24:27], 0
v_mfma_f32_32x32x16_bf16 v[104:119], v[76:79], v[28:31], v[104:119]
s_nop 11
v_exp_f32 v104, v104
v_exp_f32 v105, v105
v_exp_f32 v106, v106
v_exp_f32 v107, v107
v_exp_f32 v108, v108
v_mfma_f32_32x32x16_bf16 v[120:135], v[72:75], v[32:35], 0
v_exp_f32_e64 v109, v109
v_cvt_pk_bf16_f32 v104, v104, v105
v_cvt_pk_bf16_f32 v105, v106, v107
v_exp_f32 v110, v110
v_exp_f32 v111, v111
v_mfma_f32_32x32x16_bf16 v[120:135], v[76:79], v[36:39], v[120:135]
ds_read_b128 v[72:75], v11 offset:19456
ds_read_b32 v76, v12 offset:19456
v_exp_f32_e64 v112, v112
v_cvt_pk_bf16_f32 v106, v108, v109
v_cvt_pk_bf16_f32 v107, v110, v111
v_exp_f32 v113, v113
v_exp_f32_e64 v114, v114
s_waitcnt lgkmcnt(6)
v_mfma_f32_32x32x16_bf16 v[136:151], v[88:91], v[104:107], 0
v_exp_f32 v115, v115
v_exp_f32 v116, v116
v_exp_f32_e64 v117, v117
v_cvt_pk_bf16_f32 v112, v112, v113
v_cvt_pk_bf16_f32 v113, v114, v115
v_exp_f32 v118, v118
v_exp_f32 v119, v119
v_cvt_pk_bf16_f32 v114, v116, v117
v_cvt_pk_bf16_f32 v115, v118, v119
v_exp_f32 v120, v120
v_exp_f32 v121, v121
v_mfma_f32_32x32x16_bf16 v[136:151], v[92:95], v[112:115], v[136:151]
v_exp_f32 v122, v122
v_exp_f32 v123, v123
v_exp_f32_e64 v124, v124
v_mfma_f32_32x32x16_bf16 v[104:119], v[80:83], v[24:27], 0
v_exp_f32_e64 v125, v125
v_cvt_pk_bf16_f32 v120, v120, v121
v_cvt_pk_bf16_f32 v121, v122, v123
v_exp_f32 v126, v126
v_exp_f32 v127, v127
v_mfma_f32_32x32x16_bf16 v[104:119], v[84:87], v[28:31], v[104:119]
v_exp_f32_e64 v128, v128
v_cvt_pk_bf16_f32 v122, v124, v125
v_cvt_pk_bf16_f32 v123, v126, v127
v_exp_f32 v129, v129
v_exp_f32 v130, v130
v_mfma_f32_32x32x16_bf16 v[152:167], v[88:91], v[120:123], 0
v_exp_f32 v131, v131
v_exp_f32 v132, v132
v_exp_f32_e64 v133, v133
v_cvt_pk_bf16_f32 v128, v128, v129
v_cvt_pk_bf16_f32 v129, v130, v131
v_exp_f32 v134, v134
v_exp_f32 v135, v135
v_cvt_pk_bf16_f32 v130, v132, v133
v_cvt_pk_bf16_f32 v131, v134, v135
v_exp_f32 v104, v104
v_exp_f32 v105, v105
v_mfma_f32_32x32x16_bf16 v[152:167], v[92:95], v[128:131], v[152:167]
ds_read_b64_tr_b16 v[88:89], v13 offset:19456
ds_read_b64_tr_b16 v[90:91], v14 offset:19456
ds_read_b64_tr_b16 v[92:93], v15 offset:19456
ds_read_b64_tr_b16 v[94:95], v16 offset:19456
v_exp_f32 v106, v106
v_exp_f32 v107, v107
v_exp_f32_e64 v108, v108
v_mfma_f32_32x32x16_bf16 v[120:135], v[80:83], v[32:35], 0
v_exp_f32_e64 v109, v109
v_cvt_pk_bf16_f32 v104, v104, v105
v_cvt_pk_bf16_f32 v105, v106, v107
v_exp_f32 v110, v110
v_exp_f32 v111, v111
v_mfma_f32_32x32x16_bf16 v[120:135], v[84:87], v[36:39], v[120:135]
ds_read_b128 v[80:83], v11 offset:21888
ds_read_b32 v84, v12 offset:21888
v_exp_f32_e64 v112, v112
v_cvt_pk_bf16_f32 v106, v108, v109
v_cvt_pk_bf16_f32 v107, v110, v111
v_exp_f32 v113, v113
v_exp_f32_e64 v114, v114
s_waitcnt lgkmcnt(8)
v_mfma_f32_32x32x16_bf16 v[136:151], v[96:99], v[104:107], v[136:151]
v_exp_f32 v115, v115
v_exp_f32 v116, v116
v_exp_f32_e64 v117, v117
v_cvt_pk_bf16_f32 v112, v112, v113
v_cvt_pk_bf16_f32 v113, v114, v115
v_exp_f32 v118, v118
v_exp_f32 v119, v119
v_cvt_pk_bf16_f32 v114, v116, v117
v_cvt_pk_bf16_f32 v115, v118, v119
v_exp_f32 v120, v120
v_exp_f32 v121, v121
v_mfma_f32_32x32x16_bf16 v[136:151], v[100:103], v[112:115], v[136:151]
v_exp_f32 v122, v122
v_exp_f32 v123, v123
v_exp_f32 v124, v124
s_waitcnt lgkmcnt(6)
v_mfma_f32_32x32x16_bf16 v[104:119], v[72:75], v[24:27], v[40:55]
v_exp_f32_e64 v125, v125
v_cvt_pk_bf16_f32 v120, v120, v121
v_cvt_pk_bf16_f32 v121, v122, v123
v_exp_f32 v126, v126
v_exp_f32 v127, v127
v_mfma_f32_32x32x16_bf16 v[104:119], v[76:79], v[28:31], v[104:119]
v_exp_f32_e64 v128, v128
v_cvt_pk_bf16_f32 v122, v124, v125
v_cvt_pk_bf16_f32 v123, v126, v127
v_exp_f32 v129, v129
v_exp_f32 v130, v130
v_mfma_f32_32x32x16_bf16 v[152:167], v[96:99], v[120:123], v[152:167]
v_exp_f32 v131, v131
v_exp_f32 v132, v132
v_exp_f32_e64 v133, v133
v_cvt_pk_bf16_f32 v128, v128, v129
v_cvt_pk_bf16_f32 v129, v130, v131
v_exp_f32 v134, v134
v_exp_f32 v135, v135
v_cvt_pk_bf16_f32 v130, v132, v133
v_cvt_pk_bf16_f32 v131, v134, v135
v_exp_f32 v104, v104
v_exp_f32 v105, v105
v_mfma_f32_32x32x16_bf16 v[152:167], v[100:103], v[128:131], v[152:167]
ds_read_b64_tr_b16 v[96:97], v13 offset:21888
ds_read_b64_tr_b16 v[98:99], v14 offset:21888
ds_read_b64_tr_b16 v[100:101], v15 offset:21888
ds_read_b64_tr_b16 v[102:103], v16 offset:21888
v_exp_f32 v106, v106
v_exp_f32 v107, v107
v_exp_f32_e64 v108, v108
v_mfma_f32_32x32x16_bf16 v[120:135], v[72:75], v[32:35], 0
v_exp_f32_e64 v109, v109
v_cvt_pk_bf16_f32 v104, v104, v105
v_cvt_pk_bf16_f32 v105, v106, v107
v_exp_f32 v110, v110
v_exp_f32 v111, v111
v_mfma_f32_32x32x16_bf16 v[120:135], v[76:79], v[36:39], v[120:135]
s_barrier
ds_read_b128 v[72:75], v11 offset:0
ds_read_b32 v76, v12 offset:0
v_exp_f32 v112, v112
v_cvt_pk_bf16_f32 v106, v108, v109
v_cvt_pk_bf16_f32 v107, v110, v111
v_exp_f32 v113, v113
v_exp_f32_e64 v114, v114
s_waitcnt lgkmcnt(8)
v_mfma_f32_32x32x16_bf16 v[136:151], v[88:91], v[104:107], v[136:151]
v_exp_f32 v115, v115
v_exp_f32 v116, v116
v_exp_f32_e64 v117, v117
v_cvt_pk_bf16_f32 v112, v112, v113
v_cvt_pk_bf16_f32 v113, v114, v115
v_exp_f32 v118, v118
v_exp_f32 v119, v119
v_cvt_pk_bf16_f32 v114, v116, v117
v_cvt_pk_bf16_f32 v115, v118, v119
v_exp_f32 v120, v120
v_exp_f32 v121, v121
v_mfma_f32_32x32x16_bf16 v[136:151], v[92:95], v[112:115], v[136:151]
v_exp_f32 v122, v122
v_exp_f32 v123, v123
v_exp_f32 v124, v124
s_waitcnt lgkmcnt(6)
v_mfma_f32_32x32x16_bf16 v[104:119], v[80:83], v[32:35], v[40:55]
v_exp_f32_e64 v125, v125
v_cvt_pk_bf16_f32 v120, v120, v121
v_cvt_pk_bf16_f32 v121, v122, v123
v_exp_f32 v126, v126
v_exp_f32 v127, v127
v_mfma_f32_32x32x16_bf16 v[104:119], v[84:87], v[36:39], v[104:119]
ds_read_b128 v[80:83], v11 offset:2432
ds_read_b32 v84, v12 offset:2432
v_exp_f32_e64 v128, v128
v_cvt_pk_bf16_f32 v122, v124, v125
v_cvt_pk_bf16_f32 v123, v126, v127
v_exp_f32 v129, v129
v_exp_f32 v130, v130
v_mfma_f32_32x32x16_bf16 v[152:167], v[88:91], v[120:123], v[152:167]
s_barrier
ds_read_b64 v[200:201], v17 offset:0
ds_read_b64 v[202:203], v17 offset:8
ds_read_b64 v[204:205], v17 offset:16
ds_read_b64 v[206:207], v17 offset:24
ds_read_b32 v208, v17 offset:32
ds_read_b32 v20, v19
ds_read_b32 v21, v19 offset:32
v_exp_f32 v131, v131
v_exp_f32 v132, v132
v_exp_f32 v133, v133
v_cvt_pk_bf16_f32 v128, v128, v129
v_cvt_pk_bf16_f32 v129, v130, v131
v_exp_f32 v134, v134
v_exp_f32 v135, v135
v_cvt_pk_bf16_f32 v130, v132, v133
v_cvt_pk_bf16_f32 v131, v134, v135
v_exp_f32 v104, v104
v_exp_f32 v105, v105
v_mfma_f32_32x32x16_bf16 v[152:167], v[92:95], v[128:131], v[152:167]
ds_read_b64_tr_b16 v[88:89], v13 offset:0
ds_read_b64_tr_b16 v[90:91], v14 offset:0
ds_read_b64_tr_b16 v[92:93], v15 offset:0
ds_read_b64_tr_b16 v[94:95], v16 offset:0
v_exp_f32 v106, v106
v_exp_f32 v107, v107
v_exp_f32 v108, v108
s_waitcnt lgkmcnt(13)
v_mfma_f32_32x32x16_bf16 v[120:135], v[72:75], v[24:27], v[56:71]
v_exp_f32_e64 v109, v109
v_cvt_pk_bf16_f32 v104, v104, v105
v_cvt_pk_bf16_f32 v105, v106, v107
v_exp_f32 v110, v110
v_exp_f32 v111, v111
v_mfma_f32_32x32x16_bf16 v[120:135], v[76:79], v[28:31], v[120:135]
ds_read_b128 v[72:75], v11 offset:4864
ds_read_b32 v76, v12 offset:4864
v_exp_f32_e64 v112, v112
v_cvt_pk_bf16_f32 v106, v108, v109
v_cvt_pk_bf16_f32 v107, v110, v111
v_exp_f32 v113, v113
v_exp_f32 v114, v114
v_mfma_f32_32x32x16_bf16 v[152:167], v[96:99], v[104:107], v[152:167]
v_exp_f32 v115, v115
v_exp_f32_e64 v116, v116
s_waitcnt lgkmcnt(6)
v_mfma_f32_32x32x16_bf16 v[168:183], v[200:203], v[224:227], 0
v_exp_f32_e64 v117, v117
v_cvt_pk_bf16_f32 v112, v112, v113
v_cvt_pk_bf16_f32 v113, v114, v115
v_mfma_f32_32x32x16_bf16 v[184:199], v[200:203], v[236:239], 0
v_exp_f32 v118, v118
v_exp_f32 v119, v119
v_mfma_f32_32x32x16_bf16 v[168:183], v[204:207], v[228:231], v[168:183]
v_cvt_pk_bf16_f32 v114, v116, v117
v_cvt_pk_bf16_f32 v115, v118, v119
v_exp_f32 v120, v120
v_exp_f32 v121, v121
v_mfma_f32_32x32x16_bf16 v[152:167], v[100:103], v[112:115], v[152:167]
ds_read_b64_tr_b16 v[96:97], v13 offset:2432
ds_read_b64_tr_b16 v[98:99], v14 offset:2432
ds_read_b64_tr_b16 v[100:101], v15 offset:2432
ds_read_b64_tr_b16 v[102:103], v16 offset:2432
v_exp_f32 v122, v122
v_exp_f32 v123, v123
v_exp_f32_e64 v124, v124
v_mfma_f32_32x32x16_bf16 v[104:119], v[80:83], v[24:27], 0
v_exp_f32_e64 v125, v125
v_cvt_pk_bf16_f32 v120, v120, v121
v_cvt_pk_bf16_f32 v121, v122, v123
v_exp_f32 v126, v126
v_exp_f32 v127, v127
v_mfma_f32_32x32x16_bf16 v[104:119], v[84:87], v[28:31], v[104:119]
v_exp_f32_e64 v128, v128
v_cvt_pk_bf16_f32 v122, v124, v125
v_cvt_pk_bf16_f32 v123, v126, v127
v_exp_f32 v129, v129
v_exp_f32_e64 v130, v130
s_waitcnt lgkmcnt(6)
v_mfma_f32_32x32x16_bf16 v[136:151], v[88:91], v[120:123], v[136:151]
v_exp_f32 v131, v131
v_exp_f32 v132, v132
v_mfma_f32_32x32x16_bf16 v[184:199], v[204:207], v[240:243], v[184:199]
v_exp_f32_e64 v133, v133
v_cvt_pk_bf16_f32 v128, v128, v129
v_cvt_pk_bf16_f32 v129, v130, v131
v_mfma_f32_32x32x16_bf16 v[168:183], v[208:211], v[232:235], v[168:183]
v_exp_f32 v134, v134
v_exp_f32 v135, v135
v_mfma_f32_32x32x16_bf16 v[184:199], v[208:211], v[244:247], v[184:199]
v_cvt_pk_bf16_f32 v130, v132, v133
v_cvt_pk_bf16_f32 v131, v134, v135
v_exp_f32 v104, v104
v_exp_f32 v105, v105
v_mfma_f32_32x32x16_bf16 v[136:151], v[92:95], v[128:131], v[136:151]
ds_read_b64_tr_b16 v[88:89], v13 offset:4864
ds_read_b64_tr_b16 v[90:91], v14 offset:4864
ds_read_b64_tr_b16 v[92:93], v15 offset:4864
ds_read_b64_tr_b16 v[94:95], v16 offset:4864
v_exp_f32 v106, v106
v_exp_f32 v107, v107
v_exp_f32_e64 v108, v108
v_mfma_f32_32x32x16_bf16 v[120:135], v[80:83], v[32:35], v[56:71]
v_exp_f32_e64 v109, v109
v_cvt_pk_bf16_f32 v104, v104, v105
v_cvt_pk_bf16_f32 v105, v106, v107
v_exp_f32 v110, v110
v_exp_f32 v111, v111
v_mfma_f32_32x32x16_bf16 v[120:135], v[84:87], v[36:39], v[120:135]
ds_read_b128 v[80:83], v11 offset:7296
ds_read_b32 v84, v12 offset:7296
v_exp_f32_e64 v112, v112
v_cvt_pk_bf16_f32 v106, v108, v109
v_cvt_pk_bf16_f32 v107, v110, v111
v_exp_f32 v113, v113
v_exp_f32_e64 v114, v114
s_waitcnt lgkmcnt(6)
v_mfma_f32_32x32x16_bf16 v[136:151], v[96:99], v[104:107], v[136:151]
v_exp_f32 v115, v115
v_exp_f32 v116, v116
v_exp_f32_e64 v117, v117
v_cvt_pk_bf16_f32 v112, v112, v113
v_cvt_pk_bf16_f32 v113, v114, v115
v_exp_f32 v118, v118
v_exp_f32 v119, v119
v_cvt_pk_bf16_f32 v114, v116, v117
v_cvt_pk_bf16_f32 v115, v118, v119
v_add_f32 v212, 897988541, v178
v_rcp_f32 v212, v212
v_sub_f32 v213, 1.0, v20
v_mul_f32_e64 v212, v212, v213
v_pk_mul_f32 v[168:169], v[168:169], v[212:213] op_sel_hi:[1,0]
v_pk_mul_f32 v[170:171], v[170:171], v[212:213] op_sel_hi:[1,0]
v_pk_mul_f32 v[172:173], v[172:173], v[212:213] op_sel_hi:[1,0]
v_pk_mul_f32 v[174:175], v[174:175], v[212:213] op_sel_hi:[1,0]
v_pk_mul_f32 v[176:177], v[176:177], v[212:213] op_sel_hi:[1,0]
v_cvt_pk_bf16_f32 v168, v168, v169
v_cvt_pk_bf16_f32 v169, v170, v171
v_cvt_pk_bf16_f32 v170, v172, v173
v_cvt_pk_bf16_f32 v171, v174, v175
buffer_store_dwordx4 v[168:171], v1, s[28:31], s6 offen sc1
v_cvt_pk_bf16_f32 v252, v176, v177
v_add_f32 v214, 897988541, v194
v_rcp_f32 v214, v214
v_sub_f32 v215, 1.0, v21
v_mul_f32_e64 v214, v214, v215
v_pk_mul_f32 v[184:185], v[184:185], v[214:215] op_sel_hi:[1,0]
v_pk_mul_f32 v[186:187], v[186:187], v[214:215] op_sel_hi:[1,0]
v_pk_mul_f32 v[188:189], v[188:189], v[214:215] op_sel_hi:[1,0]
v_pk_mul_f32 v[190:191], v[190:191], v[214:215] op_sel_hi:[1,0]
v_pk_mul_f32 v[192:193], v[192:193], v[214:215] op_sel_hi:[1,0]
v_cvt_pk_bf16_f32 v184, v184, v185
v_cvt_pk_bf16_f32 v185, v186, v187
v_cvt_pk_bf16_f32 v186, v188, v189
v_cvt_pk_bf16_f32 v187, v190, v191
buffer_store_dwordx4 v[184:187], v1, s[28:31], s7 offen sc1
v_cvt_pk_bf16_f32 v253, v192, v193
v_cndmask_b32 v248, v252, v253, s[60:61]
s_nop 1
v_mov_b32_dpp v249, v248 quad_perm:[1,1,1,1] row_mask:0xf bank_mask:0xf
v_mov_b32_dpp v250, v248 quad_perm:[2,2,2,2] row_mask:0xf bank_mask:0xf
v_mov_b32_dpp v251, v248 quad_perm:[3,3,3,3] row_mask:0xf bank_mask:0xf
buffer_store_dwordx4 v[248:251], v18, s[32:35], s9 offen sc1
v_exp_f32 v120, v120
v_exp_f32_e64 v121, v121
v_mfma_f32_32x32x16_bf16 v[136:151], v[100:103], v[112:115], v[136:151]
v_exp_f32 v122, v122
v_exp_f32 v123, v123
v_exp_f32_e64 v124, v124
v_mfma_f32_32x32x16_bf16 v[104:119], v[72:75], v[24:27], 0
v_exp_f32_e64 v125, v125
v_cvt_pk_bf16_f32 v120, v120, v121
v_cvt_pk_bf16_f32 v121, v122, v123
v_exp_f32 v126, v126
v_exp_f32 v127, v127
v_mfma_f32_32x32x16_bf16 v[104:119], v[76:79], v[28:31], v[104:119]
v_exp_f32_e64 v128, v128
v_cvt_pk_bf16_f32 v122, v124, v125
v_cvt_pk_bf16_f32 v123, v126, v127
v_exp_f32 v129, v129
v_exp_f32 v130, v130
v_mfma_f32_32x32x16_bf16 v[152:167], v[96:99], v[120:123], v[152:167]
v_exp_f32 v131, v131
v_exp_f32 v132, v132
v_exp_f32_e64 v133, v133
v_cvt_pk_bf16_f32 v128, v128, v129
v_cvt_pk_bf16_f32 v129, v130, v131
v_exp_f32 v134, v134
v_exp_f32 v135, v135
v_cvt_pk_bf16_f32 v130, v132, v133
v_cvt_pk_bf16_f32 v131, v134, v135
v_exp_f32 v104, v104
v_exp_f32 v105, v105
v_mfma_f32_32x32x16_bf16 v[152:167], v[100:103], v[128:131], v[152:167]
ds_read_b64_tr_b16 v[96:97], v13 offset:7296
ds_read_b64_tr_b16 v[98:99], v14 offset:7296
ds_read_b64_tr_b16 v[100:101], v15 offset:7296
ds_read_b64_tr_b16 v[102:103], v16 offset:7296
v_exp_f32 v106, v106
v_exp_f32 v107, v107
v_exp_f32_e64 v108, v108
v_mfma_f32_32x32x16_bf16 v[120:135], v[72:75], v[32:35], 0
v_exp_f32_e64 v109, v109
v_cvt_pk_bf16_f32 v104, v104, v105
v_cvt_pk_bf16_f32 v105, v106, v107
v_exp_f32 v110, v110
v_exp_f32 v111, v111
v_mfma_f32_32x32x16_bf16 v[120:135], v[76:79], v[36:39], v[120:135]
ds_read_b128 v[72:75], v11 offset:9728
ds_read_b32 v76, v12 offset:9728
v_exp_f32_e64 v112, v112
v_cvt_pk_bf16_f32 v106, v108, v109
v_cvt_pk_bf16_f32 v107, v110, v111
v_exp_f32 v113, v113
v_exp_f32_e64 v114, v114
s_waitcnt lgkmcnt(8)
v_mfma_f32_32x32x16_bf16 v[136:151], v[88:91], v[104:107], v[136:151]
v_exp_f32 v115, v115
v_exp_f32 v116, v116
v_exp_f32_e64 v117, v117
v_cvt_pk_bf16_f32 v112, v112, v113
v_cvt_pk_bf16_f32 v113, v114, v115
v_exp_f32 v118, v118
v_exp_f32 v119, v119
v_cvt_pk_bf16_f32 v114, v116, v117
v_cvt_pk_bf16_f32 v115, v118, v119
v_exp_f32 v120, v120
v_exp_f32 v121, v121
v_mfma_f32_32x32x16_bf16 v[136:151], v[92:95], v[112:115], v[136:151]
v_exp_f32 v122, v122
v_exp_f32 v123, v123
v_exp_f32 v124, v124
s_waitcnt lgkmcnt(6)
v_mfma_f32_32x32x16_bf16 v[104:119], v[80:83], v[24:27], 0
v_exp_f32_e64 v125, v125
v_cvt_pk_bf16_f32 v120, v120, v121
v_cvt_pk_bf16_f32 v121, v122, v123
v_exp_f32 v126, v126
v_exp_f32 v127, v127
v_mfma_f32_32x32x16_bf16 v[104:119], v[84:87], v[28:31], v[104:119]
v_exp_f32_e64 v128, v128
v_cvt_pk_bf16_f32 v122, v124, v125
v_cvt_pk_bf16_f32 v123, v126, v127
v_exp_f32 v129, v129
v_exp_f32 v130, v130
v_mfma_f32_32x32x16_bf16 v[152:167], v[88:91], v[120:123], v[152:167]
v_exp_f32 v131, v131
v_exp_f32 v132, v132
v_exp_f32_e64 v133, v133
v_cvt_pk_bf16_f32 v128, v128, v129
v_cvt_pk_bf16_f32 v129, v130, v131
v_exp_f32 v134, v134
v_exp_f32 v135, v135
v_cvt_pk_bf16_f32 v130, v132, v133
v_cvt_pk_bf16_f32 v131, v134, v135
v_exp_f32 v104, v104
v_exp_f32 v105, v105
v_mfma_f32_32x32x16_bf16 v[152:167], v[92:95], v[128:131], v[152:167]
ds_read_b64_tr_b16 v[88:89], v13 offset:9728
ds_read_b64_tr_b16 v[90:91], v14 offset:9728
ds_read_b64_tr_b16 v[92:93], v15 offset:9728
ds_read_b64_tr_b16 v[94:95], v16 offset:9728
v_exp_f32 v106, v106
v_exp_f32 v107, v107
v_exp_f32_e64 v108, v108
v_mfma_f32_32x32x16_bf16 v[120:135], v[80:83], v[32:35], 0
v_exp_f32_e64 v109, v109
v_cvt_pk_bf16_f32 v104, v104, v105
v_cvt_pk_bf16_f32 v105, v106, v107
v_exp_f32 v110, v110
v_exp_f32 v111, v111
v_mfma_f32_32x32x16_bf16 v[120:135], v[84:87], v[36:39], v[120:135]
ds_read_b128 v[80:83], v11 offset:12160
ds_read_b32 v84, v12 offset:12160
v_exp_f32_e64 v112, v112
v_cvt_pk_bf16_f32 v106, v108, v109
v_cvt_pk_bf16_f32 v107, v110, v111
v_exp_f32 v113, v113
v_exp_f32_e64 v114, v114
s_waitcnt lgkmcnt(8)
v_mfma_f32_32x32x16_bf16 v[136:151], v[96:99], v[104:107], v[136:151]
v_exp_f32 v115, v115
v_exp_f32 v116, v116
v_exp_f32_e64 v117, v117
v_cvt_pk_bf16_f32 v112, v112, v113
v_cvt_pk_bf16_f32 v113, v114, v115
v_exp_f32 v118, v118
v_exp_f32 v119, v119
v_cvt_pk_bf16_f32 v114, v116, v117
v_cvt_pk_bf16_f32 v115, v118, v119
L_pdP1_2:
s_cbranch_execz L_pdP1_3
v_exp_f32 v120, v120
v_exp_f32_e64 v121, v121
v_mfma_f32_32x32x16_bf16 v[136:151], v[100:103], v[112:115], v[136:151]
v_exp_f32 v122, v122
v_exp_f32 v123, v123
v_exp_f32 v124, v124
s_waitcnt lgkmcnt(6)
v_mfma_f32_32x32x16_bf16 v[104:119], v[72:75], v[24:27], 0
v_exp_f32_e64 v125, v125
v_cvt_pk_bf16_f32 v120, v120, v121
v_cvt_pk_bf16_f32 v121, v122, v123
v_exp_f32 v126, v126
v_exp_f32 v127, v127
v_mfma_f32_32x32x16_bf16 v[104:119], v[76:79], v[28:31], v[104:119]
v_exp_f32_e64 v128, v128
v_cvt_pk_bf16_f32 v122, v124, v125
v_cvt_pk_bf16_f32 v123, v126, v127
v_exp_f32 v129, v129
v_exp_f32 v130, v130
v_mfma_f32_32x32x16_bf16 v[152:167], v[96:99], v[120:123], v[152:167]
v_exp_f32 v131, v131
v_exp_f32 v132, v132
v_exp_f32_e64 v133, v133
v_cvt_pk_bf16_f32 v128, v128, v129
v_cvt_pk_bf16_f32 v129, v130, v131
v_exp_f32 v134, v134
v_exp_f32 v135, v135
v_cvt_pk_bf16_f32 v130, v132, v133
v_cvt_pk_bf16_f32 v131, v134, v135
v_mov_b32_e64 v6, 1
v_mov_b32 v5, 161800
s_waitcnt vmcnt(0)
s_mov_b64 exec, 1
ds_add_u32 v5, v6
s_mov_b64 exec, -1
v_exp_f32 v104, v104
v_exp_f32_e64 v105, v105
v_mfma_f32_32x32x16_bf16 v[152:167], v[100:103], v[128:131], v[152:167]
ds_read_b64_tr_b16 v[96:97], v13 offset:12160
ds_read_b64_tr_b16 v[98:99], v14 offset:12160
ds_read_b64_tr_b16 v[100:101], v15 offset:12160
ds_read_b64_tr_b16 v[102:103], v16 offset:12160
v_exp_f32 v106, v106
v_exp_f32 v107, v107
v_exp_f32_e64 v108, v108
v_mfma_f32_32x32x16_bf16 v[120:135], v[72:75], v[32:35], 0
v_exp_f32_e64 v109, v109
v_cvt_pk_bf16_f32 v104, v104, v105
v_cvt_pk_bf16_f32 v105, v106, v107
v_exp_f32 v110, v110
v_exp_f32 v111, v111
v_mfma_f32_32x32x16_bf16 v[120:135], v[76:79], v[36:39], v[120:135]
v_exp_f32_e64 v112, v112
v_cvt_pk_bf16_f32 v106, v108, v109
v_cvt_pk_bf16_f32 v107, v110, v111
v_exp_f32 v113, v113
v_exp_f32_e64 v114, v114
s_waitcnt lgkmcnt(7)
v_mfma_f32_32x32x16_bf16 v[136:151], v[88:91], v[104:107], v[136:151]
v_exp_f32 v115, v115
v_exp_f32 v116, v116
v_exp_f32_e64 v117, v117
v_cvt_pk_bf16_f32 v112, v112, v113
v_cvt_pk_bf16_f32 v113, v114, v115
v_exp_f32 v118, v118
v_exp_f32 v119, v119
v_cvt_pk_bf16_f32 v114, v116, v117
v_cvt_pk_bf16_f32 v115, v118, v119
v_exp_f32 v120, v120
v_exp_f32 v121, v121
v_mfma_f32_32x32x16_bf16 v[136:151], v[92:95], v[112:115], v[136:151]
v_exp_f32 v122, v122
v_exp_f32 v123, v123
v_exp_f32 v124, v124
s_waitcnt lgkmcnt(5)
v_mfma_f32_32x32x16_bf16 v[104:119], v[80:83], v[24:27], 0
v_exp_f32_e64 v125, v125
v_cvt_pk_bf16_f32 v120, v120, v121
v_cvt_pk_bf16_f32 v121, v122, v123
v_exp_f32 v126, v126
v_exp_f32 v127, v127
v_mfma_f32_32x32x16_bf16 v[104:119], v[84:87], v[28:31], v[104:119]
v_exp_f32_e64 v128, v128
v_cvt_pk_bf16_f32 v122, v124, v125
v_cvt_pk_bf16_f32 v123, v126, v127
v_exp_f32 v129, v129
v_exp_f32 v130, v130
v_mfma_f32_32x32x16_bf16 v[152:167], v[88:91], v[120:123], v[152:167]
v_exp_f32 v131, v131
v_exp_f32 v132, v132
v_exp_f32_e64 v133, v133
v_cvt_pk_bf16_f32 v128, v128, v129
v_cvt_pk_bf16_f32 v129, v130, v131
v_exp_f32 v134, v134
v_exp_f32 v135, v135
v_cvt_pk_bf16_f32 v130, v132, v133
v_cvt_pk_bf16_f32 v131, v134, v135
v_exp_f32 v104, v104
v_exp_f32 v105, v105
v_mfma_f32_32x32x16_bf16 v[152:167], v[92:95], v[128:131], v[152:167]
v_exp_f32 v106, v106
v_exp_f32 v107, v107
v_exp_f32_e64 v108, v108
v_mfma_f32_32x32x16_bf16 v[120:135], v[80:83], v[32:35], 0
v_exp_f32_e64 v109, v109
v_cvt_pk_bf16_f32 v104, v104, v105
v_cvt_pk_bf16_f32 v105, v106, v107
v_exp_f32 v110, v110
v_exp_f32 v111, v111
v_mfma_f32_32x32x16_bf16 v[120:135], v[84:87], v[36:39], v[120:135]
v_exp_f32_e64 v112, v112
v_cvt_pk_bf16_f32 v106, v108, v109
v_cvt_pk_bf16_f32 v107, v110, v111
v_exp_f32 v113, v113
v_exp_f32_e64 v114, v114
s_waitcnt lgkmcnt(0)
v_mfma_f32_32x32x16_bf16 v[136:151], v[96:99], v[104:107], v[136:151]
v_exp_f32 v115, v115
v_exp_f32 v116, v116
v_exp_f32_e64 v117, v117
v_cvt_pk_bf16_f32 v112, v112, v113
v_cvt_pk_bf16_f32 v113, v114, v115
v_exp_f32 v118, v118
v_exp_f32 v119, v119
v_cvt_pk_bf16_f32 v114, v116, v117
v_cvt_pk_bf16_f32 v115, v118, v119
v_exp_f32 v120, v120
v_exp_f32 v121, v121
v_mfma_f32_32x32x16_bf16 v[136:151], v[100:103], v[112:115], v[136:151]
v_exp_f32 v122, v122
v_exp_f32 v123, v123
v_exp_f32 v124, v124
v_exp_f32 v125, v125
v_cvt_pk_bf16_f32 v120, v120, v121
v_cvt_pk_bf16_f32 v121, v122, v123
v_exp_f32 v126, v126
v_exp_f32 v127, v127
v_exp_f32_e64 v128, v128
v_cvt_pk_bf16_f32 v122, v124, v125
v_cvt_pk_bf16_f32 v123, v126, v127
v_exp_f32 v129, v129
v_exp_f32 v130, v130
v_mfma_f32_32x32x16_bf16 v[152:167], v[96:99], v[120:123], v[152:167]
v_exp_f32 v131, v131
v_exp_f32 v132, v132
v_exp_f32_e64 v133, v133
v_cvt_pk_bf16_f32 v128, v128, v129
v_cvt_pk_bf16_f32 v129, v130, v131
v_exp_f32 v134, v134
v_exp_f32 v135, v135
v_cvt_pk_bf16_f32 v130, v132, v133
v_cvt_pk_bf16_f32 v131, v134, v135
s_nop 1
v_mfma_f32_32x32x16_bf16 v[152:167], v[100:103], v[128:131], v[152:167]
s_branch L_attd
L_att1:
L_pdP2_2:
s_cbranch_execz L_pdP2_3
ds_read_b128 v[72:75], v11 offset:9728
ds_read_b32 v76, v12 offset:9728
ds_read_b128 v[80:83], v11 offset:12160
ds_read_b32 v84, v12 offset:12160
ds_read_b64_tr_b16 v[88:89], v13 offset:9728
ds_read_b64_tr_b16 v[90:91], v14 offset:9728
ds_read_b64_tr_b16 v[92:93], v15 offset:9728
ds_read_b64_tr_b16 v[94:95], v16 offset:9728
ds_read_b64_tr_b16 v[96:97], v13 offset:12160
ds_read_b64_tr_b16 v[98:99], v14 offset:12160
ds_read_b64_tr_b16 v[100:101], v15 offset:12160
ds_read_b64_tr_b16 v[102:103], v16 offset:12160
s_waitcnt lgkmcnt(10)
v_mfma_f32_32x32x16_bf16 v[104:119], v[72:75], v[24:27], 0
v_mfma_f32_32x32x16_bf16 v[104:119], v[76:79], v[28:31], v[104:119]
s_nop 11
v_exp_f32 v104, v104
v_exp_f32 v105, v105
v_exp_f32 v106, v106
v_exp_f32 v107, v107
v_exp_f32 v108, v108
v_mfma_f32_32x32x16_bf16 v[120:135], v[72:75], v[32:35], 0
v_exp_f32_e64 v109, v109
v_cvt_pk_bf16_f32 v104, v104, v105
v_cvt_pk_bf16_f32 v105, v106, v107
v_exp_f32 v110, v110
v_exp_f32 v111, v111
v_mfma_f32_32x32x16_bf16 v[120:135], v[76:79], v[36:39], v[120:135]
ds_read_b128 v[72:75], v11 offset:14592
ds_read_b32 v76, v12 offset:14592
v_exp_f32_e64 v112, v112
v_cvt_pk_bf16_f32 v106, v108, v109
v_cvt_pk_bf16_f32 v107, v110, v111
v_exp_f32 v113, v113
v_exp_f32_e64 v114, v114
s_waitcnt lgkmcnt(6)
v_mfma_f32_32x32x16_bf16 v[136:151], v[88:91], v[104:107], 0
v_exp_f32 v115, v115
v_exp_f32 v116, v116
v_exp_f32_e64 v117, v117
v_cvt_pk_bf16_f32 v112, v112, v113
v_cvt_pk_bf16_f32 v113, v114, v115
v_exp_f32 v118, v118
v_exp_f32 v119, v119
v_cvt_pk_bf16_f32 v114, v116, v117
v_cvt_pk_bf16_f32 v115, v118, v119
v_exp_f32 v120, v120
v_exp_f32 v121, v121
v_mfma_f32_32x32x16_bf16 v[136:151], v[92:95], v[112:115], v[136:151]
v_exp_f32 v122, v122
v_exp_f32 v123, v123
v_exp_f32_e64 v124, v124
v_mfma_f32_32x32x16_bf16 v[104:119], v[80:83], v[24:27], 0
v_exp_f32_e64 v125, v125
v_cvt_pk_bf16_f32 v120, v120, v121
v_cvt_pk_bf16_f32 v121, v122, v123
v_exp_f32 v126, v126
v_exp_f32 v127, v127
v_mfma_f32_32x32x16_bf16 v[104:119], v[84:87], v[28:31], v[104:119]
v_exp_f32_e64 v128, v128
v_cvt_pk_bf16_f32 v122, v124, v125
v_cvt_pk_bf16_f32 v123, v126, v127
v_exp_f32 v129, v129
v_exp_f32 v130, v130
v_mfma_f32_32x32x16_bf16 v[152:167], v[88:91], v[120:123], 0
v_exp_f32 v131, v131
v_exp_f32 v132, v132
v_exp_f32_e64 v133, v133
v_cvt_pk_bf16_f32 v128, v128, v129
v_cvt_pk_bf16_f32 v129, v130, v131
v_exp_f32 v134, v134
v_exp_f32 v135, v135
v_cvt_pk_bf16_f32 v130, v132, v133
v_cvt_pk_bf16_f32 v131, v134, v135
v_exp_f32 v104, v104
v_exp_f32 v105, v105
v_mfma_f32_32x32x16_bf16 v[152:167], v[92:95], v[128:131], v[152:167]
ds_read_b64_tr_b16 v[88:89], v13 offset:14592
ds_read_b64_tr_b16 v[90:91], v14 offset:14592
ds_read_b64_tr_b16 v[92:93], v15 offset:14592
ds_read_b64_tr_b16 v[94:95], v16 offset:14592
v_exp_f32 v106, v106
v_exp_f32 v107, v107
v_exp_f32_e64 v108, v108
v_mfma_f32_32x32x16_bf16 v[120:135], v[80:83], v[32:35], 0
v_exp_f32_e64 v109, v109
v_cvt_pk_bf16_f32 v104, v104, v105
v_cvt_pk_bf16_f32 v105, v106, v107
v_exp_f32 v110, v110
v_exp_f32 v111, v111
v_mfma_f32_32x32x16_bf16 v[120:135], v[84:87], v[36:39], v[120:135]
ds_read_b128 v[80:83], v11 offset:17024
ds_read_b32 v84, v12 offset:17024
v_exp_f32_e64 v112, v112
v_cvt_pk_bf16_f32 v106, v108, v109
v_cvt_pk_bf16_f32 v107, v110, v111
v_exp_f32 v113, v113
v_exp_f32_e64 v114, v114
s_waitcnt lgkmcnt(8)
v_mfma_f32_32x32x16_bf16 v[136:151], v[96:99], v[104:107], v[136:151]
v_exp_f32 v115, v115
v_exp_f32 v116, v116
v_exp_f32_e64 v117, v117
v_cvt_pk_bf16_f32 v112, v112, v113
v_cvt_pk_bf16_f32 v113, v114, v115
v_exp_f32 v118, v118
v_exp_f32 v119, v119
v_cvt_pk_bf16_f32 v114, v116, v117
v_cvt_pk_bf16_f32 v115, v118, v119
v_exp_f32 v120, v120
v_exp_f32 v121, v121
v_mfma_f32_32x32x16_bf16 v[136:151], v[100:103], v[112:115], v[136:151]
v_exp_f32 v122, v122
v_exp_f32 v123, v123
v_exp_f32 v124, v124
s_waitcnt lgkmcnt(6)
v_mfma_f32_32x32x16_bf16 v[104:119], v[72:75], v[24:27], 0
v_exp_f32_e64 v125, v125
v_cvt_pk_bf16_f32 v120, v120, v121
v_cvt_pk_bf16_f32 v121, v122, v123
v_exp_f32 v126, v126
v_exp_f32 v127, v127
v_mfma_f32_32x32x16_bf16 v[104:119], v[76:79], v[28:31], v[104:119]
v_exp_f32_e64 v128, v128
v_cvt_pk_bf16_f32 v122, v124, v125
v_cvt_pk_bf16_f32 v123, v126, v127
v_exp_f32 v129, v129
v_exp_f32 v130, v130
v_mfma_f32_32x32x16_bf16 v[152:167], v[96:99], v[120:123], v[152:167]
v_exp_f32 v131, v131
v_exp_f32 v132, v132
v_exp_f32_e64 v133, v133
v_cvt_pk_bf16_f32 v128, v128, v129
v_cvt_pk_bf16_f32 v129, v130, v131
v_exp_f32 v134, v134
v_exp_f32 v135, v135
v_cvt_pk_bf16_f32 v130, v132, v133
v_cvt_pk_bf16_f32 v131, v134, v135
v_exp_f32 v104, v104
v_exp_f32 v105, v105
v_mfma_f32_32x32x16_bf16 v[152:167], v[100:103], v[128:131], v[152:167]
ds_read_b64_tr_b16 v[96:97], v13 offset:17024
ds_read_b64_tr_b16 v[98:99], v14 offset:17024
ds_read_b64_tr_b16 v[100:101], v15 offset:17024
ds_read_b64_tr_b16 v[102:103], v16 offset:17024
v_exp_f32 v106, v106
v_exp_f32 v107, v107
v_exp_f32_e64 v108, v108
v_mfma_f32_32x32x16_bf16 v[120:135], v[72:75], v[32:35], 0
v_exp_f32_e64 v109, v109
v_cvt_pk_bf16_f32 v104, v104, v105
v_cvt_pk_bf16_f32 v105, v106, v107
v_exp_f32 v110, v110
v_exp_f32 v111, v111
v_mfma_f32_32x32x16_bf16 v[120:135], v[76:79], v[36:39], v[120:135]
s_barrier
ds_read_b128 v[72:75], v11 offset:19456
ds_read_b32 v76, v12 offset:19456
v_exp_f32 v112, v112
v_cvt_pk_bf16_f32 v106, v108, v109
v_cvt_pk_bf16_f32 v107, v110, v111
v_exp_f32 v113, v113
v_exp_f32_e64 v114, v114
s_waitcnt lgkmcnt(8)
v_mfma_f32_32x32x16_bf16 v[136:151], v[88:91], v[104:107], v[136:151]
v_exp_f32 v115, v115
v_exp_f32 v116, v116
v_exp_f32_e64 v117, v117
v_cvt_pk_bf16_f32 v112, v112, v113
v_cvt_pk_bf16_f32 v113, v114, v115
v_exp_f32 v118, v118
v_exp_f32 v119, v119
v_cvt_pk_bf16_f32 v114, v116, v117
v_cvt_pk_bf16_f32 v115, v118, v119
v_exp_f32 v120, v120
v_exp_f32 v121, v121
v_mfma_f32_32x32x16_bf16 v[136:151], v[92:95], v[112:115], v[136:151]
v_exp_f32 v122, v122
v_exp_f32 v123, v123
v_exp_f32 v124, v124
s_waitcnt lgkmcnt(6)
v_mfma_f32_32x32x16_bf16 v[104:119], v[80:83], v[24:27], 0
v_exp_f32_e64 v125, v125
v_cvt_pk_bf16_f32 v120, v120, v121
v_cvt_pk_bf16_f32 v121, v122, v123
v_exp_f32 v126, v126
v_exp_f32 v127, v127
v_mfma_f32_32x32x16_bf16 v[104:119], v[84:87], v[28:31], v[104:119]
v_exp_f32_e64 v128, v128
v_cvt_pk_bf16_f32 v122, v124, v125
v_cvt_pk_bf16_f32 v123, v126, v127
v_exp_f32 v129, v129
v_exp_f32 v130, v130
v_mfma_f32_32x32x16_bf16 v[152:167], v[88:91], v[120:123], v[152:167]
s_barrier
ds_read_b64 v[200:201], v17 offset:0
ds_read_b64 v[202:203], v17 offset:8
ds_read_b64 v[204:205], v17 offset:16
ds_read_b64 v[206:207], v17 offset:24
ds_read_b32 v208, v17 offset:32
ds_read_b32 v20, v19
ds_read_b32 v21, v19 offset:32
v_exp_f32 v131, v131
v_exp_f32 v132, v132
v_exp_f32 v133, v133
v_cvt_pk_bf16_f32 v128, v128, v129
v_cvt_pk_bf16_f32 v129, v130, v131
v_exp_f32 v134, v134
v_exp_f32 v135, v135
v_cvt_pk_bf16_f32 v130, v132, v133
v_cvt_pk_bf16_f32 v131, v134, v135
v_exp_f32 v104, v104
v_exp_f32 v105, v105
v_mfma_f32_32x32x16_bf16 v[152:167], v[92:95], v[128:131], v[152:167]
ds_read_b64_tr_b16 v[88:89], v13 offset:19456
ds_read_b64_tr_b16 v[90:91], v14 offset:19456
ds_read_b64_tr_b16 v[92:93], v15 offset:19456
ds_read_b64_tr_b16 v[94:95], v16 offset:19456
v_exp_f32 v106, v106
v_exp_f32 v107, v107
v_exp_f32_e64 v108, v108
v_mfma_f32_32x32x16_bf16 v[120:135], v[80:83], v[32:35], 0
v_exp_f32_e64 v109, v109
v_cvt_pk_bf16_f32 v104, v104, v105
v_cvt_pk_bf16_f32 v105, v106, v107
v_exp_f32 v110, v110
v_exp_f32 v111, v111
v_mfma_f32_32x32x16_bf16 v[120:135], v[84:87], v[36:39], v[120:135]
ds_read_b128 v[80:83], v11 offset:21888
ds_read_b32 v84, v12 offset:21888
v_exp_f32_e64 v112, v112
v_cvt_pk_bf16_f32 v106, v108, v109
v_cvt_pk_bf16_f32 v107, v110, v111
v_exp_f32 v113, v113
v_exp_f32_e64 v114, v114
s_waitcnt lgkmcnt(15)
v_mfma_f32_32x32x16_bf16 v[136:151], v[96:99], v[104:107], v[136:151]
v_exp_f32 v115, v115
v_exp_f32_e64 v116, v116
s_waitcnt lgkmcnt(6)
v_mfma_f32_32x32x16_bf16 v[168:183], v[200:203], v[224:227], 0
v_exp_f32_e64 v117, v117
v_cvt_pk_bf16_f32 v112, v112, v113
v_cvt_pk_bf16_f32 v113, v114, v115
v_mfma_f32_32x32x16_bf16 v[184:199], v[200:203], v[236:239], 0
v_exp_f32 v118, v118
v_exp_f32 v119, v119
v_mfma_f32_32x32x16_bf16 v[168:183], v[204:207], v[228:231], v[168:183]
v_cvt_pk_bf16_f32 v114, v116, v117
v_cvt_pk_bf16_f32 v115, v118, v119
v_exp_f32 v120, v120
v_exp_f32 v121, v121
v_mfma_f32_32x32x16_bf16 v[136:151], v[100:103], v[112:115], v[136:151]
v_exp_f32 v122, v122
v_exp_f32 v123, v123
v_exp_f32_e64 v124, v124
v_mfma_f32_32x32x16_bf16 v[104:119], v[72:75], v[24:27], v[40:55]
v_exp_f32_e64 v125, v125
v_cvt_pk_bf16_f32 v120, v120, v121
v_cvt_pk_bf16_f32 v121, v122, v123
v_exp_f32 v126, v126
v_exp_f32 v127, v127
v_mfma_f32_32x32x16_bf16 v[104:119], v[76:79], v[28:31], v[104:119]
v_exp_f32_e64 v128, v128
v_cvt_pk_bf16_f32 v122, v124, v125
v_cvt_pk_bf16_f32 v123, v126, v127
v_exp_f32 v129, v129
v_exp_f32 v130, v130
v_mfma_f32_32x32x16_bf16 v[152:167], v[96:99], v[120:123], v[152:167]
v_exp_f32 v131, v131
v_exp_f32 v132, v132
v_mfma_f32_32x32x16_bf16 v[184:199], v[204:207], v[240:243], v[184:199]
v_exp_f32_e64 v133, v133
v_cvt_pk_bf16_f32 v128, v128, v129
v_cvt_pk_bf16_f32 v129, v130, v131
v_mfma_f32_32x32x16_bf16 v[168:183], v[208:211], v[232:235], v[168:183]
v_exp_f32 v134, v134
v_exp_f32 v135, v135
v_mfma_f32_32x32x16_bf16 v[184:199], v[208:211], v[244:247], v[184:199]
v_cvt_pk_bf16_f32 v130, v132, v133
v_cvt_pk_bf16_f32 v131, v134, v135
v_exp_f32 v104, v104
v_exp_f32 v105, v105
v_mfma_f32_32x32x16_bf16 v[152:167], v[100:103], v[128:131], v[152:167]
ds_read_b64_tr_b16 v[96:97], v13 offset:21888
ds_read_b64_tr_b16 v[98:99], v14 offset:21888
ds_read_b64_tr_b16 v[100:101], v15 offset:21888
ds_read_b64_tr_b16 v[102:103], v16 offset:21888
v_exp_f32 v106, v106
v_exp_f32 v107, v107
v_exp_f32_e64 v108, v108
v_mfma_f32_32x32x16_bf16 v[120:135], v[72:75], v[32:35], 0
v_exp_f32_e64 v109, v109
v_cvt_pk_bf16_f32 v104, v104, v105
v_cvt_pk_bf16_f32 v105, v106, v107
v_exp_f32 v110, v110
v_exp_f32 v111, v111
v_mfma_f32_32x32x16_bf16 v[120:135], v[76:79], v[36:39], v[120:135]
ds_read_b128 v[72:75], v11 offset:0
ds_read_b32 v76, v12 offset:0
v_exp_f32_e64 v112, v112
v_cvt_pk_bf16_f32 v106, v108, v109
v_cvt_pk_bf16_f32 v107, v110, v111
v_exp_f32 v113, v113
v_exp_f32_e64 v114, v114
s_waitcnt lgkmcnt(8)
v_mfma_f32_32x32x16_bf16 v[136:151], v[88:91], v[104:107], v[136:151]
v_exp_f32 v115, v115
v_exp_f32 v116, v116
v_exp_f32_e64 v117, v117
v_cvt_pk_bf16_f32 v112, v112, v113
v_cvt_pk_bf16_f32 v113, v114, v115
v_exp_f32 v118, v118
v_exp_f32 v119, v119
v_cvt_pk_bf16_f32 v114, v116, v117
v_cvt_pk_bf16_f32 v115, v118, v119
v_add_f32 v212, 897988541, v178
v_rcp_f32 v212, v212
v_sub_f32 v213, 1.0, v20
v_mul_f32_e64 v212, v212, v213
v_pk_mul_f32 v[168:169], v[168:169], v[212:213] op_sel_hi:[1,0]
v_pk_mul_f32 v[170:171], v[170:171], v[212:213] op_sel_hi:[1,0]
v_pk_mul_f32 v[172:173], v[172:173], v[212:213] op_sel_hi:[1,0]
v_pk_mul_f32 v[174:175], v[174:175], v[212:213] op_sel_hi:[1,0]
v_pk_mul_f32 v[176:177], v[176:177], v[212:213] op_sel_hi:[1,0]
v_cvt_pk_bf16_f32 v168, v168, v169
v_cvt_pk_bf16_f32 v169, v170, v171
v_cvt_pk_bf16_f32 v170, v172, v173
v_cvt_pk_bf16_f32 v171, v174, v175
buffer_store_dwordx4 v[168:171], v1, s[28:31], s6 offen sc1
v_cvt_pk_bf16_f32 v252, v176, v177
v_add_f32 v214, 897988541, v194
v_rcp_f32 v214, v214
v_sub_f32 v215, 1.0, v21
v_mul_f32_e64 v214, v214, v215
v_pk_mul_f32 v[184:185], v[184:185], v[214:215] op_sel_hi:[1,0]
v_pk_mul_f32 v[186:187], v[186:187], v[214:215] op_sel_hi:[1,0]
v_pk_mul_f32 v[188:189], v[188:189], v[214:215] op_sel_hi:[1,0]
v_pk_mul_f32 v[190:191], v[190:191], v[214:215] op_sel_hi:[1,0]
v_pk_mul_f32 v[192:193], v[192:193], v[214:215] op_sel_hi:[1,0]
v_cvt_pk_bf16_f32 v184, v184, v185
v_cvt_pk_bf16_f32 v185, v186, v187
v_cvt_pk_bf16_f32 v186, v188, v189
v_cvt_pk_bf16_f32 v187, v190, v191
buffer_store_dwordx4 v[184:187], v1, s[28:31], s7 offen sc1
v_cvt_pk_bf16_f32 v253, v192, v193
v_cndmask_b32 v248, v252, v253, s[60:61]
s_nop 1
v_mov_b32_dpp v249, v248 quad_perm:[1,1,1,1] row_mask:0xf bank_mask:0xf
v_mov_b32_dpp v250, v248 quad_perm:[2,2,2,2] row_mask:0xf bank_mask:0xf
v_mov_b32_dpp v251, v248 quad_perm:[3,3,3,3] row_mask:0xf bank_mask:0xf
buffer_store_dwordx4 v[248:251], v18, s[32:35], s9 offen sc1
v_exp_f32 v120, v120
v_exp_f32_e64 v121, v121
v_mfma_f32_32x32x16_bf16 v[136:151], v[92:95], v[112:115], v[136:151]
v_exp_f32 v122, v122
v_exp_f32 v123, v123
v_exp_f32 v124, v124
s_waitcnt lgkmcnt(6)
v_mfma_f32_32x32x16_bf16 v[104:119], v[80:83], v[32:35], v[40:55]
v_exp_f32_e64 v125, v125
v_cvt_pk_bf16_f32 v120, v120, v121
v_cvt_pk_bf16_f32 v121, v122, v123
v_exp_f32 v126, v126
v_exp_f32 v127, v127
v_mfma_f32_32x32x16_bf16 v[104:119], v[84:87], v[36:39], v[104:119]
ds_read_b128 v[80:83], v11 offset:2432
ds_read_b32 v84, v12 offset:2432
v_exp_f32_e64 v128, v128
v_cvt_pk_bf16_f32 v122, v124, v125
v_cvt_pk_bf16_f32 v123, v126, v127
v_exp_f32 v129, v129
v_exp_f32 v130, v130
v_mfma_f32_32x32x16_bf16 v[152:167], v[88:91], v[120:123], v[152:167]
v_exp_f32 v131, v131
v_exp_f32 v132, v132
v_exp_f32_e64 v133, v133
v_cvt_pk_bf16_f32 v128, v128, v129
v_cvt_pk_bf16_f32 v129, v130, v131
v_exp_f32 v134, v134
v_exp_f32 v135, v135
v_cvt_pk_bf16_f32 v130, v132, v133
v_cvt_pk_bf16_f32 v131, v134, v135
v_exp_f32 v104, v104
v_exp_f32 v105, v105
v_mfma_f32_32x32x16_bf16 v[152:167], v[92:95], v[128:131], v[152:167]
ds_read_b64_tr_b16 v[88:89], v13 offset:0
ds_read_b64_tr_b16 v[90:91], v14 offset:0
ds_read_b64_tr_b16 v[92:93], v15 offset:0
ds_read_b64_tr_b16 v[94:95], v16 offset:0
v_exp_f32 v106, v106
v_exp_f32 v107, v107
v_exp_f32 v108, v108
s_waitcnt lgkmcnt(6)
v_mfma_f32_32x32x16_bf16 v[120:135], v[72:75], v[24:27], v[56:71]
v_exp_f32_e64 v109, v109
v_cvt_pk_bf16_f32 v104, v104, v105
v_cvt_pk_bf16_f32 v105, v106, v107
v_exp_f32 v110, v110
v_exp_f32 v111, v111
v_mfma_f32_32x32x16_bf16 v[120:135], v[76:79], v[28:31], v[120:135]
ds_read_b128 v[72:75], v11 offset:4864
ds_read_b32 v76, v12 offset:4864
v_exp_f32_e64 v112, v112
v_cvt_pk_bf16_f32 v106, v108, v109
v_cvt_pk_bf16_f32 v107, v110, v111
v_exp_f32 v113, v113
v_exp_f32 v114, v114
v_mfma_f32_32x32x16_bf16 v[152:167], v[96:99], v[104:107], v[152:167]
v_exp_f32 v115, v115
v_exp_f32 v116, v116
v_exp_f32_e64 v117, v117
v_cvt_pk_bf16_f32 v112, v112, v113
v_cvt_pk_bf16_f32 v113, v114, v115
v_exp_f32 v118, v118
v_exp_f32 v119, v119
v_cvt_pk_bf16_f32 v114, v116, v117
v_cvt_pk_bf16_f32 v115, v118, v119
v_exp_f32 v120, v120
v_exp_f32 v121, v121
v_mfma_f32_32x32x16_bf16 v[152:167], v[100:103], v[112:115], v[152:167]
ds_read_b64_tr_b16 v[96:97], v13 offset:2432
ds_read_b64_tr_b16 v[98:99], v14 offset:2432
ds_read_b64_tr_b16 v[100:101], v15 offset:2432
ds_read_b64_tr_b16 v[102:103], v16 offset:2432
v_exp_f32 v122, v122
v_exp_f32 v123, v123
v_exp_f32 v124, v124
s_waitcnt lgkmcnt(10)
v_mfma_f32_32x32x16_bf16 v[104:119], v[80:83], v[24:27], 0
v_exp_f32_e64 v125, v125
v_cvt_pk_bf16_f32 v120, v120, v121
v_cvt_pk_bf16_f32 v121, v122, v123
v_exp_f32 v126, v126
v_exp_f32 v127, v127
v_mfma_f32_32x32x16_bf16 v[104:119], v[84:87], v[28:31], v[104:119]
v_exp_f32_e64 v128, v128
v_cvt_pk_bf16_f32 v122, v124, v125
v_cvt_pk_bf16_f32 v123, v126, v127
v_exp_f32 v129, v129
v_exp_f32_e64 v130, v130
s_waitcnt lgkmcnt(6)
v_mfma_f32_32x32x16_bf16 v[136:151], v[88:91], v[120:123], v[136:151]
v_exp_f32 v131, v131
v_exp_f32 v132, v132
v_exp_f32_e64 v133, v133
v_cvt_pk_bf16_f32 v128, v128, v129
v_cvt_pk_bf16_f32 v129, v130, v131
v_exp_f32 v134, v134
v_exp_f32 v135, v135
v_cvt_pk_bf16_f32 v130, v132, v133
v_cvt_pk_bf16_f32 v131, v134, v135
v_exp_f32 v104, v104
v_exp_f32 v105, v105
v_mfma_f32_32x32x16_bf16 v[136:151], v[92:95], v[128:131], v[136:151]
ds_read_b64_tr_b16 v[88:89], v13 offset:4864
ds_read_b64_tr_b16 v[90:91], v14 offset:4864
ds_read_b64_tr_b16 v[92:93], v15 offset:4864
ds_read_b64_tr_b16 v[94:95], v16 offset:4864
v_exp_f32 v106, v106
v_exp_f32 v107, v107
v_exp_f32_e64 v108, v108
v_mfma_f32_32x32x16_bf16 v[120:135], v[80:83], v[32:35], v[56:71]
v_exp_f32_e64 v109, v109
v_cvt_pk_bf16_f32 v104, v104, v105
v_cvt_pk_bf16_f32 v105, v106, v107
v_exp_f32 v110, v110
v_exp_f32 v111, v111
v_mfma_f32_32x32x16_bf16 v[120:135], v[84:87], v[36:39], v[120:135]
ds_read_b128 v[80:83], v11 offset:7296
ds_read_b32 v84, v12 offset:7296
v_exp_f32_e64 v112, v112
v_cvt_pk_bf16_f32 v106, v108, v109
v_cvt_pk_bf16_f32 v107, v110, v111
v_exp_f32 v113, v113
v_exp_f32_e64 v114, v114
s_waitcnt lgkmcnt(6)
v_mfma_f32_32x32x16_bf16 v[136:151], v[96:99], v[104:107], v[136:151]
L_pdP3_2:
s_cbranch_execz L_pdP3_3
v_exp_f32 v115, v115
v_exp_f32 v116, v116
v_exp_f32 v117, v117
v_cvt_pk_bf16_f32 v112, v112, v113
v_cvt_pk_bf16_f32 v113, v114, v115
v_exp_f32 v118, v118
v_exp_f32 v119, v119
v_cvt_pk_bf16_f32 v114, v116, v117
v_cvt_pk_bf16_f32 v115, v118, v119
v_exp_f32 v120, v120
v_exp_f32 v121, v121
v_mfma_f32_32x32x16_bf16 v[136:151], v[100:103], v[112:115], v[136:151]
v_exp_f32 v122, v122
v_exp_f32 v123, v123
v_exp_f32_e64 v124, v124
v_mfma_f32_32x32x16_bf16 v[104:119], v[72:75], v[24:27], 0
v_exp_f32_e64 v125, v125
v_cvt_pk_bf16_f32 v120, v120, v121
v_cvt_pk_bf16_f32 v121, v122, v123
v_exp_f32 v126, v126
v_exp_f32 v127, v127
v_mfma_f32_32x32x16_bf16 v[104:119], v[76:79], v[28:31], v[104:119]
v_exp_f32_e64 v128, v128
v_cvt_pk_bf16_f32 v122, v124, v125
v_cvt_pk_bf16_f32 v123, v126, v127
v_exp_f32 v129, v129
v_exp_f32 v130, v130
v_mfma_f32_32x32x16_bf16 v[152:167], v[96:99], v[120:123], v[152:167]
v_exp_f32 v131, v131
v_exp_f32 v132, v132
v_exp_f32_e64 v133, v133
v_cvt_pk_bf16_f32 v128, v128, v129
v_cvt_pk_bf16_f32 v129, v130, v131
v_exp_f32 v134, v134
v_exp_f32 v135, v135
v_cvt_pk_bf16_f32 v130, v132, v133
v_cvt_pk_bf16_f32 v131, v134, v135
v_mov_b32_e64 v6, 1
v_mov_b32 v5, 161800
s_waitcnt vmcnt(0)
s_mov_b64 exec, 1
ds_add_u32 v5, v6
s_mov_b64 exec, -1
v_exp_f32 v104, v104
v_exp_f32_e64 v105, v105
v_mfma_f32_32x32x16_bf16 v[152:167], v[100:103], v[128:131], v[152:167]
ds_read_b64_tr_b16 v[96:97], v13 offset:7296
ds_read_b64_tr_b16 v[98:99], v14 offset:7296
ds_read_b64_tr_b16 v[100:101], v15 offset:7296
ds_read_b64_tr_b16 v[102:103], v16 offset:7296
v_exp_f32 v106, v106
v_exp_f32 v107, v107
v_exp_f32_e64 v108, v108
v_mfma_f32_32x32x16_bf16 v[120:135], v[72:75], v[32:35], 0
v_exp_f32_e64 v109, v109
v_cvt_pk_bf16_f32 v104, v104, v105
v_cvt_pk_bf16_f32 v105, v106, v107
v_exp_f32 v110, v110
v_exp_f32 v111, v111
v_mfma_f32_32x32x16_bf16 v[120:135], v[76:79], v[36:39], v[120:135]
v_exp_f32_e64 v112, v112
v_cvt_pk_bf16_f32 v106, v108, v109
v_cvt_pk_bf16_f32 v107, v110, v111
v_exp_f32 v113, v113
v_exp_f32_e64 v114, v114
s_waitcnt lgkmcnt(7)
v_mfma_f32_32x32x16_bf16 v[136:151], v[88:91], v[104:107], v[136:151]
v_exp_f32 v115, v115
v_exp_f32 v116, v116
v_exp_f32_e64 v117, v117
v_cvt_pk_bf16_f32 v112, v112, v113
v_cvt_pk_bf16_f32 v113, v114, v115
v_exp_f32 v118, v118
v_exp_f32 v119, v119
v_cvt_pk_bf16_f32 v114, v116, v117
v_cvt_pk_bf16_f32 v115, v118, v119
v_exp_f32 v120, v120
v_exp_f32 v121, v121
v_mfma_f32_32x32x16_bf16 v[136:151], v[92:95], v[112:115], v[136:151]
v_exp_f32 v122, v122
v_exp_f32 v123, v123
v_exp_f32 v124, v124
s_waitcnt lgkmcnt(5)
v_mfma_f32_32x32x16_bf16 v[104:119], v[80:83], v[24:27], 0
v_exp_f32_e64 v125, v125
v_cvt_pk_bf16_f32 v120, v120, v121
v_cvt_pk_bf16_f32 v121, v122, v123
v_exp_f32 v126, v126
v_exp_f32 v127, v127
v_mfma_f32_32x32x16_bf16 v[104:119], v[84:87], v[28:31], v[104:119]
v_exp_f32_e64 v128, v128
v_cvt_pk_bf16_f32 v122, v124, v125
v_cvt_pk_bf16_f32 v123, v126, v127
v_exp_f32 v129, v129
v_exp_f32 v130, v130
v_mfma_f32_32x32x16_bf16 v[152:167], v[88:91], v[120:123], v[152:167]
v_exp_f32 v131, v131
v_exp_f32 v132, v132
v_exp_f32_e64 v133, v133
v_cvt_pk_bf16_f32 v128, v128, v129
v_cvt_pk_bf16_f32 v129, v130, v131
v_exp_f32 v134, v134
v_exp_f32 v135, v135
v_cvt_pk_bf16_f32 v130, v132, v133
v_cvt_pk_bf16_f32 v131, v134, v135
v_exp_f32 v104, v104
v_exp_f32 v105, v105
v_mfma_f32_32x32x16_bf16 v[152:167], v[92:95], v[128:131], v[152:167]
v_exp_f32 v106, v106
v_exp_f32 v107, v107
v_exp_f32_e64 v108, v108
v_mfma_f32_32x32x16_bf16 v[120:135], v[80:83], v[32:35], 0
v_exp_f32_e64 v109, v109
v_cvt_pk_bf16_f32 v104, v104, v105
v_cvt_pk_bf16_f32 v105, v106, v107
v_exp_f32 v110, v110
v_exp_f32 v111, v111
v_mfma_f32_32x32x16_bf16 v[120:135], v[84:87], v[36:39], v[120:135]
v_exp_f32_e64 v112, v112
v_cvt_pk_bf16_f32 v106, v108, v109
v_cvt_pk_bf16_f32 v107, v110, v111
v_exp_f32 v113, v113
v_exp_f32_e64 v114, v114
s_waitcnt lgkmcnt(0)
v_mfma_f32_32x32x16_bf16 v[136:151], v[96:99], v[104:107], v[136:151]
v_exp_f32 v115, v115
v_exp_f32 v116, v116
v_exp_f32_e64 v117, v117
v_cvt_pk_bf16_f32 v112, v112, v113
v_cvt_pk_bf16_f32 v113, v114, v115
v_exp_f32 v118, v118
v_exp_f32 v119, v119
v_cvt_pk_bf16_f32 v114, v116, v117
v_cvt_pk_bf16_f32 v115, v118, v119
v_exp_f32 v120, v120
v_exp_f32 v121, v121
v_mfma_f32_32x32x16_bf16 v[136:151], v[100:103], v[112:115], v[136:151]
v_exp_f32 v122, v122
v_exp_f32 v123, v123
v_exp_f32 v124, v124
v_exp_f32 v125, v125
v_cvt_pk_bf16_f32 v120, v120, v121
v_cvt_pk_bf16_f32 v121, v122, v123
v_exp_f32 v126, v126
v_exp_f32 v127, v127
v_exp_f32_e64 v128, v128
v_cvt_pk_bf16_f32 v122, v124, v125
v_cvt_pk_bf16_f32 v123, v126, v127
v_exp_f32 v129, v129
v_exp_f32 v130, v130
v_mfma_f32_32x32x16_bf16 v[152:167], v[96:99], v[120:123], v[152:167]
v_exp_f32 v131, v131
v_exp_f32 v132, v132
v_exp_f32_e64 v133, v133
v_cvt_pk_bf16_f32 v128, v128, v129
v_cvt_pk_bf16_f32 v129, v130, v131
v_exp_f32 v134, v134
v_exp_f32 v135, v135
v_cvt_pk_bf16_f32 v130, v132, v133
v_cvt_pk_bf16_f32 v131, v134, v135
s_nop 1
v_mfma_f32_32x32x16_bf16 v[152:167], v[100:103], v[128:131], v[152:167]
s_branch L_attd
L_att2:
L_pdP0_3:
s_cbranch_execz L_pdP0_4
ds_read_b128 v[72:75], v11 offset:4864
ds_read_b32 v76, v12 offset:4864
ds_read_b128 v[80:83], v11 offset:7296
ds_read_b32 v84, v12 offset:7296
ds_read_b64_tr_b16 v[88:89], v13 offset:4864
ds_read_b64_tr_b16 v[90:91], v14 offset:4864
ds_read_b64_tr_b16 v[92:93], v15 offset:4864
ds_read_b64_tr_b16 v[94:95], v16 offset:4864
ds_read_b64_tr_b16 v[96:97], v13 offset:7296
ds_read_b64_tr_b16 v[98:99], v14 offset:7296
ds_read_b64_tr_b16 v[100:101], v15 offset:7296
ds_read_b64_tr_b16 v[102:103], v16 offset:7296
s_waitcnt lgkmcnt(10)
v_mfma_f32_32x32x16_bf16 v[104:119], v[72:75], v[24:27], 0
v_mfma_f32_32x32x16_bf16 v[104:119], v[76:79], v[28:31], v[104:119]
s_nop 11
v_exp_f32 v104, v104
v_exp_f32 v105, v105
v_exp_f32 v106, v106
v_exp_f32 v107, v107
v_exp_f32 v108, v108
v_mfma_f32_32x32x16_bf16 v[120:135], v[72:75], v[32:35], 0
v_exp_f32_e64 v109, v109
v_cvt_pk_bf16_f32 v104, v104, v105
v_cvt_pk_bf16_f32 v105, v106, v107
v_exp_f32 v110, v110
v_exp_f32 v111, v111
v_mfma_f32_32x32x16_bf16 v[120:135], v[76:79], v[36:39], v[120:135]
ds_read_b128 v[72:75], v11 offset:9728
ds_read_b32 v76, v12 offset:9728
v_exp_f32_e64 v112, v112
v_cvt_pk_bf16_f32 v106, v108, v109
v_cvt_pk_bf16_f32 v107, v110, v111
v_exp_f32 v113, v113
v_exp_f32_e64 v114, v114
s_waitcnt lgkmcnt(6)
v_mfma_f32_32x32x16_bf16 v[136:151], v[88:91], v[104:107], 0
v_exp_f32 v115, v115
v_exp_f32 v116, v116
v_exp_f32_e64 v117, v117
v_cvt_pk_bf16_f32 v112, v112, v113
v_cvt_pk_bf16_f32 v113, v114, v115
v_exp_f32 v118, v118
v_exp_f32 v119, v119
v_cvt_pk_bf16_f32 v114, v116, v117
v_cvt_pk_bf16_f32 v115, v118, v119
v_exp_f32 v120, v120
v_exp_f32 v121, v121
v_mfma_f32_32x32x16_bf16 v[136:151], v[92:95], v[112:115], v[136:151]
v_exp_f32 v122, v122
v_exp_f32 v123, v123
v_exp_f32_e64 v124, v124
v_mfma_f32_32x32x16_bf16 v[104:119], v[80:83], v[24:27], 0
v_exp_f32_e64 v125, v125
v_cvt_pk_bf16_f32 v120, v120, v121
v_cvt_pk_bf16_f32 v121, v122, v123
v_exp_f32 v126, v126
v_exp_f32 v127, v127
v_mfma_f32_32x32x16_bf16 v[104:119], v[84:87], v[28:31], v[104:119]
v_exp_f32_e64 v128, v128
v_cvt_pk_bf16_f32 v122, v124, v125
v_cvt_pk_bf16_f32 v123, v126, v127
v_exp_f32 v129, v129
v_exp_f32 v130, v130
v_mfma_f32_32x32x16_bf16 v[152:167], v[88:91], v[120:123], 0
v_exp_f32 v131, v131
v_exp_f32 v132, v132
v_exp_f32_e64 v133, v133
v_cvt_pk_bf16_f32 v128, v128, v129
v_cvt_pk_bf16_f32 v129, v130, v131
v_exp_f32 v134, v134
v_exp_f32 v135, v135
v_cvt_pk_bf16_f32 v130, v132, v133
v_cvt_pk_bf16_f32 v131, v134, v135
v_exp_f32 v104, v104
v_exp_f32 v105, v105
v_mfma_f32_32x32x16_bf16 v[152:167], v[92:95], v[128:131], v[152:167]
ds_read_b64_tr_b16 v[88:89], v13 offset:9728
ds_read_b64_tr_b16 v[90:91], v14 offset:9728
ds_read_b64_tr_b16 v[92:93], v15 offset:9728
ds_read_b64_tr_b16 v[94:95], v16 offset:9728
v_exp_f32 v106, v106
v_exp_f32 v107, v107
v_exp_f32_e64 v108, v108
v_mfma_f32_32x32x16_bf16 v[120:135], v[80:83], v[32:35], 0
v_exp_f32_e64 v109, v109
v_cvt_pk_bf16_f32 v104, v104, v105
v_cvt_pk_bf16_f32 v105, v106, v107
v_exp_f32 v110, v110
v_exp_f32 v111, v111
v_mfma_f32_32x32x16_bf16 v[120:135], v[84:87], v[36:39], v[120:135]
ds_read_b128 v[80:83], v11 offset:12160
ds_read_b32 v84, v12 offset:12160
v_exp_f32_e64 v112, v112
v_cvt_pk_bf16_f32 v106, v108, v109
v_cvt_pk_bf16_f32 v107, v110, v111
v_exp_f32 v113, v113
v_exp_f32_e64 v114, v114
s_waitcnt lgkmcnt(8)
v_mfma_f32_32x32x16_bf16 v[136:151], v[96:99], v[104:107], v[136:151]
v_exp_f32 v115, v115
v_exp_f32 v116, v116
v_exp_f32_e64 v117, v117
v_cvt_pk_bf16_f32 v112, v112, v113
v_cvt_pk_bf16_f32 v113, v114, v115
v_exp_f32 v118, v118
v_exp_f32 v119, v119
v_cvt_pk_bf16_f32 v114, v116, v117
v_cvt_pk_bf16_f32 v115, v118, v119
v_exp_f32 v120, v120
v_exp_f32 v121, v121
v_mfma_f32_32x32x16_bf16 v[136:151], v[100:103], v[112:115], v[136:151]
v_exp_f32 v122, v122
v_exp_f32 v123, v123
v_exp_f32 v124, v124
s_waitcnt lgkmcnt(6)
v_mfma_f32_32x32x16_bf16 v[104:119], v[72:75], v[24:27], 0
v_exp_f32_e64 v125, v125
v_cvt_pk_bf16_f32 v120, v120, v121
v_cvt_pk_bf16_f32 v121, v122, v123
v_exp_f32 v126, v126
v_exp_f32 v127, v127
v_mfma_f32_32x32x16_bf16 v[104:119], v[76:79], v[28:31], v[104:119]
v_exp_f32_e64 v128, v128
v_cvt_pk_bf16_f32 v122, v124, v125
v_cvt_pk_bf16_f32 v123, v126, v127
v_exp_f32 v129, v129
v_exp_f32 v130, v130
v_mfma_f32_32x32x16_bf16 v[152:167], v[96:99], v[120:123], v[152:167]
v_exp_f32 v131, v131
v_exp_f32 v132, v132
v_exp_f32_e64 v133, v133
v_cvt_pk_bf16_f32 v128, v128, v129
v_cvt_pk_bf16_f32 v129, v130, v131
v_exp_f32 v134, v134
v_exp_f32 v135, v135
v_cvt_pk_bf16_f32 v130, v132, v133
v_cvt_pk_bf16_f32 v131, v134, v135
v_exp_f32 v104, v104
v_exp_f32 v105, v105
v_mfma_f32_32x32x16_bf16 v[152:167], v[100:103], v[128:131], v[152:167]
ds_read_b64_tr_b16 v[96:97], v13 offset:12160
ds_read_b64_tr_b16 v[98:99], v14 offset:12160
ds_read_b64_tr_b16 v[100:101], v15 offset:12160
ds_read_b64_tr_b16 v[102:103], v16 offset:12160
v_exp_f32 v106, v106
v_exp_f32 v107, v107
v_exp_f32_e64 v108, v108
v_mfma_f32_32x32x16_bf16 v[120:135], v[72:75], v[32:35], 0
v_exp_f32_e64 v109, v109
v_cvt_pk_bf16_f32 v104, v104, v105
v_cvt_pk_bf16_f32 v105, v106, v107
v_exp_f32 v110, v110
v_exp_f32 v111, v111
v_mfma_f32_32x32x16_bf16 v[120:135], v[76:79], v[36:39], v[120:135]
s_barrier
ds_read_b128 v[72:75], v11 offset:14592
ds_read_b32 v76, v12 offset:14592
v_exp_f32 v112, v112
v_cvt_pk_bf16_f32 v106, v108, v109
v_cvt_pk_bf16_f32 v107, v110, v111
v_exp_f32 v113, v113
v_exp_f32_e64 v114, v114
s_waitcnt lgkmcnt(8)
v_mfma_f32_32x32x16_bf16 v[136:151], v[88:91], v[104:107], v[136:151]
v_exp_f32 v115, v115
v_exp_f32 v116, v116
v_exp_f32_e64 v117, v117
v_cvt_pk_bf16_f32 v112, v112, v113
v_cvt_pk_bf16_f32 v113, v114, v115
v_exp_f32 v118, v118
v_exp_f32 v119, v119
v_cvt_pk_bf16_f32 v114, v116, v117
v_cvt_pk_bf16_f32 v115, v118, v119
v_exp_f32 v120, v120
v_exp_f32 v121, v121
v_mfma_f32_32x32x16_bf16 v[136:151], v[92:95], v[112:115], v[136:151]
v_exp_f32 v122, v122
v_exp_f32 v123, v123
v_exp_f32 v124, v124
s_waitcnt lgkmcnt(6)
v_mfma_f32_32x32x16_bf16 v[104:119], v[80:83], v[24:27], 0
v_exp_f32_e64 v125, v125
v_cvt_pk_bf16_f32 v120, v120, v121
v_cvt_pk_bf16_f32 v121, v122, v123
v_exp_f32 v126, v126
v_exp_f32 v127, v127
v_mfma_f32_32x32x16_bf16 v[104:119], v[84:87], v[28:31], v[104:119]
v_exp_f32_e64 v128, v128
v_cvt_pk_bf16_f32 v122, v124, v125
v_cvt_pk_bf16_f32 v123, v126, v127
v_exp_f32 v129, v129
v_exp_f32 v130, v130
v_mfma_f32_32x32x16_bf16 v[152:167], v[88:91], v[120:123], v[152:167]
s_barrier
ds_read_b64 v[200:201], v17 offset:0
ds_read_b64 v[202:203], v17 offset:8
ds_read_b64 v[204:205], v17 offset:16
ds_read_b64 v[206:207], v17 offset:24
ds_read_b32 v208, v17 offset:32
ds_read_b32 v20, v19
ds_read_b32 v21, v19 offset:32
v_exp_f32 v131, v131
v_exp_f32 v132, v132
v_exp_f32 v133, v133
v_cvt_pk_bf16_f32 v128, v128, v129
v_cvt_pk_bf16_f32 v129, v130, v131
v_exp_f32 v134, v134
v_exp_f32 v135, v135
v_cvt_pk_bf16_f32 v130, v132, v133
v_cvt_pk_bf16_f32 v131, v134, v135
v_exp_f32 v104, v104
v_exp_f32 v105, v105
v_mfma_f32_32x32x16_bf16 v[152:167], v[92:95], v[128:131], v[152:167]
ds_read_b64_tr_b16 v[88:89], v13 offset:14592
ds_read_b64_tr_b16 v[90:91], v14 offset:14592
ds_read_b64_tr_b16 v[92:93], v15 offset:14592
ds_read_b64_tr_b16 v[94:95], v16 offset:14592
v_exp_f32 v106, v106
v_exp_f32 v107, v107
v_exp_f32_e64 v108, v108
v_mfma_f32_32x32x16_bf16 v[120:135], v[80:83], v[32:35], 0
v_exp_f32_e64 v109, v109
v_cvt_pk_bf16_f32 v104, v104, v105
v_cvt_pk_bf16_f32 v105, v106, v107
v_exp_f32 v110, v110
v_exp_f32 v111, v111
v_mfma_f32_32x32x16_bf16 v[120:135], v[84:87], v[36:39], v[120:135]
ds_read_b128 v[80:83], v11 offset:17024
ds_read_b32 v84, v12 offset:17024
v_exp_f32_e64 v112, v112
v_cvt_pk_bf16_f32 v106, v108, v109
v_cvt_pk_bf16_f32 v107, v110, v111
v_exp_f32 v113, v113
v_exp_f32_e64 v114, v114
s_waitcnt lgkmcnt(15)
v_mfma_f32_32x32x16_bf16 v[136:151], v[96:99], v[104:107], v[136:151]
v_exp_f32 v115, v115
v_exp_f32_e64 v116, v116
s_waitcnt lgkmcnt(6)
v_mfma_f32_32x32x16_bf16 v[168:183], v[200:203], v[224:227], 0
v_exp_f32_e64 v117, v117
v_cvt_pk_bf16_f32 v112, v112, v113
v_cvt_pk_bf16_f32 v113, v114, v115
v_mfma_f32_32x32x16_bf16 v[184:199], v[200:203], v[236:239], 0
v_exp_f32 v118, v118
v_exp_f32 v119, v119
v_mfma_f32_32x32x16_bf16 v[168:183], v[204:207], v[228:231], v[168:183]
v_cvt_pk_bf16_f32 v114, v116, v117
v_cvt_pk_bf16_f32 v115, v118, v119
v_exp_f32 v120, v120
v_exp_f32 v121, v121
v_mfma_f32_32x32x16_bf16 v[136:151], v[100:103], v[112:115], v[136:151]
v_exp_f32 v122, v122
v_exp_f32 v123, v123
v_exp_f32_e64 v124, v124
v_mfma_f32_32x32x16_bf16 v[104:119], v[72:75], v[24:27], 0
v_exp_f32_e64 v125, v125
v_cvt_pk_bf16_f32 v120, v120, v121
v_cvt_pk_bf16_f32 v121, v122, v123
v_exp_f32 v126, v126
v_exp_f32 v127, v127
v_mfma_f32_32x32x16_bf16 v[104:119], v[76:79], v[28:31], v[104:119]
v_exp_f32_e64 v128, v128
v_cvt_pk_bf16_f32 v122, v124, v125
v_cvt_pk_bf16_f32 v123, v126, v127
v_exp_f32 v129, v129
v_exp_f32 v130, v130
v_mfma_f32_32x32x16_bf16 v[152:167], v[96:99], v[120:123], v[152:167]
v_exp_f32 v131, v131
v_exp_f32 v132, v132
v_mfma_f32_32x32x16_bf16 v[184:199], v[204:207], v[240:243], v[184:199]
v_exp_f32_e64 v133, v133
v_cvt_pk_bf16_f32 v128, v128, v129
v_cvt_pk_bf16_f32 v129, v130, v131
v_mfma_f32_32x32x16_bf16 v[168:183], v[208:211], v[232:235], v[168:183]
v_exp_f32 v134, v134
v_exp_f32 v135, v135
v_mfma_f32_32x32x16_bf16 v[184:199], v[208:211], v[244:247], v[184:199]
v_cvt_pk_bf16_f32 v130, v132, v133
v_cvt_pk_bf16_f32 v131, v134, v135
v_exp_f32 v104, v104
v_exp_f32 v105, v105
v_mfma_f32_32x32x16_bf16 v[152:167], v[100:103], v[128:131], v[152:167]
ds_read_b64_tr_b16 v[96:97], v13 offset:17024
ds_read_b64_tr_b16 v[98:99], v14 offset:17024
ds_read_b64_tr_b16 v[100:101], v15 offset:17024
ds_read_b64_tr_b16 v[102:103], v16 offset:17024
v_exp_f32 v106, v106
v_exp_f32 v107, v107
v_exp_f32_e64 v108, v108
v_mfma_f32_32x32x16_bf16 v[120:135], v[72:75], v[32:35], 0
v_exp_f32_e64 v109, v109
v_cvt_pk_bf16_f32 v104, v104, v105
v_cvt_pk_bf16_f32 v105, v106, v107
v_exp_f32 v110, v110
v_exp_f32 v111, v111
v_mfma_f32_32x32x16_bf16 v[120:135], v[76:79], v[36:39], v[120:135]
ds_read_b128 v[72:75], v11 offset:19456
ds_read_b32 v76, v12 offset:19456
v_exp_f32_e64 v112, v112
v_cvt_pk_bf16_f32 v106, v108, v109
v_cvt_pk_bf16_f32 v107, v110, v111
v_exp_f32 v113, v113
v_exp_f32_e64 v114, v114
s_waitcnt lgkmcnt(8)
v_mfma_f32_32x32x16_bf16 v[136:151], v[88:91], v[104:107], v[136:151]
v_exp_f32 v115, v115
v_exp_f32 v116, v116
v_exp_f32_e64 v117, v117
v_cvt_pk_bf16_f32 v112, v112, v113
v_cvt_pk_bf16_f32 v113, v114, v115
v_exp_f32 v118, v118
v_exp_f32 v119, v119
v_cvt_pk_bf16_f32 v114, v116, v117
v_cvt_pk_bf16_f32 v115, v118, v119
v_add_f32 v212, 897988541, v178
v_rcp_f32 v212, v212
v_sub_f32 v213, 1.0, v20
v_mul_f32_e64 v212, v212, v213
v_pk_mul_f32 v[168:169], v[168:169], v[212:213] op_sel_hi:[1,0]
v_pk_mul_f32 v[170:171], v[170:171], v[212:213] op_sel_hi:[1,0]
v_pk_mul_f32 v[172:173], v[172:173], v[212:213] op_sel_hi:[1,0]
v_pk_mul_f32 v[174:175], v[174:175], v[212:213] op_sel_hi:[1,0]
v_pk_mul_f32 v[176:177], v[176:177], v[212:213] op_sel_hi:[1,0]
v_cvt_pk_bf16_f32 v168, v168, v169
v_cvt_pk_bf16_f32 v169, v170, v171
v_cvt_pk_bf16_f32 v170, v172, v173
v_cvt_pk_bf16_f32 v171, v174, v175
buffer_store_dwordx4 v[168:171], v1, s[28:31], s6 offen sc1
v_cvt_pk_bf16_f32 v252, v176, v177
v_add_f32 v214, 897988541, v194
v_rcp_f32 v214, v214
v_sub_f32 v215, 1.0, v21
v_mul_f32_e64 v214, v214, v215
v_pk_mul_f32 v[184:185], v[184:185], v[214:215] op_sel_hi:[1,0]
v_pk_mul_f32 v[186:187], v[186:187], v[214:215] op_sel_hi:[1,0]
v_pk_mul_f32 v[188:189], v[188:189], v[214:215] op_sel_hi:[1,0]
v_pk_mul_f32 v[190:191], v[190:191], v[214:215] op_sel_hi:[1,0]
v_pk_mul_f32 v[192:193], v[192:193], v[214:215] op_sel_hi:[1,0]
v_cvt_pk_bf16_f32 v184, v184, v185
v_cvt_pk_bf16_f32 v185, v186, v187
v_cvt_pk_bf16_f32 v186, v188, v189
v_cvt_pk_bf16_f32 v187, v190, v191
buffer_store_dwordx4 v[184:187], v1, s[28:31], s7 offen sc1
v_cvt_pk_bf16_f32 v253, v192, v193
v_cndmask_b32 v248, v252, v253, s[60:61]
s_nop 1
v_mov_b32_dpp v249, v248 quad_perm:[1,1,1,1] row_mask:0xf bank_mask:0xf
v_mov_b32_dpp v250, v248 quad_perm:[2,2,2,2] row_mask:0xf bank_mask:0xf
v_mov_b32_dpp v251, v248 quad_perm:[3,3,3,3] row_mask:0xf bank_mask:0xf
buffer_store_dwordx4 v[248:251], v18, s[32:35], s9 offen sc1
v_exp_f32 v120, v120
v_exp_f32_e64 v121, v121
v_mfma_f32_32x32x16_bf16 v[136:151], v[92:95], v[112:115], v[136:151]
v_exp_f32 v122, v122
v_exp_f32 v123, v123
v_exp_f32 v124, v124
s_waitcnt lgkmcnt(6)
v_mfma_f32_32x32x16_bf16 v[104:119], v[80:83], v[24:27], 0
v_exp_f32_e64 v125, v125
v_cvt_pk_bf16_f32 v120, v120, v121
v_cvt_pk_bf16_f32 v121, v122, v123
v_exp_f32 v126, v126
v_exp_f32 v127, v127
v_mfma_f32_32x32x16_bf16 v[104:119], v[84:87], v[28:31], v[104:119]
v_exp_f32_e64 v128, v128
v_cvt_pk_bf16_f32 v122, v124, v125
v_cvt_pk_bf16_f32 v123, v126, v127
v_exp_f32 v129, v129
v_exp_f32 v130, v130
v_mfma_f32_32x32x16_bf16 v[152:167], v[88:91], v[120:123], v[152:167]
v_exp_f32 v131, v131
v_exp_f32 v132, v132
v_exp_f32_e64 v133, v133
v_cvt_pk_bf16_f32 v128, v128, v129
v_cvt_pk_bf16_f32 v129, v130, v131
v_exp_f32 v134, v134
v_exp_f32 v135, v135
v_cvt_pk_bf16_f32 v130, v132, v133
v_cvt_pk_bf16_f32 v131, v134, v135
v_exp_f32 v104, v104
v_exp_f32 v105, v105
v_mfma_f32_32x32x16_bf16 v[152:167], v[92:95], v[128:131], v[152:167]
ds_read_b64_tr_b16 v[88:89], v13 offset:19456
ds_read_b64_tr_b16 v[90:91], v14 offset:19456
ds_read_b64_tr_b16 v[92:93], v15 offset:19456
ds_read_b64_tr_b16 v[94:95], v16 offset:19456
v_exp_f32 v106, v106
v_exp_f32 v107, v107
v_exp_f32_e64 v108, v108
v_mfma_f32_32x32x16_bf16 v[120:135], v[80:83], v[32:35], 0
v_exp_f32_e64 v109, v109
v_cvt_pk_bf16_f32 v104, v104, v105
v_cvt_pk_bf16_f32 v105, v106, v107
v_exp_f32 v110, v110
v_exp_f32 v111, v111
v_mfma_f32_32x32x16_bf16 v[120:135], v[84:87], v[36:39], v[120:135]
ds_read_b128 v[80:83], v11 offset:21888
ds_read_b32 v84, v12 offset:21888
v_exp_f32_e64 v112, v112
v_cvt_pk_bf16_f32 v106, v108, v109
v_cvt_pk_bf16_f32 v107, v110, v111
v_exp_f32 v113, v113
v_exp_f32_e64 v114, v114
s_waitcnt lgkmcnt(8)
v_mfma_f32_32x32x16_bf16 v[136:151], v[96:99], v[104:107], v[136:151]
v_exp_f32 v115, v115
v_exp_f32 v116, v116
v_exp_f32_e64 v117, v117
v_cvt_pk_bf16_f32 v112, v112, v113
v_cvt_pk_bf16_f32 v113, v114, v115
v_exp_f32 v118, v118
v_exp_f32 v119, v119
v_cvt_pk_bf16_f32 v114, v116, v117
v_cvt_pk_bf16_f32 v115, v118, v119
v_exp_f32 v120, v120
v_exp_f32 v121, v121
v_mfma_f32_32x32x16_bf16 v[136:151], v[100:103], v[112:115], v[136:151]
v_exp_f32 v122, v122
v_exp_f32 v123, v123
v_exp_f32 v124, v124
s_waitcnt lgkmcnt(6)
v_mfma_f32_32x32x16_bf16 v[104:119], v[72:75], v[24:27], v[40:55]
v_exp_f32_e64 v125, v125
v_cvt_pk_bf16_f32 v120, v120, v121
v_cvt_pk_bf16_f32 v121, v122, v123
v_exp_f32 v126, v126
v_exp_f32 v127, v127
v_mfma_f32_32x32x16_bf16 v[104:119], v[76:79], v[28:31], v[104:119]
v_exp_f32_e64 v128, v128
v_cvt_pk_bf16_f32 v122, v124, v125
v_cvt_pk_bf16_f32 v123, v126, v127
v_exp_f32 v129, v129
v_exp_f32 v130, v130
v_mfma_f32_32x32x16_bf16 v[152:167], v[96:99], v[120:123], v[152:167]
v_exp_f32 v131, v131
v_exp_f32 v132, v132
v_exp_f32_e64 v133, v133
v_cvt_pk_bf16_f32 v128, v128, v129
v_cvt_pk_bf16_f32 v129, v130, v131
v_exp_f32 v134, v134
v_exp_f32 v135, v135
v_cvt_pk_bf16_f32 v130, v132, v133
v_cvt_pk_bf16_f32 v131, v134, v135
v_exp_f32 v104, v104
v_exp_f32 v105, v105
v_mfma_f32_32x32x16_bf16 v[152:167], v[100:103], v[128:131], v[152:167]
ds_read_b64_tr_b16 v[96:97], v13 offset:21888
ds_read_b64_tr_b16 v[98:99], v14 offset:21888
ds_read_b64_tr_b16 v[100:101], v15 offset:21888
ds_read_b64_tr_b16 v[102:103], v16 offset:21888
v_exp_f32 v106, v106
v_exp_f32 v107, v107
v_exp_f32_e64 v108, v108
v_mfma_f32_32x32x16_bf16 v[120:135], v[72:75], v[32:35], 0
v_exp_f32_e64 v109, v109
v_cvt_pk_bf16_f32 v104, v104, v105
v_cvt_pk_bf16_f32 v105, v106, v107
v_exp_f32 v110, v110
v_exp_f32 v111, v111
v_mfma_f32_32x32x16_bf16 v[120:135], v[76:79], v[36:39], v[120:135]
ds_read_b128 v[72:75], v11 offset:0
ds_read_b32 v76, v12 offset:0
v_exp_f32_e64 v112, v112
v_cvt_pk_bf16_f32 v106, v108, v109
v_cvt_pk_bf16_f32 v107, v110, v111
v_exp_f32 v113, v113
v_exp_f32 v114, v114
L_pdP1_3:
s_cbranch_execz L_pdP1_4
s_waitcnt lgkmcnt(8)
v_mfma_f32_32x32x16_bf16 v[136:151], v[88:91], v[104:107], v[136:151]
v_exp_f32 v115, v115
v_exp_f32 v116, v116
v_exp_f32_e64 v117, v117
v_cvt_pk_bf16_f32 v112, v112, v113
v_cvt_pk_bf16_f32 v113, v114, v115
v_exp_f32 v118, v118
v_exp_f32 v119, v119
v_cvt_pk_bf16_f32 v114, v116, v117
v_cvt_pk_bf16_f32 v115, v118, v119
v_exp_f32 v120, v120
v_exp_f32 v121, v121
v_mfma_f32_32x32x16_bf16 v[136:151], v[92:95], v[112:115], v[136:151]
v_exp_f32 v122, v122
v_exp_f32 v123, v123
v_exp_f32 v124, v124
s_waitcnt lgkmcnt(6)
v_mfma_f32_32x32x16_bf16 v[104:119], v[80:83], v[32:35], v[40:55]
v_exp_f32_e64 v125, v125
v_cvt_pk_bf16_f32 v120, v120, v121
v_cvt_pk_bf16_f32 v121, v122, v123
v_exp_f32 v126, v126
v_exp_f32 v127, v127
v_mfma_f32_32x32x16_bf16 v[104:119], v[84:87], v[36:39], v[104:119]
ds_read_b128 v[80:83], v11 offset:2432
ds_read_b32 v84, v12 offset:2432
v_exp_f32_e64 v128, v128
v_cvt_pk_bf16_f32 v122, v124, v125
v_cvt_pk_bf16_f32 v123, v126, v127
v_exp_f32 v129, v129
v_exp_f32 v130, v130
v_mfma_f32_32x32x16_bf16 v[152:167], v[88:91], v[120:123], v[152:167]
v_exp_f32 v131, v131
v_exp_f32 v132, v132
v_exp_f32_e64 v133, v133
v_cvt_pk_bf16_f32 v128, v128, v129
v_cvt_pk_bf16_f32 v129, v130, v131
v_exp_f32 v134, v134
v_exp_f32 v135, v135
v_cvt_pk_bf16_f32 v130, v132, v133
v_cvt_pk_bf16_f32 v131, v134, v135
v_mov_b32_e64 v6, 1
v_mov_b32 v5, 161800
s_waitcnt vmcnt(0)
s_mov_b64 exec, 1
ds_add_u32 v5, v6
s_mov_b64 exec, -1
v_exp_f32 v104, v104
v_exp_f32_e64 v105, v105
v_mfma_f32_32x32x16_bf16 v[152:167], v[92:95], v[128:131], v[152:167]
ds_read_b64_tr_b16 v[88:89], v13 offset:0
ds_read_b64_tr_b16 v[90:91], v14 offset:0
ds_read_b64_tr_b16 v[92:93], v15 offset:0
ds_read_b64_tr_b16 v[94:95], v16 offset:0
v_exp_f32 v106, v106
v_exp_f32 v107, v107
v_exp_f32 v108, v108
s_waitcnt lgkmcnt(7)
v_mfma_f32_32x32x16_bf16 v[120:135], v[72:75], v[24:27], v[56:71]
v_exp_f32_e64 v109, v109
v_cvt_pk_bf16_f32 v104, v104, v105
v_cvt_pk_bf16_f32 v105, v106, v107
v_exp_f32 v110, v110
v_exp_f32 v111, v111
v_mfma_f32_32x32x16_bf16 v[120:135], v[76:79], v[28:31], v[120:135]
v_exp_f32_e64 v112, v112
v_cvt_pk_bf16_f32 v106, v108, v109
v_cvt_pk_bf16_f32 v107, v110, v111
v_exp_f32 v113, v113
v_exp_f32 v114, v114
v_mfma_f32_32x32x16_bf16 v[152:167], v[96:99], v[104:107], v[152:167]
v_exp_f32 v115, v115
v_exp_f32 v116, v116
v_exp_f32_e64 v117, v117
v_cvt_pk_bf16_f32 v112, v112, v113
v_cvt_pk_bf16_f32 v113, v114, v115
v_exp_f32 v118, v118
v_exp_f32 v119, v119
v_cvt_pk_bf16_f32 v114, v116, v117
v_cvt_pk_bf16_f32 v115, v118, v119
v_exp_f32 v120, v120
v_exp_f32 v121, v121
v_mfma_f32_32x32x16_bf16 v[152:167], v[100:103], v[112:115], v[152:167]
ds_read_b64_tr_b16 v[96:97], v13 offset:2432
ds_read_b64_tr_b16 v[98:99], v14 offset:2432
ds_read_b64_tr_b16 v[100:101], v15 offset:2432
ds_read_b64_tr_b16 v[102:103], v16 offset:2432
v_exp_f32 v122, v122
v_exp_f32 v123, v123
v_exp_f32 v124, v124
s_waitcnt lgkmcnt(9)
v_mfma_f32_32x32x16_bf16 v[104:119], v[80:83], v[24:27], 0
v_exp_f32_e64 v125, v125
v_cvt_pk_bf16_f32 v120, v120, v121
v_cvt_pk_bf16_f32 v121, v122, v123
v_exp_f32 v126, v126
v_exp_f32 v127, v127
v_mfma_f32_32x32x16_bf16 v[104:119], v[84:87], v[28:31], v[104:119]
v_exp_f32_e64 v128, v128
v_cvt_pk_bf16_f32 v122, v124, v125
v_cvt_pk_bf16_f32 v123, v126, v127
v_exp_f32 v129, v129
v_exp_f32_e64 v130, v130
s_waitcnt lgkmcnt(4)
v_mfma_f32_32x32x16_bf16 v[136:151], v[88:91], v[120:123], v[136:151]
v_exp_f32 v131, v131
v_exp_f32 v132, v132
v_exp_f32_e64 v133, v133
v_cvt_pk_bf16_f32 v128, v128, v129
v_cvt_pk_bf16_f32 v129, v130, v131
v_exp_f32 v134, v134
v_exp_f32 v135, v135
v_cvt_pk_bf16_f32 v130, v132, v133
v_cvt_pk_bf16_f32 v131, v134, v135
v_exp_f32 v104, v104
v_exp_f32 v105, v105
v_mfma_f32_32x32x16_bf16 v[136:151], v[92:95], v[128:131], v[136:151]
v_exp_f32 v106, v106
v_exp_f32 v107, v107
v_exp_f32_e64 v108, v108
v_mfma_f32_32x32x16_bf16 v[120:135], v[80:83], v[32:35], v[56:71]
v_exp_f32_e64 v109, v109
v_cvt_pk_bf16_f32 v104, v104, v105
v_cvt_pk_bf16_f32 v105, v106, v107
v_exp_f32 v110, v110
v_exp_f32 v111, v111
v_mfma_f32_32x32x16_bf16 v[120:135], v[84:87], v[36:39], v[120:135]
v_exp_f32_e64 v112, v112
v_cvt_pk_bf16_f32 v106, v108, v109
v_cvt_pk_bf16_f32 v107, v110, v111
v_exp_f32 v113, v113
v_exp_f32_e64 v114, v114
s_waitcnt lgkmcnt(0)
v_mfma_f32_32x32x16_bf16 v[136:151], v[96:99], v[104:107], v[136:151]
v_exp_f32 v115, v115
v_exp_f32 v116, v116
v_exp_f32_e64 v117, v117
v_cvt_pk_bf16_f32 v112, v112, v113
v_cvt_pk_bf16_f32 v113, v114, v115
v_exp_f32 v118, v118
v_exp_f32 v119, v119
v_cvt_pk_bf16_f32 v114, v116, v117
v_cvt_pk_bf16_f32 v115, v118, v119
v_exp_f32 v120, v120
v_exp_f32 v121, v121
v_mfma_f32_32x32x16_bf16 v[136:151], v[100:103], v[112:115], v[136:151]
v_exp_f32 v122, v122
v_exp_f32 v123, v123
v_exp_f32 v124, v124
v_exp_f32 v125, v125
v_cvt_pk_bf16_f32 v120, v120, v121
v_cvt_pk_bf16_f32 v121, v122, v123
v_exp_f32 v126, v126
v_exp_f32 v127, v127
v_exp_f32_e64 v128, v128
v_cvt_pk_bf16_f32 v122, v124, v125
v_cvt_pk_bf16_f32 v123, v126, v127
v_exp_f32 v129, v129
v_exp_f32 v130, v130
v_mfma_f32_32x32x16_bf16 v[152:167], v[96:99], v[120:123], v[152:167]
v_exp_f32 v131, v131
v_exp_f32 v132, v132
v_exp_f32_e64 v133, v133
v_cvt_pk_bf16_f32 v128, v128, v129
v_cvt_pk_bf16_f32 v129, v130, v131
v_exp_f32 v134, v134
v_exp_f32 v135, v135
v_cvt_pk_bf16_f32 v130, v132, v133
v_cvt_pk_bf16_f32 v131, v134, v135
s_nop 1
v_mfma_f32_32x32x16_bf16 v[152:167], v[100:103], v[128:131], v[152:167]
s_branch L_attd
L_exact:
s_nop 7
v_mov_b32 v85, 0
v_mov_b32 v86, 0
v_mov_b32 v87, 0
v_mov_b32 v77, 0
v_mov_b32 v78, 0
v_mov_b32_e64 v79, 0
ds_read_b128 v[72:75], v11 offset:0
ds_read_b32 v76, v12 offset:0
ds_read_b128 v[80:83], v11 offset:2432
ds_read_b32 v84, v12 offset:2432
s_waitcnt lgkmcnt(2)
v_mfma_f32_32x32x16_bf16 v[104:119], v[72:75], v[24:27], v[56:71]
v_mfma_f32_32x32x16_bf16 v[104:119], v[76:79], v[28:31], v[104:119]
ds_read_b128 v[72:75], v11 offset:4864
ds_read_b32 v76, v12 offset:4864
s_waitcnt lgkmcnt(2)
v_mfma_f32_32x32x16_bf16 v[120:135], v[80:83], v[24:27], 0
v_mfma_f32_32x32x16_bf16 v[120:135], v[84:87], v[28:31], v[120:135]
ds_read_b128 v[80:83], v11 offset:7296
ds_read_b32 v84, v12 offset:7296
s_waitcnt lgkmcnt(2)
v_mfma_f32_32x32x16_bf16 v[136:151], v[72:75], v[24:27], 0
v_mfma_f32_32x32x16_bf16 v[136:151], v[76:79], v[28:31], v[136:151]
ds_read_b128 v[72:75], v11 offset:9728
ds_read_b32 v76, v12 offset:9728
s_waitcnt lgkmcnt(2)
v_mfma_f32_32x32x16_bf16 v[152:167], v[80:83], v[24:27], 0
v_mfma_f32_32x32x16_bf16 v[152:167], v[84:87], v[28:31], v[152:167]
ds_read_b128 v[80:83], v11 offset:12160
ds_read_b32 v84, v12 offset:12160
s_waitcnt lgkmcnt(2)
v_mfma_f32_32x32x16_bf16 v[168:183], v[72:75], v[24:27], 0
v_mfma_f32_32x32x16_bf16 v[168:183], v[76:79], v[28:31], v[168:183]
ds_read_b128 v[72:75], v11 offset:14592
ds_read_b32 v76, v12 offset:14592
s_waitcnt lgkmcnt(2)
v_mfma_f32_32x32x16_bf16 v[184:199], v[80:83], v[24:27], 0
v_mfma_f32_32x32x16_bf16 v[184:199], v[84:87], v[28:31], v[184:199]
ds_read_b128 v[80:83], v11 offset:17024
ds_read_b32 v84, v12 offset:17024
s_waitcnt lgkmcnt(2)
v_mfma_f32_32x32x16_bf16 v[200:215], v[72:75], v[24:27], 0
v_mfma_f32_32x32x16_bf16 v[200:215], v[76:79], v[28:31], v[200:215]
ds_read_b128 v[72:75], v11 offset:19456
ds_read_b32 v76, v12 offset:19456
s_waitcnt lgkmcnt(2)
v_mfma_f32_32x32x16_bf16 v[216:231], v[80:83], v[24:27], 0
v_mfma_f32_32x32x16_bf16 v[216:231], v[84:87], v[28:31], v[216:231]
s_waitcnt lgkmcnt(0)
v_mfma_f32_32x32x16_bf16 v[232:247], v[72:75], v[24:27], v[40:55]
v_mfma_f32_32x32x16_bf16 v[232:247], v[76:79], v[28:31], v[232:247]
s_nop 11
s_lshl_b32 s40, s52, 1
s_add_u32 s41, s40, 0
s_cmp_ge_u32 s41, s55
s_cbranch_scc1 L_valid0
v_mov_b32 v104, 4048155338
v_mov_b32 v105, 4048155338
v_mov_b32 v106, 4048155338
v_mov_b32 v107, 4048155338
v_mov_b32 v108, 4048155338
v_mov_b32 v109, 4048155338
v_mov_b32 v110, 4048155338
v_mov_b32 v111, 4048155338
v_mov_b32 v112, 4048155338
v_mov_b32 v113, 4048155338
v_mov_b32 v114, 4048155338
v_mov_b32 v115, 4048155338
v_mov_b32 v116, 4048155338
v_mov_b32 v117, 4048155338
v_mov_b32 v118, 4048155338
v_mov_b32 v119, 4048155338
s_add_u32 s41, s40, 1
s_cmp_ge_u32 s41, s55
s_cbranch_scc1 L_valid0
s_nop 0
v_mov_b32 v120, 4048155338
v_mov_b32 v121, 4048155338
v_mov_b32 v122, 4048155338
v_mov_b32 v123, 4048155338
v_mov_b32 v124, 4048155338
v_mov_b32 v125, 4048155338
v_mov_b32 v126, 4048155338
v_mov_b32 v127, 4048155338
v_mov_b32 v128, 4048155338
v_mov_b32 v129, 4048155338
v_mov_b32 v130, 4048155338
v_mov_b32 v131, 4048155338
v_mov_b32 v132, 4048155338
v_mov_b32 v133, 4048155338
v_mov_b32 v134, 4048155338
v_mov_b32 v135, 4048155338
s_add_u32 s41, s40, 2
s_cmp_ge_u32 s41, s55
s_cbranch_scc1 L_valid0
s_nop 0
v_mov_b32 v136, 4048155338
v_mov_b32 v137, 4048155338
v_mov_b32 v138, 4048155338
v_mov_b32 v139, 4048155338
v_mov_b32 v140, 4048155338
v_mov_b32 v141, 4048155338
v_mov_b32 v142, 4048155338
v_mov_b32 v143, 4048155338
v_mov_b32 v144, 4048155338
v_mov_b32 v145, 4048155338
v_mov_b32 v146, 4048155338
v_mov_b32 v147, 4048155338
v_mov_b32 v148, 4048155338
v_mov_b32 v149, 4048155338
v_mov_b32 v150, 4048155338
v_mov_b32 v151, 4048155338
s_add_u32 s41, s40, 3
s_cmp_ge_u32 s41, s55
s_cbranch_scc1 L_valid0
s_nop 0
v_mov_b32 v152, 4048155338
v_mov_b32 v153, 4048155338
v_mov_b32 v154, 4048155338
v_mov_b32 v155, 4048155338
v_mov_b32 v156, 4048155338
v_mov_b32 v157, 4048155338
v_mov_b32 v158, 4048155338
v_mov_b32 v159, 4048155338
v_mov_b32 v160, 4048155338
v_mov_b32 v161, 4048155338
v_mov_b32 v162, 4048155338
v_mov_b32 v163, 4048155338
v_mov_b32 v164, 4048155338
v_mov_b32 v165, 4048155338
v_mov_b32 v166, 4048155338
v_mov_b32 v167, 4048155338
s_add_u32 s41, s40, 4
s_cmp_ge_u32 s41, s55
s_cbranch_scc1 L_valid0
s_nop 0
v_mov_b32 v168, 4048155338
v_mov_b32 v169, 4048155338
v_mov_b32 v170, 4048155338
v_mov_b32 v171, 4048155338
v_mov_b32 v172, 4048155338
v_mov_b32 v173, 4048155338
v_mov_b32 v174, 4048155338
v_mov_b32 v175, 4048155338
v_mov_b32 v176, 4048155338
v_mov_b32 v177, 4048155338
v_mov_b32 v178, 4048155338
v_mov_b32 v179, 4048155338
v_mov_b32 v180, 4048155338
v_mov_b32 v181, 4048155338
v_mov_b32 v182, 4048155338
v_mov_b32 v183, 4048155338
s_add_u32 s41, s40, 5
s_cmp_ge_u32 s41, s55
s_cbranch_scc1 L_valid0
s_nop 0
v_mov_b32 v184, 4048155338
v_mov_b32 v185, 4048155338
v_mov_b32 v186, 4048155338
v_mov_b32 v187, 4048155338
v_mov_b32 v188, 4048155338
v_mov_b32 v189, 4048155338
v_mov_b32 v190, 4048155338
v_mov_b32 v191, 4048155338
v_mov_b32 v192, 4048155338
v_mov_b32 v193, 4048155338
v_mov_b32 v194, 4048155338
v_mov_b32 v195, 4048155338
v_mov_b32 v196, 4048155338
v_mov_b32 v197, 4048155338
v_mov_b32 v198, 4048155338
v_mov_b32 v199, 4048155338
s_add_u32 s41, s40, 6
s_cmp_ge_u32 s41, s55
s_cbranch_scc1 L_valid0
s_nop 0
v_mov_b32 v200, 4048155338
v_mov_b32 v201, 4048155338
v_mov_b32 v202, 4048155338
v_mov_b32 v203, 4048155338
v_mov_b32 v204, 4048155338
v_mov_b32 v205, 4048155338
v_mov_b32 v206, 4048155338
v_mov_b32 v207, 4048155338
v_mov_b32 v208, 4048155338
v_mov_b32 v209, 4048155338
v_mov_b32 v210, 4048155338
v_mov_b32 v211, 4048155338
v_mov_b32 v212, 4048155338
v_mov_b32 v213, 4048155338
v_mov_b32 v214, 4048155338
v_mov_b32 v215, 4048155338
s_add_u32 s41, s40, 7
s_cmp_ge_u32 s41, s55
s_cbranch_scc1 L_valid0
s_nop 0
v_mov_b32 v216, 4048155338
v_mov_b32 v217, 4048155338
v_mov_b32 v218, 4048155338
v_mov_b32 v219, 4048155338
v_mov_b32 v220, 4048155338
v_mov_b32 v221, 4048155338
v_mov_b32 v222, 4048155338
v_mov_b32 v223, 4048155338
v_mov_b32 v224, 4048155338
v_mov_b32 v225, 4048155338
v_mov_b32 v226, 4048155338
v_mov_b32 v227, 4048155338
v_mov_b32 v228, 4048155338
v_mov_b32 v229, 4048155338
v_mov_b32 v230, 4048155338
v_mov_b32 v231, 4048155338
L_valid0:
v_max3_f32 v5, v104, v105, v106
v_max3_f32 v6, v140, v141, v142
v_max3_f32 v7, v176, v177, v178
v_max3_f32 v8, v212, v213, v214
v_max3_f32 v5, v5, v107, v108
v_max3_f32 v6, v6, v143, v144
v_max3_f32 v7, v7, v179, v180
v_max3_f32 v8, v8, v215, v216
v_max3_f32 v5, v5, v109, v110
v_max3_f32 v6, v6, v145, v146
v_max3_f32 v7, v7, v181, v182
v_max3_f32 v8, v8, v217, v218
v_max3_f32 v5, v5, v111, v112
v_max3_f32 v6, v6, v147, v148
v_max3_f32 v7, v7, v183, v184
v_max3_f32 v8, v8, v219, v220
v_max3_f32 v5, v5, v113, v114
v_max3_f32 v6, v6, v149, v150
v_max3_f32 v7, v7, v185, v186
v_max3_f32 v8, v8, v221, v222
v_max3_f32 v5, v5, v115, v116
v_max3_f32 v6, v6, v151, v152
v_max3_f32 v7, v7, v187, v188
v_max3_f32 v8, v8, v223, v224
v_max3_f32 v5, v5, v117, v118
v_max3_f32 v6, v6, v153, v154
v_max3_f32 v7, v7, v189, v190
v_max3_f32 v8, v8, v225, v226
v_max3_f32 v5, v5, v119, v120
v_max3_f32 v6, v6, v155, v156
v_max3_f32 v7, v7, v191, v192
v_max3_f32 v8, v8, v227, v228
v_max3_f32 v5, v5, v121, v122
v_max3_f32 v6, v6, v157, v158
v_max3_f32 v7, v7, v193, v194
v_max3_f32 v8, v8, v229, v230
v_max3_f32 v5, v5, v123, v124
v_max3_f32 v6, v6, v159, v160
v_max3_f32 v7, v7, v195, v196
v_max3_f32 v8, v8, v231, v232
v_max3_f32 v5, v5, v125, v126
v_max3_f32 v6, v6, v161, v162
v_max3_f32 v7, v7, v197, v198
v_max3_f32 v8, v8, v233, v234
v_max3_f32 v5, v5, v127, v128
v_max3_f32 v6, v6, v163, v164
v_max3_f32 v7, v7, v199, v200
v_max3_f32 v8, v8, v235, v236
v_max3_f32 v5, v5, v129, v130
v_max3_f32 v6, v6, v165, v166
v_max3_f32 v7, v7, v201, v202
v_max3_f32 v8, v8, v237, v238
v_max3_f32 v5, v5, v131, v132
v_max3_f32 v6, v6, v167, v168
v_max3_f32 v7, v7, v203, v204
v_max3_f32 v8, v8, v239, v240
v_max3_f32 v5, v5, v133, v134
v_max3_f32 v6, v6, v169, v170
v_max3_f32 v7, v7, v205, v206
v_max3_f32 v8, v8, v241, v242
v_max3_f32 v5, v5, v135, v136
v_max3_f32 v6, v6, v171, v172
v_max3_f32 v7, v7, v207, v208
v_max3_f32 v8, v8, v243, v244
v_max3_f32 v5, v5, v137, v138
v_max3_f32 v6, v6, v173, v174
v_max3_f32 v7, v7, v209, v210
v_max3_f32 v8, v8, v245, v246
v_max_f32 v5, v5, v139
v_max_f32 v6, v6, v175
v_max_f32 v7, v7, v211
v_max_f32 v8, v8, v247
v_max3_f32 v5, v5, v6, v7
v_max_f32 v5, v5, v8
v_mov_b32 v6, v5
s_nop 1
v_permlane32_swap_b32 v5, v6
v_max_f32_e64 v5, v5, v6
ds_read_b64_tr_b16 v[72:73], v13 offset:0
ds_read_b64_tr_b16 v[74:75], v14 offset:0
ds_read_b64_tr_b16 v[76:77], v15 offset:0
ds_read_b64_tr_b16 v[78:79], v16 offset:0
v_sub_f32 v104, v104, v5
v_sub_f32 v105, v105, v5
v_sub_f32 v106, v106, v5
v_sub_f32 v107, v107, v5
v_sub_f32 v108, v108, v5
v_sub_f32 v109, v109, v5
v_sub_f32 v110, v110, v5
v_sub_f32 v111, v111, v5
v_sub_f32 v112, v112, v5
v_sub_f32 v113, v113, v5
v_sub_f32 v114, v114, v5
v_sub_f32 v115, v115, v5
v_sub_f32 v116, v116, v5
v_sub_f32 v117, v117, v5
v_sub_f32 v118, v118, v5
v_sub_f32 v119, v119, v5
v_exp_f32 v104, v104
v_exp_f32 v105, v105
v_exp_f32 v106, v106
v_exp_f32 v107, v107
v_exp_f32 v108, v108
v_exp_f32 v109, v109
v_exp_f32 v110, v110
v_exp_f32 v111, v111
v_exp_f32 v112, v112
v_exp_f32 v113, v113
v_exp_f32 v114, v114
v_exp_f32 v115, v115
v_exp_f32 v116, v116
v_exp_f32 v117, v117
v_exp_f32 v118, v118
v_exp_f32 v119, v119
v_cvt_pk_bf16_f32 v104, v104, v105
v_cvt_pk_bf16_f32 v105, v106, v107
v_cvt_pk_bf16_f32 v106, v108, v109
v_cvt_pk_bf16_f32 v107, v110, v111
v_cvt_pk_bf16_f32 v108, v112, v113
v_cvt_pk_bf16_f32 v109, v114, v115
v_cvt_pk_bf16_f32 v110, v116, v117
v_cvt_pk_bf16_f32 v111, v118, v119
s_waitcnt lgkmcnt(0)
v_mfma_f32_32x32x16_bf16 v[88:103], v[72:75], v[104:107], 0
v_mfma_f32_32x32x16_bf16 v[88:103], v[76:79], v[108:111], v[88:103]
ds_read_b64_tr_b16 v[72:73], v13 offset:2432
ds_read_b64_tr_b16 v[74:75], v14 offset:2432
ds_read_b64_tr_b16 v[76:77], v15 offset:2432
ds_read_b64_tr_b16 v[78:79], v16 offset:2432
v_sub_f32 v120, v120, v5
v_sub_f32 v121, v121, v5
v_sub_f32 v122, v122, v5
v_sub_f32 v123, v123, v5
v_sub_f32 v124, v124, v5
v_sub_f32 v125, v125, v5
v_sub_f32 v126, v126, v5
v_sub_f32 v127, v127, v5
v_sub_f32 v128, v128, v5
v_sub_f32 v129, v129, v5
v_sub_f32 v130, v130, v5
v_sub_f32 v131, v131, v5
v_sub_f32 v132, v132, v5
v_sub_f32 v133, v133, v5
v_sub_f32 v134, v134, v5
v_sub_f32 v135, v135, v5
v_exp_f32 v120, v120
v_exp_f32 v121, v121
v_exp_f32 v122, v122
v_exp_f32 v123, v123
v_exp_f32 v124, v124
v_exp_f32 v125, v125
v_exp_f32 v126, v126
v_exp_f32 v127, v127
v_exp_f32 v128, v128
v_exp_f32 v129, v129
v_exp_f32 v130, v130
v_exp_f32 v131, v131
v_exp_f32 v132, v132
v_exp_f32 v133, v133
v_exp_f32 v134, v134
v_exp_f32_e64 v135, v135
v_cvt_pk_bf16_f32 v120, v120, v121
v_cvt_pk_bf16_f32 v121, v122, v123
v_cvt_pk_bf16_f32 v122, v124, v125
v_cvt_pk_bf16_f32 v123, v126, v127
v_cvt_pk_bf16_f32 v124, v128, v129
v_cvt_pk_bf16_f32 v125, v130, v131
v_cvt_pk_bf16_f32 v126, v132, v133
v_cvt_pk_bf16_f32 v127, v134, v135
s_waitcnt lgkmcnt(0)
v_mfma_f32_32x32x16_bf16 v[88:103], v[72:75], v[120:123], v[88:103]
v_mfma_f32_32x32x16_bf16 v[88:103], v[76:79], v[124:127], v[88:103]
ds_read_b64_tr_b16 v[72:73], v13 offset:4864
ds_read_b64_tr_b16 v[74:75], v14 offset:4864
ds_read_b64_tr_b16 v[76:77], v15 offset:4864
ds_read_b64_tr_b16 v[78:79], v16 offset:4864
v_sub_f32 v136, v136, v5
v_sub_f32 v137, v137, v5
v_sub_f32 v138, v138, v5
v_sub_f32 v139, v139, v5
v_sub_f32 v140, v140, v5
v_sub_f32 v141, v141, v5
v_sub_f32 v142, v142, v5
v_sub_f32 v143, v143, v5
v_sub_f32 v144, v144, v5
v_sub_f32 v145, v145, v5
v_sub_f32 v146, v146, v5
v_sub_f32 v147, v147, v5
v_sub_f32 v148, v148, v5
v_sub_f32 v149, v149, v5
v_sub_f32 v150, v150, v5
v_sub_f32 v151, v151, v5
v_exp_f32 v136, v136
v_exp_f32 v137, v137
v_exp_f32 v138, v138
v_exp_f32 v139, v139
v_exp_f32 v140, v140
v_exp_f32 v141, v141
v_exp_f32 v142, v142
v_exp_f32 v143, v143
v_exp_f32 v144, v144
v_exp_f32 v145, v145
v_exp_f32 v146, v146
v_exp_f32 v147, v147
v_exp_f32 v148, v148
v_exp_f32 v149, v149
v_exp_f32 v150, v150
v_exp_f32_e64 v151, v151
v_cvt_pk_bf16_f32 v136, v136, v137
v_cvt_pk_bf16_f32 v137, v138, v139
v_cvt_pk_bf16_f32 v138, v140, v141
v_cvt_pk_bf16_f32 v139, v142, v143
v_cvt_pk_bf16_f32 v140, v144, v145
v_cvt_pk_bf16_f32 v141, v146, v147
v_cvt_pk_bf16_f32 v142, v148, v149
v_cvt_pk_bf16_f32 v143, v150, v151
s_waitcnt lgkmcnt(0)
v_mfma_f32_32x32x16_bf16 v[88:103], v[72:75], v[136:139], v[88:103]
v_mfma_f32_32x32x16_bf16 v[88:103], v[76:79], v[140:143], v[88:103]
ds_read_b64_tr_b16 v[72:73], v13 offset:7296
ds_read_b64_tr_b16 v[74:75], v14 offset:7296
ds_read_b64_tr_b16 v[76:77], v15 offset:7296
ds_read_b64_tr_b16 v[78:79], v16 offset:7296
v_sub_f32 v152, v152, v5
v_sub_f32 v153, v153, v5
v_sub_f32 v154, v154, v5
v_sub_f32 v155, v155, v5
v_sub_f32 v156, v156, v5
v_sub_f32 v157, v157, v5
v_sub_f32 v158, v158, v5
v_sub_f32 v159, v159, v5
v_sub_f32 v160, v160, v5
v_sub_f32 v161, v161, v5
v_sub_f32 v162, v162, v5
v_sub_f32 v163, v163, v5
v_sub_f32 v164, v164, v5
v_sub_f32 v165, v165, v5
v_sub_f32 v166, v166, v5
v_sub_f32 v167, v167, v5
v_exp_f32 v152, v152
v_exp_f32 v153, v153
v_exp_f32 v154, v154
v_exp_f32 v155, v155
v_exp_f32 v156, v156
v_exp_f32 v157, v157
v_exp_f32 v158, v158
v_exp_f32 v159, v159
v_exp_f32 v160, v160
v_exp_f32 v161, v161
v_exp_f32 v162, v162
v_exp_f32 v163, v163
v_exp_f32 v164, v164
v_exp_f32 v165, v165
v_exp_f32 v166, v166
v_exp_f32_e64 v167, v167
v_cvt_pk_bf16_f32 v152, v152, v153
v_cvt_pk_bf16_f32 v153, v154, v155
v_cvt_pk_bf16_f32 v154, v156, v157
v_cvt_pk_bf16_f32 v155, v158, v159
v_cvt_pk_bf16_f32 v156, v160, v161
v_cvt_pk_bf16_f32 v157, v162, v163
v_cvt_pk_bf16_f32 v158, v164, v165
v_cvt_pk_bf16_f32 v159, v166, v167
s_waitcnt lgkmcnt(0)
v_mfma_f32_32x32x16_bf16 v[88:103], v[72:75], v[152:155], v[88:103]
v_mfma_f32_32x32x16_bf16 v[88:103], v[76:79], v[156:159], v[88:103]
ds_read_b64_tr_b16 v[72:73], v13 offset:9728
ds_read_b64_tr_b16 v[74:75], v14 offset:9728
ds_read_b64_tr_b16 v[76:77], v15 offset:9728
ds_read_b64_tr_b16 v[78:79], v16 offset:9728
v_sub_f32 v168, v168, v5
v_sub_f32 v169, v169, v5
v_sub_f32 v170, v170, v5
v_sub_f32 v171, v171, v5
v_sub_f32 v172, v172, v5
v_sub_f32 v173, v173, v5
v_sub_f32 v174, v174, v5
v_sub_f32 v175, v175, v5
v_sub_f32 v176, v176, v5
v_sub_f32 v177, v177, v5
v_sub_f32 v178, v178, v5
v_sub_f32 v179, v179, v5
v_sub_f32 v180, v180, v5
v_sub_f32 v181, v181, v5
v_sub_f32 v182, v182, v5
v_sub_f32 v183, v183, v5
v_exp_f32 v168, v168
v_exp_f32 v169, v169
v_exp_f32 v170, v170
v_exp_f32 v171, v171
v_exp_f32 v172, v172
v_exp_f32 v173, v173
v_exp_f32 v174, v174
v_exp_f32 v175, v175
v_exp_f32 v176, v176
v_exp_f32 v177, v177
v_exp_f32 v178, v178
v_exp_f32 v179, v179
v_exp_f32 v180, v180
v_exp_f32 v181, v181
v_exp_f32 v182, v182
v_exp_f32_e64 v183, v183
v_cvt_pk_bf16_f32 v168, v168, v169
v_cvt_pk_bf16_f32 v169, v170, v171
v_cvt_pk_bf16_f32 v170, v172, v173
v_cvt_pk_bf16_f32 v171, v174, v175
v_cvt_pk_bf16_f32 v172, v176, v177
v_cvt_pk_bf16_f32 v173, v178, v179
v_cvt_pk_bf16_f32 v174, v180, v181
v_cvt_pk_bf16_f32 v175, v182, v183
s_waitcnt lgkmcnt(0)
v_mfma_f32_32x32x16_bf16 v[88:103], v[72:75], v[168:171], v[88:103]
v_mfma_f32_32x32x16_bf16 v[88:103], v[76:79], v[172:175], v[88:103]
ds_read_b64_tr_b16 v[72:73], v13 offset:12160
ds_read_b64_tr_b16 v[74:75], v14 offset:12160
ds_read_b64_tr_b16 v[76:77], v15 offset:12160
ds_read_b64_tr_b16 v[78:79], v16 offset:12160
v_sub_f32 v184, v184, v5
v_sub_f32 v185, v185, v5
v_sub_f32 v186, v186, v5
v_sub_f32 v187, v187, v5
v_sub_f32 v188, v188, v5
v_sub_f32 v189, v189, v5
v_sub_f32 v190, v190, v5
v_sub_f32 v191, v191, v5
v_sub_f32 v192, v192, v5
v_sub_f32 v193, v193, v5
v_sub_f32 v194, v194, v5
v_sub_f32 v195, v195, v5
v_sub_f32 v196, v196, v5
v_sub_f32 v197, v197, v5
v_sub_f32 v198, v198, v5
v_sub_f32 v199, v199, v5
v_exp_f32 v184, v184
v_exp_f32 v185, v185
v_exp_f32 v186, v186
v_exp_f32 v187, v187
v_exp_f32 v188, v188
v_exp_f32 v189, v189
v_exp_f32 v190, v190
v_exp_f32 v191, v191
v_exp_f32 v192, v192
v_exp_f32 v193, v193
v_exp_f32 v194, v194
v_exp_f32 v195, v195
v_exp_f32 v196, v196
v_exp_f32 v197, v197
v_exp_f32 v198, v198
v_exp_f32_e64 v199, v199
v_cvt_pk_bf16_f32 v184, v184, v185
v_cvt_pk_bf16_f32 v185, v186, v187
v_cvt_pk_bf16_f32 v186, v188, v189
v_cvt_pk_bf16_f32 v187, v190, v191
v_cvt_pk_bf16_f32 v188, v192, v193
v_cvt_pk_bf16_f32 v189, v194, v195
v_cvt_pk_bf16_f32 v190, v196, v197
v_cvt_pk_bf16_f32 v191, v198, v199
s_waitcnt lgkmcnt(0)
v_mfma_f32_32x32x16_bf16 v[88:103], v[72:75], v[184:187], v[88:103]
v_mfma_f32_32x32x16_bf16 v[88:103], v[76:79], v[188:191], v[88:103]
ds_read_b64_tr_b16 v[72:73], v13 offset:14592
ds_read_b64_tr_b16 v[74:75], v14 offset:14592
ds_read_b64_tr_b16 v[76:77], v15 offset:14592
ds_read_b64_tr_b16 v[78:79], v16 offset:14592
v_sub_f32 v200, v200, v5
v_sub_f32 v201, v201, v5
v_sub_f32 v202, v202, v5
v_sub_f32 v203, v203, v5
v_sub_f32 v204, v204, v5
v_sub_f32 v205, v205, v5
v_sub_f32 v206, v206, v5
v_sub_f32 v207, v207, v5
v_sub_f32 v208, v208, v5
v_sub_f32 v209, v209, v5
v_sub_f32 v210, v210, v5
v_sub_f32 v211, v211, v5
v_sub_f32 v212, v212, v5
v_sub_f32 v213, v213, v5
v_sub_f32 v214, v214, v5
v_sub_f32 v215, v215, v5
v_exp_f32 v200, v200
v_exp_f32 v201, v201
v_exp_f32 v202, v202
v_exp_f32 v203, v203
v_exp_f32 v204, v204
v_exp_f32 v205, v205
v_exp_f32 v206, v206
v_exp_f32 v207, v207
v_exp_f32 v208, v208
v_exp_f32 v209, v209
v_exp_f32 v210, v210
v_exp_f32 v211, v211
v_exp_f32 v212, v212
v_exp_f32 v213, v213
v_exp_f32 v214, v214
v_exp_f32_e64 v215, v215
v_cvt_pk_bf16_f32 v200, v200, v201
v_cvt_pk_bf16_f32 v201, v202, v203
v_cvt_pk_bf16_f32 v202, v204, v205
v_cvt_pk_bf16_f32 v203, v206, v207
v_cvt_pk_bf16_f32 v204, v208, v209
v_cvt_pk_bf16_f32 v205, v210, v211
v_cvt_pk_bf16_f32 v206, v212, v213
v_cvt_pk_bf16_f32 v207, v214, v215
s_waitcnt lgkmcnt(0)
v_mfma_f32_32x32x16_bf16 v[88:103], v[72:75], v[200:203], v[88:103]
v_mfma_f32_32x32x16_bf16 v[88:103], v[76:79], v[204:207], v[88:103]
ds_read_b64_tr_b16 v[72:73], v13 offset:17024
ds_read_b64_tr_b16 v[74:75], v14 offset:17024
ds_read_b64_tr_b16 v[76:77], v15 offset:17024
ds_read_b64_tr_b16 v[78:79], v16 offset:17024
v_sub_f32 v216, v216, v5
v_sub_f32 v217, v217, v5
v_sub_f32 v218, v218, v5
v_sub_f32 v219, v219, v5
v_sub_f32 v220, v220, v5
v_sub_f32 v221, v221, v5
v_sub_f32 v222, v222, v5
v_sub_f32 v223, v223, v5
v_sub_f32 v224, v224, v5
v_sub_f32 v225, v225, v5
v_sub_f32 v226, v226, v5
v_sub_f32 v227, v227, v5
v_sub_f32 v228, v228, v5
v_sub_f32 v229, v229, v5
v_sub_f32 v230, v230, v5
v_sub_f32 v231, v231, v5
v_exp_f32 v216, v216
v_exp_f32 v217, v217
v_exp_f32 v218, v218
v_exp_f32 v219, v219
v_exp_f32 v220, v220
v_exp_f32 v221, v221
v_exp_f32 v222, v222
v_exp_f32 v223, v223
v_exp_f32 v224, v224
v_exp_f32 v225, v225
v_exp_f32 v226, v226
v_exp_f32 v227, v227
v_exp_f32 v228, v228
v_exp_f32 v229, v229
v_exp_f32 v230, v230
v_exp_f32_e64 v231, v231
v_cvt_pk_bf16_f32 v216, v216, v217
v_cvt_pk_bf16_f32 v217, v218, v219
v_cvt_pk_bf16_f32 v218, v220, v221
v_cvt_pk_bf16_f32 v219, v222, v223
v_cvt_pk_bf16_f32 v220, v224, v225
v_cvt_pk_bf16_f32 v221, v226, v227
v_cvt_pk_bf16_f32 v222, v228, v229
v_cvt_pk_bf16_f32 v223, v230, v231
s_waitcnt lgkmcnt(0)
v_mfma_f32_32x32x16_bf16 v[88:103], v[72:75], v[216:219], v[88:103]
v_mfma_f32_32x32x16_bf16 v[88:103], v[76:79], v[220:223], v[88:103]
ds_read_b64_tr_b16 v[72:73], v13 offset:19456
ds_read_b64_tr_b16 v[74:75], v14 offset:19456
ds_read_b64_tr_b16 v[76:77], v15 offset:19456
ds_read_b64_tr_b16 v[78:79], v16 offset:19456
v_sub_f32 v232, v232, v5
v_sub_f32 v233, v233, v5
v_sub_f32 v234, v234, v5
v_sub_f32 v235, v235, v5
v_sub_f32 v236, v236, v5
v_sub_f32 v237, v237, v5
v_sub_f32 v238, v238, v5
v_sub_f32 v239, v239, v5
v_sub_f32 v240, v240, v5
v_sub_f32 v241, v241, v5
v_sub_f32 v242, v242, v5
v_sub_f32 v243, v243, v5
v_sub_f32 v244, v244, v5
v_sub_f32 v245, v245, v5
v_sub_f32 v246, v246, v5
v_sub_f32 v247, v247, v5
v_exp_f32 v232, v232
v_exp_f32 v233, v233
v_exp_f32 v234, v234
v_exp_f32 v235, v235
v_exp_f32 v236, v236
v_exp_f32 v237, v237
v_exp_f32 v238, v238
v_exp_f32 v239, v239
v_exp_f32 v240, v240
v_exp_f32 v241, v241
v_exp_f32 v242, v242
v_exp_f32 v243, v243
v_exp_f32 v244, v244
v_exp_f32 v245, v245
v_exp_f32 v246, v246
v_exp_f32_e64 v247, v247
v_cvt_pk_bf16_f32 v232, v232, v233
v_cvt_pk_bf16_f32 v233, v234, v235
v_cvt_pk_bf16_f32 v234, v236, v237
v_cvt_pk_bf16_f32 v235, v238, v239
v_cvt_pk_bf16_f32 v236, v240, v241
v_cvt_pk_bf16_f32 v237, v242, v243
v_cvt_pk_bf16_f32 v238, v244, v245
v_cvt_pk_bf16_f32 v239, v246, v247
s_waitcnt lgkmcnt(0)
v_mfma_f32_32x32x16_bf16 v[88:103], v[72:75], v[232:235], v[88:103]
v_mfma_f32_32x32x16_bf16 v[88:103], v[76:79], v[236:239], v[88:103]
s_nop 11
v_rcp_f32 v104, v98
s_nop 0
v_mul_f32_e64 v104, v104, v20
v_pk_mul_f32 v[88:89], v[88:89], v[104:105] op_sel_hi:[1,0]
v_pk_mul_f32 v[90:91], v[90:91], v[104:105] op_sel_hi:[1,0]
v_pk_mul_f32 v[92:93], v[92:93], v[104:105] op_sel_hi:[1,0]
v_pk_mul_f32 v[94:95], v[94:95], v[104:105] op_sel_hi:[1,0]
v_pk_mul_f32 v[96:97], v[96:97], v[104:105] op_sel_hi:[1,0]
v_cvt_pk_bf16_f32 v88, v88, v89
v_cvt_pk_bf16_f32 v89, v90, v91
v_cvt_pk_bf16_f32 v90, v92, v93
v_cvt_pk_bf16_f32 v91, v94, v95
buffer_store_dwordx4 v[88:91], v1, s[28:31], s4 offen sc1
v_cvt_pk_bf16_f32 v252, v96, v97
v_mov_b32 v77, 0
v_mov_b32 v78, 0
v_mov_b32_e64 v79, 0
ds_read_b128 v[72:75], v11 offset:2432
ds_read_b32 v76, v12 offset:2432
ds_read_b128 v[80:83], v11 offset:4864
ds_read_b32 v84, v12 offset:4864
s_waitcnt lgkmcnt(2)
v_mfma_f32_32x32x16_bf16 v[104:119], v[72:75], v[32:35], v[56:71]
v_mfma_f32_32x32x16_bf16 v[104:119], v[76:79], v[36:39], v[104:119]
ds_read_b128 v[72:75], v11 offset:7296
ds_read_b32 v76, v12 offset:7296
s_waitcnt lgkmcnt(2)
v_mfma_f32_32x32x16_bf16 v[120:135], v[80:83], v[32:35], 0
v_mfma_f32_32x32x16_bf16 v[120:135], v[84:87], v[36:39], v[120:135]
ds_read_b128 v[80:83], v11 offset:9728
ds_read_b32 v84, v12 offset:9728
s_waitcnt lgkmcnt(2)
v_mfma_f32_32x32x16_bf16 v[136:151], v[72:75], v[32:35], 0
v_mfma_f32_32x32x16_bf16 v[136:151], v[76:79], v[36:39], v[136:151]
ds_read_b128 v[72:75], v11 offset:12160
ds_read_b32 v76, v12 offset:12160
s_waitcnt lgkmcnt(2)
v_mfma_f32_32x32x16_bf16 v[152:167], v[80:83], v[32:35], 0
v_mfma_f32_32x32x16_bf16 v[152:167], v[84:87], v[36:39], v[152:167]
ds_read_b128 v[80:83], v11 offset:14592
ds_read_b32 v84, v12 offset:14592
s_waitcnt lgkmcnt(2)
v_mfma_f32_32x32x16_bf16 v[168:183], v[72:75], v[32:35], 0
v_mfma_f32_32x32x16_bf16 v[168:183], v[76:79], v[36:39], v[168:183]
ds_read_b128 v[72:75], v11 offset:17024
ds_read_b32 v76, v12 offset:17024
s_waitcnt lgkmcnt(2)
v_mfma_f32_32x32x16_bf16 v[184:199], v[80:83], v[32:35], 0
v_mfma_f32_32x32x16_bf16 v[184:199], v[84:87], v[36:39], v[184:199]
ds_read_b128 v[80:83], v11 offset:19456
ds_read_b32 v84, v12 offset:19456
s_waitcnt lgkmcnt(2)
v_mfma_f32_32x32x16_bf16 v[200:215], v[72:75], v[32:35], 0
v_mfma_f32_32x32x16_bf16 v[200:215], v[76:79], v[36:39], v[200:215]
ds_read_b128 v[72:75], v11 offset:21888
ds_read_b32 v76, v12 offset:21888
s_waitcnt lgkmcnt(2)
v_mfma_f32_32x32x16_bf16 v[216:231], v[80:83], v[32:35], 0
v_mfma_f32_32x32x16_bf16 v[216:231], v[84:87], v[36:39], v[216:231]
s_waitcnt lgkmcnt(0)
v_mfma_f32_32x32x16_bf16 v[232:247], v[72:75], v[32:35], v[40:55]
v_mfma_f32_32x32x16_bf16 v[232:247], v[76:79], v[36:39], v[232:247]
s_nop 11
s_lshl_b32 s40, s52, 1
s_add_u32 s41, s40, 1
s_cmp_ge_u32 s41, s55
s_cbranch_scc1 L_valid1
v_mov_b32 v104, 4048155338
v_mov_b32 v105, 4048155338
v_mov_b32 v106, 4048155338
v_mov_b32 v107, 4048155338
v_mov_b32 v108, 4048155338
v_mov_b32 v109, 4048155338
v_mov_b32 v110, 4048155338
v_mov_b32 v111, 4048155338
v_mov_b32 v112, 4048155338
v_mov_b32 v113, 4048155338
v_mov_b32 v114, 4048155338
v_mov_b32 v115, 4048155338
v_mov_b32 v116, 4048155338
v_mov_b32 v117, 4048155338
v_mov_b32 v118, 4048155338
v_mov_b32 v119, 4048155338
s_add_u32 s41, s40, 2
s_cmp_ge_u32 s41, s55
s_cbranch_scc1 L_valid1
s_nop 0
v_mov_b32 v120, 4048155338
v_mov_b32 v121, 4048155338
v_mov_b32 v122, 4048155338
v_mov_b32 v123, 4048155338
v_mov_b32 v124, 4048155338
v_mov_b32 v125, 4048155338
v_mov_b32 v126, 4048155338
v_mov_b32 v127, 4048155338
v_mov_b32 v128, 4048155338
v_mov_b32 v129, 4048155338
v_mov_b32 v130, 4048155338
v_mov_b32 v131, 4048155338
v_mov_b32 v132, 4048155338
v_mov_b32 v133, 4048155338
v_mov_b32 v134, 4048155338
v_mov_b32 v135, 4048155338
s_add_u32 s41, s40, 3
s_cmp_ge_u32 s41, s55
s_cbranch_scc1 L_valid1
s_nop 0
v_mov_b32 v136, 4048155338
v_mov_b32 v137, 4048155338
v_mov_b32 v138, 4048155338
v_mov_b32 v139, 4048155338
v_mov_b32 v140, 4048155338
v_mov_b32 v141, 4048155338
v_mov_b32 v142, 4048155338
v_mov_b32 v143, 4048155338
v_mov_b32 v144, 4048155338
v_mov_b32 v145, 4048155338
v_mov_b32 v146, 4048155338
v_mov_b32 v147, 4048155338
v_mov_b32 v148, 4048155338
v_mov_b32 v149, 4048155338
v_mov_b32 v150, 4048155338
v_mov_b32 v151, 4048155338
s_add_u32 s41, s40, 4
s_cmp_ge_u32 s41, s55
s_cbranch_scc1 L_valid1
s_nop 0
v_mov_b32 v152, 4048155338
v_mov_b32 v153, 4048155338
v_mov_b32 v154, 4048155338
v_mov_b32 v155, 4048155338
v_mov_b32 v156, 4048155338
v_mov_b32 v157, 4048155338
v_mov_b32 v158, 4048155338
v_mov_b32 v159, 4048155338
v_mov_b32 v160, 4048155338
v_mov_b32 v161, 4048155338
v_mov_b32 v162, 4048155338
v_mov_b32 v163, 4048155338
v_mov_b32 v164, 4048155338
v_mov_b32 v165, 4048155338
v_mov_b32 v166, 4048155338
v_mov_b32 v167, 4048155338
s_add_u32 s41, s40, 5
s_cmp_ge_u32 s41, s55
s_cbranch_scc1 L_valid1
s_nop 0
v_mov_b32 v168, 4048155338
v_mov_b32 v169, 4048155338
v_mov_b32 v170, 4048155338
v_mov_b32 v171, 4048155338
v_mov_b32 v172, 4048155338
v_mov_b32 v173, 4048155338
v_mov_b32 v174, 4048155338
v_mov_b32 v175, 4048155338
v_mov_b32 v176, 4048155338
v_mov_b32 v177, 4048155338
v_mov_b32 v178, 4048155338
v_mov_b32 v179, 4048155338
v_mov_b32 v180, 4048155338
v_mov_b32 v181, 4048155338
v_mov_b32 v182, 4048155338
v_mov_b32 v183, 4048155338
s_add_u32 s41, s40, 6
s_cmp_ge_u32 s41, s55
s_cbranch_scc1 L_valid1
s_nop 0
v_mov_b32 v184, 4048155338
v_mov_b32 v185, 4048155338
v_mov_b32 v186, 4048155338
v_mov_b32 v187, 4048155338
v_mov_b32 v188, 4048155338
v_mov_b32 v189, 4048155338
v_mov_b32 v190, 4048155338
v_mov_b32 v191, 4048155338
v_mov_b32 v192, 4048155338
v_mov_b32 v193, 4048155338
v_mov_b32 v194, 4048155338
v_mov_b32 v195, 4048155338
v_mov_b32 v196, 4048155338
v_mov_b32 v197, 4048155338
v_mov_b32 v198, 4048155338
v_mov_b32 v199, 4048155338
s_add_u32 s41, s40, 7
s_cmp_ge_u32 s41, s55
s_cbranch_scc1 L_valid1
s_nop 0
v_mov_b32 v200, 4048155338
v_mov_b32 v201, 4048155338
v_mov_b32 v202, 4048155338
v_mov_b32 v203, 4048155338
v_mov_b32 v204, 4048155338
v_mov_b32 v205, 4048155338
v_mov_b32 v206, 4048155338
v_mov_b32 v207, 4048155338
v_mov_b32 v208, 4048155338
v_mov_b32 v209, 4048155338
v_mov_b32 v210, 4048155338
v_mov_b32 v211, 4048155338
v_mov_b32 v212, 4048155338
v_mov_b32 v213, 4048155338
v_mov_b32 v214, 4048155338
v_mov_b32 v215, 4048155338
s_add_u32 s41, s40, 8
s_cmp_ge_u32 s41, s55
s_cbranch_scc1 L_valid1
s_nop 0
v_mov_b32 v216, 4048155338
v_mov_b32 v217, 4048155338
v_mov_b32 v218, 4048155338
v_mov_b32 v219, 4048155338
v_mov_b32 v220, 4048155338
v_mov_b32 v221, 4048155338
v_mov_b32 v222, 4048155338
v_mov_b32 v223, 4048155338
v_mov_b32 v224, 4048155338
v_mov_b32 v225, 4048155338
v_mov_b32 v226, 4048155338
v_mov_b32 v227, 4048155338
v_mov_b32 v228, 4048155338
v_mov_b32 v229, 4048155338
v_mov_b32 v230, 4048155338
v_mov_b32 v231, 4048155338
L_valid1:
v_max3_f32 v5, v104, v105, v106
v_max3_f32 v6, v140, v141, v142
v_max3_f32 v7, v176, v177, v178
v_max3_f32 v8, v212, v213, v214
v_max3_f32 v5, v5, v107, v108
v_max3_f32 v6, v6, v143, v144
v_max3_f32 v7, v7, v179, v180
v_max3_f32 v8, v8, v215, v216
v_max3_f32 v5, v5, v109, v110
v_max3_f32 v6, v6, v145, v146
v_max3_f32 v7, v7, v181, v182
v_max3_f32 v8, v8, v217, v218
v_max3_f32 v5, v5, v111, v112
v_max3_f32 v6, v6, v147, v148
v_max3_f32 v7, v7, v183, v184
v_max3_f32 v8, v8, v219, v220
v_max3_f32 v5, v5, v113, v114
v_max3_f32 v6, v6, v149, v150
v_max3_f32 v7, v7, v185, v186
v_max3_f32 v8, v8, v221, v222
v_max3_f32 v5, v5, v115, v116
v_max3_f32 v6, v6, v151, v152
v_max3_f32 v7, v7, v187, v188
v_max3_f32 v8, v8, v223, v224
v_max3_f32 v5, v5, v117, v118
v_max3_f32 v6, v6, v153, v154
v_max3_f32 v7, v7, v189, v190
v_max3_f32 v8, v8, v225, v226
v_max3_f32 v5, v5, v119, v120
v_max3_f32 v6, v6, v155, v156
v_max3_f32 v7, v7, v191, v192
v_max3_f32 v8, v8, v227, v228
v_max3_f32 v5, v5, v121, v122
v_max3_f32 v6, v6, v157, v158
v_max3_f32 v7, v7, v193, v194
v_max3_f32 v8, v8, v229, v230
v_max3_f32 v5, v5, v123, v124
v_max3_f32 v6, v6, v159, v160
v_max3_f32 v7, v7, v195, v196
v_max3_f32 v8, v8, v231, v232
v_max3_f32 v5, v5, v125, v126
v_max3_f32 v6, v6, v161, v162
v_max3_f32 v7, v7, v197, v198
v_max3_f32 v8, v8, v233, v234
v_max3_f32 v5, v5, v127, v128
v_max3_f32 v6, v6, v163, v164
v_max3_f32 v7, v7, v199, v200
v_max3_f32 v8, v8, v235, v236
v_max3_f32 v5, v5, v129, v130
v_max3_f32 v6, v6, v165, v166
v_max3_f32 v7, v7, v201, v202
v_max3_f32 v8, v8, v237, v238
v_max3_f32 v5, v5, v131, v132
v_max3_f32 v6, v6, v167, v168
v_max3_f32 v7, v7, v203, v204
v_max3_f32 v8, v8, v239, v240
v_max3_f32 v5, v5, v133, v134
v_max3_f32 v6, v6, v169, v170
v_max3_f32 v7, v7, v205, v206
v_max3_f32 v8, v8, v241, v242
v_max3_f32 v5, v5, v135, v136
v_max3_f32 v6, v6, v171, v172
v_max3_f32 v7, v7, v207, v208
v_max3_f32 v8, v8, v243, v244
v_max3_f32 v5, v5, v137, v138
v_max3_f32 v6, v6, v173, v174
v_max3_f32 v7, v7, v209, v210
v_max3_f32 v8, v8, v245, v246
v_max_f32 v5, v5, v139
v_max_f32 v6, v6, v175
v_max_f32 v7, v7, v211
v_max_f32 v8, v8, v247
v_max3_f32 v5, v5, v6, v7
v_max_f32 v5, v5, v8
v_mov_b32 v6, v5
s_nop 1
v_permlane32_swap_b32 v5, v6
v_max_f32_e64 v5, v5, v6
ds_read_b64_tr_b16 v[72:73], v13 offset:2432
ds_read_b64_tr_b16 v[74:75], v14 offset:2432
ds_read_b64_tr_b16 v[76:77], v15 offset:2432
ds_read_b64_tr_b16 v[78:79], v16 offset:2432
v_sub_f32 v104, v104, v5
v_sub_f32 v105, v105, v5
v_sub_f32 v106, v106, v5
v_sub_f32 v107, v107, v5
v_sub_f32 v108, v108, v5
v_sub_f32 v109, v109, v5
v_sub_f32 v110, v110, v5
v_sub_f32 v111, v111, v5
v_sub_f32 v112, v112, v5
v_sub_f32 v113, v113, v5
v_sub_f32 v114, v114, v5
v_sub_f32 v115, v115, v5
v_sub_f32 v116, v116, v5
v_sub_f32 v117, v117, v5
v_sub_f32 v118, v118, v5
v_sub_f32 v119, v119, v5
v_exp_f32 v104, v104
v_exp_f32 v105, v105
v_exp_f32 v106, v106
v_exp_f32 v107, v107
v_exp_f32 v108, v108
v_exp_f32 v109, v109
v_exp_f32 v110, v110
v_exp_f32 v111, v111
v_exp_f32 v112, v112
v_exp_f32 v113, v113
v_exp_f32 v114, v114
v_exp_f32 v115, v115
v_exp_f32 v116, v116
v_exp_f32 v117, v117
v_exp_f32 v118, v118
v_exp_f32 v119, v119
v_cvt_pk_bf16_f32 v104, v104, v105
v_cvt_pk_bf16_f32 v105, v106, v107
v_cvt_pk_bf16_f32 v106, v108, v109
v_cvt_pk_bf16_f32 v107, v110, v111
v_cvt_pk_bf16_f32 v108, v112, v113
v_cvt_pk_bf16_f32 v109, v114, v115
v_cvt_pk_bf16_f32 v110, v116, v117
v_cvt_pk_bf16_f32 v111, v118, v119
s_waitcnt lgkmcnt(0)
v_mfma_f32_32x32x16_bf16 v[88:103], v[72:75], v[104:107], 0
v_mfma_f32_32x32x16_bf16 v[88:103], v[76:79], v[108:111], v[88:103]
ds_read_b64_tr_b16 v[72:73], v13 offset:4864
ds_read_b64_tr_b16 v[74:75], v14 offset:4864
ds_read_b64_tr_b16 v[76:77], v15 offset:4864
ds_read_b64_tr_b16 v[78:79], v16 offset:4864
v_sub_f32 v120, v120, v5
v_sub_f32 v121, v121, v5
v_sub_f32 v122, v122, v5
v_sub_f32 v123, v123, v5
v_sub_f32 v124, v124, v5
v_sub_f32 v125, v125, v5
v_sub_f32 v126, v126, v5
v_sub_f32 v127, v127, v5
v_sub_f32 v128, v128, v5
v_sub_f32 v129, v129, v5
v_sub_f32 v130, v130, v5
v_sub_f32 v131, v131, v5
v_sub_f32 v132, v132, v5
v_sub_f32 v133, v133, v5
v_sub_f32 v134, v134, v5
v_sub_f32 v135, v135, v5
v_exp_f32 v120, v120
v_exp_f32 v121, v121
v_exp_f32 v122, v122
v_exp_f32 v123, v123
v_exp_f32 v124, v124
v_exp_f32 v125, v125
v_exp_f32 v126, v126
v_exp_f32 v127, v127
v_exp_f32 v128, v128
v_exp_f32 v129, v129
v_exp_f32 v130, v130
v_exp_f32 v131, v131
v_exp_f32 v132, v132
v_exp_f32 v133, v133
v_exp_f32 v134, v134
v_exp_f32_e64 v135, v135
v_cvt_pk_bf16_f32 v120, v120, v121
v_cvt_pk_bf16_f32 v121, v122, v123
v_cvt_pk_bf16_f32 v122, v124, v125
v_cvt_pk_bf16_f32 v123, v126, v127
v_cvt_pk_bf16_f32 v124, v128, v129
v_cvt_pk_bf16_f32 v125, v130, v131
v_cvt_pk_bf16_f32 v126, v132, v133
v_cvt_pk_bf16_f32 v127, v134, v135
s_waitcnt lgkmcnt(0)
v_mfma_f32_32x32x16_bf16 v[88:103], v[72:75], v[120:123], v[88:103]
v_mfma_f32_32x32x16_bf16 v[88:103], v[76:79], v[124:127], v[88:103]
ds_read_b64_tr_b16 v[72:73], v13 offset:7296
ds_read_b64_tr_b16 v[74:75], v14 offset:7296
ds_read_b64_tr_b16 v[76:77], v15 offset:7296
ds_read_b64_tr_b16 v[78:79], v16 offset:7296
v_sub_f32 v136, v136, v5
v_sub_f32 v137, v137, v5
v_sub_f32 v138, v138, v5
v_sub_f32 v139, v139, v5
v_sub_f32 v140, v140, v5
v_sub_f32 v141, v141, v5
v_sub_f32 v142, v142, v5
v_sub_f32 v143, v143, v5
v_sub_f32 v144, v144, v5
v_sub_f32 v145, v145, v5
v_sub_f32 v146, v146, v5
v_sub_f32 v147, v147, v5
v_sub_f32 v148, v148, v5
v_sub_f32 v149, v149, v5
v_sub_f32 v150, v150, v5
v_sub_f32 v151, v151, v5
v_exp_f32 v136, v136
v_exp_f32 v137, v137
v_exp_f32 v138, v138
v_exp_f32 v139, v139
v_exp_f32 v140, v140
v_exp_f32 v141, v141
v_exp_f32 v142, v142
v_exp_f32 v143, v143
v_exp_f32 v144, v144
v_exp_f32 v145, v145
v_exp_f32 v146, v146
v_exp_f32 v147, v147
v_exp_f32 v148, v148
v_exp_f32 v149, v149
v_exp_f32 v150, v150
v_exp_f32_e64 v151, v151
v_cvt_pk_bf16_f32 v136, v136, v137
v_cvt_pk_bf16_f32 v137, v138, v139
v_cvt_pk_bf16_f32 v138, v140, v141
v_cvt_pk_bf16_f32 v139, v142, v143
v_cvt_pk_bf16_f32 v140, v144, v145
v_cvt_pk_bf16_f32 v141, v146, v147
v_cvt_pk_bf16_f32 v142, v148, v149
v_cvt_pk_bf16_f32 v143, v150, v151
s_waitcnt lgkmcnt(0)
v_mfma_f32_32x32x16_bf16 v[88:103], v[72:75], v[136:139], v[88:103]
v_mfma_f32_32x32x16_bf16 v[88:103], v[76:79], v[140:143], v[88:103]
ds_read_b64_tr_b16 v[72:73], v13 offset:9728
ds_read_b64_tr_b16 v[74:75], v14 offset:9728
ds_read_b64_tr_b16 v[76:77], v15 offset:9728
ds_read_b64_tr_b16 v[78:79], v16 offset:9728
v_sub_f32 v152, v152, v5
v_sub_f32 v153, v153, v5
v_sub_f32 v154, v154, v5
v_sub_f32 v155, v155, v5
v_sub_f32 v156, v156, v5
v_sub_f32 v157, v157, v5
v_sub_f32 v158, v158, v5
v_sub_f32 v159, v159, v5
v_sub_f32 v160, v160, v5
v_sub_f32 v161, v161, v5
v_sub_f32 v162, v162, v5
v_sub_f32 v163, v163, v5
v_sub_f32 v164, v164, v5
v_sub_f32 v165, v165, v5
v_sub_f32 v166, v166, v5
v_sub_f32 v167, v167, v5
v_exp_f32 v152, v152
v_exp_f32 v153, v153
v_exp_f32 v154, v154
v_exp_f32 v155, v155
v_exp_f32 v156, v156
v_exp_f32 v157, v157
v_exp_f32 v158, v158
v_exp_f32 v159, v159
v_exp_f32 v160, v160
v_exp_f32 v161, v161
v_exp_f32 v162, v162
v_exp_f32 v163, v163
v_exp_f32 v164, v164
v_exp_f32 v165, v165
v_exp_f32 v166, v166
v_exp_f32_e64 v167, v167
v_cvt_pk_bf16_f32 v152, v152, v153
v_cvt_pk_bf16_f32 v153, v154, v155
v_cvt_pk_bf16_f32 v154, v156, v157
v_cvt_pk_bf16_f32 v155, v158, v159
v_cvt_pk_bf16_f32 v156, v160, v161
v_cvt_pk_bf16_f32 v157, v162, v163
v_cvt_pk_bf16_f32 v158, v164, v165
v_cvt_pk_bf16_f32 v159, v166, v167
s_waitcnt lgkmcnt(0)
v_mfma_f32_32x32x16_bf16 v[88:103], v[72:75], v[152:155], v[88:103]
v_mfma_f32_32x32x16_bf16 v[88:103], v[76:79], v[156:159], v[88:103]
ds_read_b64_tr_b16 v[72:73], v13 offset:12160
ds_read_b64_tr_b16 v[74:75], v14 offset:12160
ds_read_b64_tr_b16 v[76:77], v15 offset:12160
ds_read_b64_tr_b16 v[78:79], v16 offset:12160
v_sub_f32 v168, v168, v5
v_sub_f32 v169, v169, v5
v_sub_f32 v170, v170, v5
v_sub_f32 v171, v171, v5
v_sub_f32 v172, v172, v5
v_sub_f32 v173, v173, v5
v_sub_f32 v174, v174, v5
v_sub_f32 v175, v175, v5
v_sub_f32 v176, v176, v5
v_sub_f32 v177, v177, v5
v_sub_f32 v178, v178, v5
v_sub_f32 v179, v179, v5
v_sub_f32 v180, v180, v5
v_sub_f32 v181, v181, v5
v_sub_f32 v182, v182, v5
v_sub_f32 v183, v183, v5
v_exp_f32 v168, v168
v_exp_f32 v169, v169
v_exp_f32 v170, v170
v_exp_f32 v171, v171
v_exp_f32 v172, v172
v_exp_f32 v173, v173
v_exp_f32 v174, v174
v_exp_f32 v175, v175
v_exp_f32 v176, v176
v_exp_f32 v177, v177
v_exp_f32 v178, v178
v_exp_f32 v179, v179
v_exp_f32 v180, v180
v_exp_f32 v181, v181
v_exp_f32 v182, v182
v_exp_f32_e64 v183, v183
v_cvt_pk_bf16_f32 v168, v168, v169
v_cvt_pk_bf16_f32 v169, v170, v171
v_cvt_pk_bf16_f32 v170, v172, v173
v_cvt_pk_bf16_f32 v171, v174, v175
v_cvt_pk_bf16_f32 v172, v176, v177
v_cvt_pk_bf16_f32 v173, v178, v179
v_cvt_pk_bf16_f32 v174, v180, v181
v_cvt_pk_bf16_f32 v175, v182, v183
s_waitcnt lgkmcnt(0)
v_mfma_f32_32x32x16_bf16 v[88:103], v[72:75], v[168:171], v[88:103]
v_mfma_f32_32x32x16_bf16 v[88:103], v[76:79], v[172:175], v[88:103]
ds_read_b64_tr_b16 v[72:73], v13 offset:14592
ds_read_b64_tr_b16 v[74:75], v14 offset:14592
ds_read_b64_tr_b16 v[76:77], v15 offset:14592
ds_read_b64_tr_b16 v[78:79], v16 offset:14592
v_sub_f32 v184, v184, v5
v_sub_f32 v185, v185, v5
v_sub_f32 v186, v186, v5
v_sub_f32 v187, v187, v5
v_sub_f32 v188, v188, v5
v_sub_f32 v189, v189, v5
v_sub_f32 v190, v190, v5
v_sub_f32 v191, v191, v5
v_sub_f32 v192, v192, v5
v_sub_f32 v193, v193, v5
v_sub_f32 v194, v194, v5
v_sub_f32 v195, v195, v5
v_sub_f32 v196, v196, v5
v_sub_f32 v197, v197, v5
v_sub_f32 v198, v198, v5
v_sub_f32 v199, v199, v5
v_exp_f32 v184, v184
v_exp_f32 v185, v185
v_exp_f32 v186, v186
v_exp_f32 v187, v187
v_exp_f32 v188, v188
v_exp_f32 v189, v189
v_exp_f32 v190, v190
v_exp_f32 v191, v191
v_exp_f32 v192, v192
v_exp_f32 v193, v193
v_exp_f32 v194, v194
v_exp_f32 v195, v195
v_exp_f32 v196, v196
v_exp_f32 v197, v197
v_exp_f32 v198, v198
v_exp_f32_e64 v199, v199
v_cvt_pk_bf16_f32 v184, v184, v185
v_cvt_pk_bf16_f32 v185, v186, v187
v_cvt_pk_bf16_f32 v186, v188, v189
v_cvt_pk_bf16_f32 v187, v190, v191
v_cvt_pk_bf16_f32 v188, v192, v193
v_cvt_pk_bf16_f32 v189, v194, v195
v_cvt_pk_bf16_f32 v190, v196, v197
v_cvt_pk_bf16_f32 v191, v198, v199
s_waitcnt lgkmcnt(0)
v_mfma_f32_32x32x16_bf16 v[88:103], v[72:75], v[184:187], v[88:103]
v_mfma_f32_32x32x16_bf16 v[88:103], v[76:79], v[188:191], v[88:103]
ds_read_b64_tr_b16 v[72:73], v13 offset:17024
ds_read_b64_tr_b16 v[74:75], v14 offset:17024
ds_read_b64_tr_b16 v[76:77], v15 offset:17024
ds_read_b64_tr_b16 v[78:79], v16 offset:17024
v_sub_f32 v200, v200, v5
v_sub_f32 v201, v201, v5
v_sub_f32 v202, v202, v5
v_sub_f32 v203, v203, v5
v_sub_f32 v204, v204, v5
v_sub_f32 v205, v205, v5
v_sub_f32 v206, v206, v5
v_sub_f32 v207, v207, v5
v_sub_f32 v208, v208, v5
v_sub_f32 v209, v209, v5
v_sub_f32 v210, v210, v5
v_sub_f32 v211, v211, v5
v_sub_f32 v212, v212, v5
v_sub_f32 v213, v213, v5
v_sub_f32 v214, v214, v5
v_sub_f32 v215, v215, v5
v_exp_f32 v200, v200
v_exp_f32 v201, v201
v_exp_f32 v202, v202
v_exp_f32 v203, v203
v_exp_f32 v204, v204
v_exp_f32 v205, v205
v_exp_f32 v206, v206
v_exp_f32 v207, v207
v_exp_f32 v208, v208
v_exp_f32 v209, v209
v_exp_f32 v210, v210
v_exp_f32 v211, v211
v_exp_f32 v212, v212
v_exp_f32 v213, v213
v_exp_f32 v214, v214
v_exp_f32_e64 v215, v215
v_cvt_pk_bf16_f32 v200, v200, v201
v_cvt_pk_bf16_f32 v201, v202, v203
v_cvt_pk_bf16_f32 v202, v204, v205
v_cvt_pk_bf16_f32 v203, v206, v207
v_cvt_pk_bf16_f32 v204, v208, v209
v_cvt_pk_bf16_f32 v205, v210, v211
v_cvt_pk_bf16_f32 v206, v212, v213
v_cvt_pk_bf16_f32 v207, v214, v215
s_waitcnt lgkmcnt(0)
v_mfma_f32_32x32x16_bf16 v[88:103], v[72:75], v[200:203], v[88:103]
v_mfma_f32_32x32x16_bf16 v[88:103], v[76:79], v[204:207], v[88:103]
ds_read_b64_tr_b16 v[72:73], v13 offset:19456
ds_read_b64_tr_b16 v[74:75], v14 offset:19456
ds_read_b64_tr_b16 v[76:77], v15 offset:19456
ds_read_b64_tr_b16 v[78:79], v16 offset:19456
v_sub_f32 v216, v216, v5
v_sub_f32 v217, v217, v5
v_sub_f32 v218, v218, v5
v_sub_f32 v219, v219, v5
v_sub_f32 v220, v220, v5
v_sub_f32 v221, v221, v5
v_sub_f32 v222, v222, v5
v_sub_f32 v223, v223, v5
v_sub_f32 v224, v224, v5
v_sub_f32 v225, v225, v5
v_sub_f32 v226, v226, v5
v_sub_f32 v227, v227, v5
v_sub_f32 v228, v228, v5
v_sub_f32 v229, v229, v5
v_sub_f32 v230, v230, v5
v_sub_f32 v231, v231, v5
v_exp_f32 v216, v216
v_exp_f32 v217, v217
v_exp_f32 v218, v218
v_exp_f32 v219, v219
v_exp_f32 v220, v220
v_exp_f32 v221, v221
v_exp_f32 v222, v222
v_exp_f32 v223, v223
v_exp_f32 v224, v224
v_exp_f32 v225, v225
v_exp_f32 v226, v226
v_exp_f32 v227, v227
v_exp_f32 v228, v228
v_exp_f32 v229, v229
v_exp_f32 v230, v230
v_exp_f32_e64 v231, v231
v_cvt_pk_bf16_f32 v216, v216, v217
v_cvt_pk_bf16_f32 v217, v218, v219
v_cvt_pk_bf16_f32 v218, v220, v221
v_cvt_pk_bf16_f32 v219, v222, v223
v_cvt_pk_bf16_f32 v220, v224, v225
v_cvt_pk_bf16_f32 v221, v226, v227
v_cvt_pk_bf16_f32 v222, v228, v229
v_cvt_pk_bf16_f32 v223, v230, v231
s_waitcnt lgkmcnt(0)
v_mfma_f32_32x32x16_bf16 v[88:103], v[72:75], v[216:219], v[88:103]
v_mfma_f32_32x32x16_bf16 v[88:103], v[76:79], v[220:223], v[88:103]
ds_read_b64_tr_b16 v[72:73], v13 offset:21888
ds_read_b64_tr_b16 v[74:75], v14 offset:21888
ds_read_b64_tr_b16 v[76:77], v15 offset:21888
ds_read_b64_tr_b16 v[78:79], v16 offset:21888
v_sub_f32 v232, v232, v5
v_sub_f32 v233, v233, v5
v_sub_f32 v234, v234, v5
v_sub_f32 v235, v235, v5
v_sub_f32 v236, v236, v5
v_sub_f32 v237, v237, v5
v_sub_f32 v238, v238, v5
v_sub_f32 v239, v239, v5
v_sub_f32 v240, v240, v5
v_sub_f32 v241, v241, v5
v_sub_f32 v242, v242, v5
v_sub_f32 v243, v243, v5
v_sub_f32 v244, v244, v5
v_sub_f32 v245, v245, v5
v_sub_f32 v246, v246, v5
v_sub_f32 v247, v247, v5
v_exp_f32 v232, v232
v_exp_f32 v233, v233
v_exp_f32 v234, v234
v_exp_f32 v235, v235
v_exp_f32 v236, v236
v_exp_f32 v237, v237
v_exp_f32 v238, v238
v_exp_f32 v239, v239
v_exp_f32 v240, v240
v_exp_f32 v241, v241
v_exp_f32 v242, v242
v_exp_f32 v243, v243
v_exp_f32 v244, v244
v_exp_f32 v245, v245
v_exp_f32 v246, v246
v_exp_f32_e64 v247, v247
v_cvt_pk_bf16_f32 v232, v232, v233
v_cvt_pk_bf16_f32 v233, v234, v235
v_cvt_pk_bf16_f32 v234, v236, v237
v_cvt_pk_bf16_f32 v235, v238, v239
v_cvt_pk_bf16_f32 v236, v240, v241
v_cvt_pk_bf16_f32 v237, v242, v243
v_cvt_pk_bf16_f32 v238, v244, v245
v_cvt_pk_bf16_f32 v239, v246, v247
s_waitcnt lgkmcnt(0)
v_mfma_f32_32x32x16_bf16 v[88:103], v[72:75], v[232:235], v[88:103]
v_mfma_f32_32x32x16_bf16 v[88:103], v[76:79], v[236:239], v[88:103]
s_nop 11
v_rcp_f32 v104, v98
s_nop 0
v_mul_f32_e64 v104, v104, v21
v_pk_mul_f32 v[88:89], v[88:89], v[104:105] op_sel_hi:[1,0]
v_pk_mul_f32 v[90:91], v[90:91], v[104:105] op_sel_hi:[1,0]
v_pk_mul_f32 v[92:93], v[92:93], v[104:105] op_sel_hi:[1,0]
v_pk_mul_f32 v[94:95], v[94:95], v[104:105] op_sel_hi:[1,0]
v_pk_mul_f32 v[96:97], v[96:97], v[104:105] op_sel_hi:[1,0]
v_cvt_pk_bf16_f32 v88, v88, v89
v_cvt_pk_bf16_f32 v89, v90, v91
v_cvt_pk_bf16_f32 v90, v92, v93
v_cvt_pk_bf16_f32 v91, v94, v95
buffer_store_dwordx4 v[88:91], v1, s[28:31], s5 offen sc1
v_cvt_pk_bf16_f32 v253, v96, v97
s_nop 1
s_branch L_p3C
L_p2H:
s_mov_b32 s59, 0
L_p2H2:
v_mov_b32 v8, 0
global_load_dword v9, v8, s[96:97] sc1
s_getpc_b64 s[54:55]
L_pc2:
s_sub_u32 s54, s54, L_pc2-L_V
s_subb_u32 s55, s55, 0
s_lshr_b32 s56, s2, 3
s_lshl_b32 s56, s56, 2
s_add_u32 s56, s56, s52
s_lshl_b32 s56, s56, 7
v_lshl_add_u32 v13, v0, 14, s56
v_min_u32 v13, L_code_end-L_V-4, v13
global_load_dword v89, v13, s[54:55]
s_load_dwordx2 s[4:5], s[0:1], 16
s_load_dwordx2 s[6:7], s[0:1], 48
s_mov_b64 exec, 0
s_cmp_eq_u32 s52, 0
s_cbranch_scc1 L_pdP0_0
s_cmp_eq_u32 s52, 1
s_cbranch_scc1 L_pdP1_0
s_cmp_eq_u32 s52, 2
s_cbranch_scc1 L_pdP2_0
s_branch L_pdP3_0
L_retH:
s_mov_b64 exec, -1
s_add_u32 s48, s14, 15347712
s_addc_u32 s49, s15, 0
s_mov_b32 s50, 196608
s_mov_b32 s51, 0x20000
s_and_b32 s40, s2, 7
s_lshr_b32 s41, s2, 3
s_and_b32 s53, s40, 1
s_lshl_b32 s53, s53, 4
s_lshr_b32 s42, s41, 1
s_add_u32 s53, s53, s42
s_and_b32 s54, s40, 6
s_and_b32 s41, s41, 1
s_add_u32 s54, s54, s41
s_and_b32 s40, s2, 7
s_lshr_b32 s41, s2, 3
s_mul_i32 s40, s40, 30
s_add_u32 s40, s40, s41
s_cmp_lt_u32 s41, 30
s_cselect_b32 s40, s40, 255
s_cmp_lt_u32 s40, 234
s_cselect_b32 s45, 1, 0
s_cselect_b32 s40, s40, 0
s_mul_i32 s39, s40, 7282
s_lshr_b32 s39, s39, 16
s_mul_i32 s41, s39, 9
s_sub_u32 s44, s40, s41
s_lshl_b32 s40, s52, 6
v_add_u32 v1, s40, v0
v_lshlrev_b32 v2, 4, v0
s_waitcnt lgkmcnt(0)
s_lshl_b32 s40, s54, 5
s_add_u32 s40, s40, s53
s_lshl_b32 s40, s40, 8
s_add_u32 s40, s40, 0
v_and_b32 v80, 3, v0
v_bfe_u32 v81, v0, 2, 2
v_add_u32_e64 v82, -1, v80
v_cmp_gt_u32 s[24:25], 2, v82
v_cmp_lt_u32 s[28:29], 1, v81
s_cmp_eq_u32 s54, 0
s_cselect_b64 s[24:25], 0, s[24:25]
s_or_b64 s[24:25], s[24:25], s[28:29]
v_and_b32 v80, 15, v0
v_cndmask_b32 v81, 9, v80, s[24:25]
v_lshl_add_u32 v4, v81, 2, s40
v_add_u32 v80, 32, v80
v_and_b32 v81, 1, v0
v_add_u32 v81, 16, v81
v_cmp_gt_u32 vcc, 16, v0
s_nop 1
v_cndmask_b32 v80, v81, v80, vcc
v_lshl_add_u32 v10, v80, 2, s40
s_and_b32 s40, s2, 7
s_lshr_b32 s41, s2, 3
s_and_b32 s24, s40, 1
s_lshr_b32 s40, s40, 1
s_lshl_b32 s40, s40, 2
s_and_b32 s25, s41, 3
s_add_u32 s25, s25, s40
s_bfe_u32 s26, s41, 0x20002
s_lshr_b32 s27, s25, 1
s_and_b32 s28, s25, 1
s_lshl_b32 s29, s27, 5
s_lshl_b32 s30, s24, 4
s_add_u32 s29, s29, s30
v_and_b32 v80, 15, v0
v_add_u32 v80, s29, v80
v_lshlrev_b32_e64 v80, 8, v80
v_mov_b32 v83, 0x03000000
s_cmp_eq_u32 s59, 0
s_cbranch_scc0 L_sV
s_lshl_b32 s30, s28, 2
s_add_u32 s30, s30, s26
s_lshl_b32 s30, s30, 2
s_add_u32 s30, s30, 0
v_add_u32 v80, s30, v80
v_add_u32 v81, 32, v80
v_add_u32 v82, 8192, v80
s_sub_u32 s30, s26, 1
s_cmp_lt_u32 s30, 2
s_cselect_b32 s30, 32, 16
s_cmp_lt_u32 s27, 7
s_cselect_b32 s30, s30, 16
v_cmp_gt_u32 vcc, 16, v0
s_nop 1
v_cndmask_b32 v81, v82, v81, vcc
v_cmp_gt_u32 vcc, s30, v0
s_nop 1
v_cndmask_b32 v13, v83, v81, vcc
s_branch L_sD
L_sV:
s_lshl_b32 s30, s28, 2
s_add_u32 s30, s30, 64
v_add_u32 v80, s30, v80
s_lshl_b32 s30, s24, 2
s_add_u32 s30, s30, s26
s_lshl_b32 s30, s30, 2
v_and_b32_e64 v81, 3, v0
v_bfe_u32 v82, v0, 2, 3
v_lshl_add_u32 v81, v82, 5, v81
v_add_u32 v81, s30, v81
s_lshl_b32 s30, s25, 2
s_add_u32 s30, s30, 128
v_lshl_add_u32 v81, v81, 8, s30
s_cmp_eq_u32 s26, 0
s_cselect_b32 s30, 48, 32
v_cmp_gt_u32 vcc, 32, v0
s_nop 1
v_cndmask_b32 v81, v80, v81, vcc
v_cmp_gt_u32 vcc, s30, v0
s_nop 1
v_cndmask_b32 v13, v83, v81, vcc
L_sD:
s_mul_i32 s24, s54, 209728
s_lshr_b32 s24, s24, 16
v_mul_u32_u24 v80, 7282, v0
v_lshrrev_b32 v80, 16, v80
v_add_u32 v80, s24, v80
v_mul_u32_u24 v80, 5, v80
v_lshrrev_b32 v80, 4, v80
v_sub_u32 v81, s54, v80
s_mul_i32 s24, s24, 9
v_add_u32 v82, s24, v0
v_lshlrev_b32 v80, 1, v82
v_add_u32_e64 v80, v80, v81
s_lshl_b32 s24, s53, 2
s_add_u32 s24, s24, 65536
v_lshl_add_u32 v80, v80, 7, s24
v_cmp_gt_u32 vcc, 2, v81
s_nop 1
v_cndmask_b32_e64 v80, v83, v80, vcc
v_cmp_gt_u32 vcc, 234, v82
s_nop 1
v_cndmask_b32 v80, v83, v80, vcc
v_cmp_gt_u32 vcc, 45, v0
s_nop 1
v_cndmask_b32_e64 v14, v83, v80, vcc
s_mul_i32 s40, s39, 5
s_add_u32 s41, s40, 4
s_min_u32 s41, s41, 127
s_lshr_b32 s40, s40, 4
s_lshr_b32 s41, s41, 4
s_cmp_eq_u32 s40, s41
s_cselect_b32 s40, 31, 63
v_and_b32 v80, s40, v0
s_mul_i32 s40, s39, 9
s_add_u32 s40, s40, s44
s_lshl_b32 s40, s40, 8
s_add_u32 s40, s40, 65536
v_lshl_add_u32 v15, v80, 2, s40
v_lshrrev_b32 v80, 3, v0
v_and_b32 v81, 7, v0
v_bfe_u32 v82, v0, 4, 1
v_lshlrev_b32 v82, 1, v82
v_xor_b32 v81, v81, v82
v_lshlrev_b32_e64 v81, 4, v81
v_mul_u32_u24 v6, 1152, v80
v_add_u32 v6, v6, v81
v_lshrrev_b32 v82, 1, v80
v_mul_u32_u24 v82, 18, v82
v_and_b32 v83, 1, v80
v_add3_u32 v82, v82, v83, 16
v_mul_u32_u24 v7, 1152, v82
v_add_u32 v7, v7, v81
v_xor_b32 v90, 64, v6
v_xor_b32 v91, 64, v7
v_lshrrev_b32 v80, 4, v0
v_mul_u32_u24 v80, 1792, v80
v_and_b32_e64 v81, 15, v0
v_lshl_add_u32 v5, v81, 4, v80
s_lshl_b32 s40, s52, 8
v_add_u32 v5, s40, v5
v_and_b32 v80, 15, v0
v_lshrrev_b32 v81, 4, v0
v_mul_u32_u24 v82, 80, v80
v_lshl_add_u32 v82, v81, 5, v82
s_lshl_b32 s40, s52, 3
v_add_u32 v82, s40, v82
v_mov_b32 v84, 1920
v_cmp_gt_u32 s[24:25], 32, v0
s_nop 1
v_cndmask_b32 v11, v84, v82, s[24:25]
v_and_b32 v82, 3, v0
v_mul_u32_u24 v82, 80, v82
v_lshl_add_u32 v82, v81, 5, v82
v_lshrrev_b32_e64 v83, 2, v80
v_lshl_add_u32 v82, v83, 3, v82
v_add_u32 v82, 1280, v82
v_and_b32_e64 v83, 31, v0
v_mul_u32_u24 v83, 80, v83
s_add_u32 s40, s40, 56
v_add_u32 v83, s40, v83
v_cmp_gt_u32 vcc, 20, v0
s_nop 1
v_cndmask_b32_e64 v83, v84, v83, vcc
v_cndmask_b32 v82, v84, v82, s[24:25]
s_cmp_eq_u32 s52, 0
s_cselect_b64 vcc, -1, 0
v_cndmask_b32 v82, v83, v82, vcc
s_cmp_eq_u32 s52, 3
s_cselect_b64 vcc, -1, 0
v_cndmask_b32 v12, v82, v84, vcc
v_and_b32 v82, 1, v0
v_lshlrev_b32 v82, 4, v82
v_mov_b32 v83, 0x3f80
v_lshlrev_b32 v82, v82, v83
v_lshrrev_b32 v80, 1, v80
v_cmp_eq_u32 vcc, 0, v80
s_nop 1
v_cndmask_b32 v92, 0, v82, vcc
v_cmp_eq_u32 vcc, 1, v80
s_nop 1
v_cndmask_b32 v93, 0, v82, vcc
v_cmp_eq_u32 vcc, 2, v80
s_nop 1
v_cndmask_b32 v94, 0, v82, vcc
v_cmp_eq_u32 vcc, 3, v80
s_nop 1
v_cndmask_b32 v95, 0, v82, vcc
s_mul_i32 s41, s53, 155648
s_add_u32 s41, s41, 4718592
s_add_u32 s24, s14, s41
s_addc_u32 s25, s15, 0
s_mov_b32 s26, 155648
s_mov_b32 s27, 0x20000
s_mul_i32 s41, s53, 28672
s_add_u32 s41, s41, 9699328
s_add_u32 s28, s14, s41
s_addc_u32 s29, s15, 0
s_mov_b32 s30, 28672
s_mov_b32 s31, 0x20000
s_add_u32 s32, s14, 10616832
s_addc_u32 s33, s15, 0
s_mov_b32 s34, 8192
s_mov_b32 s35, 0x20000
s_lshl_b32 s40, s44, 7
s_add_u32 s16, s4, s40
s_addc_u32 s17, s5, 0
s_sub_u32 s18, 663552, s40
s_mul_i32 s18, s18, s45
s_mov_b32 s19, 0x20000
s_add_u32 s20, s6, s40
s_addc_u32 s21, s7, 0
s_sub_u32 s22, 663552, s40
s_mul_i32 s22, s22, s45
s_mov_b32 s23, 0x20000
s_mov_b32 s46, 65536
s_mov_b32 s99, 16384
L_tg:
s_waitcnt vmcnt(0)
v_readfirstlane_b32 s98, v9
s_nop 0
s_cmp_lg_u32 s98, 0
s_cbranch_scc1 L_tgk
global_load_dword v9, v8, s[96:97] sc1
s_sub_u32 s99, s99, 1
s_cbranch_scc0 L_tg
L_tgk:
v_mov_b32 v81, 1
v_mov_b32 v80, 161792
s_waitcnt vmcnt(0)
s_mov_b64 exec, 1
ds_add_u32 v80, v81
s_mov_b64 exec, -1
s_lshl_b32 s41, s54, 3
s_sub_u32 s41, s41, 8
s_mul_i32 s41, s41, 2432
s_lshl_b32 s47, s52, 10
s_add_u32 s41, s41, s47
s_cmp_eq_u32 s59, 0
s_cbranch_scc1 L_nvb
s_barrier
L_nvb:
s_cmp_lg_u32 s52, 1
s_cbranch_scc1 L_ns1
v_mov_b32 v80, 161792
s_mov_b32 s99, 262144
L_arr1:
ds_read_b32 v81, v80
s_waitcnt lgkmcnt(0)
v_readfirstlane_b32 s40, v81
s_nop 0
s_cmp_ge_u32 s40, 8
s_cbranch_scc1 L_arr1_ok
s_sleep 1
s_sub_u32 s99, s99, 1
s_cbranch_scc0 L_arr1
L_arr1_ok:
buffer_store_dword v9, v13, s[48:51], 0 offen sc1
L_ns1:
s_cmp_lg_u32 s52, 0
s_cbranch_scc1 L_nf1
s_cmp_eq_u32 s59, 0
s_cbranch_scc1 L_pr
s_sleep 30
s_branch L_pg
L_pr:
v_mov_b32 v80, 161792
s_mov_b32 s99, 262144
L_arr0:
ds_read_b32 v81, v80
s_waitcnt lgkmcnt(0)
v_readfirstlane_b32 s40, v81
s_nop 0
s_cmp_ge_u32 s40, 8
s_cbranch_scc1 L_arr0_ok
s_sleep 1
s_sub_u32 s99, s99, 1
s_cbranch_scc0 L_arr0
L_arr0_ok:
s_sleep 19
L_pg:
s_mov_b32 s99, 16384
L_pollE:
buffer_load_dword v88, v4, s[48:51], 0 offen sc1
s_waitcnt vmcnt(0)
L_pollE_c:
v_cmp_ne_u32 vcc, s98, v88
s_nop 0
s_cmp_eq_u64 vcc, 0
s_cbranch_scc1 L_pollE_ok
s_sub_u32 s99, s99, 1
s_cbranch_scc0 L_pollE
L_pollE_ok:
L_nf1:
L_pdP2_3:
s_cbranch_execz L_retH
s_barrier
s_mov_b32 s63, 24576
buffer_load_dword v3, v10, s[48:51], 0 offen sc1
s_add_u32 s40, s41, 14336
s_add_u32 m0, s47, 14336
s_cmp_lt_i32 s40, 0
s_cselect_b32 s43, s58, s40
v_add_u32_e64 v80, s43, v2
buffer_load_dwordx4 v80, s[24:27], 0 offen sc1 lds
s_add_u32 s40, s41, 18432
s_add_u32 m0, s47, 18432
s_cmp_lt_i32 s40, 0
s_cselect_b32 s43, s58, s40
v_add_u32_e64 v81, s43, v2
buffer_load_dwordx4 v81, s[24:27], 0 offen sc1 lds
s_add_u32 s40, s41, 22528
s_add_u32 m0, s47, 22528
s_cmp_lt_i32 s40, 0
s_cselect_b32 s43, s58, s40
v_add_u32_e64 v82, s43, v2
buffer_load_dwordx4 v82, s[24:27], 0 offen sc1 lds
s_add_u32 s40, s41, 0
s_add_u32 m0, s47, 0
s_cmp_lt_i32 s40, 0
s_cselect_b32 s43, s58, s40
v_add_u32_e64 v83, s43, v2
buffer_load_dwordx4 v83, s[24:27], 0 offen sc1 lds
s_add_u32 s40, s41, 4096
s_add_u32 m0, s47, 4096
s_cmp_lt_i32 s40, 0
s_cselect_b32 s43, s58, s40
v_add_u32_e64 v84, s43, v2
buffer_load_dwordx4 v84, s[24:27], 0 offen sc1 lds
s_add_u32 s40, s41, 8192
s_add_u32 m0, s47, 8192
s_cmp_lt_i32 s40, 0
s_cselect_b32 s43, s58, s40
v_add_u32_e64 v80, s43, v2
buffer_load_dwordx4 v80, s[24:27], 0 offen sc1 lds
s_cmp_lt_u32 s52, 2
s_cselect_b32 s42, 12288, s63
s_add_u32 s40, s41, s42
s_add_u32 m0, s47, s42
s_cmp_lt_i32 s40, 0
s_cselect_b32 s43, s58, s40
v_add_u32 v81, s43, v2
buffer_load_dwordx4 v81, s[24:27], 0 offen sc1 lds
s_add_u32 s40, s41, 28672
s_add_u32 m0, s47, 28672
s_cmp_lt_i32 s40, 0
s_cselect_b32 s43, s58, s40
v_add_u32_e64 v82, s43, v2
buffer_load_dwordx4 v82, s[24:27], 0 offen sc1 lds
s_add_u32 s40, s41, 32768
s_add_u32 m0, s47, 32768
s_cmp_lt_i32 s40, 0
s_cselect_b32 s43, s58, s40
v_add_u32_e64 v83, s43, v2
buffer_load_dwordx4 v83, s[24:27], 0 offen sc1 lds
s_add_u32 s40, s41, 36864
s_add_u32 m0, s47, 36864
s_cmp_lt_i32 s40, 0
s_cselect_b32 s43, s58, s40
v_add_u32_e64 v84, s43, v2
buffer_load_dwordx4 v84, s[24:27], 0 offen sc1 lds
s_cmp_eq_u32 s52, 3
s_cselect_b32 s43, s58, 1024
v_add_u32_e64 v85, s43, v5
s_waitcnt vmcnt(10)
v_cmp_ne_u32 vcc, s98, v3
s_nop 0
s_cmp_eq_u64 vcc, 0
s_cbranch_scc0 L_late
s_waitcnt vmcnt(7)
s_barrier
buffer_load_dwordx4 v[16:19], v5, s[28:31], 0 offen sc1
s_mov_b32 s41, 7168
buffer_load_dwordx4 v[20:23], v5, s[28:31], s41 offen sc1
s_mov_b32 s41, 14336
buffer_load_dwordx4 v[24:27], v5, s[28:31], s41 offen sc1
s_mov_b32 s41, 21504
buffer_load_dwordx4 v[28:31], v5, s[28:31], s41 offen sc1
buffer_load_dwordx4 v[32:35], v85, s[28:31], 0 offen sc1
s_mov_b32 s41, 7168
buffer_load_dwordx4 v[36:39], v85, s[28:31], s41 offen sc1
s_mov_b32 s41, 14336
buffer_load_dwordx4 v[40:43], v85, s[28:31], s41 offen sc1
s_mov_b32 s41, 21504
buffer_load_dwordx4 v[44:47], v85, s[28:31], s41 offen sc1
s_lshl_b32 s41, s54, 10
v_lshlrev_b32 v80, 2, v1
buffer_load_dword v81, v80, s[32:35], s41 offen sc1
s_waitcnt vmcnt(9)
s_barrier
s_branch L_parts
L_late:
s_waitcnt vmcnt(7)
s_barrier
s_waitcnt vmcnt(0)
buffer_load_dword v3, v10, s[48:51], 0 offen sc1
s_barrier
s_waitcnt vmcnt(0)
L_pdP3_3:
s_cbranch_execz L_retH
s_mov_b32 s99, 16384
s_branch L_pollL_c
L_pollL:
buffer_load_dword v3, v10, s[48:51], 0 offen sc1
s_waitcnt vmcnt(0)
L_pollL_c:
v_cmp_ne_u32 vcc, s98, v3
s_nop 0
s_cmp_eq_u64 vcc, 0
s_cbranch_scc1 L_pollL_ok
s_sub_u32 s99, s99, 1
s_cbranch_scc0 L_pollL
L_pollL_ok:
buffer_load_dwordx4 v[16:19], v5, s[28:31], 0 offen sc1
s_mov_b32 s41, 7168
buffer_load_dwordx4 v[20:23], v5, s[28:31], s41 offen sc1
s_mov_b32 s41, 14336
buffer_load_dwordx4 v[24:27], v5, s[28:31], s41 offen sc1
s_mov_b32 s41, 21504
buffer_load_dwordx4 v[28:31], v5, s[28:31], s41 offen sc1
buffer_load_dwordx4 v[32:35], v85, s[28:31], 0 offen sc1
s_mov_b32 s41, 7168
buffer_load_dwordx4 v[36:39], v85, s[28:31], s41 offen sc1
s_mov_b32 s41, 14336
buffer_load_dwordx4 v[40:43], v85, s[28:31], s41 offen sc1
s_mov_b32 s41, 21504
buffer_load_dwordx4 v[44:47], v85, s[28:31], s41 offen sc1
s_lshl_b32 s41, s54, 10
v_lshlrev_b32_e64 v80, 2, v1
buffer_load_dword v81, v80, s[32:35], s41 offen sc1
L_parts:
s_waitcnt vmcnt(0)
s_setprio 3
v_mfma_f32_16x16x32_bf16 v[48:51], v[92:95], v[16:19], 0
v_mfma_f32_16x16x32_bf16 v[48:51], v[92:95], v[20:23], v[48:51]
v_mfma_f32_16x16x32_bf16 v[48:51], v[92:95], v[24:27], v[48:51]
v_mfma_f32_16x16x32_bf16 v[48:51], v[92:95], v[28:31], v[48:51]
v_mfma_f32_16x16x32_bf16 v[52:55], v[92:95], v[32:35], 0
v_mfma_f32_16x16x32_bf16 v[52:55], v[92:95], v[36:39], v[52:55]
v_mfma_f32_16x16x32_bf16 v[52:55], v[92:95], v[40:43], v[52:55]
v_mfma_f32_16x16x32_bf16 v[52:55], v[92:95], v[44:47], v[52:55]
ds_write_b32 v80, v81 offset:43008
v_lshlrev_b32_e64 v82, 3, v0
v_add_u32 v82, 44032, v82
ds_write2_b32 v82, v14, v9 offset0:0 offset1:1
v_cvt_pk_bf16_f32 v48, v48, v49
v_cvt_pk_bf16_f32 v49, v50, v51
ds_write_b64 v11, v[48:49] offset:40960
s_nop 0
v_cvt_pk_bf16_f32 v52, v52, v53
v_cvt_pk_bf16_f32 v53, v54, v55
ds_write_b64 v12, v[52:53] offset:40960
s_setprio 0
s_waitcnt lgkmcnt(0)
s_barrier
s_cmp_eq_u32 s52, 0
s_cbranch_scc1 L_h0
s_cmp_lg_u32 s52, 1
s_cbranch_scc1 L_hw2
s_mov_b32 s42, 0
s_mov_b32 m0, 47104
s_nop 0
buffer_load_dwordx4 v6, s[20:23], s42 offen lds
s_mov_b32 s42, 29952
s_mov_b32 m0, 50176
s_nop 0
buffer_load_dwordx4 v90, s[20:23], s42 offen lds
s_mov_b32 s42, 62208
s_mov_b32 m0, 53248
s_nop 0
buffer_load_dwordx4 v6, s[20:23], s42 offen lds
s_mov_b32 s42, 92160
s_mov_b32 m0, 56320
s_nop 0
buffer_load_dwordx4 v90, s[20:23], s42 offen lds
s_mov_b32 s42, 124416
s_mov_b32 m0, 59392
s_nop 0
buffer_load_dwordx4 v6, s[20:23], s42 offen lds
s_mov_b32 s42, 154368
s_mov_b32 m0, 62464
s_nop 0
buffer_load_dwordx4 v90, s[20:23], s42 offen lds
s_mov_b32 s42, 186624
s_mov_b32 m0, 65536
s_nop 0
buffer_load_dwordx4 v6, s[20:23], s42 offen lds
s_mov_b32 s42, 216576
s_mov_b32 m0, 68608
s_nop 0
buffer_load_dwordx4 v90, s[20:23], s42 offen lds
s_waitcnt vmcnt(7)
s_mov_b32 s42, 248832
s_mov_b32 m0, 71680
s_nop 0
buffer_load_dwordx4 v6, s[20:23], s42 offen lds
s_waitcnt vmcnt(7)
s_mov_b32 s42, 278784
s_mov_b32 m0, 74752
s_nop 0
buffer_load_dwordx4 v90, s[20:23], s42 offen lds
s_waitcnt vmcnt(7)
s_mov_b32 s42, 311040
s_mov_b32 m0, 77824
s_nop 0
buffer_load_dwordx4 v6, s[20:23], s42 offen lds
s_waitcnt vmcnt(7)
s_mov_b32 s42, 340992
s_mov_b32 m0, 80896
s_nop 0
buffer_load_dwordx4 v90, s[20:23], s42 offen lds
s_waitcnt vmcnt(7)
s_mov_b32 s42, 373248
s_mov_b32 m0, 83968
s_nop 0
buffer_load_dwordx4 v6, s[20:23], s42 offen lds
s_waitcnt vmcnt(7)
s_mov_b32 s42, 403200
s_mov_b32 m0, 87040
s_nop 0
buffer_load_dwordx4 v90, s[20:23], s42 offen lds
s_waitcnt vmcnt(7)
s_mov_b32 s42, 435456
s_mov_b32 m0, 90112
s_nop 0
buffer_load_dwordx4 v6, s[20:23], s42 offen lds
s_waitcnt vmcnt(7)
s_mov_b32 s42, 465408
s_mov_b32 m0, 93184
s_nop 0
buffer_load_dwordx4 v90, s[20:23], s42 offen lds
s_waitcnt vmcnt(7)
s_mov_b32 s42, 497664
s_mov_b32 m0, 96256
s_nop 0
buffer_load_dwordx4 v6, s[20:23], s42 offen lds
s_waitcnt vmcnt(7)
s_mov_b32 s42, 527616
s_mov_b32 m0, 99328
s_nop 0
buffer_load_dwordx4 v90, s[20:23], s42 offen lds
s_waitcnt vmcnt(7)
s_mov_b32 s42, 559872
s_mov_b32 m0, 102400
s_nop 0
buffer_load_dwordx4 v6, s[20:23], s42 offen lds
s_waitcnt vmcnt(7)
s_mov_b32 s42, 589824
s_mov_b32 m0, 105472
s_nop 0
buffer_load_dwordx4 v90, s[20:23], s42 offen lds
s_waitcnt vmcnt(7)
s_mov_b32 s42, 622080
s_mov_b32 m0, 108544
s_nop 0
buffer_load_dwordx4 v6, s[20:23], s42 offen lds
s_waitcnt vmcnt(7)
s_mov_b32 s42, 652032
s_mov_b32 m0, 111616
s_nop 0
buffer_load_dwordx4 v90, s[20:23], s42 offen lds
s_waitcnt vmcnt(7)
s_mov_b32 s42, 165888
s_mov_b32 m0, 114688
s_nop 0
buffer_load_dwordx4 v7, s[20:23], s42 offen lds
s_waitcnt vmcnt(7)
s_mov_b32 s42, 414720
s_mov_b32 m0, 117760
s_nop 0
buffer_load_dwordx4 v91, s[20:23], s42 offen lds
s_waitcnt vmcnt(7)
s_mov_b32 s42, 0
s_mov_b32 m0, 120832
s_nop 0
buffer_load_dwordx4 v6, s[16:19], s42 offen lds
s_waitcnt vmcnt(7)
s_mov_b32 s42, 29952
s_mov_b32 m0, 123904
s_nop 0
buffer_load_dwordx4 v90, s[16:19], s42 offen lds
s_waitcnt vmcnt(7)
s_mov_b32 s42, 62208
s_mov_b32 m0, 126976
s_nop 0
buffer_load_dwordx4 v6, s[16:19], s42 offen lds
s_waitcnt vmcnt(7)
s_mov_b32 s42, 92160
s_mov_b32 m0, 130048
s_nop 0
buffer_load_dwordx4 v90, s[16:19], s42 offen lds
s_waitcnt vmcnt(7)
s_mov_b32 s42, 124416
s_mov_b32 m0, 133120
s_nop 0
buffer_load_dwordx4 v6, s[16:19], s42 offen lds
s_waitcnt vmcnt(7)
s_mov_b32 s42, 154368
s_mov_b32 m0, 136192
s_nop 0
buffer_load_dwordx4 v90, s[16:19], s42 offen lds
s_waitcnt vmcnt(7)
s_mov_b32 s42, 186624
s_mov_b32 m0, 139264
s_nop 0
buffer_load_dwordx4 v6, s[16:19], s42 offen lds
s_waitcnt vmcnt(7)
s_mov_b32 s42, 216576
s_mov_b32 m0, 142336
s_nop 0
buffer_load_dwordx4 v90, s[16:19], s42 offen lds
s_waitcnt vmcnt(7)
s_mov_b32 s42, 248832
s_mov_b32 m0, 145408
s_nop 0
buffer_load_dwordx4 v6, s[16:19], s42 offen lds
s_waitcnt vmcnt(7)
s_mov_b32 s42, 278784
s_mov_b32 m0, 148480
s_nop 0
buffer_load_dwordx4 v90, s[16:19], s42 offen lds
s_waitcnt vmcnt(7)
s_mov_b32 s42, 311040
s_mov_b32 m0, 151552
s_nop 0
buffer_load_dwordx4 v6, s[16:19], s42 offen lds
s_waitcnt vmcnt(7)
s_mov_b32 s42, 340992
s_mov_b32 m0, 154624
s_nop 0
buffer_load_dwordx4 v90, s[16:19], s42 offen lds
s_waitcnt vmcnt(7)
s_mov_b32 s42, 373248
s_mov_b32 m0, 157696
s_nop 0
buffer_load_dwordx4 v6, s[16:19], s42 offen lds
s_waitcnt vmcnt(7)
s_mov_b32 s42, 403200
s_mov_b32 m0, 160768
s_nop 0
buffer_load_dwordx4 v90, s[16:19], s42 offen lds
s_waitcnt vmcnt(7)
s_barrier
s_cmp_eq_u32 s45, 0
s_cbranch_scc1 L_hfin
s_waitcnt vmcnt(0)
s_mov_b32 s42, 414720
s_mov_b32 m0, 0
s_nop 0
buffer_load_dwordx4 v6, s[16:19], s42 offen lds
s_mov_b32 s42, 444672
s_mov_b32 m0, 3072
s_nop 0
buffer_load_dwordx4 v90, s[16:19], s42 offen lds
s_mov_b32 s42, 476928
s_mov_b32 m0, 6144
s_nop 0
buffer_load_dwordx4 v6, s[16:19], s42 offen lds
s_mov_b32 s42, 506880
s_mov_b32 m0, 9216
s_nop 0
buffer_load_dwordx4 v90, s[16:19], s42 offen lds
s_mov_b32 s42, 539136
s_mov_b32 m0, 12288
s_nop 0
buffer_load_dwordx4 v6, s[16:19], s42 offen lds
s_mov_b32 s42, 569088
s_mov_b32 m0, 15360
s_nop 0
buffer_load_dwordx4 v90, s[16:19], s42 offen lds
s_mov_b32 s42, 601344
s_mov_b32 m0, 18432
s_nop 0
buffer_load_dwordx4 v6, s[16:19], s42 offen lds
s_mov_b32 s42, 631296
s_mov_b32 m0, 21504
s_nop 0
buffer_load_dwordx4 v90, s[16:19], s42 offen lds
s_mov_b32 s42, 0
s_mov_b32 m0, 24576
s_nop 0
buffer_load_dwordx4 v7, s[16:19], s42 offen lds
s_mov_b32 s42, 248832
s_mov_b32 m0, 27648
s_nop 0
buffer_load_dwordx4 v91, s[16:19], s42 offen lds
s_mov_b32 s42, 497664
s_mov_b32 m0, 30720
s_nop 0
buffer_load_dwordx4 v7, s[16:19], s42 offen lds
s_branch L_hwd
L_hw2:
s_cmp_lg_u32 s52, 2
s_cbranch_scc1 L_hw3
s_mov_b32 s42, 9216
s_mov_b32 m0, 48128
s_nop 0
buffer_load_dwordx4 v90, s[20:23], s42 offen lds
s_mov_b32 s42, 41472
s_mov_b32 m0, 51200
s_nop 0
buffer_load_dwordx4 v6, s[20:23], s42 offen lds
s_mov_b32 s42, 71424
s_mov_b32 m0, 54272
s_nop 0
buffer_load_dwordx4 v90, s[20:23], s42 offen lds
s_mov_b32 s42, 103680
s_mov_b32 m0, 57344
s_nop 0
buffer_load_dwordx4 v6, s[20:23], s42 offen lds
s_mov_b32 s42, 133632
s_mov_b32 m0, 60416
s_nop 0
buffer_load_dwordx4 v90, s[20:23], s42 offen lds
s_mov_b32 s42, 165888
s_mov_b32 m0, 63488
s_nop 0
buffer_load_dwordx4 v6, s[20:23], s42 offen lds
s_mov_b32 s42, 195840
s_mov_b32 m0, 66560
s_nop 0
buffer_load_dwordx4 v90, s[20:23], s42 offen lds
s_mov_b32 s42, 228096
s_mov_b32 m0, 69632
s_nop 0
buffer_load_dwordx4 v6, s[20:23], s42 offen lds
s_waitcnt vmcnt(7)
s_mov_b32 s42, 258048
s_mov_b32 m0, 72704
s_nop 0
buffer_load_dwordx4 v90, s[20:23], s42 offen lds
s_waitcnt vmcnt(7)
s_mov_b32 s42, 290304
s_mov_b32 m0, 75776
s_nop 0
buffer_load_dwordx4 v6, s[20:23], s42 offen lds
s_waitcnt vmcnt(7)
s_mov_b32 s42, 320256
s_mov_b32 m0, 78848
s_nop 0
buffer_load_dwordx4 v90, s[20:23], s42 offen lds
s_waitcnt vmcnt(7)
s_mov_b32 s42, 352512
s_mov_b32 m0, 81920
s_nop 0
buffer_load_dwordx4 v6, s[20:23], s42 offen lds
s_waitcnt vmcnt(7)
s_mov_b32 s42, 382464
s_mov_b32 m0, 84992
s_nop 0
buffer_load_dwordx4 v90, s[20:23], s42 offen lds
s_waitcnt vmcnt(7)
s_mov_b32 s42, 414720
s_mov_b32 m0, 88064
s_nop 0
buffer_load_dwordx4 v6, s[20:23], s42 offen lds
s_waitcnt vmcnt(7)
s_mov_b32 s42, 444672
s_mov_b32 m0, 91136
s_nop 0
buffer_load_dwordx4 v90, s[20:23], s42 offen lds
s_waitcnt vmcnt(7)
s_mov_b32 s42, 476928
s_mov_b32 m0, 94208
s_nop 0
buffer_load_dwordx4 v6, s[20:23], s42 offen lds
s_waitcnt vmcnt(7)
s_mov_b32 s42, 506880
s_mov_b32 m0, 97280
s_nop 0
buffer_load_dwordx4 v90, s[20:23], s42 offen lds
s_waitcnt vmcnt(7)
s_mov_b32 s42, 539136
s_mov_b32 m0, 100352
s_nop 0
buffer_load_dwordx4 v6, s[20:23], s42 offen lds
s_waitcnt vmcnt(7)
s_mov_b32 s42, 569088
s_mov_b32 m0, 103424
s_nop 0
buffer_load_dwordx4 v90, s[20:23], s42 offen lds
s_waitcnt vmcnt(7)
s_mov_b32 s42, 601344
s_mov_b32 m0, 106496
s_nop 0
buffer_load_dwordx4 v6, s[20:23], s42 offen lds
s_waitcnt vmcnt(7)
s_mov_b32 s42, 631296
s_mov_b32 m0, 109568
s_nop 0
buffer_load_dwordx4 v90, s[20:23], s42 offen lds
s_waitcnt vmcnt(7)
s_mov_b32 s42, 0
s_mov_b32 m0, 112640
s_nop 0
buffer_load_dwordx4 v7, s[20:23], s42 offen lds
s_waitcnt vmcnt(7)
s_mov_b32 s42, 248832
s_mov_b32 m0, 115712
s_nop 0
buffer_load_dwordx4 v91, s[20:23], s42 offen lds
s_waitcnt vmcnt(7)
s_mov_b32 s42, 497664
s_mov_b32 m0, 118784
s_nop 0
buffer_load_dwordx4 v7, s[20:23], s42 offen lds
s_waitcnt vmcnt(7)
s_mov_b32 s42, 9216
s_mov_b32 m0, 121856
s_nop 0
buffer_load_dwordx4 v90, s[16:19], s42 offen lds
s_waitcnt vmcnt(7)
s_mov_b32 s42, 41472
s_mov_b32 m0, 124928
s_nop 0
buffer_load_dwordx4 v6, s[16:19], s42 offen lds
s_waitcnt vmcnt(7)
s_mov_b32 s42, 71424
s_mov_b32 m0, 128000
s_nop 0
buffer_load_dwordx4 v90, s[16:19], s42 offen lds
s_waitcnt vmcnt(7)
s_mov_b32 s42, 103680
s_mov_b32 m0, 131072
s_nop 0
buffer_load_dwordx4 v6, s[16:19], s42 offen lds
s_waitcnt vmcnt(7)
s_mov_b32 s42, 133632
s_mov_b32 m0, 134144
s_nop 0
buffer_load_dwordx4 v90, s[16:19], s42 offen lds
s_waitcnt vmcnt(7)
s_mov_b32 s42, 165888
s_mov_b32 m0, 137216
s_nop 0
buffer_load_dwordx4 v6, s[16:19], s42 offen lds
s_waitcnt vmcnt(7)
s_mov_b32 s42, 195840
s_mov_b32 m0, 140288
s_nop 0
buffer_load_dwordx4 v90, s[16:19], s42 offen lds
s_waitcnt vmcnt(7)
s_mov_b32 s42, 228096
s_mov_b32 m0, 143360
s_nop 0
buffer_load_dwordx4 v6, s[16:19], s42 offen lds
s_waitcnt vmcnt(7)
s_mov_b32 s42, 258048
s_mov_b32 m0, 146432
s_nop 0
buffer_load_dwordx4 v90, s[16:19], s42 offen lds
s_waitcnt vmcnt(7)
s_mov_b32 s42, 290304
s_mov_b32 m0, 149504
s_nop 0
buffer_load_dwordx4 v6, s[16:19], s42 offen lds
s_waitcnt vmcnt(7)
s_mov_b32 s42, 320256
s_mov_b32 m0, 152576
s_nop 0
buffer_load_dwordx4 v90, s[16:19], s42 offen lds
s_waitcnt vmcnt(7)
s_mov_b32 s42, 352512
s_mov_b32 m0, 155648
s_nop 0
buffer_load_dwordx4 v6, s[16:19], s42 offen lds
s_waitcnt vmcnt(7)
s_mov_b32 s42, 382464
s_mov_b32 m0, 158720
s_nop 0
buffer_load_dwordx4 v90, s[16:19], s42 offen lds
s_waitcnt vmcnt(7)
s_barrier
s_cmp_eq_u32 s45, 0
s_cbranch_scc1 L_hfin
s_waitcnt vmcnt(0)
s_mov_b32 s42, 423936
s_mov_b32 m0, 1024
s_nop 0
buffer_load_dwordx4 v90, s[16:19], s42 offen lds
s_mov_b32 s42, 456192
s_mov_b32 m0, 4096
s_nop 0
buffer_load_dwordx4 v6, s[16:19], s42 offen lds
s_mov_b32 s42, 486144
s_mov_b32 m0, 7168
s_nop 0
buffer_load_dwordx4 v90, s[16:19], s42 offen lds
s_mov_b32 s42, 518400
s_mov_b32 m0, 10240
s_nop 0
buffer_load_dwordx4 v6, s[16:19], s42 offen lds
s_mov_b32 s42, 548352
s_mov_b32 m0, 13312
s_nop 0
buffer_load_dwordx4 v90, s[16:19], s42 offen lds
s_mov_b32 s42, 580608
s_mov_b32 m0, 16384
s_nop 0
buffer_load_dwordx4 v6, s[16:19], s42 offen lds
s_mov_b32 s42, 610560
s_mov_b32 m0, 19456
s_nop 0
buffer_load_dwordx4 v90, s[16:19], s42 offen lds
s_mov_b32 s42, 642816
s_mov_b32 m0, 22528
s_nop 0
buffer_load_dwordx4 v6, s[16:19], s42 offen lds
s_mov_b32 s42, 82944
s_mov_b32 m0, 25600
s_nop 0
buffer_load_dwordx4 v91, s[16:19], s42 offen lds
s_mov_b32 s42, 331776
s_mov_b32 m0, 28672
s_nop 0
buffer_load_dwordx4 v7, s[16:19], s42 offen lds
s_mov_b32 s42, 580608
s_mov_b32 m0, 31744
s_nop 0
buffer_load_dwordx4 v91, s[16:19], s42 offen lds
s_branch L_hwd
L_hw3:
s_mov_b32 s42, 20736
s_mov_b32 m0, 49152
s_nop 0
buffer_load_dwordx4 v6, s[20:23], s42 offen lds
s_mov_b32 s42, 50688
s_mov_b32 m0, 52224
s_nop 0
buffer_load_dwordx4 v90, s[20:23], s42 offen lds
s_mov_b32 s42, 82944
s_mov_b32 m0, 55296
s_nop 0
buffer_load_dwordx4 v6, s[20:23], s42 offen lds
s_mov_b32 s42, 112896
s_mov_b32 m0, 58368
s_nop 0
buffer_load_dwordx4 v90, s[20:23], s42 offen lds
s_mov_b32 s42, 145152
s_mov_b32 m0, 61440
s_nop 0
buffer_load_dwordx4 v6, s[20:23], s42 offen lds
s_mov_b32 s42, 175104
s_mov_b32 m0, 64512
s_nop 0
buffer_load_dwordx4 v90, s[20:23], s42 offen lds
s_mov_b32 s42, 207360
s_mov_b32 m0, 67584
s_nop 0
buffer_load_dwordx4 v6, s[20:23], s42 offen lds
s_mov_b32 s42, 237312
s_mov_b32 m0, 70656
s_nop 0
buffer_load_dwordx4 v90, s[20:23], s42 offen lds
s_waitcnt vmcnt(7)
s_mov_b32 s42, 269568
s_mov_b32 m0, 73728
s_nop 0
buffer_load_dwordx4 v6, s[20:23], s42 offen lds
s_waitcnt vmcnt(7)
s_mov_b32 s42, 299520
s_mov_b32 m0, 76800
s_nop 0
buffer_load_dwordx4 v90, s[20:23], s42 offen lds
s_waitcnt vmcnt(7)
s_mov_b32 s42, 331776
s_mov_b32 m0, 79872
s_nop 0
buffer_load_dwordx4 v6, s[20:23], s42 offen lds
s_waitcnt vmcnt(7)
s_mov_b32 s42, 361728
s_mov_b32 m0, 82944
s_nop 0
buffer_load_dwordx4 v90, s[20:23], s42 offen lds
s_waitcnt vmcnt(7)
s_mov_b32 s42, 393984
s_mov_b32 m0, 86016
s_nop 0
buffer_load_dwordx4 v6, s[20:23], s42 offen lds
s_waitcnt vmcnt(7)
s_mov_b32 s42, 423936
s_mov_b32 m0, 89088
s_nop 0
buffer_load_dwordx4 v90, s[20:23], s42 offen lds
s_waitcnt vmcnt(7)
s_mov_b32 s42, 456192
s_mov_b32 m0, 92160
s_nop 0
buffer_load_dwordx4 v6, s[20:23], s42 offen lds
s_waitcnt vmcnt(7)
s_mov_b32 s42, 486144
s_mov_b32 m0, 95232
s_nop 0
buffer_load_dwordx4 v90, s[20:23], s42 offen lds
s_waitcnt vmcnt(7)
s_mov_b32 s42, 518400
s_mov_b32 m0, 98304
s_nop 0
buffer_load_dwordx4 v6, s[20:23], s42 offen lds
s_waitcnt vmcnt(7)
s_mov_b32 s42, 548352
s_mov_b32 m0, 101376
s_nop 0
buffer_load_dwordx4 v90, s[20:23], s42 offen lds
s_waitcnt vmcnt(7)
s_mov_b32 s42, 580608
s_mov_b32 m0, 104448
s_nop 0
buffer_load_dwordx4 v6, s[20:23], s42 offen lds
s_waitcnt vmcnt(7)
s_mov_b32 s42, 610560
s_mov_b32 m0, 107520
s_nop 0
buffer_load_dwordx4 v90, s[20:23], s42 offen lds
s_waitcnt vmcnt(7)
s_mov_b32 s42, 642816
s_mov_b32 m0, 110592
s_nop 0
buffer_load_dwordx4 v6, s[20:23], s42 offen lds
s_waitcnt vmcnt(7)
s_mov_b32 s42, 82944
s_mov_b32 m0, 113664
s_nop 0
buffer_load_dwordx4 v91, s[20:23], s42 offen lds
s_waitcnt vmcnt(7)
s_mov_b32 s42, 331776
s_mov_b32 m0, 116736
s_nop 0
buffer_load_dwordx4 v7, s[20:23], s42 offen lds
s_waitcnt vmcnt(7)
s_mov_b32 s42, 580608
s_mov_b32 m0, 119808
s_nop 0
buffer_load_dwordx4 v91, s[20:23], s42 offen lds
s_waitcnt vmcnt(7)
L_pdP0_4:
s_cbranch_execz L_retH
s_mov_b32 s42, 20736
s_mov_b32 m0, 122880
s_nop 0
buffer_load_dwordx4 v6, s[16:19], s42 offen lds
s_waitcnt vmcnt(7)
s_mov_b32 s42, 50688
s_mov_b32 m0, 125952
s_nop 0
buffer_load_dwordx4 v90, s[16:19], s42 offen lds
s_waitcnt vmcnt(7)
s_mov_b32 s42, 82944
s_mov_b32 m0, 129024
s_nop 0
buffer_load_dwordx4 v6, s[16:19], s42 offen lds
s_waitcnt vmcnt(7)
s_mov_b32 s42, 112896
s_mov_b32 m0, 132096
s_nop 0
buffer_load_dwordx4 v90, s[16:19], s42 offen lds
s_waitcnt vmcnt(7)
s_mov_b32 s42, 145152
s_mov_b32 m0, 135168
s_nop 0
buffer_load_dwordx4 v6, s[16:19], s42 offen lds
s_waitcnt vmcnt(7)
s_mov_b32 s42, 175104
s_mov_b32 m0, 138240
s_nop 0
buffer_load_dwordx4 v90, s[16:19], s42 offen lds
s_waitcnt vmcnt(7)
s_mov_b32 s42, 207360
s_mov_b32 m0, 141312
s_nop 0
buffer_load_dwordx4 v6, s[16:19], s42 offen lds
s_waitcnt vmcnt(7)
s_mov_b32 s42, 237312
s_mov_b32 m0, 144384
s_nop 0
buffer_load_dwordx4 v90, s[16:19], s42 offen lds
s_waitcnt vmcnt(7)
s_mov_b32 s42, 269568
s_mov_b32 m0, 147456
s_nop 0
buffer_load_dwordx4 v6, s[16:19], s42 offen lds
s_waitcnt vmcnt(7)
s_mov_b32 s42, 299520
s_mov_b32 m0, 150528
s_nop 0
buffer_load_dwordx4 v90, s[16:19], s42 offen lds
s_waitcnt vmcnt(7)
s_mov_b32 s42, 331776
s_mov_b32 m0, 153600
s_nop 0
buffer_load_dwordx4 v6, s[16:19], s42 offen lds
s_waitcnt vmcnt(7)
s_mov_b32 s42, 361728
s_mov_b32 m0, 156672
s_nop 0
buffer_load_dwordx4 v90, s[16:19], s42 offen lds
s_waitcnt vmcnt(7)
s_mov_b32 s42, 393984
s_mov_b32 m0, 159744
s_nop 0
buffer_load_dwordx4 v6, s[16:19], s42 offen lds
s_waitcnt vmcnt(7)
s_barrier
s_cmp_eq_u32 s45, 0
s_cbranch_scc1 L_hfin
s_waitcnt vmcnt(0)
s_mov_b32 s42, 435456
s_mov_b32 m0, 2048
s_nop 0
buffer_load_dwordx4 v6, s[16:19], s42 offen lds
s_mov_b32 s42, 465408
s_mov_b32 m0, 5120
s_nop 0
buffer_load_dwordx4 v90, s[16:19], s42 offen lds
s_mov_b32 s42, 497664
s_mov_b32 m0, 8192
s_nop 0
buffer_load_dwordx4 v6, s[16:19], s42 offen lds
s_mov_b32 s42, 527616
s_mov_b32 m0, 11264
s_nop 0
buffer_load_dwordx4 v90, s[16:19], s42 offen lds
s_mov_b32 s42, 559872
s_mov_b32 m0, 14336
s_nop 0
buffer_load_dwordx4 v6, s[16:19], s42 offen lds
s_mov_b32 s42, 589824
s_mov_b32 m0, 17408
s_nop 0
buffer_load_dwordx4 v90, s[16:19], s42 offen lds
s_mov_b32 s42, 622080
s_mov_b32 m0, 20480
s_nop 0
buffer_load_dwordx4 v6, s[16:19], s42 offen lds
s_mov_b32 s42, 652032
s_mov_b32 m0, 23552
s_nop 0
buffer_load_dwordx4 v90, s[16:19], s42 offen lds
s_mov_b32 s42, 165888
s_mov_b32 m0, 26624
s_nop 0
buffer_load_dwordx4 v7, s[16:19], s42 offen lds
s_mov_b32 s42, 414720
s_mov_b32 m0, 29696
s_nop 0
buffer_load_dwordx4 v91, s[16:19], s42 offen lds
L_hwd:
s_mov_b32 s16, s39
s_mov_b32 s17, s44
s_barrier
s_waitcnt vmcnt(0)
s_barrier
s_barrier
s_branch L_p3F
L_h0:
L_pdP1_4:
s_cbranch_execz L_retH
v_add_u32 v82, s46, v15
s_mov_b32 s16, s39
s_mov_b32 s17, s44
v_mov_b32 v80, 161800
s_mov_b32 s99, 262144
L_arrb:
ds_read_b32 v81, v80
s_waitcnt lgkmcnt(0)
v_readfirstlane_b32 s40, v81
s_nop 0
s_cmp_ge_u32 s40, 4
s_cbranch_scc1 L_arrb_ok
s_sleep 1
s_sub_u32 s99, s99, 1
s_cbranch_scc0 L_arrb
L_arrb_ok:
buffer_store_dword v9, v14, s[48:51], s46 offen sc1
s_barrier
s_cmp_eq_u32 s45, 0
s_cbranch_scc1 L_hfin
s_sleep 6
s_mov_b32 s99, 16384
L_poll2b:
buffer_load_dword v88, v82, s[48:51], 0 offen sc1
s_waitcnt vmcnt(0)
L_poll2b_c:
v_cmp_ne_u32 vcc, s98, v88
s_nop 0
s_cmp_eq_u64 vcc, 0
s_cbranch_scc1 L_poll2b_ok
s_sub_u32 s99, s99, 1
s_cbranch_scc0 L_poll2b
L_poll2b_ok:
s_barrier
s_sleep 8
s_mov_b32 s99, 16384
L_poll2:
buffer_load_dword v88, v15, s[48:51], 0 offen sc1
s_waitcnt vmcnt(0)
L_poll2_c:
v_cmp_ne_u32 vcc, s98, v88
s_nop 0
s_cmp_eq_u64 vcc, 0
s_cbranch_scc1 L_poll2_ok
s_sub_u32 s99, s99, 1
s_cbranch_scc0 L_poll2
L_poll2_ok:
s_barrier
s_barrier
s_branch L_p3F
L_hfin:
L_end:
s_endpgm
.section .rodata,"a"
.p2align 6
.amdhsa_kernel gated_mix__sliding_block__linear_kernel_hedgehog__prompt_kernel
  .amdhsa_next_free_vgpr 256
  .amdhsa_next_free_sgpr 102
  .amdhsa_accum_offset 256
  .amdhsa_group_segment_fixed_size 0
  .amdhsa_kernarg_size 88
  .amdhsa_user_sgpr_count 2
  .amdhsa_user_sgpr_kernarg_segment_ptr 1
  .amdhsa_system_sgpr_workgroup_id_x 1
.end_amdhsa_kernel
.text
L_code_end:
```
